```python
import torch

def _softmax(x, axis=-1):
    return torch.softmax(x, dim=axis)

def _gelu(x):
    return torch.nn.functional.gelu(x, approximate='tanh')

def _silu(x):
    return torch.nn.functional.silu(x)

def _sigmoid(x):
    return torch.sigmoid(x)

def _layernorm(x, axis=-1, eps=1e-05):
    m = x.mean(dim=axis, keepdim=True)
    v = x.var(dim=axis, keepdim=True, unbiased=False)
    return (x - m) / torch.sqrt(v + eps)

def _scatter_add(tgt, idx, src, axis=0):
    return tgt.clone().index_add_(axis, idx, src)

def _segment_sum(src, seg, n):
    out = torch.zeros((n,) + src.shape[1:], dtype=src.dtype)
    return out.index_add_(0, seg, src)

def _pad(x, pw):
    flat = tuple((v for pair in reversed(pw) for v in pair))
    return torch.nn.functional.pad(x, flat)
kernel_name = 'interleave_layers__memory_aug_recurrent_mem_tr__dense_activation_silu__prompt'

def setup_inputs():

    _w = lambda a: (lambda t: t.to(torch.bfloat16) if t.is_floating_point() else t)(torch.as_tensor(a))

    def _A_setup():
        B, S, Dm = (1, 2048, 640)
        H, Dh = (32, 128)
        M, seg = (8, 32)
        seg = min(seg, S)
        S = S // seg * seg
        return {'x': _w((lambda *s: torch.randn(*s, dtype=torch.bfloat16) * 0.05)(B, S, Dm)), 'mem0': _w((lambda *s: torch.randn(*s, dtype=torch.bfloat16) * 0.4)(B, M, Dm)), 'Wq': _w((lambda *s: torch.randn(*s, dtype=torch.bfloat16) * 1.6)(Dm, H, Dh) * Dm ** (-0.5)), 'Wk': _w((lambda *s: torch.randn(*s, dtype=torch.bfloat16) * 1.6)(Dm, H, Dh) * Dm ** (-0.5)), 'Wv': _w((lambda *s: torch.randn(*s, dtype=torch.bfloat16) * 0.4)(Dm, H, Dh) * Dm ** (-0.5)), 'Wo': _w((lambda *s: torch.randn(*s, dtype=torch.bfloat16) * 0.4)(H, Dh, Dm) * (H * Dh) ** (-0.5)), 'seg_len': seg}
    _A_in = _A_setup()

    def _B_setup():
        B, S, D, F = (1, 2048, 640, 1728)
        return {'x': _w((lambda *s: torch.randn(*s, dtype=torch.bfloat16) * 0.05)(B, S, D)), 'w1': _w((lambda *s: torch.randn(*s, dtype=torch.bfloat16) * 1.6)(D, F) * D ** (-0.5)), 'w2': _w((lambda *s: torch.randn(*s, dtype=torch.bfloat16) * 0.2)(F, D) * F ** (-0.5))}
    _B_in = _B_setup()
    return {'A_x': _A_in['x'], 'A_mem0': _A_in['mem0'], 'A_Wq': _A_in['Wq'], 'A_Wk': _A_in['Wk'], 'A_Wv': _A_in['Wv'], 'A_Wo': _A_in['Wo'], 'A_seg_len': _A_in['seg_len'], 'B_x': _B_in['x'], 'B_w1': _B_in['w1'], 'B_w2': _B_in['w2']}

def reference(A_x, A_mem0, A_Wq, A_Wk, A_Wv, A_Wo, A_seg_len, B_x, B_w1, B_w2):

    def _A_ref(x, mem0, Wq, Wk, Wv, Wo, seg_len):
        B, S, Dm = x.shape
        H, Dh = (Wq.shape[1], Wq.shape[2])
        M = mem0.shape[1]
        scale = Dh ** (-0.5)
        n_seg = S // seg_len
        L = M + seg_len
        idx = torch.arange(L)
        mask = (idx[:, None] < M) | (idx[:, None] >= idx[None, :])
        mem = mem0
        outs = []
        for s in range(n_seg):
            xs = x[:, s * seg_len:(s + 1) * seg_len, :].clone()
            h = torch.concatenate([mem, xs], axis=1)
            q = torch.einsum('btd,dhe->bhte', h, Wq)
            k = torch.einsum('btd,dhe->bhte', h, Wk)
            v = torch.einsum('btd,dhe->bhte', h, Wv)
            scores = torch.einsum('bhqe,bhke->bhqk', q, k) * scale
            scores = torch.where(mask[None, None], scores, -1000000000.0)
            p = _softmax(scores, axis=-1)
            o = torch.einsum('bhqk,bhke->bhqe', p, v)
            o = torch.einsum('bhte,hed->btd', o, Wo)
            mem = o[:, :M, :].clone()
            outs.append(o[:, M:, :])
        return torch.concatenate(outs, axis=1)

    def _B_ref(x, w1, w2):
        h = torch.einsum('bsd,df->bsf', x, w1)
        h = _silu(h)
        out = torch.einsum('bsf,fd->bsd', h, w2)
        return out
    x = A_x
    x = x + _A_ref(_layernorm(x, axis=-1), A_mem0, A_Wq, A_Wk, A_Wv, A_Wo, A_seg_len)
    x = x + _B_ref(_layernorm(x, axis=-1), B_w1, B_w2)
    x = x + _A_ref(_layernorm(x, axis=-1), A_mem0, A_Wq, A_Wk, A_Wv, A_Wo, A_seg_len)
    x = x + _B_ref(_layernorm(x, axis=-1), B_w1, B_w2)
    return x
```

```asm
; @launch grid=(256,1,1) block=(256,1,1) lds=163840
.amdgcn_target "amdgcn-amd-amdhsa--gfx950"
.text
.globl interleave_layers__memory_aug_recurrent_mem_tr__dense_activation_silu__prompt_kernel
.p2align 8
.type interleave_layers__memory_aug_recurrent_mem_tr__dense_activation_silu__prompt_kernel,@function
interleave_layers__memory_aug_recurrent_mem_tr__dense_activation_silu__prompt_kernel:
    s_cmp_ge_u32 s2, 256
    s_cbranch_scc1 L_end
    s_load_dwordx16 s[24:39], s[0:1], 0
    s_load_dwordx8 s[40:47], s[0:1], 64
    s_load_dwordx2 s[48:49], s[0:1], 96
    v_and_b32 v1, 63, v0
    v_lshrrev_b32 v2, 6, v0
    s_nop 0
    v_readfirstlane_b32 s3, v2
    s_add_u32 s50, s2, 0
    s_and_b32 s50, s50, 7
    s_lshr_b32 s51, s2, 3
    s_mov_b32 s52, 2000000
    s_mov_b32 s54, 0
    s_waitcnt lgkmcnt(0)
    s_mov_b32 s4, s48
    s_mov_b32 s5, s49
    s_mov_b32 s6, 260046848
    s_mov_b32 s7, 0x20000
    s_mov_b32 s8, s46
    s_mov_b32 s9, s47
    s_mov_b32 s10, 256
    s_mov_b32 s11, 0x20000
    s_mov_b32 s12, s26
    s_mov_b32 s13, s27
    s_mov_b32 s14, 10240
    s_mov_b32 s15, 0x20000
    s_mov_b32 s16, s24
    s_mov_b32 s17, s25
    s_mov_b32 s18, 2621440
    s_mov_b32 s19, 0x20000
    s_mov_b32 s20, s44
    s_mov_b32 s21, s45
    s_mov_b32 s22, 2621440
    s_mov_b32 s23, 0x20000
    s_sub_u32 s38, 0, s48
    s_and_b32 s38, s38, 2097151
    s_add_u32 s38, s38, 2097152
    s_mov_b32 s99, s2
    s_or_b32 s55, s2, s3
    s_cbranch_scc1 L_rot
    s_getreg_b32 s55, hwreg(HW_REG_XCC_ID)
    s_and_b32 s55, s55, 7
    s_add_u32 s55, s55, 8
    v_mov_b32 v2, s55
    buffer_store_dword v2, off, s[8:11], 0 offset:144 sc1
L_rot:
    v_mov_b32 v2, 144
Lp_1:
    buffer_load_dword v3, v2, s[8:11], 0 offen sc1
    s_waitcnt vmcnt(0)
    v_cmp_gt_i32 vcc, 1, v3
    s_cbranch_vccz Lpd_2
    s_sleep 1
    s_mov_b32 s54, 144
    s_sub_u32 s52, s52, 1
    s_cbranch_scc1 L_abort
    s_branch Lp_1
Lpd_2:
    v_readfirstlane_b32 s55, v3
    s_add_u32 s50, s50, s55
    s_and_b32 s50, s50, 7
    s_lshl_b32 s55, s50, 2
    s_lshr_b32 s50, 1985229328, s55
    s_and_b32 s50, s50, 7
    s_lshl_b32 s99, s51, 3
    s_add_u32 s99, s99, s50
    s_mov_b32 s53, 0
    s_movk_i32 s55, 255
    s_cmp_ge_u32 s50, 2
    s_cbranch_scc1 L_dec_w
    s_cmp_ge_u32 s51, 16
    s_cselect_b32 s39, 1, 0
    s_cmp_ge_u32 s51, 30
    s_cselect_b32 s39, 2, s39
    s_branch L_dec_done
L_dec_w:
    s_cmp_ge_u32 s50, 5
    s_cselect_b32 s53, 1, 0
    s_mul_i32 s56, s53, 3
    s_sub_u32 s56, s50, s56
    s_cmp_eq_u32 s56, 4
    s_cbranch_scc1 L_dec_c
    s_sub_u32 s57, s50, 5
    s_lshl_b32 s57, s57, 5
    s_cmp_eq_u32 s50, 2
    s_cselect_b32 s57, 64, s57
    s_add_u32 s57, s57, s51
    s_cmp_lg_u32 s50, 3
    s_cselect_b32 s55, s57, s55
    s_cmp_eq_u32 s56, 3
    s_cbranch_scc1 L_dec_b
    s_mov_b32 s39, 8
    s_cmp_lt_u32 s51, 10
    s_cbranch_scc1 L_dec_done
    s_sub_u32 s51, s51, 10
    s_mov_b32 s39, 9
    s_cmp_lt_u32 s51, 10
    s_cbranch_scc1 L_dec_done
    s_sub_u32 s51, s51, 10
    s_mov_b32 s39, 6
    s_cmp_lt_u32 s51, 7
    s_cbranch_scc1 L_dec_done
    s_sub_u32 s51, s51, 1
    s_mov_b32 s39, 5
    s_branch L_dec_done
L_dec_b:
    s_mov_b32 s39, 7
    s_cmp_lt_u32 s51, 10
    s_cbranch_scc1 L_dec_done
    s_sub_u32 s51, s51, 10
    s_mov_b32 s39, 5
    s_cmp_lt_u32 s51, 6
    s_cbranch_scc1 L_dec_done
    s_sub_u32 s51, s51, 6
    s_mov_b32 s39, 4
    s_branch L_dec_done
L_dec_c:
    s_lshl_b32 s57, s53, 4
    s_lshr_b32 s53, s51, 4
    s_and_b32 s51, s51, 15
    s_add_u32 s51, s51, s57
    s_add_u32 s57, s51, 96
    s_cmp_eq_u32 s53, 1
    s_cselect_b32 s55, s57, s55
    s_mov_b32 s39, 3
L_dec_done:
    s_sub_u32 s56, s39, 3
    s_cmp_lt_u32 s56, 2
    s_cbranch_scc0 L_or_done
    s_cmp_ge_u32 s55, 128
    s_cbranch_scc1 L_dispatch
L_or_done:
    s_cmp_ge_u32 s55, 128
    s_cbranch_scc1 L_arrive
    v_and_b32 v60, 15, v0
    v_lshrrev_b32 v61, 4, v0
    v_mul_u32_u24 v62, 1280, v60
    v_lshl_add_u32 v62, v61, 4, v62
    s_mul_i32 s56, s55, 20480
    buffer_load_dwordx4 v[64:67], v62, s[16:19], s56 offen
    buffer_load_dwordx4 v[68:71], v62, s[16:19], s56 offen offset:256
    buffer_load_dwordx4 v[72:75], v62, s[16:19], s56 offen offset:512
    buffer_load_dwordx4 v[76:79], v62, s[16:19], s56 offen offset:768
    buffer_load_dwordx4 v[80:83], v62, s[16:19], s56 offen offset:1024
    v_lshlrev_b32 v61, 9, v61
    v_lshl_add_u32 v61, v60, 4, v61
    v_lshlrev_b32 v2, 4, v0
    v_mov_b32 v4, 0
    v_mov_b32 v5, 0
    v_mov_b32 v6, 0
    v_mov_b32 v7, 0
    v_mov_b32 v8, -1
    v_mov_b32 v9, -1
    v_mov_b32 v10, -1
    v_mov_b32 v11, -1
    s_lshl_b32 s56, s55, 13
    buffer_store_dwordx4 v[4:7], v2, s[4:7], s56 offen sc1
    s_add_u32 s56, s56, 4096
    buffer_store_dwordx4 v[4:7], v2, s[4:7], s56 offen sc1
    s_lshl_b32 s56, s55, 14
    s_add_u32 s56, s56, s38
    s_cmp_ge_u32 s55, 112
    s_cbranch_scc1 L_warm
    s_add_u32 s57, s56, 0
    buffer_store_dwordx4 v[8:11], v2, s[4:7], s57 offen sc1
    s_add_u32 s57, s56, 4096
    buffer_store_dwordx4 v[8:11], v2, s[4:7], s57 offen sc1
    s_add_u32 s57, s56, 8192
    buffer_store_dwordx4 v[8:11], v2, s[4:7], s57 offen sc1
    s_add_u32 s57, s56, 12288
    buffer_store_dwordx4 v[8:11], v2, s[4:7], s57 offen sc1
    s_add_u32 s56, s56, 2097152
    s_cmp_eq_u32 s55, 48
    s_cbranch_scc1 L_mem0
    s_cmp_gt_u32 s55, 88
    s_cbranch_scc1 L_warm
    buffer_store_dwordx4 v[8:11], v2, s[4:7], s56 offen sc1
    s_add_u32 s56, s56, 4096
    buffer_store_dwordx4 v[8:11], v2, s[4:7], s56 offen sc1
    s_add_u32 s56, s56, 4096
    buffer_store_dwordx4 v[8:11], v2, s[4:7], s56 offen sc1
    s_add_u32 s56, s56, 4096
    buffer_store_dwordx4 v[8:11], v2, s[4:7], s56 offen sc1
    s_add_u32 s56, s56, 4096
    s_branch L_warm
L_mem0:
    v_bfe_u32 v12, v0, 4, 2
    v_bfe_u32 v13, v0, 2, 1
    v_lshl_add_u32 v12, v12, 1, v13
    v_mul_u32_u24 v12, 1280, v12
    v_lshrrev_b32 v13, 6, v0
    v_lshl_add_u32 v12, v13, 5, v12
    v_and_b32 v13, 3, v0
    v_lshl_add_u32 v12, v13, 3, v12
    v_bfe_u32 v13, v0, 3, 1
    v_lshl_add_u32 v12, v13, 2, v12
    v_lshlrev_b32 v13, 2, v0
    buffer_load_dword v16, v12, s[12:15], 0 offen offset:0
    buffer_load_dword v17, v12, s[12:15], 0 offen offset:128
    buffer_load_dword v18, v12, s[12:15], 0 offen offset:256
    buffer_load_dword v19, v12, s[12:15], 0 offen offset:384
    buffer_load_dword v20, v12, s[12:15], 0 offen offset:512
    buffer_load_dword v21, v12, s[12:15], 0 offen offset:640
    buffer_load_dword v22, v12, s[12:15], 0 offen offset:768
    buffer_load_dword v23, v12, s[12:15], 0 offen offset:896
    buffer_load_dword v24, v12, s[12:15], 0 offen offset:1024
    buffer_load_dword v25, v12, s[12:15], 0 offen offset:1152
    s_waitcnt vmcnt(0)
    v_min_u32 v16, -2, v16
    buffer_store_dword v16, v13, s[4:7], s56 offen sc1
    s_add_u32 s56, s56, 1024
    v_min_u32 v17, -2, v17
    buffer_store_dword v17, v13, s[4:7], s56 offen sc1
    s_add_u32 s56, s56, 1024
    v_min_u32 v18, -2, v18
    buffer_store_dword v18, v13, s[4:7], s56 offen sc1
    s_add_u32 s56, s56, 1024
    v_min_u32 v19, -2, v19
    buffer_store_dword v19, v13, s[4:7], s56 offen sc1
    s_add_u32 s56, s56, 1024
    v_min_u32 v20, -2, v20
    buffer_store_dword v20, v13, s[4:7], s56 offen sc1
    s_add_u32 s56, s56, 1024
    v_min_u32 v21, -2, v21
    buffer_store_dword v21, v13, s[4:7], s56 offen sc1
    s_add_u32 s56, s56, 1024
    v_min_u32 v22, -2, v22
    buffer_store_dword v22, v13, s[4:7], s56 offen sc1
    s_add_u32 s56, s56, 1024
    v_min_u32 v23, -2, v23
    buffer_store_dword v23, v13, s[4:7], s56 offen sc1
    s_add_u32 s56, s56, 1024
    v_min_u32 v24, -2, v24
    buffer_store_dword v24, v13, s[4:7], s56 offen sc1
    s_add_u32 s56, s56, 1024
    v_min_u32 v25, -2, v25
    buffer_store_dword v25, v13, s[4:7], s56 offen sc1
    s_add_u32 s56, s56, 1024
L_warm:
    s_lshr_b32 s56, s55, 1
    s_mul_i32 s56, s56, 40960
    s_and_b32 s57, s55, 1
    s_lshl_b32 s57, s57, 8
    s_add_u32 s56, s56, s57
    s_add_u32 s56, s56, 196083712
    s_waitcnt vmcnt(2)
    buffer_store_dwordx4 v[64:67], v61, s[4:7], s56 offen sc1
    s_add_u32 s56, s56, 8192
    buffer_store_dwordx4 v[68:71], v61, s[4:7], s56 offen sc1
    s_add_u32 s56, s56, 8192
    buffer_store_dwordx4 v[72:75], v61, s[4:7], s56 offen sc1
    s_add_u32 s56, s56, 8192
    buffer_store_dwordx4 v[76:79], v61, s[4:7], s56 offen sc1
    s_add_u32 s56, s56, 8192
    buffer_store_dwordx4 v[80:83], v61, s[4:7], s56 offen sc1
    s_add_u32 s56, s56, 8192
    s_waitcnt vmcnt(0)
L_arrive:
    s_barrier
    s_cmp_lg_u32 s3, 0
    s_cbranch_scc1 L_dispatch
    s_getreg_b32 s55, hwreg(HW_REG_XCC_ID)
    s_and_b32 s55, s55, 7
    s_lshl_b32 s55, s55, 3
    s_lshl_b64 s[56:57], 1, s55
    v_mov_b32 v2, s56
    v_mov_b32 v3, s57
    s_lshl_b32 s56, s50, 3
    s_mov_b64 exec, 1
    buffer_atomic_add_x2 v[2:3], off, s[8:11], s56 sc1
    s_mov_b64 exec, -1
L_dispatch:
    s_cmp_eq_u32 s39, 0
    s_cbranch_scc1 L_role_head
    s_cmp_eq_u32 s39, 1
    s_cbranch_scc1 L_role_woc
    s_cmp_eq_u32 s39, 2
    s_cbranch_scc1 L_role_help
    s_cmp_eq_u32 s39, 3
    s_cbranch_scc1 L_role_kv
    s_cmp_eq_u32 s39, 4
    s_cbranch_scc1 L_role_qq
    s_cmp_eq_u32 s39, 5
    s_cbranch_scc1 L_role_att
    s_cmp_eq_u32 s39, 6
    s_cbranch_scc1 L_role_ff1
    s_cmp_eq_u32 s39, 7
    s_cbranch_scc1 L_role_wos
    s_cmp_eq_u32 s39, 8
    s_cbranch_scc1 L_role_wor
    s_cmp_eq_u32 s39, 9
    s_cbranch_scc1 L_role_ff2
    s_branch L_role_spare
L_abort:
    s_lshl_b32 s55, s2, 16
    s_or_b32 s55, s55, s54
    v_mov_b32 v2, s55
    s_mov_b64 exec, 1
    buffer_store_dword v2, off, s[8:11], 0 offset:192
    v_mov_b32 v2, 1
    buffer_atomic_add v2, off, s[8:11], 0 offset:196
    s_waitcnt vmcnt(0)
L_end:
    s_endpgm
L_role_kv:
    s_waitcnt vmcnt(0)
    s_cmp_eq_u32 s53, 0
    s_cbranch_scc1 Llate_3
    v_mov_b32 v2, 128
Lp_4:
    buffer_load_dword v3, v2, s[8:11], 0 offen sc1
    s_waitcnt vmcnt(0)
    v_cmp_gt_i32 vcc, 1, v3
    s_cbranch_vccz Lpd_5
    s_sleep 8
    s_mov_b32 s54, 128
    s_sub_u32 s52, s52, 1
    s_cbranch_scc1 L_abort
    s_branch Lp_4
Lpd_5:
    v_mov_b32 v2, 53248
    s_cmp_eq_u32 s53, 0
    s_cselect_b32 s56, 0, 1
Lp_6:
    buffer_load_dword v3, v2, s[4:7], 0 offen sc1
    s_waitcnt vmcnt(0)
    v_cmp_gt_i32 vcc, s56, v3
    s_cbranch_vccz Lpd_7
    s_sleep 8
    s_mov_b32 s54, 129
    s_sub_u32 s52, s52, 1
    s_cbranch_scc1 L_abort
    s_branch Lp_6
Lpd_7:
Llate_3:
L_kv_par:
    s_mov_b32 s12, s30
    s_mov_b32 s13, s31
    s_mov_b32 s14, 5242880
    s_mov_b32 s15, 0x20000
    s_mov_b32 s16, s32
    s_mov_b32 s17, s33
    s_mov_b32 s18, 5242880
    s_mov_b32 s19, 0x20000
    s_lshl_b32 s67, s51, 8
    s_lshl_b32 s55, s3, 6
    s_add_u32 s67, s67, s55
    s_mov_b32 s68, s67
    s_lshl_b32 s63, s53, 11
    s_add_u32 s63, s63, s51
    s_lshl_b32 s63, s63, 14
    s_lshl_b32 s55, s3, 11
    s_add_u32 s63, s63, s55
    s_add_u32 s63, s63, 8388608
    s_lshl_b32 s65, s53, 5
    s_add_u32 s65, s65, s51
    s_lshl_b32 s65, s65, 2
    s_add_u32 s65, s65, s3
    s_add_u32 s65, s65, 416
    s_lshl_b32 s65, s65, 7
    s_add_u32 s55, s53, 0
    s_mul_i32 s62, s55, 2621440
    s_mul_i32 s55, s3, 10240
    s_add_u32 s62, s62, s55
    s_add_u32 s62, s62, 196083712
    v_lshrrev_b32 v252, 4, v1
    v_bfe_u32 v253, v1, 2, 2
    v_and_b32 v254, 3, v1
    s_mul_i32 s69, s3, 40960
    v_mov_b32 v20, 0x3f803f80
    v_mov_b32 v21, 0x3f803f80
    v_mov_b32 v22, 0x3f803f80
    v_mov_b32 v23, 0x3f803f80
    v_lshrrev_b32 v250, 1, v252
    v_lshl_add_u32 v250, v250, 3, v253
    v_lshlrev_b32 v250, 8, v250
    v_and_b32 v251, 1, v252
    v_lshl_add_u32 v250, v251, 5, v250
    v_lshl_add_u32 v250, v254, 3, v250
    v_xor_b32 v251, s3, v253
    v_lshl_add_u32 v250, v251, 6, v250
    s_add_u32 s55, s3, 0
    s_and_b32 s55, s55, 3
    s_mul_i32 s55, s55, 40960
    v_add_u32 v24, s55, v250
    s_add_u32 s55, s3, 1
    s_and_b32 s55, s55, 3
    s_mul_i32 s55, s55, 40960
    v_add_u32 v25, s55, v250
    s_add_u32 s55, s3, 2
    s_and_b32 s55, s55, 3
    s_mul_i32 s55, s55, 40960
    v_add_u32 v26, s55, v250
    s_add_u32 s55, s3, 3
    s_and_b32 s55, s55, 3
    s_mul_i32 s55, s55, 40960
    v_add_u32 v27, s55, v250
    v_lshrrev_b32 v251, 4, v1
    v_mul_u32_u24 v191, 8192, v251
    v_lshlrev_b32 v251, 2, v251
    v_and_b32 v250, 15, v1
    v_xor_b32 v251, v251, v250
    v_lshl_add_u32 v191, v251, 4, v191
    s_mul_i32 s56, s3, 1310656
    s_add_u32 s56, s56, s68
    s_mov_b32 m0, s69
    s_nop 0
    buffer_load_dwordx4 v191, s[16:19], s56 offen lds
    s_add_u32 m0, m0, 1024
    s_add_u32 s56, s56, 32768
    buffer_load_dwordx4 v191, s[16:19], s56 offen lds
    s_add_u32 m0, m0, 1024
    s_add_u32 s56, s56, 32768
    buffer_load_dwordx4 v191, s[16:19], s56 offen lds
    s_add_u32 m0, m0, 1024
    s_add_u32 s56, s56, 32768
    buffer_load_dwordx4 v191, s[16:19], s56 offen lds
    s_add_u32 m0, m0, 1024
    s_add_u32 s56, s56, 32768
    buffer_load_dwordx4 v191, s[16:19], s56 offen lds
    s_add_u32 m0, m0, 1024
    s_add_u32 s56, s56, 32768
    buffer_load_dwordx4 v191, s[16:19], s56 offen lds
    s_add_u32 m0, m0, 1024
    s_add_u32 s56, s56, 32768
    buffer_load_dwordx4 v191, s[16:19], s56 offen lds
    s_add_u32 m0, m0, 1024
    s_add_u32 s56, s56, 32768
    buffer_load_dwordx4 v191, s[16:19], s56 offen lds
    s_add_u32 m0, m0, 1024
    s_add_u32 s56, s56, 32768
    buffer_load_dwordx4 v191, s[16:19], s56 offen lds
    s_add_u32 m0, m0, 1024
    s_add_u32 s56, s56, 32768
    buffer_load_dwordx4 v191, s[16:19], s56 offen lds
    s_add_u32 m0, m0, 1024
    s_add_u32 s56, s56, 32768
    buffer_load_dwordx4 v191, s[16:19], s56 offen lds
    s_add_u32 m0, m0, 1024
    s_add_u32 s56, s56, 32768
    buffer_load_dwordx4 v191, s[16:19], s56 offen lds
    s_add_u32 m0, m0, 1024
    s_add_u32 s56, s56, 32768
    buffer_load_dwordx4 v191, s[16:19], s56 offen lds
    s_add_u32 m0, m0, 1024
    s_add_u32 s56, s56, 32768
    buffer_load_dwordx4 v191, s[16:19], s56 offen lds
    s_add_u32 m0, m0, 1024
    s_add_u32 s56, s56, 32768
    buffer_load_dwordx4 v191, s[16:19], s56 offen lds
    s_add_u32 m0, m0, 1024
    s_add_u32 s56, s56, 32768
    buffer_load_dwordx4 v191, s[16:19], s56 offen lds
    s_add_u32 m0, m0, 1024
    s_add_u32 s56, s56, 32768
    buffer_load_dwordx4 v191, s[16:19], s56 offen lds
    s_add_u32 m0, m0, 1024
    s_add_u32 s56, s56, 32768
    buffer_load_dwordx4 v191, s[16:19], s56 offen lds
    s_add_u32 m0, m0, 1024
    s_add_u32 s56, s56, 32768
    buffer_load_dwordx4 v191, s[16:19], s56 offen lds
    s_add_u32 m0, m0, 1024
    s_add_u32 s56, s56, 32768
    buffer_load_dwordx4 v191, s[16:19], s56 offen lds
    s_add_u32 m0, m0, 1024
    s_add_u32 s56, s56, 32768
    buffer_load_dwordx4 v191, s[16:19], s56 offen lds
    s_add_u32 m0, m0, 1024
    s_add_u32 s56, s56, 32768
    buffer_load_dwordx4 v191, s[16:19], s56 offen lds
    s_add_u32 m0, m0, 1024
    s_add_u32 s56, s56, 32768
    buffer_load_dwordx4 v191, s[16:19], s56 offen lds
    s_add_u32 m0, m0, 1024
    s_add_u32 s56, s56, 32768
    buffer_load_dwordx4 v191, s[16:19], s56 offen lds
    s_add_u32 m0, m0, 1024
    s_add_u32 s56, s56, 32768
    buffer_load_dwordx4 v191, s[16:19], s56 offen lds
    s_add_u32 m0, m0, 1024
    s_add_u32 s56, s56, 32768
    buffer_load_dwordx4 v191, s[16:19], s56 offen lds
    s_add_u32 m0, m0, 1024
    s_add_u32 s56, s56, 32768
    buffer_load_dwordx4 v191, s[16:19], s56 offen lds
    s_add_u32 m0, m0, 1024
    s_add_u32 s56, s56, 32768
    buffer_load_dwordx4 v191, s[16:19], s56 offen lds
    s_add_u32 m0, m0, 1024
    s_add_u32 s56, s56, 32768
    buffer_load_dwordx4 v191, s[16:19], s56 offen lds
    s_add_u32 m0, m0, 1024
    s_add_u32 s56, s56, 32768
    buffer_load_dwordx4 v191, s[16:19], s56 offen lds
    s_add_u32 m0, m0, 1024
    s_add_u32 s56, s56, 32768
    buffer_load_dwordx4 v191, s[16:19], s56 offen lds
    s_add_u32 m0, m0, 1024
    s_add_u32 s56, s56, 32768
    buffer_load_dwordx4 v191, s[16:19], s56 offen lds
    s_add_u32 m0, m0, 1024
    s_add_u32 s56, s56, 32768
    buffer_load_dwordx4 v191, s[16:19], s56 offen lds
    s_add_u32 m0, m0, 1024
    s_add_u32 s56, s56, 32768
    buffer_load_dwordx4 v191, s[16:19], s56 offen lds
    s_add_u32 m0, m0, 1024
    s_add_u32 s56, s56, 32768
    buffer_load_dwordx4 v191, s[16:19], s56 offen lds
    s_add_u32 m0, m0, 1024
    s_add_u32 s56, s56, 32768
    buffer_load_dwordx4 v191, s[16:19], s56 offen lds
    s_add_u32 m0, m0, 1024
    s_add_u32 s56, s56, 32768
    buffer_load_dwordx4 v191, s[16:19], s56 offen lds
    s_add_u32 m0, m0, 1024
    s_add_u32 s56, s56, 32768
    buffer_load_dwordx4 v191, s[16:19], s56 offen lds
    s_add_u32 m0, m0, 1024
    s_add_u32 s56, s56, 32768
    buffer_load_dwordx4 v191, s[16:19], s56 offen lds
    s_add_u32 m0, m0, 1024
    s_add_u32 s56, s56, 32768
    buffer_load_dwordx4 v191, s[16:19], s56 offen lds
    s_waitcnt vmcnt(0)
    s_barrier
    s_or_b32 s55, s53, s51
    s_or_b32 s55, s55, s3
    s_cbranch_scc1 Lld_8
    v_mov_b32 v28, 1
    buffer_store_dword v28, off, s[8:11], 0 offset:148 sc1
Lld_8:
    ds_read_b64_tr_b16 a[160:161], v24 offset:0
    ds_read_b64_tr_b16 a[162:163], v24 offset:1024
    ds_read_b64_tr_b16 a[164:165], v24 offset:4096
    ds_read_b64_tr_b16 a[166:167], v24 offset:5120
    ds_read_b64_tr_b16 a[168:169], v24 offset:8192
    ds_read_b64_tr_b16 a[170:171], v24 offset:9216
    ds_read_b64_tr_b16 a[172:173], v24 offset:12288
    ds_read_b64_tr_b16 a[174:175], v24 offset:13312
    ds_read_b64_tr_b16 a[176:177], v24 offset:16384
    ds_read_b64_tr_b16 a[178:179], v24 offset:17408
    ds_read_b64_tr_b16 a[180:181], v24 offset:20480
    ds_read_b64_tr_b16 a[182:183], v24 offset:21504
    ds_read_b64_tr_b16 a[184:185], v24 offset:24576
    ds_read_b64_tr_b16 a[186:187], v24 offset:25600
    ds_read_b64_tr_b16 a[188:189], v24 offset:28672
    ds_read_b64_tr_b16 a[190:191], v24 offset:29696
    ds_read_b64_tr_b16 a[192:193], v24 offset:32768
    ds_read_b64_tr_b16 a[194:195], v24 offset:33792
    ds_read_b64_tr_b16 a[196:197], v24 offset:36864
    ds_read_b64_tr_b16 a[198:199], v24 offset:37888
    ds_read_b64_tr_b16 a[200:201], v25 offset:0
    ds_read_b64_tr_b16 a[202:203], v25 offset:1024
    ds_read_b64_tr_b16 a[204:205], v25 offset:4096
    ds_read_b64_tr_b16 a[206:207], v25 offset:5120
    ds_read_b64_tr_b16 a[208:209], v25 offset:8192
    ds_read_b64_tr_b16 a[210:211], v25 offset:9216
    ds_read_b64_tr_b16 a[212:213], v25 offset:12288
    ds_read_b64_tr_b16 a[214:215], v25 offset:13312
    ds_read_b64_tr_b16 a[216:217], v25 offset:16384
    ds_read_b64_tr_b16 a[218:219], v25 offset:17408
    ds_read_b64_tr_b16 a[220:221], v25 offset:20480
    ds_read_b64_tr_b16 a[222:223], v25 offset:21504
    ds_read_b64_tr_b16 a[224:225], v25 offset:24576
    ds_read_b64_tr_b16 a[226:227], v25 offset:25600
    ds_read_b64_tr_b16 a[228:229], v25 offset:28672
    ds_read_b64_tr_b16 a[230:231], v25 offset:29696
    ds_read_b64_tr_b16 a[232:233], v25 offset:32768
    ds_read_b64_tr_b16 a[234:235], v25 offset:33792
    ds_read_b64_tr_b16 a[236:237], v25 offset:36864
    ds_read_b64_tr_b16 a[238:239], v25 offset:37888
    ds_read_b64_tr_b16 a[240:241], v26 offset:0
    ds_read_b64_tr_b16 a[242:243], v26 offset:1024
    ds_read_b64_tr_b16 a[244:245], v26 offset:4096
    ds_read_b64_tr_b16 a[246:247], v26 offset:5120
    ds_read_b64_tr_b16 a[248:249], v26 offset:8192
    ds_read_b64_tr_b16 a[250:251], v26 offset:9216
    ds_read_b64_tr_b16 a[252:253], v26 offset:12288
    ds_read_b64_tr_b16 a[254:255], v26 offset:13312
    ds_read_b64_tr_b16 v[192:193], v26 offset:16384
    ds_read_b64_tr_b16 v[194:195], v26 offset:17408
    ds_read_b64_tr_b16 v[196:197], v26 offset:20480
    ds_read_b64_tr_b16 v[198:199], v26 offset:21504
    ds_read_b64_tr_b16 v[200:201], v26 offset:24576
    ds_read_b64_tr_b16 v[202:203], v26 offset:25600
    ds_read_b64_tr_b16 v[204:205], v26 offset:28672
    ds_read_b64_tr_b16 v[206:207], v26 offset:29696
    ds_read_b64_tr_b16 v[208:209], v26 offset:32768
    ds_read_b64_tr_b16 v[210:211], v26 offset:33792
    ds_read_b64_tr_b16 v[212:213], v26 offset:36864
    ds_read_b64_tr_b16 v[214:215], v26 offset:37888
    ds_read_b64_tr_b16 v[216:217], v27 offset:0
    ds_read_b64_tr_b16 v[218:219], v27 offset:1024
    ds_read_b64_tr_b16 v[220:221], v27 offset:4096
    ds_read_b64_tr_b16 v[222:223], v27 offset:5120
    ds_read_b64_tr_b16 v[224:225], v27 offset:8192
    ds_read_b64_tr_b16 v[226:227], v27 offset:9216
    ds_read_b64_tr_b16 v[228:229], v27 offset:12288
    ds_read_b64_tr_b16 v[230:231], v27 offset:13312
    ds_read_b64_tr_b16 v[232:233], v27 offset:16384
    ds_read_b64_tr_b16 v[234:235], v27 offset:17408
    ds_read_b64_tr_b16 v[236:237], v27 offset:20480
    ds_read_b64_tr_b16 v[238:239], v27 offset:21504
    ds_read_b64_tr_b16 v[240:241], v27 offset:24576
    ds_read_b64_tr_b16 v[242:243], v27 offset:25600
    ds_read_b64_tr_b16 v[244:245], v27 offset:28672
    ds_read_b64_tr_b16 v[246:247], v27 offset:29696
    ds_read_b64_tr_b16 v[248:249], v27 offset:32768
    ds_read_b64_tr_b16 v[250:251], v27 offset:33792
    ds_read_b64_tr_b16 v[252:253], v27 offset:36864
    ds_read_b64_tr_b16 v[254:255], v27 offset:37888
    s_waitcnt lgkmcnt(0)
    s_barrier
    s_mul_i32 s56, s3, 1310656
    s_add_u32 s56, s56, s67
    s_mov_b32 m0, s69
    s_nop 0
    buffer_load_dwordx4 v191, s[12:15], s56 offen lds
    s_add_u32 m0, m0, 1024
    s_add_u32 s56, s56, 32768
    buffer_load_dwordx4 v191, s[12:15], s56 offen lds
    s_add_u32 m0, m0, 1024
    s_add_u32 s56, s56, 32768
    buffer_load_dwordx4 v191, s[12:15], s56 offen lds
    s_add_u32 m0, m0, 1024
    s_add_u32 s56, s56, 32768
    buffer_load_dwordx4 v191, s[12:15], s56 offen lds
    s_add_u32 m0, m0, 1024
    s_add_u32 s56, s56, 32768
    buffer_load_dwordx4 v191, s[12:15], s56 offen lds
    s_add_u32 m0, m0, 1024
    s_add_u32 s56, s56, 32768
    buffer_load_dwordx4 v191, s[12:15], s56 offen lds
    s_add_u32 m0, m0, 1024
    s_add_u32 s56, s56, 32768
    buffer_load_dwordx4 v191, s[12:15], s56 offen lds
    s_add_u32 m0, m0, 1024
    s_add_u32 s56, s56, 32768
    buffer_load_dwordx4 v191, s[12:15], s56 offen lds
    s_add_u32 m0, m0, 1024
    s_add_u32 s56, s56, 32768
    buffer_load_dwordx4 v191, s[12:15], s56 offen lds
    s_add_u32 m0, m0, 1024
    s_add_u32 s56, s56, 32768
    buffer_load_dwordx4 v191, s[12:15], s56 offen lds
    s_add_u32 m0, m0, 1024
    s_add_u32 s56, s56, 32768
    buffer_load_dwordx4 v191, s[12:15], s56 offen lds
    s_add_u32 m0, m0, 1024
    s_add_u32 s56, s56, 32768
    buffer_load_dwordx4 v191, s[12:15], s56 offen lds
    s_add_u32 m0, m0, 1024
    s_add_u32 s56, s56, 32768
    buffer_load_dwordx4 v191, s[12:15], s56 offen lds
    s_add_u32 m0, m0, 1024
    s_add_u32 s56, s56, 32768
    buffer_load_dwordx4 v191, s[12:15], s56 offen lds
    s_add_u32 m0, m0, 1024
    s_add_u32 s56, s56, 32768
    buffer_load_dwordx4 v191, s[12:15], s56 offen lds
    s_add_u32 m0, m0, 1024
    s_add_u32 s56, s56, 32768
    buffer_load_dwordx4 v191, s[12:15], s56 offen lds
    s_add_u32 m0, m0, 1024
    s_add_u32 s56, s56, 32768
    buffer_load_dwordx4 v191, s[12:15], s56 offen lds
    s_add_u32 m0, m0, 1024
    s_add_u32 s56, s56, 32768
    buffer_load_dwordx4 v191, s[12:15], s56 offen lds
    s_add_u32 m0, m0, 1024
    s_add_u32 s56, s56, 32768
    buffer_load_dwordx4 v191, s[12:15], s56 offen lds
    s_add_u32 m0, m0, 1024
    s_add_u32 s56, s56, 32768
    buffer_load_dwordx4 v191, s[12:15], s56 offen lds
    s_add_u32 m0, m0, 1024
    s_add_u32 s56, s56, 32768
    buffer_load_dwordx4 v191, s[12:15], s56 offen lds
    s_add_u32 m0, m0, 1024
    s_add_u32 s56, s56, 32768
    buffer_load_dwordx4 v191, s[12:15], s56 offen lds
    s_add_u32 m0, m0, 1024
    s_add_u32 s56, s56, 32768
    buffer_load_dwordx4 v191, s[12:15], s56 offen lds
    s_add_u32 m0, m0, 1024
    s_add_u32 s56, s56, 32768
    buffer_load_dwordx4 v191, s[12:15], s56 offen lds
    s_add_u32 m0, m0, 1024
    s_add_u32 s56, s56, 32768
    buffer_load_dwordx4 v191, s[12:15], s56 offen lds
    s_add_u32 m0, m0, 1024
    s_add_u32 s56, s56, 32768
    buffer_load_dwordx4 v191, s[12:15], s56 offen lds
    s_add_u32 m0, m0, 1024
    s_add_u32 s56, s56, 32768
    buffer_load_dwordx4 v191, s[12:15], s56 offen lds
    s_add_u32 m0, m0, 1024
    s_add_u32 s56, s56, 32768
    buffer_load_dwordx4 v191, s[12:15], s56 offen lds
    s_add_u32 m0, m0, 1024
    s_add_u32 s56, s56, 32768
    buffer_load_dwordx4 v191, s[12:15], s56 offen lds
    s_add_u32 m0, m0, 1024
    s_add_u32 s56, s56, 32768
    buffer_load_dwordx4 v191, s[12:15], s56 offen lds
    s_add_u32 m0, m0, 1024
    s_add_u32 s56, s56, 32768
    buffer_load_dwordx4 v191, s[12:15], s56 offen lds
    s_add_u32 m0, m0, 1024
    s_add_u32 s56, s56, 32768
    buffer_load_dwordx4 v191, s[12:15], s56 offen lds
    s_add_u32 m0, m0, 1024
    s_add_u32 s56, s56, 32768
    buffer_load_dwordx4 v191, s[12:15], s56 offen lds
    s_add_u32 m0, m0, 1024
    s_add_u32 s56, s56, 32768
    buffer_load_dwordx4 v191, s[12:15], s56 offen lds
    s_add_u32 m0, m0, 1024
    s_add_u32 s56, s56, 32768
    buffer_load_dwordx4 v191, s[12:15], s56 offen lds
    s_add_u32 m0, m0, 1024
    s_add_u32 s56, s56, 32768
    buffer_load_dwordx4 v191, s[12:15], s56 offen lds
    s_add_u32 m0, m0, 1024
    s_add_u32 s56, s56, 32768
    buffer_load_dwordx4 v191, s[12:15], s56 offen lds
    s_add_u32 m0, m0, 1024
    s_add_u32 s56, s56, 32768
    buffer_load_dwordx4 v191, s[12:15], s56 offen lds
    s_add_u32 m0, m0, 1024
    s_add_u32 s56, s56, 32768
    buffer_load_dwordx4 v191, s[12:15], s56 offen lds
    s_add_u32 m0, m0, 1024
    s_add_u32 s56, s56, 32768
    buffer_load_dwordx4 v191, s[12:15], s56 offen lds
    v_mfma_f32_32x32x16_bf16 v[132:147], v[20:23], a[160:163], 0
    v_mfma_f32_32x32x16_bf16 v[132:147], v[20:23], a[164:167], v[132:147]
    v_mfma_f32_32x32x16_bf16 v[132:147], v[20:23], a[168:171], v[132:147]
    v_mfma_f32_32x32x16_bf16 v[132:147], v[20:23], a[172:175], v[132:147]
    v_mfma_f32_32x32x16_bf16 v[132:147], v[20:23], a[176:179], v[132:147]
    v_mfma_f32_32x32x16_bf16 v[132:147], v[20:23], a[180:183], v[132:147]
    v_mfma_f32_32x32x16_bf16 v[132:147], v[20:23], a[184:187], v[132:147]
    v_mfma_f32_32x32x16_bf16 v[132:147], v[20:23], a[188:191], v[132:147]
    v_mfma_f32_32x32x16_bf16 v[132:147], v[20:23], a[192:195], v[132:147]
    v_mfma_f32_32x32x16_bf16 v[132:147], v[20:23], a[196:199], v[132:147]
    v_mfma_f32_32x32x16_bf16 v[132:147], v[20:23], a[200:203], v[132:147]
    v_mfma_f32_32x32x16_bf16 v[132:147], v[20:23], a[204:207], v[132:147]
    v_mfma_f32_32x32x16_bf16 v[132:147], v[20:23], a[208:211], v[132:147]
    v_mfma_f32_32x32x16_bf16 v[132:147], v[20:23], a[212:215], v[132:147]
    v_mfma_f32_32x32x16_bf16 v[132:147], v[20:23], a[216:219], v[132:147]
    v_mfma_f32_32x32x16_bf16 v[132:147], v[20:23], a[220:223], v[132:147]
    v_mfma_f32_32x32x16_bf16 v[132:147], v[20:23], a[224:227], v[132:147]
    v_mfma_f32_32x32x16_bf16 v[132:147], v[20:23], a[228:231], v[132:147]
    v_mfma_f32_32x32x16_bf16 v[132:147], v[20:23], a[232:235], v[132:147]
    v_mfma_f32_32x32x16_bf16 v[132:147], v[20:23], a[236:239], v[132:147]
    v_mfma_f32_32x32x16_bf16 v[132:147], v[20:23], a[240:243], v[132:147]
    v_mfma_f32_32x32x16_bf16 v[132:147], v[20:23], a[244:247], v[132:147]
    v_mfma_f32_32x32x16_bf16 v[132:147], v[20:23], a[248:251], v[132:147]
    v_mfma_f32_32x32x16_bf16 v[132:147], v[20:23], a[252:255], v[132:147]
    v_mfma_f32_32x32x16_bf16 v[132:147], v[20:23], v[192:195], v[132:147]
    v_mfma_f32_32x32x16_bf16 v[132:147], v[20:23], v[196:199], v[132:147]
    v_mfma_f32_32x32x16_bf16 v[132:147], v[20:23], v[200:203], v[132:147]
    v_mfma_f32_32x32x16_bf16 v[132:147], v[20:23], v[204:207], v[132:147]
    v_mfma_f32_32x32x16_bf16 v[132:147], v[20:23], v[208:211], v[132:147]
    v_mfma_f32_32x32x16_bf16 v[132:147], v[20:23], v[212:215], v[132:147]
    v_mfma_f32_32x32x16_bf16 v[132:147], v[20:23], v[216:219], v[132:147]
    v_mfma_f32_32x32x16_bf16 v[132:147], v[20:23], v[220:223], v[132:147]
    v_mfma_f32_32x32x16_bf16 v[132:147], v[20:23], v[224:227], v[132:147]
    v_mfma_f32_32x32x16_bf16 v[132:147], v[20:23], v[228:231], v[132:147]
    v_mfma_f32_32x32x16_bf16 v[132:147], v[20:23], v[232:235], v[132:147]
    v_mfma_f32_32x32x16_bf16 v[132:147], v[20:23], v[236:239], v[132:147]
    v_mfma_f32_32x32x16_bf16 v[132:147], v[20:23], v[240:243], v[132:147]
    v_mfma_f32_32x32x16_bf16 v[132:147], v[20:23], v[244:247], v[132:147]
    v_mfma_f32_32x32x16_bf16 v[132:147], v[20:23], v[248:251], v[132:147]
    v_mfma_f32_32x32x16_bf16 v[132:147], v[20:23], v[252:255], v[132:147]
    s_waitcnt vmcnt(0)
    s_barrier
    s_or_b32 s55, s53, s51
    s_or_b32 s55, s55, s3
    s_cbranch_scc1 Lld_9
    v_mov_b32 v28, 2
    buffer_store_dword v28, off, s[8:11], 0 offset:148 sc1
Lld_9:
    ds_read_b64_tr_b16 a[0:1], v24 offset:0
    ds_read_b64_tr_b16 a[2:3], v24 offset:1024
    ds_read_b64_tr_b16 a[4:5], v24 offset:4096
    ds_read_b64_tr_b16 a[6:7], v24 offset:5120
    ds_read_b64_tr_b16 a[8:9], v24 offset:8192
    ds_read_b64_tr_b16 a[10:11], v24 offset:9216
    ds_read_b64_tr_b16 a[12:13], v24 offset:12288
    ds_read_b64_tr_b16 a[14:15], v24 offset:13312
    ds_read_b64_tr_b16 a[16:17], v24 offset:16384
    ds_read_b64_tr_b16 a[18:19], v24 offset:17408
    ds_read_b64_tr_b16 a[20:21], v24 offset:20480
    ds_read_b64_tr_b16 a[22:23], v24 offset:21504
    ds_read_b64_tr_b16 a[24:25], v24 offset:24576
    ds_read_b64_tr_b16 a[26:27], v24 offset:25600
    ds_read_b64_tr_b16 a[28:29], v24 offset:28672
    ds_read_b64_tr_b16 a[30:31], v24 offset:29696
    ds_read_b64_tr_b16 a[32:33], v24 offset:32768
    ds_read_b64_tr_b16 a[34:35], v24 offset:33792
    ds_read_b64_tr_b16 a[36:37], v24 offset:36864
    ds_read_b64_tr_b16 a[38:39], v24 offset:37888
    ds_read_b64_tr_b16 a[40:41], v25 offset:0
    ds_read_b64_tr_b16 a[42:43], v25 offset:1024
    ds_read_b64_tr_b16 a[44:45], v25 offset:4096
    ds_read_b64_tr_b16 a[46:47], v25 offset:5120
    ds_read_b64_tr_b16 a[48:49], v25 offset:8192
    ds_read_b64_tr_b16 a[50:51], v25 offset:9216
    ds_read_b64_tr_b16 a[52:53], v25 offset:12288
    ds_read_b64_tr_b16 a[54:55], v25 offset:13312
    ds_read_b64_tr_b16 a[56:57], v25 offset:16384
    ds_read_b64_tr_b16 a[58:59], v25 offset:17408
    ds_read_b64_tr_b16 a[60:61], v25 offset:20480
    ds_read_b64_tr_b16 a[62:63], v25 offset:21504
    ds_read_b64_tr_b16 a[64:65], v25 offset:24576
    ds_read_b64_tr_b16 a[66:67], v25 offset:25600
    ds_read_b64_tr_b16 a[68:69], v25 offset:28672
    ds_read_b64_tr_b16 a[70:71], v25 offset:29696
    ds_read_b64_tr_b16 a[72:73], v25 offset:32768
    ds_read_b64_tr_b16 a[74:75], v25 offset:33792
    ds_read_b64_tr_b16 a[76:77], v25 offset:36864
    ds_read_b64_tr_b16 a[78:79], v25 offset:37888
    ds_read_b64_tr_b16 a[80:81], v26 offset:0
    ds_read_b64_tr_b16 a[82:83], v26 offset:1024
    ds_read_b64_tr_b16 a[84:85], v26 offset:4096
    ds_read_b64_tr_b16 a[86:87], v26 offset:5120
    ds_read_b64_tr_b16 a[88:89], v26 offset:8192
    ds_read_b64_tr_b16 a[90:91], v26 offset:9216
    ds_read_b64_tr_b16 a[92:93], v26 offset:12288
    ds_read_b64_tr_b16 a[94:95], v26 offset:13312
    ds_read_b64_tr_b16 a[96:97], v26 offset:16384
    ds_read_b64_tr_b16 a[98:99], v26 offset:17408
    ds_read_b64_tr_b16 a[100:101], v26 offset:20480
    ds_read_b64_tr_b16 a[102:103], v26 offset:21504
    ds_read_b64_tr_b16 a[104:105], v26 offset:24576
    ds_read_b64_tr_b16 a[106:107], v26 offset:25600
    ds_read_b64_tr_b16 a[108:109], v26 offset:28672
    ds_read_b64_tr_b16 a[110:111], v26 offset:29696
    ds_read_b64_tr_b16 a[112:113], v26 offset:32768
    ds_read_b64_tr_b16 a[114:115], v26 offset:33792
    ds_read_b64_tr_b16 a[116:117], v26 offset:36864
    ds_read_b64_tr_b16 a[118:119], v26 offset:37888
    ds_read_b64_tr_b16 a[120:121], v27 offset:0
    ds_read_b64_tr_b16 a[122:123], v27 offset:1024
    ds_read_b64_tr_b16 a[124:125], v27 offset:4096
    ds_read_b64_tr_b16 a[126:127], v27 offset:5120
    ds_read_b64_tr_b16 a[128:129], v27 offset:8192
    ds_read_b64_tr_b16 a[130:131], v27 offset:9216
    ds_read_b64_tr_b16 a[132:133], v27 offset:12288
    ds_read_b64_tr_b16 a[134:135], v27 offset:13312
    ds_read_b64_tr_b16 a[136:137], v27 offset:16384
    ds_read_b64_tr_b16 a[138:139], v27 offset:17408
    ds_read_b64_tr_b16 a[140:141], v27 offset:20480
    ds_read_b64_tr_b16 a[142:143], v27 offset:21504
    ds_read_b64_tr_b16 a[144:145], v27 offset:24576
    ds_read_b64_tr_b16 a[146:147], v27 offset:25600
    ds_read_b64_tr_b16 a[148:149], v27 offset:28672
    ds_read_b64_tr_b16 a[150:151], v27 offset:29696
    ds_read_b64_tr_b16 a[152:153], v27 offset:32768
    ds_read_b64_tr_b16 a[154:155], v27 offset:33792
    ds_read_b64_tr_b16 a[156:157], v27 offset:36864
    ds_read_b64_tr_b16 a[158:159], v27 offset:37888
    s_waitcnt lgkmcnt(0)
    s_barrier
    v_mfma_f32_32x32x16_bf16 v[116:131], a[0:3], v[20:23], 0
    v_mfma_f32_32x32x16_bf16 v[116:131], a[4:7], v[20:23], v[116:131]
    v_mfma_f32_32x32x16_bf16 v[116:131], a[8:11], v[20:23], v[116:131]
    v_mfma_f32_32x32x16_bf16 v[116:131], a[12:15], v[20:23], v[116:131]
    v_mfma_f32_32x32x16_bf16 v[116:131], a[16:19], v[20:23], v[116:131]
    v_mfma_f32_32x32x16_bf16 v[116:131], a[20:23], v[20:23], v[116:131]
    v_mfma_f32_32x32x16_bf16 v[116:131], a[24:27], v[20:23], v[116:131]
    v_mfma_f32_32x32x16_bf16 v[116:131], a[28:31], v[20:23], v[116:131]
    v_mfma_f32_32x32x16_bf16 v[116:131], a[32:35], v[20:23], v[116:131]
    v_mfma_f32_32x32x16_bf16 v[116:131], a[36:39], v[20:23], v[116:131]
    v_mfma_f32_32x32x16_bf16 v[116:131], a[40:43], v[20:23], v[116:131]
    v_mfma_f32_32x32x16_bf16 v[116:131], a[44:47], v[20:23], v[116:131]
    v_mfma_f32_32x32x16_bf16 v[116:131], a[48:51], v[20:23], v[116:131]
    v_mfma_f32_32x32x16_bf16 v[116:131], a[52:55], v[20:23], v[116:131]
    v_mfma_f32_32x32x16_bf16 v[116:131], a[56:59], v[20:23], v[116:131]
    v_mfma_f32_32x32x16_bf16 v[116:131], a[60:63], v[20:23], v[116:131]
    v_mfma_f32_32x32x16_bf16 v[116:131], a[64:67], v[20:23], v[116:131]
    v_mfma_f32_32x32x16_bf16 v[116:131], a[68:71], v[20:23], v[116:131]
    v_mfma_f32_32x32x16_bf16 v[116:131], a[72:75], v[20:23], v[116:131]
    v_mfma_f32_32x32x16_bf16 v[116:131], a[76:79], v[20:23], v[116:131]
    v_mfma_f32_32x32x16_bf16 v[116:131], a[80:83], v[20:23], v[116:131]
    v_mfma_f32_32x32x16_bf16 v[116:131], a[84:87], v[20:23], v[116:131]
    v_mfma_f32_32x32x16_bf16 v[116:131], a[88:91], v[20:23], v[116:131]
    v_mfma_f32_32x32x16_bf16 v[116:131], a[92:95], v[20:23], v[116:131]
    v_mfma_f32_32x32x16_bf16 v[116:131], a[96:99], v[20:23], v[116:131]
    v_mfma_f32_32x32x16_bf16 v[116:131], a[100:103], v[20:23], v[116:131]
    v_mfma_f32_32x32x16_bf16 v[116:131], a[104:107], v[20:23], v[116:131]
    v_mfma_f32_32x32x16_bf16 v[116:131], a[108:111], v[20:23], v[116:131]
    v_mfma_f32_32x32x16_bf16 v[116:131], a[112:115], v[20:23], v[116:131]
    v_mfma_f32_32x32x16_bf16 v[116:131], a[116:119], v[20:23], v[116:131]
    v_mfma_f32_32x32x16_bf16 v[116:131], a[120:123], v[20:23], v[116:131]
    v_mfma_f32_32x32x16_bf16 v[116:131], a[124:127], v[20:23], v[116:131]
    v_mfma_f32_32x32x16_bf16 v[116:131], a[128:131], v[20:23], v[116:131]
    v_mfma_f32_32x32x16_bf16 v[116:131], a[132:135], v[20:23], v[116:131]
    v_mfma_f32_32x32x16_bf16 v[116:131], a[136:139], v[20:23], v[116:131]
    v_mfma_f32_32x32x16_bf16 v[116:131], a[140:143], v[20:23], v[116:131]
    v_mfma_f32_32x32x16_bf16 v[116:131], a[144:147], v[20:23], v[116:131]
    v_mfma_f32_32x32x16_bf16 v[116:131], a[148:151], v[20:23], v[116:131]
    v_mfma_f32_32x32x16_bf16 v[116:131], a[152:155], v[20:23], v[116:131]
    v_mfma_f32_32x32x16_bf16 v[116:131], a[156:159], v[20:23], v[116:131]
L_kv_con:
    v_lshlrev_b32 v2, 4, v1
    s_mul_i32 s55, s53, 40
    s_mul_i32 s56, s3, 10
    s_add_u32 s55, s55, s56
    s_add_u32 s55, s55, 0
    v_min_u32 v3, 9, v1
    v_add_u32 v3, s55, v3
    v_lshlrev_b32 v3, 7, v3
    v_mov_b32 v189, 0
    s_cmp_eq_u32 s53, 0
    s_cselect_b32 s55, 64, 0
    v_mov_b32 v189, s55
    s_lshl_b32 s55, s53, 7
    s_add_u32 s55, s55, 672
    s_lshl_b32 s55, s55, 7
    v_mov_b32 v11, s55
    v_cmp_gt_u32 vcc, 10, v1
    s_nop 1
    v_cndmask_b32 v3, v11, v3, vcc
    v_cndmask_b32 v189, 6, v189, vcc
    s_add_u32 s55, s3, 0
    s_and_b32 s55, s55, 3
    s_mul_i32 s55, s55, 10240
    v_add_u32 v5, s55, v2
    s_add_u32 s55, s3, 1
    s_and_b32 s55, s55, 3
    s_mul_i32 s55, s55, 10240
    v_add_u32 v6, s55, v2
    s_add_u32 s55, s3, 2
    s_and_b32 s55, s55, 3
    s_mul_i32 s55, s55, 10240
    v_add_u32 v7, s55, v2
    s_add_u32 s55, s3, 3
    s_and_b32 s55, s55, 3
    s_mul_i32 s55, s55, 10240
    v_add_u32 v8, s55, v2
    v_lshlrev_b32 v9, 3, v0
    v_add_u32 v9, 49152, v9
    v_and_b32 v10, 31, v1
    v_lshlrev_b32 v10, 3, v10
    v_add_u32 v10, 49152, v10
    s_lshl_b32 s55, s3, 8
    s_add_u32 s55, s55, 53248
    v_and_b32 v190, 31, v1
    v_lshl_add_u32 v190, v190, 2, s55
    v_lshrrev_b32 v191, 5, v1
    v_lshl_add_u32 v191, v191, 4, s55
    v_mov_b32 v16, 128
Lp_10:
    buffer_load_dword v11, v16, s[8:11], 0 offen sc1
    s_waitcnt vmcnt(0)
    v_cmp_gt_i32 vcc, 1, v11
    s_cbranch_vccz Lpd_11
    s_sleep 8
    s_mov_b32 s54, 16
    s_sub_u32 s52, s52, 1
    s_cbranch_scc1 L_abort
    s_branch Lp_10
Lpd_11:
L_kv_nw:
    s_mov_b32 s60, 0
    s_mov_b32 s61, 0
    s_mul_i32 s66, s3, 10240
    s_barrier
    s_mov_b32 s70, 262144000
    v_mov_b32 v4, -100
    v_mov_b32 v19, 0
L_kv_slow:
    s_add_u32 s57, s60, 1
    v_add_u32 v188, v189, v4
    v_cmp_gt_i32 vcc, s57, v188
    s_cbranch_vccz L_kv_rdy
L_kv_poll:
    buffer_load_dword v11, v3, s[4:7], 0 offen sc1
    s_waitcnt vmcnt(0)
    buffer_store_dword v19, off, s[4:7], s70 sc1
    s_mov_b32 s70, 262144000
    v_add_u32 v188, v189, v11
    v_cmp_gt_i32 vcc, s57, v188
    s_cbranch_vccz L_kv_rdy
    s_sleep 1
    s_mov_b32 s54, 17
    s_sub_u32 s52, s52, 1
    s_cbranch_scc1 L_abort
    s_branch L_kv_poll
L_kv_rdy:
    s_branch L_kv_alt
.p2align 6
L_kv_loop:
    s_waitcnt vmcnt(4)
    s_cmp_eq_u32 s71, 262144000
    s_cbranch_scc1 L_kv_slow
L_kv_go:
    ds_read_b128 v[20:23], v5 offset:0
    ds_read_b128 v[24:27], v5 offset:1024
    ds_read_b128 v[28:31], v5 offset:2048
    ds_read_b128 v[32:35], v5 offset:3072
    ds_read_b128 v[36:39], v5 offset:4096
    ds_read_b128 v[40:43], v5 offset:5120
    ds_read_b128 v[44:47], v5 offset:6144
    ds_read_b128 v[48:51], v5 offset:7168
    ds_read_b128 v[52:55], v5 offset:8192
    ds_read_b128 v[56:59], v5 offset:9216
    s_add_u32 s55, s60, 1
    s_and_b32 s55, s55, 63
    s_cselect_b32 s55, 0, 2621440
    s_sub_u32 s62, s62, s55
    s_add_u32 s62, s62, 40960
    s_xor_b32 s66, s66, 0x10000
    s_add_u32 s57, s60, 2
    s_waitcnt lgkmcnt(9)
    v_mfma_f32_32x32x16_bf16 v[84:99], a[0:3], v[20:23], 0
    v_lshlrev_b32 v16, 16, v20
    v_and_b32 v17, 0xffff0000, v20
    v_mov_b32 v12, v16
    v_mov_b32 v13, v17
    v_mul_f32 v14, v16, v16
    v_mfma_f32_32x32x16_bf16 v[100:115], v[20:23], a[160:163], 0
    v_mul_f32 v15, v17, v17
    v_lshlrev_b32 v164, 16, v21
    v_and_b32 v165, 0xffff0000, v21
    v_add_f32 v12, v12, v164
    v_add_f32 v13, v13, v165
    s_waitcnt lgkmcnt(8)
    v_mfma_f32_32x32x16_bf16 v[84:99], a[4:7], v[24:27], v[84:99]
    v_fmac_f32 v14, v164, v164
    v_fmac_f32 v15, v165, v165
    v_lshlrev_b32 v16, 16, v22
    v_and_b32 v17, 0xffff0000, v22
    v_add_f32 v12, v12, v16
    v_mfma_f32_32x32x16_bf16 v[100:115], v[24:27], a[164:167], v[100:115]
    v_add_f32 v13, v13, v17
    v_fmac_f32 v14, v16, v16
    v_fmac_f32 v15, v17, v17
    v_lshlrev_b32 v164, 16, v23
    v_and_b32 v165, 0xffff0000, v23
    s_waitcnt lgkmcnt(7)
    v_mfma_f32_32x32x16_bf16 v[84:99], a[8:11], v[28:31], v[84:99]
    v_add_f32 v12, v12, v164
    v_add_f32 v13, v13, v165
    v_fmac_f32 v14, v164, v164
    v_fmac_f32 v15, v165, v165
    v_lshlrev_b32 v16, 16, v24
    v_mfma_f32_32x32x16_bf16 v[100:115], v[28:31], a[168:171], v[100:115]
    v_and_b32 v17, 0xffff0000, v24
    v_add_f32 v12, v12, v16
    v_add_f32 v13, v13, v17
    v_fmac_f32 v14, v16, v16
    v_fmac_f32 v15, v17, v17
    s_waitcnt lgkmcnt(6)
    v_mfma_f32_32x32x16_bf16 v[84:99], a[12:15], v[32:35], v[84:99]
    v_lshlrev_b32 v164, 16, v25
    v_and_b32 v165, 0xffff0000, v25
    v_add_f32 v12, v12, v164
    v_add_f32 v13, v13, v165
    v_fmac_f32 v14, v164, v164
    v_mfma_f32_32x32x16_bf16 v[100:115], v[32:35], a[172:175], v[100:115]
    v_fmac_f32 v15, v165, v165
    v_lshlrev_b32 v16, 16, v26
    v_and_b32 v17, 0xffff0000, v26
    v_add_f32 v12, v12, v16
    v_add_f32 v13, v13, v17
    s_waitcnt lgkmcnt(5)
    v_mfma_f32_32x32x16_bf16 v[84:99], a[16:19], v[36:39], v[84:99]
    v_fmac_f32 v14, v16, v16
    v_fmac_f32 v15, v17, v17
    v_lshlrev_b32 v164, 16, v27
    v_and_b32 v165, 0xffff0000, v27
    v_add_f32 v12, v12, v164
    v_mfma_f32_32x32x16_bf16 v[100:115], v[36:39], a[176:179], v[100:115]
    v_add_f32 v13, v13, v165
    v_fmac_f32 v14, v164, v164
    v_fmac_f32 v15, v165, v165
    v_lshlrev_b32 v16, 16, v28
    v_and_b32 v17, 0xffff0000, v28
    s_waitcnt lgkmcnt(4)
    v_mfma_f32_32x32x16_bf16 v[84:99], a[20:23], v[40:43], v[84:99]
    s_barrier
    ds_read_b128 v[60:63], v6 offset:0
    v_add_f32 v12, v12, v16
    v_add_f32 v13, v13, v17
    v_fmac_f32 v14, v16, v16
    v_fmac_f32 v15, v17, v17
    v_lshlrev_b32 v164, 16, v29
    v_mfma_f32_32x32x16_bf16 v[100:115], v[40:43], a[180:183], v[100:115]
    v_and_b32 v165, 0xffff0000, v29
    v_add_f32 v12, v12, v164
    v_add_f32 v13, v13, v165
    v_fmac_f32 v14, v164, v164
    v_fmac_f32 v15, v165, v165
    s_waitcnt lgkmcnt(4)
    v_mfma_f32_32x32x16_bf16 v[84:99], a[24:27], v[44:47], v[84:99]
    ds_read_b128 v[64:67], v6 offset:1024
    v_lshlrev_b32 v16, 16, v30
    v_and_b32 v17, 0xffff0000, v30
    v_add_f32 v12, v12, v16
    v_add_f32 v13, v13, v17
    v_fmac_f32 v14, v16, v16
    v_mfma_f32_32x32x16_bf16 v[100:115], v[44:47], a[184:187], v[100:115]
    v_fmac_f32 v15, v17, v17
    v_lshlrev_b32 v164, 16, v31
    v_and_b32 v165, 0xffff0000, v31
    v_add_f32 v12, v12, v164
    v_add_f32 v13, v13, v165
    s_waitcnt lgkmcnt(4)
    v_mfma_f32_32x32x16_bf16 v[84:99], a[28:31], v[48:51], v[84:99]
    ds_read_b128 v[68:71], v6 offset:2048
    v_fmac_f32 v14, v164, v164
    v_fmac_f32 v15, v165, v165
    v_lshlrev_b32 v16, 16, v32
    v_and_b32 v17, 0xffff0000, v32
    v_add_f32 v12, v12, v16
    v_mfma_f32_32x32x16_bf16 v[100:115], v[48:51], a[188:191], v[100:115]
    v_add_f32 v13, v13, v17
    v_fmac_f32 v14, v16, v16
    v_fmac_f32 v15, v17, v17
    v_lshlrev_b32 v164, 16, v33
    v_and_b32 v165, 0xffff0000, v33
    s_waitcnt lgkmcnt(4)
    v_mfma_f32_32x32x16_bf16 v[84:99], a[32:35], v[52:55], v[84:99]
    ds_read_b128 v[72:75], v6 offset:3072
    v_add_f32 v12, v12, v164
    v_add_f32 v13, v13, v165
    v_fmac_f32 v14, v164, v164
    v_fmac_f32 v15, v165, v165
    v_lshlrev_b32 v16, 16, v34
    v_mfma_f32_32x32x16_bf16 v[100:115], v[52:55], a[192:195], v[100:115]
    v_and_b32 v17, 0xffff0000, v34
    v_add_f32 v12, v12, v16
    v_add_f32 v13, v13, v17
    v_fmac_f32 v14, v16, v16
    v_fmac_f32 v15, v17, v17
    s_waitcnt lgkmcnt(4)
    v_mfma_f32_32x32x16_bf16 v[84:99], a[36:39], v[56:59], v[84:99]
    ds_read_b128 v[76:79], v6 offset:4096
    v_lshlrev_b32 v164, 16, v35
    v_and_b32 v165, 0xffff0000, v35
    v_add_f32 v12, v12, v164
    v_add_f32 v13, v13, v165
    v_fmac_f32 v14, v164, v164
    v_mfma_f32_32x32x16_bf16 v[100:115], v[56:59], a[196:199], v[100:115]
    v_fmac_f32 v15, v165, v165
    v_lshlrev_b32 v16, 16, v36
    v_and_b32 v17, 0xffff0000, v36
    v_add_f32 v12, v12, v16
    v_add_f32 v13, v13, v17
L_kv_join:
    s_waitcnt lgkmcnt(4)
    v_mfma_f32_32x32x16_bf16 v[84:99], a[40:43], v[60:63], v[84:99]
    ds_read_b128 v[80:83], v6 offset:5120
    v_fmac_f32 v14, v16, v16
    v_fmac_f32 v15, v17, v17
    v_lshlrev_b32 v164, 16, v37
    v_and_b32 v165, 0xffff0000, v37
    v_add_f32 v12, v12, v164
    v_mfma_f32_32x32x16_bf16 v[100:115], v[60:63], a[200:203], v[100:115]
    v_add_f32 v13, v13, v165
    v_fmac_f32 v14, v164, v164
    v_fmac_f32 v15, v165, v165
    v_lshlrev_b32 v16, 16, v38
    v_and_b32 v17, 0xffff0000, v38
    s_waitcnt lgkmcnt(4)
    v_mfma_f32_32x32x16_bf16 v[84:99], a[44:47], v[64:67], v[84:99]
    ds_read_b128 v[60:63], v6 offset:6144
    v_add_f32 v12, v12, v16
    v_add_f32 v13, v13, v17
    v_fmac_f32 v14, v16, v16
    v_fmac_f32 v15, v17, v17
    v_lshlrev_b32 v164, 16, v39
    v_mfma_f32_32x32x16_bf16 v[100:115], v[64:67], a[204:207], v[100:115]
    v_and_b32 v165, 0xffff0000, v39
    v_add_f32 v12, v12, v164
    v_add_f32 v13, v13, v165
    v_fmac_f32 v14, v164, v164
    v_fmac_f32 v15, v165, v165
    s_waitcnt lgkmcnt(4)
    v_mfma_f32_32x32x16_bf16 v[84:99], a[48:51], v[68:71], v[84:99]
    ds_read_b128 v[64:67], v6 offset:7168
    v_lshlrev_b32 v16, 16, v40
    v_and_b32 v17, 0xffff0000, v40
    v_add_f32 v12, v12, v16
    v_add_f32 v13, v13, v17
    v_fmac_f32 v14, v16, v16
    v_mfma_f32_32x32x16_bf16 v[100:115], v[68:71], a[208:211], v[100:115]
    v_fmac_f32 v15, v17, v17
    v_lshlrev_b32 v164, 16, v41
    v_and_b32 v165, 0xffff0000, v41
    v_add_f32 v12, v12, v164
    v_add_f32 v13, v13, v165
    s_waitcnt lgkmcnt(4)
    v_mfma_f32_32x32x16_bf16 v[84:99], a[52:55], v[72:75], v[84:99]
    ds_read_b128 v[68:71], v6 offset:8192
    v_fmac_f32 v14, v164, v164
    v_fmac_f32 v15, v165, v165
    v_lshlrev_b32 v16, 16, v42
    v_and_b32 v17, 0xffff0000, v42
    v_add_f32 v12, v12, v16
    v_mfma_f32_32x32x16_bf16 v[100:115], v[72:75], a[212:215], v[100:115]
    s_waitcnt vmcnt(0)
    buffer_store_dword v19, off, s[4:7], s70 sc1
    s_mov_b32 s70, 262144000
    v_add_f32 v13, v13, v17
    v_fmac_f32 v14, v16, v16
    v_fmac_f32 v15, v17, v17
    s_waitcnt lgkmcnt(4)
    v_mfma_f32_32x32x16_bf16 v[84:99], a[56:59], v[76:79], v[84:99]
    ds_read_b128 v[72:75], v6 offset:9216
    v_lshlrev_b32 v164, 16, v43
    v_and_b32 v165, 0xffff0000, v43
    v_add_f32 v12, v12, v164
    v_add_f32 v13, v13, v165
    v_fmac_f32 v14, v164, v164
    v_mfma_f32_32x32x16_bf16 v[100:115], v[76:79], a[216:219], v[100:115]
    v_fmac_f32 v15, v165, v165
    v_lshlrev_b32 v16, 16, v44
    v_and_b32 v17, 0xffff0000, v44
    v_add_f32 v12, v12, v16
    v_add_f32 v13, v13, v17
    s_waitcnt lgkmcnt(4)
    v_mfma_f32_32x32x16_bf16 v[84:99], a[60:63], v[80:83], v[84:99]
    ds_read_b128 v[76:79], v7 offset:0
    v_fmac_f32 v14, v16, v16
    v_fmac_f32 v15, v17, v17
    v_lshlrev_b32 v164, 16, v45
    v_and_b32 v165, 0xffff0000, v45
    v_add_f32 v12, v12, v164
    v_mfma_f32_32x32x16_bf16 v[100:115], v[80:83], a[220:223], v[100:115]
    v_add_f32 v13, v13, v165
    v_fmac_f32 v14, v164, v164
    v_fmac_f32 v15, v165, v165
    v_lshlrev_b32 v16, 16, v46
    v_and_b32 v17, 0xffff0000, v46
    s_waitcnt lgkmcnt(4)
    v_mfma_f32_32x32x16_bf16 v[84:99], a[64:67], v[60:63], v[84:99]
    ds_read_b128 v[80:83], v7 offset:1024
    v_add_f32 v12, v12, v16
    v_add_f32 v13, v13, v17
    v_fmac_f32 v14, v16, v16
    v_fmac_f32 v15, v17, v17
    v_lshlrev_b32 v164, 16, v47
    v_mfma_f32_32x32x16_bf16 v[100:115], v[60:63], a[224:227], v[100:115]
    v_and_b32 v165, 0xffff0000, v47
    v_add_f32 v12, v12, v164
    v_add_f32 v13, v13, v165
    v_fmac_f32 v14, v164, v164
    v_fmac_f32 v15, v165, v165
    s_waitcnt lgkmcnt(4)
    v_mfma_f32_32x32x16_bf16 v[84:99], a[68:71], v[64:67], v[84:99]
    ds_read_b128 v[60:63], v7 offset:2048
    v_lshlrev_b32 v16, 16, v48
    v_and_b32 v17, 0xffff0000, v48
    v_add_f32 v12, v12, v16
    v_add_f32 v13, v13, v17
    v_fmac_f32 v14, v16, v16
    v_mfma_f32_32x32x16_bf16 v[100:115], v[64:67], a[228:231], v[100:115]
    buffer_load_dword v11, v3, s[4:7], 0 offen sc1
    v_fmac_f32 v15, v17, v17
    v_lshlrev_b32 v164, 16, v49
    v_and_b32 v165, 0xffff0000, v49
    s_waitcnt lgkmcnt(4)
    v_mfma_f32_32x32x16_bf16 v[84:99], a[72:75], v[68:71], v[84:99]
    ds_read_b128 v[64:67], v7 offset:3072
    v_add_f32 v12, v12, v164
    v_add_f32 v13, v13, v165
    v_fmac_f32 v14, v164, v164
    v_fmac_f32 v15, v165, v165
    v_lshlrev_b32 v16, 16, v50
    v_mfma_f32_32x32x16_bf16 v[100:115], v[68:71], a[232:235], v[100:115]
    v_and_b32 v17, 0xffff0000, v50
    v_add_f32 v12, v12, v16
    v_add_f32 v13, v13, v17
    v_fmac_f32 v14, v16, v16
    v_fmac_f32 v15, v17, v17
    s_waitcnt lgkmcnt(4)
    v_mfma_f32_32x32x16_bf16 v[84:99], a[76:79], v[72:75], v[84:99]
    ds_read_b128 v[68:71], v7 offset:4096
    v_lshlrev_b32 v164, 16, v51
    v_and_b32 v165, 0xffff0000, v51
    v_add_f32 v12, v12, v164
    v_add_f32 v13, v13, v165
    v_fmac_f32 v14, v164, v164
    v_mfma_f32_32x32x16_bf16 v[100:115], v[72:75], a[236:239], v[100:115]
    v_fmac_f32 v15, v165, v165
    v_lshlrev_b32 v16, 16, v52
    v_and_b32 v17, 0xffff0000, v52
    v_add_f32 v12, v12, v16
    v_add_f32 v13, v13, v17
    s_waitcnt lgkmcnt(4)
    v_mfma_f32_32x32x16_bf16 v[84:99], a[80:83], v[76:79], v[84:99]
    ds_read_b128 v[72:75], v7 offset:5120
    v_fmac_f32 v14, v16, v16
    v_fmac_f32 v15, v17, v17
    v_lshlrev_b32 v164, 16, v53
    v_and_b32 v165, 0xffff0000, v53
    v_add_f32 v12, v12, v164
    v_mfma_f32_32x32x16_bf16 v[100:115], v[76:79], a[240:243], v[100:115]
    v_add_f32 v13, v13, v165
    v_fmac_f32 v14, v164, v164
    v_fmac_f32 v15, v165, v165
    v_lshlrev_b32 v16, 16, v54
    v_and_b32 v17, 0xffff0000, v54
    s_waitcnt lgkmcnt(4)
    v_mfma_f32_32x32x16_bf16 v[84:99], a[84:87], v[80:83], v[84:99]
    ds_read_b128 v[76:79], v7 offset:6144
    v_add_f32 v12, v12, v16
    v_add_f32 v13, v13, v17
    v_fmac_f32 v14, v16, v16
    v_fmac_f32 v15, v17, v17
    v_lshlrev_b32 v164, 16, v55
    v_mfma_f32_32x32x16_bf16 v[100:115], v[80:83], a[244:247], v[100:115]
    v_and_b32 v165, 0xffff0000, v55
    v_add_f32 v12, v12, v164
    v_add_f32 v13, v13, v165
    v_fmac_f32 v14, v164, v164
    v_fmac_f32 v15, v165, v165
    s_waitcnt lgkmcnt(4)
    v_mfma_f32_32x32x16_bf16 v[84:99], a[88:91], v[60:63], v[84:99]
    ds_read_b128 v[80:83], v7 offset:7168
    v_lshlrev_b32 v16, 16, v56
    v_and_b32 v17, 0xffff0000, v56
    v_add_f32 v12, v12, v16
    v_add_f32 v13, v13, v17
    v_fmac_f32 v14, v16, v16
    v_mfma_f32_32x32x16_bf16 v[100:115], v[60:63], a[248:251], v[100:115]
    v_fmac_f32 v15, v17, v17
    v_lshlrev_b32 v164, 16, v57
    v_and_b32 v165, 0xffff0000, v57
    v_add_f32 v12, v12, v164
    v_add_f32 v13, v13, v165
    s_waitcnt lgkmcnt(4)
    v_mfma_f32_32x32x16_bf16 v[84:99], a[92:95], v[64:67], v[84:99]
    ds_read_b128 v[60:63], v7 offset:8192
    v_fmac_f32 v14, v164, v164
    v_fmac_f32 v15, v165, v165
    v_lshlrev_b32 v16, 16, v58
    v_and_b32 v17, 0xffff0000, v58
    v_add_f32 v12, v12, v16
    v_mfma_f32_32x32x16_bf16 v[100:115], v[64:67], a[252:255], v[100:115]
    v_add_f32 v13, v13, v17
    v_fmac_f32 v14, v16, v16
    v_fmac_f32 v15, v17, v17
    v_lshlrev_b32 v164, 16, v59
    v_and_b32 v165, 0xffff0000, v59
    s_waitcnt lgkmcnt(4)
    v_mfma_f32_32x32x16_bf16 v[84:99], a[96:99], v[68:71], v[84:99]
    ds_read_b128 v[64:67], v7 offset:9216
    v_add_f32 v12, v12, v164
    v_add_f32 v13, v13, v165
    v_fmac_f32 v14, v164, v164
    v_fmac_f32 v15, v165, v165
    v_add_f32 v12, v12, v13
    v_mfma_f32_32x32x16_bf16 v[100:115], v[68:71], v[192:195], v[100:115]
    v_add_f32 v13, v14, v15
    ds_write_b64 v9, v[12:13]
    s_waitcnt lgkmcnt(5)
    v_mfma_f32_32x32x16_bf16 v[84:99], a[100:103], v[72:75], v[84:99]
    ds_read_b128 v[68:71], v8 offset:0
    v_mfma_f32_32x32x16_bf16 v[100:115], v[72:75], v[196:199], v[100:115]
    s_waitcnt lgkmcnt(1)
    s_barrier
    ds_read_b64 v[148:149], v10 offset:0
    ds_read_b64 v[150:151], v10 offset:256
    ds_read_b64 v[152:153], v10 offset:512
    ds_read_b64 v[154:155], v10 offset:768
    ds_read_b64 v[156:157], v10 offset:1024
    ds_read_b64 v[158:159], v10 offset:1280
    ds_read_b64 v[160:161], v10 offset:1536
    ds_read_b64 v[162:163], v10 offset:1792
    v_mfma_f32_32x32x16_bf16 v[84:99], a[104:107], v[76:79], v[84:99]
    ds_read_b128 v[72:75], v8 offset:1024
    v_mfma_f32_32x32x16_bf16 v[100:115], v[76:79], v[200:203], v[100:115]
    v_mfma_f32_32x32x16_bf16 v[84:99], a[108:111], v[80:83], v[84:99]
    ds_read_b128 v[76:79], v8 offset:2048
    s_waitcnt lgkmcnt(2)
    v_add_f32 v148, v148, v156
    v_add_f32 v149, v149, v157
    v_add_f32 v150, v150, v158
    v_add_f32 v151, v151, v159
    v_mfma_f32_32x32x16_bf16 v[100:115], v[80:83], v[204:207], v[100:115]
    v_add_f32 v152, v152, v160
    v_add_f32 v153, v153, v161
    v_add_f32 v154, v154, v162
    v_add_f32 v155, v155, v163
    v_add_f32 v148, v148, v152
    v_mfma_f32_32x32x16_bf16 v[84:99], a[112:115], v[60:63], v[84:99]
    ds_read_b128 v[80:83], v8 offset:3072
    s_waitcnt vmcnt(0)
    v_add_u32 v188, v189, v11
    v_cmp_gt_i32 vcc, s57, v188
    v_add_f32 v149, v149, v153
    v_add_f32 v150, v150, v154
    v_add_f32 v151, v151, v155
    v_mfma_f32_32x32x16_bf16 v[84:99], a[116:119], v[64:67], v[84:99]
    ds_read_b128 v[60:63], v8 offset:4096
    s_cmp_eq_u64 vcc, 0
    s_cselect_b32 s71, s62, 262144000
    buffer_load_dword v11, v3, s[4:7], 0 offen sc1
    v_add_f32 v148, v148, v150
    v_add_f32 v149, v149, v151
    v_mul_f32 v180, 0.0015625, v148
    v_mfma_f32_32x32x16_bf16 v[84:99], a[120:123], v[68:71], v[84:99]
    ds_read_b128 v[64:67], v8 offset:5120
    v_mul_f32 v181, 0.0015625, v149
    v_fma_f32 v181, -v180, v180, v181
    v_max_f32 v181, 0, v181
    v_cvt_pk_bf16_f32 v181, v181, v181
    v_and_b32 v181, 0xffff0000, v181
    s_waitcnt lgkmcnt(4)
    v_mfma_f32_32x32x16_bf16 v[84:99], a[124:127], v[72:75], v[84:99]
    ds_read_b128 v[68:71], v8 offset:6144
    s_mov_b32 m0, s66
    s_mov_b32 s56, s71
    buffer_load_dwordx4 v2, s[4:7], s56 offen offset:0 sc1 lds
    v_add_f32 v181, 0x3727c5ac, v181
    v_cvt_pk_bf16_f32 v181, v181, v181
    v_and_b32 v181, 0xffff0000, v181
    s_waitcnt lgkmcnt(4)
    v_mfma_f32_32x32x16_bf16 v[84:99], a[128:131], v[76:79], v[84:99]
    ds_read_b128 v[72:75], v8 offset:7168
    v_sqrt_f32 v16, v181
    v_cvt_pk_bf16_f32 v180, v180, v180
    v_and_b32 v180, 0xffff0000, v180
    v_cvt_pk_bf16_f32 v16, v16, v16
    s_waitcnt lgkmcnt(4)
    v_mfma_f32_32x32x16_bf16 v[84:99], a[132:135], v[80:83], v[84:99]
    ds_read_b128 v[76:79], v8 offset:8192
    buffer_load_dwordx4 v2, s[4:7], s56 offen offset:1024 sc1 lds
    v_and_b32 v16, 0xffff0000, v16
    v_rcp_f32 v181, v16
    s_waitcnt lgkmcnt(4)
    v_mfma_f32_32x32x16_bf16 v[84:99], a[136:139], v[60:63], v[84:99]
    ds_read_b128 v[80:83], v8 offset:9216
    ds_write_b32 v190, v180
    ds_write_b32 v190, v181 offset:128
    s_waitcnt lgkmcnt(6)
    v_mfma_f32_32x32x16_bf16 v[84:99], a[140:143], v[64:67], v[84:99]
    ds_read_b128 v[60:63], v7 offset:8192
    buffer_load_dwordx4 v2, s[4:7], s56 offen offset:2048 sc1 lds
    s_waitcnt lgkmcnt(6)
    v_mfma_f32_32x32x16_bf16 v[84:99], a[144:147], v[68:71], v[84:99]
    ds_read_b128 v[64:67], v7 offset:9216
    s_waitcnt lgkmcnt(2)
    ds_read_b128 v[148:151], v191 offset:0
    ds_read_b128 v[164:167], v191 offset:128
    ds_read_b128 v[152:155], v191 offset:32
    ds_read_b128 v[168:171], v191 offset:160
    ds_read_b128 v[156:159], v191 offset:64
    ds_read_b128 v[172:175], v191 offset:192
    ds_read_b128 v[160:163], v191 offset:96
    ds_read_b128 v[176:179], v191 offset:224
    v_mfma_f32_32x32x16_bf16 v[84:99], a[148:151], v[72:75], v[84:99]
    ds_read_b128 v[68:71], v8 offset:0
    buffer_load_dwordx4 v2, s[4:7], s56 offen offset:3072 sc1 lds
    v_mfma_f32_32x32x16_bf16 v[84:99], a[152:155], v[76:79], v[84:99]
    ds_read_b128 v[72:75], v8 offset:1024
    v_mfma_f32_32x32x16_bf16 v[84:99], a[156:159], v[80:83], v[84:99]
    ds_read_b128 v[76:79], v8 offset:2048
    s_add_u32 m0, m0, 4096
    s_add_u32 s56, s56, 4096
    buffer_load_dwordx4 v2, s[4:7], s56 offen offset:0 sc1 lds
    s_waitcnt lgkmcnt(12)
    v_mfma_f32_32x32x16_bf16 v[100:115], v[60:63], v[208:211], v[100:115]
    ds_read_b128 v[80:83], v8 offset:3072
    s_waitcnt lgkmcnt(12)
    v_mfma_f32_32x32x16_bf16 v[100:115], v[64:67], v[212:215], v[100:115]
    ds_read_b128 v[60:63], v8 offset:4096
    buffer_load_dwordx4 v2, s[4:7], s56 offen offset:1024 sc1 lds
    s_nop 0
    v_fma_f32 v84, -v180, v116, v84
    v_fma_f32 v85, -v180, v117, v85
    v_fma_f32 v86, -v180, v118, v86
    s_waitcnt lgkmcnt(4)
    v_mfma_f32_32x32x16_bf16 v[100:115], v[68:71], v[216:219], v[100:115]
    ds_read_b128 v[64:67], v8 offset:5120
    v_fma_f32 v87, -v180, v119, v87
    v_fma_f32 v88, -v180, v120, v88
    v_fma_f32 v89, -v180, v121, v89
    v_fma_f32 v90, -v180, v122, v90
    v_fma_f32 v91, -v180, v123, v91
    s_waitcnt lgkmcnt(4)
    v_mfma_f32_32x32x16_bf16 v[100:115], v[72:75], v[220:223], v[100:115]
    ds_read_b128 v[68:71], v8 offset:6144
    buffer_load_dwordx4 v2, s[4:7], s56 offen offset:2048 sc1 lds
    v_fma_f32 v92, -v180, v124, v92
    v_fma_f32 v93, -v180, v125, v93
    v_fma_f32 v94, -v180, v126, v94
    s_waitcnt lgkmcnt(4)
    v_mfma_f32_32x32x16_bf16 v[100:115], v[76:79], v[224:227], v[100:115]
    ds_read_b128 v[72:75], v8 offset:7168
    v_fma_f32 v95, -v180, v127, v95
    v_fma_f32 v96, -v180, v128, v96
    v_fma_f32 v97, -v180, v129, v97
    v_fma_f32 v98, -v180, v130, v98
    v_fma_f32 v99, -v180, v131, v99
    s_waitcnt lgkmcnt(4)
    v_mfma_f32_32x32x16_bf16 v[100:115], v[80:83], v[228:231], v[100:115]
    ds_read_b128 v[76:79], v8 offset:8192
    buffer_load_dwordx4 v2, s[4:7], s56 offen offset:3072 sc1 lds
    v_mul_f32 v84, v181, v84
    v_mul_f32 v85, v181, v85
    v_mul_f32 v86, v181, v86
    s_waitcnt lgkmcnt(4)
    v_mfma_f32_32x32x16_bf16 v[100:115], v[60:63], v[232:235], v[100:115]
    ds_read_b128 v[80:83], v8 offset:9216
    v_mul_f32 v87, v181, v87
    v_mul_f32 v88, v181, v88
    v_mul_f32 v89, v181, v89
    v_mul_f32 v90, v181, v90
    v_mul_f32 v91, v181, v91
    s_waitcnt lgkmcnt(4)
    v_mfma_f32_32x32x16_bf16 v[100:115], v[64:67], v[236:239], v[100:115]
    s_add_u32 m0, m0, 4096
    s_add_u32 s56, s56, 4096
    buffer_load_dwordx4 v2, s[4:7], s56 offen offset:0 sc1 lds
    v_mul_f32 v92, v181, v92
    v_mul_f32 v93, v181, v93
    v_mul_f32 v94, v181, v94
    s_waitcnt lgkmcnt(3)
    v_mfma_f32_32x32x16_bf16 v[100:115], v[68:71], v[240:243], v[100:115]
    v_mul_f32 v95, v181, v95
    v_mul_f32 v96, v181, v96
    v_mul_f32 v97, v181, v97
    v_mul_f32 v98, v181, v98
    v_mul_f32 v99, v181, v99
    s_waitcnt lgkmcnt(2)
    v_mfma_f32_32x32x16_bf16 v[100:115], v[72:75], v[244:247], v[100:115]
    buffer_load_dwordx4 v2, s[4:7], s56 offen offset:1024 sc1 lds
    v_cvt_pk_bf16_f32 v20, v84, v92
    v_cvt_pk_bf16_f32 v21, v85, v93
    v_cvt_pk_bf16_f32 v22, v86, v94
    s_waitcnt lgkmcnt(1)
    v_mfma_f32_32x32x16_bf16 v[100:115], v[76:79], v[248:251], v[100:115]
    v_cvt_pk_bf16_f32 v23, v87, v95
    v_cvt_pk_bf16_f32 v24, v88, v96
    v_cvt_pk_bf16_f32 v25, v89, v97
    v_cvt_pk_bf16_f32 v26, v90, v98
    v_cvt_pk_bf16_f32 v27, v91, v99
    s_waitcnt lgkmcnt(0)
    v_mfma_f32_32x32x16_bf16 v[100:115], v[80:83], v[252:255], v[100:115]
    v_xor_b32 v9, 2048, v9
    v_xor_b32 v10, 2048, v10
    v_xor_b32 v5, 0x10000, v5
    v_xor_b32 v6, 0x10000, v6
    v_xor_b32 v7, 0x10000, v7
    v_xor_b32 v8, 0x10000, v8
    s_add_u32 s64, s63, 8192
    s_add_u32 s60, s60, 1
    v_mov_b32 v19, s60
    s_mov_b32 s70, s65
    s_cmp_lg_u32 s71, 262144000
    s_cbranch_scc1 L_kv_c2
    s_waitcnt vmcnt(10)
    v_add_u32 v188, v189, v11
    v_cmp_gt_i32 vcc, s57, v188
    s_cbranch_vccnz L_kv_c2
    s_mov_b32 s71, s62
    s_mov_b32 m0, s66
    s_mov_b32 s56, s62
    buffer_load_dwordx4 v2, s[4:7], s56 offen offset:0 sc1 lds
    buffer_load_dwordx4 v2, s[4:7], s56 offen offset:1024 sc1 lds
    buffer_load_dwordx4 v2, s[4:7], s56 offen offset:2048 sc1 lds
    buffer_load_dwordx4 v2, s[4:7], s56 offen offset:3072 sc1 lds
    s_add_u32 m0, m0, 4096
    s_add_u32 s56, s56, 4096
    buffer_load_dwordx4 v2, s[4:7], s56 offen offset:0 sc1 lds
    buffer_load_dwordx4 v2, s[4:7], s56 offen offset:1024 sc1 lds
    buffer_load_dwordx4 v2, s[4:7], s56 offen offset:2048 sc1 lds
    buffer_load_dwordx4 v2, s[4:7], s56 offen offset:3072 sc1 lds
    s_add_u32 m0, m0, 4096
    s_add_u32 s56, s56, 4096
    buffer_load_dwordx4 v2, s[4:7], s56 offen offset:0 sc1 lds
    buffer_load_dwordx4 v2, s[4:7], s56 offen offset:1024 sc1 lds
L_kv_c2:
    buffer_load_dword v4, v3, s[4:7], 0 offen sc1
    buffer_store_dwordx4 v[20:23], v2, s[4:7], s63 offen offset:0 sc1
    buffer_store_dwordx4 v[24:27], v2, s[4:7], s63 offen offset:1024 sc1
    v_pk_fma_f32 v[100:101], v[148:149], v[132:133], v[100:101] neg_lo:[1,0,0] neg_hi:[1,0,0]
    v_pk_fma_f32 v[102:103], v[150:151], v[132:133], v[102:103] neg_lo:[1,0,0] neg_hi:[1,0,0]
    v_pk_fma_f32 v[104:105], v[152:153], v[132:133], v[104:105] neg_lo:[1,0,0] neg_hi:[1,0,0]
    v_pk_fma_f32 v[106:107], v[154:155], v[132:133], v[106:107] neg_lo:[1,0,0] neg_hi:[1,0,0]
    v_pk_fma_f32 v[108:109], v[156:157], v[132:133], v[108:109] neg_lo:[1,0,0] neg_hi:[1,0,0]
    v_pk_fma_f32 v[110:111], v[158:159], v[132:133], v[110:111] neg_lo:[1,0,0] neg_hi:[1,0,0]
    v_pk_fma_f32 v[112:113], v[160:161], v[132:133], v[112:113] neg_lo:[1,0,0] neg_hi:[1,0,0]
    v_pk_fma_f32 v[114:115], v[162:163], v[132:133], v[114:115] neg_lo:[1,0,0] neg_hi:[1,0,0]
    v_pk_mul_f32 v[100:101], v[164:165], v[100:101]
    v_pk_mul_f32 v[102:103], v[166:167], v[102:103]
    v_pk_mul_f32 v[104:105], v[168:169], v[104:105]
    v_pk_mul_f32 v[106:107], v[170:171], v[106:107]
    v_pk_mul_f32 v[108:109], v[172:173], v[108:109]
    v_pk_mul_f32 v[110:111], v[174:175], v[110:111]
    v_pk_mul_f32 v[112:113], v[176:177], v[112:113]
    v_pk_mul_f32 v[114:115], v[178:179], v[114:115]
    v_cvt_pk_bf16_f32 v60, v100, v101
    v_cvt_pk_bf16_f32 v61, v102, v103
    v_cvt_pk_bf16_f32 v62, v108, v109
    v_cvt_pk_bf16_f32 v63, v110, v111
    buffer_store_dwordx4 v[60:63], v2, s[4:7], s64 offen offset:0 sc1
    v_cvt_pk_bf16_f32 v64, v104, v105
    v_cvt_pk_bf16_f32 v65, v106, v107
    v_cvt_pk_bf16_f32 v66, v112, v113
    v_cvt_pk_bf16_f32 v67, v114, v115
    buffer_store_dwordx4 v[64:67], v2, s[4:7], s64 offen offset:1024 sc1
    s_add_u32 s55, s60, 0
    s_and_b32 s55, s55, 63
    s_cselect_b32 s55, 0, 33554432
    s_sub_u32 s63, s63, s55
    s_add_u32 s63, s63, 524288
    s_cmp_lt_u32 s60, 64
    s_cbranch_scc1 L_kv_loop
    s_waitcnt vmcnt(0)
    buffer_store_dword v19, off, s[4:7], s70 sc1
    s_mov_b32 s70, 262144000
    s_endpgm
L_kv_alt:
    s_mov_b32 m0, s66
    s_mov_b32 s56, s62
    buffer_load_dwordx4 v2, s[4:7], s56 offen offset:0 sc1 lds
    buffer_load_dwordx4 v2, s[4:7], s56 offen offset:1024 sc1 lds
    buffer_load_dwordx4 v2, s[4:7], s56 offen offset:2048 sc1 lds
    buffer_load_dwordx4 v2, s[4:7], s56 offen offset:3072 sc1 lds
    s_add_u32 m0, m0, 4096
    s_add_u32 s56, s56, 4096
    buffer_load_dwordx4 v2, s[4:7], s56 offen offset:0 sc1 lds
    s_waitcnt vmcnt(4)
    ds_read_b128 v[20:23], v5 offset:0
    buffer_load_dwordx4 v2, s[4:7], s56 offen offset:1024 sc1 lds
    s_waitcnt vmcnt(4)
    ds_read_b128 v[24:27], v5 offset:1024
    s_waitcnt lgkmcnt(1)
    v_mfma_f32_32x32x16_bf16 v[84:99], a[0:3], v[20:23], 0
    buffer_load_dwordx4 v2, s[4:7], s56 offen offset:2048 sc1 lds
    v_lshlrev_b32 v16, 16, v20
    v_and_b32 v17, 0xffff0000, v20
    v_mov_b32 v12, v16
    v_mov_b32 v13, v17
    v_mul_f32 v14, v16, v16
    v_mfma_f32_32x32x16_bf16 v[100:115], v[20:23], a[160:163], 0
    s_waitcnt vmcnt(4)
    ds_read_b128 v[28:31], v5 offset:2048
    v_mul_f32 v15, v17, v17
    v_lshlrev_b32 v164, 16, v21
    v_and_b32 v165, 0xffff0000, v21
    v_add_f32 v12, v12, v164
    v_add_f32 v13, v13, v165
    s_waitcnt lgkmcnt(1)
    v_mfma_f32_32x32x16_bf16 v[84:99], a[4:7], v[24:27], v[84:99]
    buffer_load_dwordx4 v2, s[4:7], s56 offen offset:3072 sc1 lds
    v_fmac_f32 v14, v164, v164
    v_fmac_f32 v15, v165, v165
    v_lshlrev_b32 v16, 16, v22
    v_and_b32 v17, 0xffff0000, v22
    v_add_f32 v12, v12, v16
    v_mfma_f32_32x32x16_bf16 v[100:115], v[24:27], a[164:167], v[100:115]
    s_waitcnt vmcnt(4)
    ds_read_b128 v[32:35], v5 offset:3072
    v_add_f32 v13, v13, v17
    v_fmac_f32 v14, v16, v16
    v_fmac_f32 v15, v17, v17
    v_lshlrev_b32 v164, 16, v23
    v_and_b32 v165, 0xffff0000, v23
    s_waitcnt lgkmcnt(1)
    v_mfma_f32_32x32x16_bf16 v[84:99], a[8:11], v[28:31], v[84:99]
    s_add_u32 m0, m0, 4096
    s_add_u32 s56, s56, 4096
    buffer_load_dwordx4 v2, s[4:7], s56 offen offset:0 sc1 lds
    v_add_f32 v12, v12, v164
    v_add_f32 v13, v13, v165
    v_fmac_f32 v14, v164, v164
    v_fmac_f32 v15, v165, v165
    v_lshlrev_b32 v16, 16, v24
    v_mfma_f32_32x32x16_bf16 v[100:115], v[28:31], a[168:171], v[100:115]
    s_waitcnt vmcnt(4)
    ds_read_b128 v[36:39], v5 offset:4096
    v_and_b32 v17, 0xffff0000, v24
    v_add_f32 v12, v12, v16
    v_add_f32 v13, v13, v17
    v_fmac_f32 v14, v16, v16
    v_fmac_f32 v15, v17, v17
    s_waitcnt lgkmcnt(1)
    v_mfma_f32_32x32x16_bf16 v[84:99], a[12:15], v[32:35], v[84:99]
    buffer_load_dwordx4 v2, s[4:7], s56 offen offset:1024 sc1 lds
    v_lshlrev_b32 v164, 16, v25
    v_and_b32 v165, 0xffff0000, v25
    v_add_f32 v12, v12, v164
    v_add_f32 v13, v13, v165
    v_fmac_f32 v14, v164, v164
    v_mfma_f32_32x32x16_bf16 v[100:115], v[32:35], a[172:175], v[100:115]
    s_waitcnt vmcnt(4)
    ds_read_b128 v[40:43], v5 offset:5120
    v_fmac_f32 v15, v165, v165
    v_lshlrev_b32 v16, 16, v26
    v_and_b32 v17, 0xffff0000, v26
    v_add_f32 v12, v12, v16
    v_add_f32 v13, v13, v17
    s_waitcnt lgkmcnt(1)
    v_mfma_f32_32x32x16_bf16 v[84:99], a[16:19], v[36:39], v[84:99]
    s_add_u32 s55, s60, 1
    s_and_b32 s55, s55, 63
    s_cselect_b32 s55, 0, 2621440
    s_sub_u32 s62, s62, s55
    s_add_u32 s62, s62, 40960
    s_xor_b32 s66, s66, 0x10000
    s_add_u32 s57, s60, 2
    v_fmac_f32 v14, v16, v16
    v_fmac_f32 v15, v17, v17
    v_lshlrev_b32 v164, 16, v27
    v_and_b32 v165, 0xffff0000, v27
    v_add_f32 v12, v12, v164
    v_mfma_f32_32x32x16_bf16 v[100:115], v[36:39], a[176:179], v[100:115]
    s_waitcnt vmcnt(3)
    ds_read_b128 v[44:47], v5 offset:6144
    v_add_f32 v13, v13, v165
    v_fmac_f32 v14, v164, v164
    v_fmac_f32 v15, v165, v165
    v_lshlrev_b32 v16, 16, v28
    v_and_b32 v17, 0xffff0000, v28
    s_waitcnt lgkmcnt(1)
    v_mfma_f32_32x32x16_bf16 v[84:99], a[20:23], v[40:43], v[84:99]
    v_add_f32 v12, v12, v16
    v_add_f32 v13, v13, v17
    v_fmac_f32 v14, v16, v16
    v_fmac_f32 v15, v17, v17
    v_lshlrev_b32 v164, 16, v29
    v_mfma_f32_32x32x16_bf16 v[100:115], v[40:43], a[180:183], v[100:115]
    s_waitcnt vmcnt(2)
    ds_read_b128 v[48:51], v5 offset:7168
    v_and_b32 v165, 0xffff0000, v29
    v_add_f32 v12, v12, v164
    v_add_f32 v13, v13, v165
    v_fmac_f32 v14, v164, v164
    v_fmac_f32 v15, v165, v165
    s_waitcnt lgkmcnt(1)
    v_mfma_f32_32x32x16_bf16 v[84:99], a[24:27], v[44:47], v[84:99]
    s_waitcnt vmcnt(1)
    ds_read_b128 v[52:55], v5 offset:8192
    v_lshlrev_b32 v16, 16, v30
    v_and_b32 v17, 0xffff0000, v30
    v_add_f32 v12, v12, v16
    v_add_f32 v13, v13, v17
    v_fmac_f32 v14, v16, v16
    v_mfma_f32_32x32x16_bf16 v[100:115], v[44:47], a[184:187], v[100:115]
    s_waitcnt vmcnt(0)
    ds_read_b128 v[56:59], v5 offset:9216
    v_fmac_f32 v15, v17, v17
    v_lshlrev_b32 v164, 16, v31
    v_and_b32 v165, 0xffff0000, v31
    v_add_f32 v12, v12, v164
    v_add_f32 v13, v13, v165
    s_waitcnt lgkmcnt(2)
    v_mfma_f32_32x32x16_bf16 v[84:99], a[28:31], v[48:51], v[84:99]
    buffer_store_dword v19, off, s[4:7], s70 sc1
    s_mov_b32 s70, 262144000
    s_barrier
    v_fmac_f32 v14, v164, v164
    v_fmac_f32 v15, v165, v165
    v_lshlrev_b32 v16, 16, v32
    v_and_b32 v17, 0xffff0000, v32
    v_add_f32 v12, v12, v16
    v_mfma_f32_32x32x16_bf16 v[100:115], v[48:51], a[188:191], v[100:115]
    ds_read_b128 v[60:63], v6 offset:0
    v_add_f32 v13, v13, v17
    v_fmac_f32 v14, v16, v16
    v_fmac_f32 v15, v17, v17
    v_lshlrev_b32 v164, 16, v33
    v_and_b32 v165, 0xffff0000, v33
    s_waitcnt lgkmcnt(2)
    v_mfma_f32_32x32x16_bf16 v[84:99], a[32:35], v[52:55], v[84:99]
    ds_read_b128 v[64:67], v6 offset:1024
    v_add_f32 v12, v12, v164
    v_add_f32 v13, v13, v165
    v_fmac_f32 v14, v164, v164
    v_fmac_f32 v15, v165, v165
    v_lshlrev_b32 v16, 16, v34
    v_mfma_f32_32x32x16_bf16 v[100:115], v[52:55], a[192:195], v[100:115]
    ds_read_b128 v[68:71], v6 offset:2048
    v_and_b32 v17, 0xffff0000, v34
    v_add_f32 v12, v12, v16
    v_add_f32 v13, v13, v17
    v_fmac_f32 v14, v16, v16
    v_fmac_f32 v15, v17, v17
    s_waitcnt lgkmcnt(3)
    v_mfma_f32_32x32x16_bf16 v[84:99], a[36:39], v[56:59], v[84:99]
    ds_read_b128 v[72:75], v6 offset:3072
    v_lshlrev_b32 v164, 16, v35
    v_and_b32 v165, 0xffff0000, v35
    v_add_f32 v12, v12, v164
    v_add_f32 v13, v13, v165
    v_fmac_f32 v14, v164, v164
    v_mfma_f32_32x32x16_bf16 v[100:115], v[56:59], a[196:199], v[100:115]
    ds_read_b128 v[76:79], v6 offset:4096
    v_fmac_f32 v15, v165, v165
    v_lshlrev_b32 v16, 16, v36
    v_and_b32 v17, 0xffff0000, v36
    v_add_f32 v12, v12, v16
    v_add_f32 v13, v13, v17
    s_branch L_kv_join
L_role_qq:
    s_waitcnt vmcnt(0)
    s_cmp_eq_u32 s53, 0
    s_cbranch_scc1 Llate_12
    v_mov_b32 v2, 128
Lp_13:
    buffer_load_dword v3, v2, s[8:11], 0 offen sc1
    s_waitcnt vmcnt(0)
    v_cmp_gt_i32 vcc, 1, v3
    s_cbranch_vccz Lpd_14
    s_sleep 8
    s_mov_b32 s54, 128
    s_sub_u32 s52, s52, 1
    s_cbranch_scc1 L_abort
    s_branch Lp_13
Lpd_14:
    v_mov_b32 v2, 53248
    s_cmp_eq_u32 s53, 0
    s_cselect_b32 s56, 0, 1
Lp_15:
    buffer_load_dword v3, v2, s[4:7], 0 offen sc1
    s_waitcnt vmcnt(0)
    v_cmp_gt_i32 vcc, s56, v3
    s_cbranch_vccz Lpd_16
    s_sleep 8
    s_mov_b32 s54, 129
    s_sub_u32 s52, s52, 1
    s_cbranch_scc1 L_abort
    s_branch Lp_15
Lpd_16:
Llate_12:
L_qq_par:
    s_mov_b32 s12, s28
    s_mov_b32 s13, s29
    s_mov_b32 s14, 5242880
    s_mov_b32 s15, 0x20000
    s_mov_b32 s16, s28
    s_mov_b32 s17, s29
    s_mov_b32 s18, 5242880
    s_mov_b32 s19, 0x20000
    s_lshl_b32 s67, s51, 9
    s_lshl_b32 s55, s3, 6
    s_add_u32 s67, s67, s55
    s_add_u32 s68, s67, 256
    s_lshl_b32 s63, s53, 10
    s_add_u32 s63, s63, s51
    s_lshl_b32 s63, s63, 14
    s_lshl_b32 s55, s3, 11
    s_add_u32 s63, s63, s55
    s_add_u32 s63, s63, 75497472
    s_lshl_b32 s65, s53, 4
    s_add_u32 s65, s65, s51
    s_lshl_b32 s65, s65, 2
    s_add_u32 s65, s65, s3
    s_add_u32 s65, s65, 288
    s_lshl_b32 s65, s65, 7
    s_add_u32 s55, s53, 0
    s_mul_i32 s62, s55, 2621440
    s_mul_i32 s55, s3, 10240
    s_add_u32 s62, s62, s55
    s_add_u32 s62, s62, 196083712
    v_lshrrev_b32 v252, 4, v1
    v_bfe_u32 v253, v1, 2, 2
    v_and_b32 v254, 3, v1
    s_mul_i32 s69, s3, 40960
    v_mov_b32 v20, 0x3f803f80
    v_mov_b32 v21, 0x3f803f80
    v_mov_b32 v22, 0x3f803f80
    v_mov_b32 v23, 0x3f803f80
    v_lshrrev_b32 v250, 1, v252
    v_lshl_add_u32 v250, v250, 3, v253
    v_lshlrev_b32 v250, 8, v250
    v_and_b32 v251, 1, v252
    v_lshl_add_u32 v250, v251, 5, v250
    v_lshl_add_u32 v250, v254, 3, v250
    v_xor_b32 v251, s3, v253
    v_lshl_add_u32 v250, v251, 6, v250
    s_add_u32 s55, s3, 0
    s_and_b32 s55, s55, 3
    s_mul_i32 s55, s55, 40960
    v_add_u32 v24, s55, v250
    s_add_u32 s55, s3, 1
    s_and_b32 s55, s55, 3
    s_mul_i32 s55, s55, 40960
    v_add_u32 v25, s55, v250
    s_add_u32 s55, s3, 2
    s_and_b32 s55, s55, 3
    s_mul_i32 s55, s55, 40960
    v_add_u32 v26, s55, v250
    s_add_u32 s55, s3, 3
    s_and_b32 s55, s55, 3
    s_mul_i32 s55, s55, 40960
    v_add_u32 v27, s55, v250
    v_lshrrev_b32 v251, 4, v1
    v_mul_u32_u24 v191, 8192, v251
    v_lshlrev_b32 v251, 2, v251
    v_and_b32 v250, 15, v1
    v_xor_b32 v251, v251, v250
    v_lshl_add_u32 v191, v251, 4, v191
    s_mul_i32 s56, s3, 1310656
    s_add_u32 s56, s56, s68
    s_mov_b32 m0, s69
    s_nop 0
    buffer_load_dwordx4 v191, s[16:19], s56 offen lds
    s_add_u32 m0, m0, 1024
    s_add_u32 s56, s56, 32768
    buffer_load_dwordx4 v191, s[16:19], s56 offen lds
    s_add_u32 m0, m0, 1024
    s_add_u32 s56, s56, 32768
    buffer_load_dwordx4 v191, s[16:19], s56 offen lds
    s_add_u32 m0, m0, 1024
    s_add_u32 s56, s56, 32768
    buffer_load_dwordx4 v191, s[16:19], s56 offen lds
    s_add_u32 m0, m0, 1024
    s_add_u32 s56, s56, 32768
    buffer_load_dwordx4 v191, s[16:19], s56 offen lds
    s_add_u32 m0, m0, 1024
    s_add_u32 s56, s56, 32768
    buffer_load_dwordx4 v191, s[16:19], s56 offen lds
    s_add_u32 m0, m0, 1024
    s_add_u32 s56, s56, 32768
    buffer_load_dwordx4 v191, s[16:19], s56 offen lds
    s_add_u32 m0, m0, 1024
    s_add_u32 s56, s56, 32768
    buffer_load_dwordx4 v191, s[16:19], s56 offen lds
    s_add_u32 m0, m0, 1024
    s_add_u32 s56, s56, 32768
    buffer_load_dwordx4 v191, s[16:19], s56 offen lds
    s_add_u32 m0, m0, 1024
    s_add_u32 s56, s56, 32768
    buffer_load_dwordx4 v191, s[16:19], s56 offen lds
    s_add_u32 m0, m0, 1024
    s_add_u32 s56, s56, 32768
    buffer_load_dwordx4 v191, s[16:19], s56 offen lds
    s_add_u32 m0, m0, 1024
    s_add_u32 s56, s56, 32768
    buffer_load_dwordx4 v191, s[16:19], s56 offen lds
    s_add_u32 m0, m0, 1024
    s_add_u32 s56, s56, 32768
    buffer_load_dwordx4 v191, s[16:19], s56 offen lds
    s_add_u32 m0, m0, 1024
    s_add_u32 s56, s56, 32768
    buffer_load_dwordx4 v191, s[16:19], s56 offen lds
    s_add_u32 m0, m0, 1024
    s_add_u32 s56, s56, 32768
    buffer_load_dwordx4 v191, s[16:19], s56 offen lds
    s_add_u32 m0, m0, 1024
    s_add_u32 s56, s56, 32768
    buffer_load_dwordx4 v191, s[16:19], s56 offen lds
    s_add_u32 m0, m0, 1024
    s_add_u32 s56, s56, 32768
    buffer_load_dwordx4 v191, s[16:19], s56 offen lds
    s_add_u32 m0, m0, 1024
    s_add_u32 s56, s56, 32768
    buffer_load_dwordx4 v191, s[16:19], s56 offen lds
    s_add_u32 m0, m0, 1024
    s_add_u32 s56, s56, 32768
    buffer_load_dwordx4 v191, s[16:19], s56 offen lds
    s_add_u32 m0, m0, 1024
    s_add_u32 s56, s56, 32768
    buffer_load_dwordx4 v191, s[16:19], s56 offen lds
    s_add_u32 m0, m0, 1024
    s_add_u32 s56, s56, 32768
    buffer_load_dwordx4 v191, s[16:19], s56 offen lds
    s_add_u32 m0, m0, 1024
    s_add_u32 s56, s56, 32768
    buffer_load_dwordx4 v191, s[16:19], s56 offen lds
    s_add_u32 m0, m0, 1024
    s_add_u32 s56, s56, 32768
    buffer_load_dwordx4 v191, s[16:19], s56 offen lds
    s_add_u32 m0, m0, 1024
    s_add_u32 s56, s56, 32768
    buffer_load_dwordx4 v191, s[16:19], s56 offen lds
    s_add_u32 m0, m0, 1024
    s_add_u32 s56, s56, 32768
    buffer_load_dwordx4 v191, s[16:19], s56 offen lds
    s_add_u32 m0, m0, 1024
    s_add_u32 s56, s56, 32768
    buffer_load_dwordx4 v191, s[16:19], s56 offen lds
    s_add_u32 m0, m0, 1024
    s_add_u32 s56, s56, 32768
    buffer_load_dwordx4 v191, s[16:19], s56 offen lds
    s_add_u32 m0, m0, 1024
    s_add_u32 s56, s56, 32768
    buffer_load_dwordx4 v191, s[16:19], s56 offen lds
    s_add_u32 m0, m0, 1024
    s_add_u32 s56, s56, 32768
    buffer_load_dwordx4 v191, s[16:19], s56 offen lds
    s_add_u32 m0, m0, 1024
    s_add_u32 s56, s56, 32768
    buffer_load_dwordx4 v191, s[16:19], s56 offen lds
    s_add_u32 m0, m0, 1024
    s_add_u32 s56, s56, 32768
    buffer_load_dwordx4 v191, s[16:19], s56 offen lds
    s_add_u32 m0, m0, 1024
    s_add_u32 s56, s56, 32768
    buffer_load_dwordx4 v191, s[16:19], s56 offen lds
    s_add_u32 m0, m0, 1024
    s_add_u32 s56, s56, 32768
    buffer_load_dwordx4 v191, s[16:19], s56 offen lds
    s_add_u32 m0, m0, 1024
    s_add_u32 s56, s56, 32768
    buffer_load_dwordx4 v191, s[16:19], s56 offen lds
    s_add_u32 m0, m0, 1024
    s_add_u32 s56, s56, 32768
    buffer_load_dwordx4 v191, s[16:19], s56 offen lds
    s_add_u32 m0, m0, 1024
    s_add_u32 s56, s56, 32768
    buffer_load_dwordx4 v191, s[16:19], s56 offen lds
    s_add_u32 m0, m0, 1024
    s_add_u32 s56, s56, 32768
    buffer_load_dwordx4 v191, s[16:19], s56 offen lds
    s_add_u32 m0, m0, 1024
    s_add_u32 s56, s56, 32768
    buffer_load_dwordx4 v191, s[16:19], s56 offen lds
    s_add_u32 m0, m0, 1024
    s_add_u32 s56, s56, 32768
    buffer_load_dwordx4 v191, s[16:19], s56 offen lds
    s_add_u32 m0, m0, 1024
    s_add_u32 s56, s56, 32768
    buffer_load_dwordx4 v191, s[16:19], s56 offen lds
    s_waitcnt vmcnt(0)
    s_barrier
    ds_read_b64_tr_b16 a[160:161], v24 offset:0
    ds_read_b64_tr_b16 a[162:163], v24 offset:1024
    ds_read_b64_tr_b16 a[164:165], v24 offset:4096
    ds_read_b64_tr_b16 a[166:167], v24 offset:5120
    ds_read_b64_tr_b16 a[168:169], v24 offset:8192
    ds_read_b64_tr_b16 a[170:171], v24 offset:9216
    ds_read_b64_tr_b16 a[172:173], v24 offset:12288
    ds_read_b64_tr_b16 a[174:175], v24 offset:13312
    ds_read_b64_tr_b16 a[176:177], v24 offset:16384
    ds_read_b64_tr_b16 a[178:179], v24 offset:17408
    ds_read_b64_tr_b16 a[180:181], v24 offset:20480
    ds_read_b64_tr_b16 a[182:183], v24 offset:21504
    ds_read_b64_tr_b16 a[184:185], v24 offset:24576
    ds_read_b64_tr_b16 a[186:187], v24 offset:25600
    ds_read_b64_tr_b16 a[188:189], v24 offset:28672
    ds_read_b64_tr_b16 a[190:191], v24 offset:29696
    ds_read_b64_tr_b16 a[192:193], v24 offset:32768
    ds_read_b64_tr_b16 a[194:195], v24 offset:33792
    ds_read_b64_tr_b16 a[196:197], v24 offset:36864
    ds_read_b64_tr_b16 a[198:199], v24 offset:37888
    ds_read_b64_tr_b16 a[200:201], v25 offset:0
    ds_read_b64_tr_b16 a[202:203], v25 offset:1024
    ds_read_b64_tr_b16 a[204:205], v25 offset:4096
    ds_read_b64_tr_b16 a[206:207], v25 offset:5120
    ds_read_b64_tr_b16 a[208:209], v25 offset:8192
    ds_read_b64_tr_b16 a[210:211], v25 offset:9216
    ds_read_b64_tr_b16 a[212:213], v25 offset:12288
    ds_read_b64_tr_b16 a[214:215], v25 offset:13312
    ds_read_b64_tr_b16 a[216:217], v25 offset:16384
    ds_read_b64_tr_b16 a[218:219], v25 offset:17408
    ds_read_b64_tr_b16 a[220:221], v25 offset:20480
    ds_read_b64_tr_b16 a[222:223], v25 offset:21504
    ds_read_b64_tr_b16 a[224:225], v25 offset:24576
    ds_read_b64_tr_b16 a[226:227], v25 offset:25600
    ds_read_b64_tr_b16 a[228:229], v25 offset:28672
    ds_read_b64_tr_b16 a[230:231], v25 offset:29696
    ds_read_b64_tr_b16 a[232:233], v25 offset:32768
    ds_read_b64_tr_b16 a[234:235], v25 offset:33792
    ds_read_b64_tr_b16 a[236:237], v25 offset:36864
    ds_read_b64_tr_b16 a[238:239], v25 offset:37888
    ds_read_b64_tr_b16 a[240:241], v26 offset:0
    ds_read_b64_tr_b16 a[242:243], v26 offset:1024
    ds_read_b64_tr_b16 a[244:245], v26 offset:4096
    ds_read_b64_tr_b16 a[246:247], v26 offset:5120
    ds_read_b64_tr_b16 a[248:249], v26 offset:8192
    ds_read_b64_tr_b16 a[250:251], v26 offset:9216
    ds_read_b64_tr_b16 a[252:253], v26 offset:12288
    ds_read_b64_tr_b16 a[254:255], v26 offset:13312
    ds_read_b64_tr_b16 v[192:193], v26 offset:16384
    ds_read_b64_tr_b16 v[194:195], v26 offset:17408
    ds_read_b64_tr_b16 v[196:197], v26 offset:20480
    ds_read_b64_tr_b16 v[198:199], v26 offset:21504
    ds_read_b64_tr_b16 v[200:201], v26 offset:24576
    ds_read_b64_tr_b16 v[202:203], v26 offset:25600
    ds_read_b64_tr_b16 v[204:205], v26 offset:28672
    ds_read_b64_tr_b16 v[206:207], v26 offset:29696
    ds_read_b64_tr_b16 v[208:209], v26 offset:32768
    ds_read_b64_tr_b16 v[210:211], v26 offset:33792
    ds_read_b64_tr_b16 v[212:213], v26 offset:36864
    ds_read_b64_tr_b16 v[214:215], v26 offset:37888
    ds_read_b64_tr_b16 v[216:217], v27 offset:0
    ds_read_b64_tr_b16 v[218:219], v27 offset:1024
    ds_read_b64_tr_b16 v[220:221], v27 offset:4096
    ds_read_b64_tr_b16 v[222:223], v27 offset:5120
    ds_read_b64_tr_b16 v[224:225], v27 offset:8192
    ds_read_b64_tr_b16 v[226:227], v27 offset:9216
    ds_read_b64_tr_b16 v[228:229], v27 offset:12288
    ds_read_b64_tr_b16 v[230:231], v27 offset:13312
    ds_read_b64_tr_b16 v[232:233], v27 offset:16384
    ds_read_b64_tr_b16 v[234:235], v27 offset:17408
    ds_read_b64_tr_b16 v[236:237], v27 offset:20480
    ds_read_b64_tr_b16 v[238:239], v27 offset:21504
    ds_read_b64_tr_b16 v[240:241], v27 offset:24576
    ds_read_b64_tr_b16 v[242:243], v27 offset:25600
    ds_read_b64_tr_b16 v[244:245], v27 offset:28672
    ds_read_b64_tr_b16 v[246:247], v27 offset:29696
    ds_read_b64_tr_b16 v[248:249], v27 offset:32768
    ds_read_b64_tr_b16 v[250:251], v27 offset:33792
    ds_read_b64_tr_b16 v[252:253], v27 offset:36864
    ds_read_b64_tr_b16 v[254:255], v27 offset:37888
    s_waitcnt lgkmcnt(0)
    s_barrier
    s_mul_i32 s56, s3, 1310656
    s_add_u32 s56, s56, s67
    s_mov_b32 m0, s69
    s_nop 0
    buffer_load_dwordx4 v191, s[12:15], s56 offen lds
    s_add_u32 m0, m0, 1024
    s_add_u32 s56, s56, 32768
    buffer_load_dwordx4 v191, s[12:15], s56 offen lds
    s_add_u32 m0, m0, 1024
    s_add_u32 s56, s56, 32768
    buffer_load_dwordx4 v191, s[12:15], s56 offen lds
    s_add_u32 m0, m0, 1024
    s_add_u32 s56, s56, 32768
    buffer_load_dwordx4 v191, s[12:15], s56 offen lds
    s_add_u32 m0, m0, 1024
    s_add_u32 s56, s56, 32768
    buffer_load_dwordx4 v191, s[12:15], s56 offen lds
    s_add_u32 m0, m0, 1024
    s_add_u32 s56, s56, 32768
    buffer_load_dwordx4 v191, s[12:15], s56 offen lds
    s_add_u32 m0, m0, 1024
    s_add_u32 s56, s56, 32768
    buffer_load_dwordx4 v191, s[12:15], s56 offen lds
    s_add_u32 m0, m0, 1024
    s_add_u32 s56, s56, 32768
    buffer_load_dwordx4 v191, s[12:15], s56 offen lds
    s_add_u32 m0, m0, 1024
    s_add_u32 s56, s56, 32768
    buffer_load_dwordx4 v191, s[12:15], s56 offen lds
    s_add_u32 m0, m0, 1024
    s_add_u32 s56, s56, 32768
    buffer_load_dwordx4 v191, s[12:15], s56 offen lds
    s_add_u32 m0, m0, 1024
    s_add_u32 s56, s56, 32768
    buffer_load_dwordx4 v191, s[12:15], s56 offen lds
    s_add_u32 m0, m0, 1024
    s_add_u32 s56, s56, 32768
    buffer_load_dwordx4 v191, s[12:15], s56 offen lds
    s_add_u32 m0, m0, 1024
    s_add_u32 s56, s56, 32768
    buffer_load_dwordx4 v191, s[12:15], s56 offen lds
    s_add_u32 m0, m0, 1024
    s_add_u32 s56, s56, 32768
    buffer_load_dwordx4 v191, s[12:15], s56 offen lds
    s_add_u32 m0, m0, 1024
    s_add_u32 s56, s56, 32768
    buffer_load_dwordx4 v191, s[12:15], s56 offen lds
    s_add_u32 m0, m0, 1024
    s_add_u32 s56, s56, 32768
    buffer_load_dwordx4 v191, s[12:15], s56 offen lds
    s_add_u32 m0, m0, 1024
    s_add_u32 s56, s56, 32768
    buffer_load_dwordx4 v191, s[12:15], s56 offen lds
    s_add_u32 m0, m0, 1024
    s_add_u32 s56, s56, 32768
    buffer_load_dwordx4 v191, s[12:15], s56 offen lds
    s_add_u32 m0, m0, 1024
    s_add_u32 s56, s56, 32768
    buffer_load_dwordx4 v191, s[12:15], s56 offen lds
    s_add_u32 m0, m0, 1024
    s_add_u32 s56, s56, 32768
    buffer_load_dwordx4 v191, s[12:15], s56 offen lds
    s_add_u32 m0, m0, 1024
    s_add_u32 s56, s56, 32768
    buffer_load_dwordx4 v191, s[12:15], s56 offen lds
    s_add_u32 m0, m0, 1024
    s_add_u32 s56, s56, 32768
    buffer_load_dwordx4 v191, s[12:15], s56 offen lds
    s_add_u32 m0, m0, 1024
    s_add_u32 s56, s56, 32768
    buffer_load_dwordx4 v191, s[12:15], s56 offen lds
    s_add_u32 m0, m0, 1024
    s_add_u32 s56, s56, 32768
    buffer_load_dwordx4 v191, s[12:15], s56 offen lds
    s_add_u32 m0, m0, 1024
    s_add_u32 s56, s56, 32768
    buffer_load_dwordx4 v191, s[12:15], s56 offen lds
    s_add_u32 m0, m0, 1024
    s_add_u32 s56, s56, 32768
    buffer_load_dwordx4 v191, s[12:15], s56 offen lds
    s_add_u32 m0, m0, 1024
    s_add_u32 s56, s56, 32768
    buffer_load_dwordx4 v191, s[12:15], s56 offen lds
    s_add_u32 m0, m0, 1024
    s_add_u32 s56, s56, 32768
    buffer_load_dwordx4 v191, s[12:15], s56 offen lds
    s_add_u32 m0, m0, 1024
    s_add_u32 s56, s56, 32768
    buffer_load_dwordx4 v191, s[12:15], s56 offen lds
    s_add_u32 m0, m0, 1024
    s_add_u32 s56, s56, 32768
    buffer_load_dwordx4 v191, s[12:15], s56 offen lds
    s_add_u32 m0, m0, 1024
    s_add_u32 s56, s56, 32768
    buffer_load_dwordx4 v191, s[12:15], s56 offen lds
    s_add_u32 m0, m0, 1024
    s_add_u32 s56, s56, 32768
    buffer_load_dwordx4 v191, s[12:15], s56 offen lds
    s_add_u32 m0, m0, 1024
    s_add_u32 s56, s56, 32768
    buffer_load_dwordx4 v191, s[12:15], s56 offen lds
    s_add_u32 m0, m0, 1024
    s_add_u32 s56, s56, 32768
    buffer_load_dwordx4 v191, s[12:15], s56 offen lds
    s_add_u32 m0, m0, 1024
    s_add_u32 s56, s56, 32768
    buffer_load_dwordx4 v191, s[12:15], s56 offen lds
    s_add_u32 m0, m0, 1024
    s_add_u32 s56, s56, 32768
    buffer_load_dwordx4 v191, s[12:15], s56 offen lds
    s_add_u32 m0, m0, 1024
    s_add_u32 s56, s56, 32768
    buffer_load_dwordx4 v191, s[12:15], s56 offen lds
    s_add_u32 m0, m0, 1024
    s_add_u32 s56, s56, 32768
    buffer_load_dwordx4 v191, s[12:15], s56 offen lds
    s_add_u32 m0, m0, 1024
    s_add_u32 s56, s56, 32768
    buffer_load_dwordx4 v191, s[12:15], s56 offen lds
    s_add_u32 m0, m0, 1024
    s_add_u32 s56, s56, 32768
    buffer_load_dwordx4 v191, s[12:15], s56 offen lds
    v_mfma_f32_32x32x16_bf16 v[132:147], a[160:163], v[20:23], 0
    v_mfma_f32_32x32x16_bf16 v[132:147], a[164:167], v[20:23], v[132:147]
    v_mfma_f32_32x32x16_bf16 v[132:147], a[168:171], v[20:23], v[132:147]
    v_mfma_f32_32x32x16_bf16 v[132:147], a[172:175], v[20:23], v[132:147]
    v_mfma_f32_32x32x16_bf16 v[132:147], a[176:179], v[20:23], v[132:147]
    v_mfma_f32_32x32x16_bf16 v[132:147], a[180:183], v[20:23], v[132:147]
    v_mfma_f32_32x32x16_bf16 v[132:147], a[184:187], v[20:23], v[132:147]
    v_mfma_f32_32x32x16_bf16 v[132:147], a[188:191], v[20:23], v[132:147]
    v_mfma_f32_32x32x16_bf16 v[132:147], a[192:195], v[20:23], v[132:147]
    v_mfma_f32_32x32x16_bf16 v[132:147], a[196:199], v[20:23], v[132:147]
    v_mfma_f32_32x32x16_bf16 v[132:147], a[200:203], v[20:23], v[132:147]
    v_mfma_f32_32x32x16_bf16 v[132:147], a[204:207], v[20:23], v[132:147]
    v_mfma_f32_32x32x16_bf16 v[132:147], a[208:211], v[20:23], v[132:147]
    v_mfma_f32_32x32x16_bf16 v[132:147], a[212:215], v[20:23], v[132:147]
    v_mfma_f32_32x32x16_bf16 v[132:147], a[216:219], v[20:23], v[132:147]
    v_mfma_f32_32x32x16_bf16 v[132:147], a[220:223], v[20:23], v[132:147]
    v_mfma_f32_32x32x16_bf16 v[132:147], a[224:227], v[20:23], v[132:147]
    v_mfma_f32_32x32x16_bf16 v[132:147], a[228:231], v[20:23], v[132:147]
    v_mfma_f32_32x32x16_bf16 v[132:147], a[232:235], v[20:23], v[132:147]
    v_mfma_f32_32x32x16_bf16 v[132:147], a[236:239], v[20:23], v[132:147]
    v_mfma_f32_32x32x16_bf16 v[132:147], a[240:243], v[20:23], v[132:147]
    v_mfma_f32_32x32x16_bf16 v[132:147], a[244:247], v[20:23], v[132:147]
    v_mfma_f32_32x32x16_bf16 v[132:147], a[248:251], v[20:23], v[132:147]
    v_mfma_f32_32x32x16_bf16 v[132:147], a[252:255], v[20:23], v[132:147]
    v_mfma_f32_32x32x16_bf16 v[132:147], v[192:195], v[20:23], v[132:147]
    v_mfma_f32_32x32x16_bf16 v[132:147], v[196:199], v[20:23], v[132:147]
    v_mfma_f32_32x32x16_bf16 v[132:147], v[200:203], v[20:23], v[132:147]
    v_mfma_f32_32x32x16_bf16 v[132:147], v[204:207], v[20:23], v[132:147]
    v_mfma_f32_32x32x16_bf16 v[132:147], v[208:211], v[20:23], v[132:147]
    v_mfma_f32_32x32x16_bf16 v[132:147], v[212:215], v[20:23], v[132:147]
    v_mfma_f32_32x32x16_bf16 v[132:147], v[216:219], v[20:23], v[132:147]
    v_mfma_f32_32x32x16_bf16 v[132:147], v[220:223], v[20:23], v[132:147]
    v_mfma_f32_32x32x16_bf16 v[132:147], v[224:227], v[20:23], v[132:147]
    v_mfma_f32_32x32x16_bf16 v[132:147], v[228:231], v[20:23], v[132:147]
    v_mfma_f32_32x32x16_bf16 v[132:147], v[232:235], v[20:23], v[132:147]
    v_mfma_f32_32x32x16_bf16 v[132:147], v[236:239], v[20:23], v[132:147]
    v_mfma_f32_32x32x16_bf16 v[132:147], v[240:243], v[20:23], v[132:147]
    v_mfma_f32_32x32x16_bf16 v[132:147], v[244:247], v[20:23], v[132:147]
    v_mfma_f32_32x32x16_bf16 v[132:147], v[248:251], v[20:23], v[132:147]
    v_mfma_f32_32x32x16_bf16 v[132:147], v[252:255], v[20:23], v[132:147]
    s_waitcnt vmcnt(0)
    s_barrier
    ds_read_b64_tr_b16 a[0:1], v24 offset:0
    ds_read_b64_tr_b16 a[2:3], v24 offset:1024
    ds_read_b64_tr_b16 a[4:5], v24 offset:4096
    ds_read_b64_tr_b16 a[6:7], v24 offset:5120
    ds_read_b64_tr_b16 a[8:9], v24 offset:8192
    ds_read_b64_tr_b16 a[10:11], v24 offset:9216
    ds_read_b64_tr_b16 a[12:13], v24 offset:12288
    ds_read_b64_tr_b16 a[14:15], v24 offset:13312
    ds_read_b64_tr_b16 a[16:17], v24 offset:16384
    ds_read_b64_tr_b16 a[18:19], v24 offset:17408
    ds_read_b64_tr_b16 a[20:21], v24 offset:20480
    ds_read_b64_tr_b16 a[22:23], v24 offset:21504
    ds_read_b64_tr_b16 a[24:25], v24 offset:24576
    ds_read_b64_tr_b16 a[26:27], v24 offset:25600
    ds_read_b64_tr_b16 a[28:29], v24 offset:28672
    ds_read_b64_tr_b16 a[30:31], v24 offset:29696
    ds_read_b64_tr_b16 a[32:33], v24 offset:32768
    ds_read_b64_tr_b16 a[34:35], v24 offset:33792
    ds_read_b64_tr_b16 a[36:37], v24 offset:36864
    ds_read_b64_tr_b16 a[38:39], v24 offset:37888
    ds_read_b64_tr_b16 a[40:41], v25 offset:0
    ds_read_b64_tr_b16 a[42:43], v25 offset:1024
    ds_read_b64_tr_b16 a[44:45], v25 offset:4096
    ds_read_b64_tr_b16 a[46:47], v25 offset:5120
    ds_read_b64_tr_b16 a[48:49], v25 offset:8192
    ds_read_b64_tr_b16 a[50:51], v25 offset:9216
    ds_read_b64_tr_b16 a[52:53], v25 offset:12288
    ds_read_b64_tr_b16 a[54:55], v25 offset:13312
    ds_read_b64_tr_b16 a[56:57], v25 offset:16384
    ds_read_b64_tr_b16 a[58:59], v25 offset:17408
    ds_read_b64_tr_b16 a[60:61], v25 offset:20480
    ds_read_b64_tr_b16 a[62:63], v25 offset:21504
    ds_read_b64_tr_b16 a[64:65], v25 offset:24576
    ds_read_b64_tr_b16 a[66:67], v25 offset:25600
    ds_read_b64_tr_b16 a[68:69], v25 offset:28672
    ds_read_b64_tr_b16 a[70:71], v25 offset:29696
    ds_read_b64_tr_b16 a[72:73], v25 offset:32768
    ds_read_b64_tr_b16 a[74:75], v25 offset:33792
    ds_read_b64_tr_b16 a[76:77], v25 offset:36864
    ds_read_b64_tr_b16 a[78:79], v25 offset:37888
    ds_read_b64_tr_b16 a[80:81], v26 offset:0
    ds_read_b64_tr_b16 a[82:83], v26 offset:1024
    ds_read_b64_tr_b16 a[84:85], v26 offset:4096
    ds_read_b64_tr_b16 a[86:87], v26 offset:5120
    ds_read_b64_tr_b16 a[88:89], v26 offset:8192
    ds_read_b64_tr_b16 a[90:91], v26 offset:9216
    ds_read_b64_tr_b16 a[92:93], v26 offset:12288
    ds_read_b64_tr_b16 a[94:95], v26 offset:13312
    ds_read_b64_tr_b16 a[96:97], v26 offset:16384
    ds_read_b64_tr_b16 a[98:99], v26 offset:17408
    ds_read_b64_tr_b16 a[100:101], v26 offset:20480
    ds_read_b64_tr_b16 a[102:103], v26 offset:21504
    ds_read_b64_tr_b16 a[104:105], v26 offset:24576
    ds_read_b64_tr_b16 a[106:107], v26 offset:25600
    ds_read_b64_tr_b16 a[108:109], v26 offset:28672
    ds_read_b64_tr_b16 a[110:111], v26 offset:29696
    ds_read_b64_tr_b16 a[112:113], v26 offset:32768
    ds_read_b64_tr_b16 a[114:115], v26 offset:33792
    ds_read_b64_tr_b16 a[116:117], v26 offset:36864
    ds_read_b64_tr_b16 a[118:119], v26 offset:37888
    ds_read_b64_tr_b16 a[120:121], v27 offset:0
    ds_read_b64_tr_b16 a[122:123], v27 offset:1024
    ds_read_b64_tr_b16 a[124:125], v27 offset:4096
    ds_read_b64_tr_b16 a[126:127], v27 offset:5120
    ds_read_b64_tr_b16 a[128:129], v27 offset:8192
    ds_read_b64_tr_b16 a[130:131], v27 offset:9216
    ds_read_b64_tr_b16 a[132:133], v27 offset:12288
    ds_read_b64_tr_b16 a[134:135], v27 offset:13312
    ds_read_b64_tr_b16 a[136:137], v27 offset:16384
    ds_read_b64_tr_b16 a[138:139], v27 offset:17408
    ds_read_b64_tr_b16 a[140:141], v27 offset:20480
    ds_read_b64_tr_b16 a[142:143], v27 offset:21504
    ds_read_b64_tr_b16 a[144:145], v27 offset:24576
    ds_read_b64_tr_b16 a[146:147], v27 offset:25600
    ds_read_b64_tr_b16 a[148:149], v27 offset:28672
    ds_read_b64_tr_b16 a[150:151], v27 offset:29696
    ds_read_b64_tr_b16 a[152:153], v27 offset:32768
    ds_read_b64_tr_b16 a[154:155], v27 offset:33792
    ds_read_b64_tr_b16 a[156:157], v27 offset:36864
    ds_read_b64_tr_b16 a[158:159], v27 offset:37888
    s_waitcnt lgkmcnt(0)
    s_barrier
    v_mfma_f32_32x32x16_bf16 v[116:131], a[0:3], v[20:23], 0
    v_mfma_f32_32x32x16_bf16 v[116:131], a[4:7], v[20:23], v[116:131]
    v_mfma_f32_32x32x16_bf16 v[116:131], a[8:11], v[20:23], v[116:131]
    v_mfma_f32_32x32x16_bf16 v[116:131], a[12:15], v[20:23], v[116:131]
    v_mfma_f32_32x32x16_bf16 v[116:131], a[16:19], v[20:23], v[116:131]
    v_mfma_f32_32x32x16_bf16 v[116:131], a[20:23], v[20:23], v[116:131]
    v_mfma_f32_32x32x16_bf16 v[116:131], a[24:27], v[20:23], v[116:131]
    v_mfma_f32_32x32x16_bf16 v[116:131], a[28:31], v[20:23], v[116:131]
    v_mfma_f32_32x32x16_bf16 v[116:131], a[32:35], v[20:23], v[116:131]
    v_mfma_f32_32x32x16_bf16 v[116:131], a[36:39], v[20:23], v[116:131]
    v_mfma_f32_32x32x16_bf16 v[116:131], a[40:43], v[20:23], v[116:131]
    v_mfma_f32_32x32x16_bf16 v[116:131], a[44:47], v[20:23], v[116:131]
    v_mfma_f32_32x32x16_bf16 v[116:131], a[48:51], v[20:23], v[116:131]
    v_mfma_f32_32x32x16_bf16 v[116:131], a[52:55], v[20:23], v[116:131]
    v_mfma_f32_32x32x16_bf16 v[116:131], a[56:59], v[20:23], v[116:131]
    v_mfma_f32_32x32x16_bf16 v[116:131], a[60:63], v[20:23], v[116:131]
    v_mfma_f32_32x32x16_bf16 v[116:131], a[64:67], v[20:23], v[116:131]
    v_mfma_f32_32x32x16_bf16 v[116:131], a[68:71], v[20:23], v[116:131]
    v_mfma_f32_32x32x16_bf16 v[116:131], a[72:75], v[20:23], v[116:131]
    v_mfma_f32_32x32x16_bf16 v[116:131], a[76:79], v[20:23], v[116:131]
    v_mfma_f32_32x32x16_bf16 v[116:131], a[80:83], v[20:23], v[116:131]
    v_mfma_f32_32x32x16_bf16 v[116:131], a[84:87], v[20:23], v[116:131]
    v_mfma_f32_32x32x16_bf16 v[116:131], a[88:91], v[20:23], v[116:131]
    v_mfma_f32_32x32x16_bf16 v[116:131], a[92:95], v[20:23], v[116:131]
    v_mfma_f32_32x32x16_bf16 v[116:131], a[96:99], v[20:23], v[116:131]
    v_mfma_f32_32x32x16_bf16 v[116:131], a[100:103], v[20:23], v[116:131]
    v_mfma_f32_32x32x16_bf16 v[116:131], a[104:107], v[20:23], v[116:131]
    v_mfma_f32_32x32x16_bf16 v[116:131], a[108:111], v[20:23], v[116:131]
    v_mfma_f32_32x32x16_bf16 v[116:131], a[112:115], v[20:23], v[116:131]
    v_mfma_f32_32x32x16_bf16 v[116:131], a[116:119], v[20:23], v[116:131]
    v_mfma_f32_32x32x16_bf16 v[116:131], a[120:123], v[20:23], v[116:131]
    v_mfma_f32_32x32x16_bf16 v[116:131], a[124:127], v[20:23], v[116:131]
    v_mfma_f32_32x32x16_bf16 v[116:131], a[128:131], v[20:23], v[116:131]
    v_mfma_f32_32x32x16_bf16 v[116:131], a[132:135], v[20:23], v[116:131]
    v_mfma_f32_32x32x16_bf16 v[116:131], a[136:139], v[20:23], v[116:131]
    v_mfma_f32_32x32x16_bf16 v[116:131], a[140:143], v[20:23], v[116:131]
    v_mfma_f32_32x32x16_bf16 v[116:131], a[144:147], v[20:23], v[116:131]
    v_mfma_f32_32x32x16_bf16 v[116:131], a[148:151], v[20:23], v[116:131]
    v_mfma_f32_32x32x16_bf16 v[116:131], a[152:155], v[20:23], v[116:131]
    v_mfma_f32_32x32x16_bf16 v[116:131], a[156:159], v[20:23], v[116:131]
L_qq_con:
    v_lshlrev_b32 v2, 4, v1
    s_mul_i32 s55, s53, 40
    s_mul_i32 s56, s3, 10
    s_add_u32 s55, s55, s56
    s_add_u32 s55, s55, 0
    v_min_u32 v3, 9, v1
    v_add_u32 v3, s55, v3
    v_lshlrev_b32 v3, 7, v3
    v_mov_b32 v189, 0
    s_cmp_eq_u32 s53, 0
    s_cselect_b32 s55, 64, 0
    v_mov_b32 v189, s55
    s_lshl_b32 s55, s53, 7
    s_add_u32 s55, s55, 672
    s_lshl_b32 s55, s55, 7
    v_mov_b32 v11, s55
    v_cmp_gt_u32 vcc, 10, v1
    s_nop 1
    v_cndmask_b32 v3, v11, v3, vcc
    v_cndmask_b32 v189, 6, v189, vcc
    s_add_u32 s55, s3, 0
    s_and_b32 s55, s55, 3
    s_mul_i32 s55, s55, 10240
    v_add_u32 v5, s55, v2
    s_add_u32 s55, s3, 1
    s_and_b32 s55, s55, 3
    s_mul_i32 s55, s55, 10240
    v_add_u32 v6, s55, v2
    s_add_u32 s55, s3, 2
    s_and_b32 s55, s55, 3
    s_mul_i32 s55, s55, 10240
    v_add_u32 v7, s55, v2
    s_add_u32 s55, s3, 3
    s_and_b32 s55, s55, 3
    s_mul_i32 s55, s55, 10240
    v_add_u32 v8, s55, v2
    v_lshlrev_b32 v9, 3, v0
    v_add_u32 v9, 49152, v9
    v_and_b32 v10, 31, v1
    v_lshlrev_b32 v10, 3, v10
    v_add_u32 v10, 49152, v10
    v_mov_b32 v16, 128
Lp_17:
    buffer_load_dword v11, v16, s[8:11], 0 offen sc1
    s_waitcnt vmcnt(0)
    v_cmp_gt_i32 vcc, 1, v11
    s_cbranch_vccz Lpd_18
    s_sleep 8
    s_mov_b32 s54, 16
    s_sub_u32 s52, s52, 1
    s_cbranch_scc1 L_abort
    s_branch Lp_17
Lpd_18:
L_qq_nw:
    s_mov_b32 s60, 0
    s_mov_b32 s61, 0
    s_mul_i32 s66, s3, 10240
    s_barrier
    s_mov_b32 s70, 262144000
    v_mov_b32 v4, -100
    v_mov_b32 v19, 0
L_qq_slow:
    s_add_u32 s57, s60, 1
    v_add_u32 v188, v189, v4
    v_cmp_gt_i32 vcc, s57, v188
    s_cbranch_vccz L_qq_rdy
L_qq_poll:
    buffer_load_dword v11, v3, s[4:7], 0 offen sc1
    s_waitcnt vmcnt(0)
    buffer_store_dword v19, off, s[4:7], s70 sc1
    s_mov_b32 s70, 262144000
    v_add_u32 v188, v189, v11
    v_cmp_gt_i32 vcc, s57, v188
    s_cbranch_vccz L_qq_rdy
    s_sleep 1
    s_mov_b32 s54, 17
    s_sub_u32 s52, s52, 1
    s_cbranch_scc1 L_abort
    s_branch L_qq_poll
L_qq_rdy:
    s_branch L_qq_alt
.p2align 6
L_qq_loop:
    s_waitcnt vmcnt(4)
    s_cmp_eq_u32 s71, 262144000
    s_cbranch_scc1 L_qq_slow
L_qq_go:
    ds_read_b128 v[20:23], v5 offset:0
    ds_read_b128 v[24:27], v5 offset:1024
    ds_read_b128 v[28:31], v5 offset:2048
    ds_read_b128 v[32:35], v5 offset:3072
    ds_read_b128 v[36:39], v5 offset:4096
    ds_read_b128 v[40:43], v5 offset:5120
    ds_read_b128 v[44:47], v5 offset:6144
    ds_read_b128 v[48:51], v5 offset:7168
    ds_read_b128 v[52:55], v5 offset:8192
    ds_read_b128 v[56:59], v5 offset:9216
    s_add_u32 s55, s60, 1
    s_and_b32 s55, s55, 63
    s_cselect_b32 s55, 0, 2621440
    s_sub_u32 s62, s62, s55
    s_add_u32 s62, s62, 40960
    s_xor_b32 s66, s66, 0x10000
    s_add_u32 s57, s60, 2
    s_waitcnt lgkmcnt(9)
    v_mfma_f32_32x32x16_bf16 v[84:99], a[0:3], v[20:23], 0
    v_lshlrev_b32 v16, 16, v20
    v_and_b32 v17, 0xffff0000, v20
    v_mov_b32 v12, v16
    v_mov_b32 v13, v17
    v_mul_f32 v14, v16, v16
    v_mfma_f32_32x32x16_bf16 v[100:115], a[160:163], v[20:23], 0
    v_mul_f32 v15, v17, v17
    v_lshlrev_b32 v164, 16, v21
    v_and_b32 v165, 0xffff0000, v21
    v_add_f32 v12, v12, v164
    v_add_f32 v13, v13, v165
    s_waitcnt lgkmcnt(8)
    v_mfma_f32_32x32x16_bf16 v[84:99], a[4:7], v[24:27], v[84:99]
    v_fmac_f32 v14, v164, v164
    v_fmac_f32 v15, v165, v165
    v_lshlrev_b32 v16, 16, v22
    v_and_b32 v17, 0xffff0000, v22
    v_add_f32 v12, v12, v16
    v_mfma_f32_32x32x16_bf16 v[100:115], a[164:167], v[24:27], v[100:115]
    v_add_f32 v13, v13, v17
    v_fmac_f32 v14, v16, v16
    v_fmac_f32 v15, v17, v17
    v_lshlrev_b32 v164, 16, v23
    v_and_b32 v165, 0xffff0000, v23
    s_waitcnt lgkmcnt(7)
    v_mfma_f32_32x32x16_bf16 v[84:99], a[8:11], v[28:31], v[84:99]
    v_add_f32 v12, v12, v164
    v_add_f32 v13, v13, v165
    v_fmac_f32 v14, v164, v164
    v_fmac_f32 v15, v165, v165
    v_lshlrev_b32 v16, 16, v24
    v_mfma_f32_32x32x16_bf16 v[100:115], a[168:171], v[28:31], v[100:115]
    v_and_b32 v17, 0xffff0000, v24
    v_add_f32 v12, v12, v16
    v_add_f32 v13, v13, v17
    v_fmac_f32 v14, v16, v16
    v_fmac_f32 v15, v17, v17
    s_waitcnt lgkmcnt(6)
    v_mfma_f32_32x32x16_bf16 v[84:99], a[12:15], v[32:35], v[84:99]
    v_lshlrev_b32 v164, 16, v25
    v_and_b32 v165, 0xffff0000, v25
    v_add_f32 v12, v12, v164
    v_add_f32 v13, v13, v165
    v_fmac_f32 v14, v164, v164
    v_mfma_f32_32x32x16_bf16 v[100:115], a[172:175], v[32:35], v[100:115]
    v_fmac_f32 v15, v165, v165
    v_lshlrev_b32 v16, 16, v26
    v_and_b32 v17, 0xffff0000, v26
    v_add_f32 v12, v12, v16
    v_add_f32 v13, v13, v17
    s_waitcnt lgkmcnt(5)
    v_mfma_f32_32x32x16_bf16 v[84:99], a[16:19], v[36:39], v[84:99]
    v_fmac_f32 v14, v16, v16
    v_fmac_f32 v15, v17, v17
    v_lshlrev_b32 v164, 16, v27
    v_and_b32 v165, 0xffff0000, v27
    v_add_f32 v12, v12, v164
    v_mfma_f32_32x32x16_bf16 v[100:115], a[176:179], v[36:39], v[100:115]
    v_add_f32 v13, v13, v165
    v_fmac_f32 v14, v164, v164
    v_fmac_f32 v15, v165, v165
    v_lshlrev_b32 v16, 16, v28
    v_and_b32 v17, 0xffff0000, v28
    s_waitcnt lgkmcnt(4)
    v_mfma_f32_32x32x16_bf16 v[84:99], a[20:23], v[40:43], v[84:99]
    s_barrier
    ds_read_b128 v[60:63], v6 offset:0
    v_add_f32 v12, v12, v16
    v_add_f32 v13, v13, v17
    v_fmac_f32 v14, v16, v16
    v_fmac_f32 v15, v17, v17
    v_lshlrev_b32 v164, 16, v29
    v_mfma_f32_32x32x16_bf16 v[100:115], a[180:183], v[40:43], v[100:115]
    v_and_b32 v165, 0xffff0000, v29
    v_add_f32 v12, v12, v164
    v_add_f32 v13, v13, v165
    v_fmac_f32 v14, v164, v164
    v_fmac_f32 v15, v165, v165
    s_waitcnt lgkmcnt(4)
    v_mfma_f32_32x32x16_bf16 v[84:99], a[24:27], v[44:47], v[84:99]
    ds_read_b128 v[64:67], v6 offset:1024
    v_lshlrev_b32 v16, 16, v30
    v_and_b32 v17, 0xffff0000, v30
    v_add_f32 v12, v12, v16
    v_add_f32 v13, v13, v17
    v_fmac_f32 v14, v16, v16
    v_mfma_f32_32x32x16_bf16 v[100:115], a[184:187], v[44:47], v[100:115]
    v_fmac_f32 v15, v17, v17
    v_lshlrev_b32 v164, 16, v31
    v_and_b32 v165, 0xffff0000, v31
    v_add_f32 v12, v12, v164
    v_add_f32 v13, v13, v165
    s_waitcnt lgkmcnt(4)
    v_mfma_f32_32x32x16_bf16 v[84:99], a[28:31], v[48:51], v[84:99]
    ds_read_b128 v[68:71], v6 offset:2048
    v_fmac_f32 v14, v164, v164
    v_fmac_f32 v15, v165, v165
    v_lshlrev_b32 v16, 16, v32
    v_and_b32 v17, 0xffff0000, v32
    v_add_f32 v12, v12, v16
    v_mfma_f32_32x32x16_bf16 v[100:115], a[188:191], v[48:51], v[100:115]
    v_add_f32 v13, v13, v17
    v_fmac_f32 v14, v16, v16
    v_fmac_f32 v15, v17, v17
    v_lshlrev_b32 v164, 16, v33
    v_and_b32 v165, 0xffff0000, v33
    s_waitcnt lgkmcnt(4)
    v_mfma_f32_32x32x16_bf16 v[84:99], a[32:35], v[52:55], v[84:99]
    ds_read_b128 v[72:75], v6 offset:3072
    v_add_f32 v12, v12, v164
    v_add_f32 v13, v13, v165
    v_fmac_f32 v14, v164, v164
    v_fmac_f32 v15, v165, v165
    v_lshlrev_b32 v16, 16, v34
    v_mfma_f32_32x32x16_bf16 v[100:115], a[192:195], v[52:55], v[100:115]
    v_and_b32 v17, 0xffff0000, v34
    v_add_f32 v12, v12, v16
    v_add_f32 v13, v13, v17
    v_fmac_f32 v14, v16, v16
    v_fmac_f32 v15, v17, v17
    s_waitcnt lgkmcnt(4)
    v_mfma_f32_32x32x16_bf16 v[84:99], a[36:39], v[56:59], v[84:99]
    ds_read_b128 v[76:79], v6 offset:4096
    v_lshlrev_b32 v164, 16, v35
    v_and_b32 v165, 0xffff0000, v35
    v_add_f32 v12, v12, v164
    v_add_f32 v13, v13, v165
    v_fmac_f32 v14, v164, v164
    v_mfma_f32_32x32x16_bf16 v[100:115], a[196:199], v[56:59], v[100:115]
    v_fmac_f32 v15, v165, v165
    v_lshlrev_b32 v16, 16, v36
    v_and_b32 v17, 0xffff0000, v36
    v_add_f32 v12, v12, v16
    v_add_f32 v13, v13, v17
L_qq_join:
    s_waitcnt lgkmcnt(4)
    v_mfma_f32_32x32x16_bf16 v[84:99], a[40:43], v[60:63], v[84:99]
    ds_read_b128 v[80:83], v6 offset:5120
    v_fmac_f32 v14, v16, v16
    v_fmac_f32 v15, v17, v17
    v_lshlrev_b32 v164, 16, v37
    v_and_b32 v165, 0xffff0000, v37
    v_add_f32 v12, v12, v164
    v_mfma_f32_32x32x16_bf16 v[100:115], a[200:203], v[60:63], v[100:115]
    v_add_f32 v13, v13, v165
    v_fmac_f32 v14, v164, v164
    v_fmac_f32 v15, v165, v165
    v_lshlrev_b32 v16, 16, v38
    v_and_b32 v17, 0xffff0000, v38
    s_waitcnt lgkmcnt(4)
    v_mfma_f32_32x32x16_bf16 v[84:99], a[44:47], v[64:67], v[84:99]
    ds_read_b128 v[60:63], v6 offset:6144
    v_add_f32 v12, v12, v16
    v_add_f32 v13, v13, v17
    v_fmac_f32 v14, v16, v16
    v_fmac_f32 v15, v17, v17
    v_lshlrev_b32 v164, 16, v39
    v_mfma_f32_32x32x16_bf16 v[100:115], a[204:207], v[64:67], v[100:115]
    v_and_b32 v165, 0xffff0000, v39
    v_add_f32 v12, v12, v164
    v_add_f32 v13, v13, v165
    v_fmac_f32 v14, v164, v164
    v_fmac_f32 v15, v165, v165
    s_waitcnt lgkmcnt(4)
    v_mfma_f32_32x32x16_bf16 v[84:99], a[48:51], v[68:71], v[84:99]
    ds_read_b128 v[64:67], v6 offset:7168
    v_lshlrev_b32 v16, 16, v40
    v_and_b32 v17, 0xffff0000, v40
    v_add_f32 v12, v12, v16
    v_add_f32 v13, v13, v17
    v_fmac_f32 v14, v16, v16
    v_mfma_f32_32x32x16_bf16 v[100:115], a[208:211], v[68:71], v[100:115]
    v_fmac_f32 v15, v17, v17
    v_lshlrev_b32 v164, 16, v41
    v_and_b32 v165, 0xffff0000, v41
    v_add_f32 v12, v12, v164
    v_add_f32 v13, v13, v165
    s_waitcnt lgkmcnt(4)
    v_mfma_f32_32x32x16_bf16 v[84:99], a[52:55], v[72:75], v[84:99]
    ds_read_b128 v[68:71], v6 offset:8192
    v_fmac_f32 v14, v164, v164
    v_fmac_f32 v15, v165, v165
    v_lshlrev_b32 v16, 16, v42
    v_and_b32 v17, 0xffff0000, v42
    v_add_f32 v12, v12, v16
    v_mfma_f32_32x32x16_bf16 v[100:115], a[212:215], v[72:75], v[100:115]
    s_waitcnt vmcnt(0)
    buffer_store_dword v19, off, s[4:7], s70 sc1
    s_mov_b32 s70, 262144000
    v_add_f32 v13, v13, v17
    v_fmac_f32 v14, v16, v16
    v_fmac_f32 v15, v17, v17
    s_waitcnt lgkmcnt(4)
    v_mfma_f32_32x32x16_bf16 v[84:99], a[56:59], v[76:79], v[84:99]
    ds_read_b128 v[72:75], v6 offset:9216
    v_lshlrev_b32 v164, 16, v43
    v_and_b32 v165, 0xffff0000, v43
    v_add_f32 v12, v12, v164
    v_add_f32 v13, v13, v165
    v_fmac_f32 v14, v164, v164
    v_mfma_f32_32x32x16_bf16 v[100:115], a[216:219], v[76:79], v[100:115]
    v_fmac_f32 v15, v165, v165
    v_lshlrev_b32 v16, 16, v44
    v_and_b32 v17, 0xffff0000, v44
    v_add_f32 v12, v12, v16
    v_add_f32 v13, v13, v17
    s_waitcnt lgkmcnt(4)
    v_mfma_f32_32x32x16_bf16 v[84:99], a[60:63], v[80:83], v[84:99]
    ds_read_b128 v[76:79], v7 offset:0
    v_fmac_f32 v14, v16, v16
    v_fmac_f32 v15, v17, v17
    v_lshlrev_b32 v164, 16, v45
    v_and_b32 v165, 0xffff0000, v45
    v_add_f32 v12, v12, v164
    v_mfma_f32_32x32x16_bf16 v[100:115], a[220:223], v[80:83], v[100:115]
    v_add_f32 v13, v13, v165
    v_fmac_f32 v14, v164, v164
    v_fmac_f32 v15, v165, v165
    v_lshlrev_b32 v16, 16, v46
    v_and_b32 v17, 0xffff0000, v46
    s_waitcnt lgkmcnt(4)
    v_mfma_f32_32x32x16_bf16 v[84:99], a[64:67], v[60:63], v[84:99]
    ds_read_b128 v[80:83], v7 offset:1024
    v_add_f32 v12, v12, v16
    v_add_f32 v13, v13, v17
    v_fmac_f32 v14, v16, v16
    v_fmac_f32 v15, v17, v17
    v_lshlrev_b32 v164, 16, v47
    v_mfma_f32_32x32x16_bf16 v[100:115], a[224:227], v[60:63], v[100:115]
    v_and_b32 v165, 0xffff0000, v47
    v_add_f32 v12, v12, v164
    v_add_f32 v13, v13, v165
    v_fmac_f32 v14, v164, v164
    v_fmac_f32 v15, v165, v165
    s_waitcnt lgkmcnt(4)
    v_mfma_f32_32x32x16_bf16 v[84:99], a[68:71], v[64:67], v[84:99]
    ds_read_b128 v[60:63], v7 offset:2048
    v_lshlrev_b32 v16, 16, v48
    v_and_b32 v17, 0xffff0000, v48
    v_add_f32 v12, v12, v16
    v_add_f32 v13, v13, v17
    v_fmac_f32 v14, v16, v16
    v_mfma_f32_32x32x16_bf16 v[100:115], a[228:231], v[64:67], v[100:115]
    buffer_load_dword v11, v3, s[4:7], 0 offen sc1
    v_fmac_f32 v15, v17, v17
    v_lshlrev_b32 v164, 16, v49
    v_and_b32 v165, 0xffff0000, v49
    s_waitcnt lgkmcnt(4)
    v_mfma_f32_32x32x16_bf16 v[84:99], a[72:75], v[68:71], v[84:99]
    ds_read_b128 v[64:67], v7 offset:3072
    v_add_f32 v12, v12, v164
    v_add_f32 v13, v13, v165
    v_fmac_f32 v14, v164, v164
    v_fmac_f32 v15, v165, v165
    v_lshlrev_b32 v16, 16, v50
    v_mfma_f32_32x32x16_bf16 v[100:115], a[232:235], v[68:71], v[100:115]
    v_and_b32 v17, 0xffff0000, v50
    v_add_f32 v12, v12, v16
    v_add_f32 v13, v13, v17
    v_fmac_f32 v14, v16, v16
    v_fmac_f32 v15, v17, v17
    s_waitcnt lgkmcnt(4)
    v_mfma_f32_32x32x16_bf16 v[84:99], a[76:79], v[72:75], v[84:99]
    ds_read_b128 v[68:71], v7 offset:4096
    v_lshlrev_b32 v164, 16, v51
    v_and_b32 v165, 0xffff0000, v51
    v_add_f32 v12, v12, v164
    v_add_f32 v13, v13, v165
    v_fmac_f32 v14, v164, v164
    v_mfma_f32_32x32x16_bf16 v[100:115], a[236:239], v[72:75], v[100:115]
    v_fmac_f32 v15, v165, v165
    v_lshlrev_b32 v16, 16, v52
    v_and_b32 v17, 0xffff0000, v52
    v_add_f32 v12, v12, v16
    v_add_f32 v13, v13, v17
    s_waitcnt lgkmcnt(4)
    v_mfma_f32_32x32x16_bf16 v[84:99], a[80:83], v[76:79], v[84:99]
    ds_read_b128 v[72:75], v7 offset:5120
    v_fmac_f32 v14, v16, v16
    v_fmac_f32 v15, v17, v17
    v_lshlrev_b32 v164, 16, v53
    v_and_b32 v165, 0xffff0000, v53
    v_add_f32 v12, v12, v164
    v_mfma_f32_32x32x16_bf16 v[100:115], a[240:243], v[76:79], v[100:115]
    v_add_f32 v13, v13, v165
    v_fmac_f32 v14, v164, v164
    v_fmac_f32 v15, v165, v165
    v_lshlrev_b32 v16, 16, v54
    v_and_b32 v17, 0xffff0000, v54
    s_waitcnt lgkmcnt(4)
    v_mfma_f32_32x32x16_bf16 v[84:99], a[84:87], v[80:83], v[84:99]
    ds_read_b128 v[76:79], v7 offset:6144
    v_add_f32 v12, v12, v16
    v_add_f32 v13, v13, v17
    v_fmac_f32 v14, v16, v16
    v_fmac_f32 v15, v17, v17
    v_lshlrev_b32 v164, 16, v55
    v_mfma_f32_32x32x16_bf16 v[100:115], a[244:247], v[80:83], v[100:115]
    v_and_b32 v165, 0xffff0000, v55
    v_add_f32 v12, v12, v164
    v_add_f32 v13, v13, v165
    v_fmac_f32 v14, v164, v164
    v_fmac_f32 v15, v165, v165
    s_waitcnt lgkmcnt(4)
    v_mfma_f32_32x32x16_bf16 v[84:99], a[88:91], v[60:63], v[84:99]
    ds_read_b128 v[80:83], v7 offset:7168
    v_lshlrev_b32 v16, 16, v56
    v_and_b32 v17, 0xffff0000, v56
    v_add_f32 v12, v12, v16
    v_add_f32 v13, v13, v17
    v_fmac_f32 v14, v16, v16
    v_mfma_f32_32x32x16_bf16 v[100:115], a[248:251], v[60:63], v[100:115]
    v_fmac_f32 v15, v17, v17
    v_lshlrev_b32 v164, 16, v57
    v_and_b32 v165, 0xffff0000, v57
    v_add_f32 v12, v12, v164
    v_add_f32 v13, v13, v165
    s_waitcnt lgkmcnt(4)
    v_mfma_f32_32x32x16_bf16 v[84:99], a[92:95], v[64:67], v[84:99]
    ds_read_b128 v[60:63], v7 offset:8192
    v_fmac_f32 v14, v164, v164
    v_fmac_f32 v15, v165, v165
    v_lshlrev_b32 v16, 16, v58
    v_and_b32 v17, 0xffff0000, v58
    v_add_f32 v12, v12, v16
    v_mfma_f32_32x32x16_bf16 v[100:115], a[252:255], v[64:67], v[100:115]
    v_add_f32 v13, v13, v17
    v_fmac_f32 v14, v16, v16
    v_fmac_f32 v15, v17, v17
    v_lshlrev_b32 v164, 16, v59
    v_and_b32 v165, 0xffff0000, v59
    s_waitcnt lgkmcnt(4)
    v_mfma_f32_32x32x16_bf16 v[84:99], a[96:99], v[68:71], v[84:99]
    ds_read_b128 v[64:67], v7 offset:9216
    v_add_f32 v12, v12, v164
    v_add_f32 v13, v13, v165
    v_fmac_f32 v14, v164, v164
    v_fmac_f32 v15, v165, v165
    v_add_f32 v12, v12, v13
    v_mfma_f32_32x32x16_bf16 v[100:115], v[192:195], v[68:71], v[100:115]
    v_add_f32 v13, v14, v15
    ds_write_b64 v9, v[12:13]
    s_waitcnt lgkmcnt(5)
    v_mfma_f32_32x32x16_bf16 v[84:99], a[100:103], v[72:75], v[84:99]
    ds_read_b128 v[68:71], v8 offset:0
    v_mfma_f32_32x32x16_bf16 v[100:115], v[196:199], v[72:75], v[100:115]
    s_waitcnt lgkmcnt(1)
    s_barrier
    ds_read_b64 v[148:149], v10 offset:0
    ds_read_b64 v[150:151], v10 offset:256
    ds_read_b64 v[152:153], v10 offset:512
    ds_read_b64 v[154:155], v10 offset:768
    ds_read_b64 v[156:157], v10 offset:1024
    ds_read_b64 v[158:159], v10 offset:1280
    ds_read_b64 v[160:161], v10 offset:1536
    ds_read_b64 v[162:163], v10 offset:1792
    v_mfma_f32_32x32x16_bf16 v[84:99], a[104:107], v[76:79], v[84:99]
    ds_read_b128 v[72:75], v8 offset:1024
    v_mfma_f32_32x32x16_bf16 v[100:115], v[200:203], v[76:79], v[100:115]
    v_mfma_f32_32x32x16_bf16 v[84:99], a[108:111], v[80:83], v[84:99]
    ds_read_b128 v[76:79], v8 offset:2048
    s_waitcnt lgkmcnt(2)
    v_add_f32 v148, v148, v156
    v_add_f32 v149, v149, v157
    v_add_f32 v150, v150, v158
    v_add_f32 v151, v151, v159
    v_mfma_f32_32x32x16_bf16 v[100:115], v[204:207], v[80:83], v[100:115]
    v_add_f32 v152, v152, v160
    v_add_f32 v153, v153, v161
    v_add_f32 v154, v154, v162
    v_add_f32 v155, v155, v163
    v_add_f32 v148, v148, v152
    v_mfma_f32_32x32x16_bf16 v[84:99], a[112:115], v[60:63], v[84:99]
    ds_read_b128 v[80:83], v8 offset:3072
    s_waitcnt vmcnt(0)
    v_add_u32 v188, v189, v11
    v_cmp_gt_i32 vcc, s57, v188
    v_add_f32 v149, v149, v153
    v_add_f32 v150, v150, v154
    v_add_f32 v151, v151, v155
    v_mfma_f32_32x32x16_bf16 v[84:99], a[116:119], v[64:67], v[84:99]
    ds_read_b128 v[60:63], v8 offset:4096
    s_cmp_eq_u64 vcc, 0
    s_cselect_b32 s71, s62, 262144000
    buffer_load_dword v11, v3, s[4:7], 0 offen sc1
    v_add_f32 v148, v148, v150
    v_add_f32 v149, v149, v151
    v_mul_f32 v180, 0.0015625, v148
    v_mfma_f32_32x32x16_bf16 v[84:99], a[120:123], v[68:71], v[84:99]
    ds_read_b128 v[64:67], v8 offset:5120
    v_mul_f32 v181, 0.0015625, v149
    v_fma_f32 v181, -v180, v180, v181
    v_max_f32 v181, 0, v181
    v_cvt_pk_bf16_f32 v181, v181, v181
    v_and_b32 v181, 0xffff0000, v181
    s_waitcnt lgkmcnt(4)
    v_mfma_f32_32x32x16_bf16 v[84:99], a[124:127], v[72:75], v[84:99]
    ds_read_b128 v[68:71], v8 offset:6144
    s_mov_b32 m0, s66
    s_mov_b32 s56, s71
    buffer_load_dwordx4 v2, s[4:7], s56 offen offset:0 sc1 lds
    v_add_f32 v181, 0x3727c5ac, v181
    v_cvt_pk_bf16_f32 v181, v181, v181
    v_and_b32 v181, 0xffff0000, v181
    s_waitcnt lgkmcnt(4)
    v_mfma_f32_32x32x16_bf16 v[84:99], a[128:131], v[76:79], v[84:99]
    ds_read_b128 v[72:75], v8 offset:7168
    v_sqrt_f32 v16, v181
    v_cvt_pk_bf16_f32 v180, v180, v180
    v_and_b32 v180, 0xffff0000, v180
    v_cvt_pk_bf16_f32 v16, v16, v16
    s_waitcnt lgkmcnt(4)
    v_mfma_f32_32x32x16_bf16 v[84:99], a[132:135], v[80:83], v[84:99]
    ds_read_b128 v[76:79], v8 offset:8192
    buffer_load_dwordx4 v2, s[4:7], s56 offen offset:1024 sc1 lds
    v_and_b32 v16, 0xffff0000, v16
    v_rcp_f32 v181, v16
    s_waitcnt lgkmcnt(4)
    v_mfma_f32_32x32x16_bf16 v[84:99], a[136:139], v[60:63], v[84:99]
    ds_read_b128 v[80:83], v8 offset:9216
    s_waitcnt lgkmcnt(4)
    v_mfma_f32_32x32x16_bf16 v[84:99], a[140:143], v[64:67], v[84:99]
    ds_read_b128 v[60:63], v7 offset:8192
    buffer_load_dwordx4 v2, s[4:7], s56 offen offset:2048 sc1 lds
    s_waitcnt lgkmcnt(4)
    v_mfma_f32_32x32x16_bf16 v[84:99], a[144:147], v[68:71], v[84:99]
    ds_read_b128 v[64:67], v7 offset:9216
    s_waitcnt lgkmcnt(4)
    v_mfma_f32_32x32x16_bf16 v[84:99], a[148:151], v[72:75], v[84:99]
    ds_read_b128 v[68:71], v8 offset:0
    buffer_load_dwordx4 v2, s[4:7], s56 offen offset:3072 sc1 lds
    s_waitcnt lgkmcnt(4)
    v_mfma_f32_32x32x16_bf16 v[84:99], a[152:155], v[76:79], v[84:99]
    ds_read_b128 v[72:75], v8 offset:1024
    s_waitcnt lgkmcnt(4)
    v_mfma_f32_32x32x16_bf16 v[84:99], a[156:159], v[80:83], v[84:99]
    ds_read_b128 v[76:79], v8 offset:2048
    s_add_u32 m0, m0, 4096
    s_add_u32 s56, s56, 4096
    buffer_load_dwordx4 v2, s[4:7], s56 offen offset:0 sc1 lds
    s_waitcnt lgkmcnt(4)
    v_mfma_f32_32x32x16_bf16 v[100:115], v[208:211], v[60:63], v[100:115]
    ds_read_b128 v[80:83], v8 offset:3072
    s_waitcnt lgkmcnt(4)
    v_mfma_f32_32x32x16_bf16 v[100:115], v[212:215], v[64:67], v[100:115]
    ds_read_b128 v[60:63], v8 offset:4096
    buffer_load_dwordx4 v2, s[4:7], s56 offen offset:1024 sc1 lds
    s_nop 0
    v_fma_f32 v84, -v180, v116, v84
    v_fma_f32 v85, -v180, v117, v85
    v_fma_f32 v86, -v180, v118, v86
    s_waitcnt lgkmcnt(4)
    v_mfma_f32_32x32x16_bf16 v[100:115], v[216:219], v[68:71], v[100:115]
    ds_read_b128 v[64:67], v8 offset:5120
    v_fma_f32 v87, -v180, v119, v87
    v_fma_f32 v88, -v180, v120, v88
    v_fma_f32 v89, -v180, v121, v89
    v_fma_f32 v90, -v180, v122, v90
    v_fma_f32 v91, -v180, v123, v91
    s_waitcnt lgkmcnt(4)
    v_mfma_f32_32x32x16_bf16 v[100:115], v[220:223], v[72:75], v[100:115]
    ds_read_b128 v[68:71], v8 offset:6144
    buffer_load_dwordx4 v2, s[4:7], s56 offen offset:2048 sc1 lds
    v_fma_f32 v92, -v180, v124, v92
    v_fma_f32 v93, -v180, v125, v93
    v_fma_f32 v94, -v180, v126, v94
    s_waitcnt lgkmcnt(4)
    v_mfma_f32_32x32x16_bf16 v[100:115], v[224:227], v[76:79], v[100:115]
    ds_read_b128 v[72:75], v8 offset:7168
    v_fma_f32 v95, -v180, v127, v95
    v_fma_f32 v96, -v180, v128, v96
    v_fma_f32 v97, -v180, v129, v97
    v_fma_f32 v98, -v180, v130, v98
    v_fma_f32 v99, -v180, v131, v99
    s_waitcnt lgkmcnt(4)
    v_mfma_f32_32x32x16_bf16 v[100:115], v[228:231], v[80:83], v[100:115]
    ds_read_b128 v[76:79], v8 offset:8192
    buffer_load_dwordx4 v2, s[4:7], s56 offen offset:3072 sc1 lds
    v_mul_f32 v84, v181, v84
    v_mul_f32 v85, v181, v85
    v_mul_f32 v86, v181, v86
    s_waitcnt lgkmcnt(4)
    v_mfma_f32_32x32x16_bf16 v[100:115], v[232:235], v[60:63], v[100:115]
    ds_read_b128 v[80:83], v8 offset:9216
    v_mul_f32 v87, v181, v87
    v_mul_f32 v88, v181, v88
    v_mul_f32 v89, v181, v89
    v_mul_f32 v90, v181, v90
    v_mul_f32 v91, v181, v91
    s_waitcnt lgkmcnt(4)
    v_mfma_f32_32x32x16_bf16 v[100:115], v[236:239], v[64:67], v[100:115]
    s_add_u32 m0, m0, 4096
    s_add_u32 s56, s56, 4096
    buffer_load_dwordx4 v2, s[4:7], s56 offen offset:0 sc1 lds
    v_mul_f32 v92, v181, v92
    v_mul_f32 v93, v181, v93
    v_mul_f32 v94, v181, v94
    s_waitcnt lgkmcnt(3)
    v_mfma_f32_32x32x16_bf16 v[100:115], v[240:243], v[68:71], v[100:115]
    v_mul_f32 v95, v181, v95
    v_mul_f32 v96, v181, v96
    v_mul_f32 v97, v181, v97
    v_mul_f32 v98, v181, v98
    v_mul_f32 v99, v181, v99
    s_waitcnt lgkmcnt(2)
    v_mfma_f32_32x32x16_bf16 v[100:115], v[244:247], v[72:75], v[100:115]
    buffer_load_dwordx4 v2, s[4:7], s56 offen offset:1024 sc1 lds
    v_cvt_pk_bf16_f32 v20, v84, v92
    v_cvt_pk_bf16_f32 v21, v85, v93
    v_cvt_pk_bf16_f32 v22, v86, v94
    s_waitcnt lgkmcnt(1)
    v_mfma_f32_32x32x16_bf16 v[100:115], v[248:251], v[76:79], v[100:115]
    v_cvt_pk_bf16_f32 v23, v87, v95
    v_cvt_pk_bf16_f32 v24, v88, v96
    v_cvt_pk_bf16_f32 v25, v89, v97
    v_cvt_pk_bf16_f32 v26, v90, v98
    v_cvt_pk_bf16_f32 v27, v91, v99
    s_waitcnt lgkmcnt(0)
    v_mfma_f32_32x32x16_bf16 v[100:115], v[252:255], v[80:83], v[100:115]
    v_xor_b32 v9, 2048, v9
    v_xor_b32 v10, 2048, v10
    v_xor_b32 v5, 0x10000, v5
    v_xor_b32 v6, 0x10000, v6
    v_xor_b32 v7, 0x10000, v7
    v_xor_b32 v8, 0x10000, v8
    s_add_u32 s64, s63, 8192
    s_add_u32 s60, s60, 1
    v_mov_b32 v19, s60
    s_mov_b32 s70, s65
    s_cmp_lg_u32 s71, 262144000
    s_cbranch_scc1 L_qq_c2
    s_waitcnt vmcnt(10)
    v_add_u32 v188, v189, v11
    v_cmp_gt_i32 vcc, s57, v188
    s_cbranch_vccnz L_qq_c2
    s_mov_b32 s71, s62
    s_mov_b32 m0, s66
    s_mov_b32 s56, s62
    buffer_load_dwordx4 v2, s[4:7], s56 offen offset:0 sc1 lds
    buffer_load_dwordx4 v2, s[4:7], s56 offen offset:1024 sc1 lds
    buffer_load_dwordx4 v2, s[4:7], s56 offen offset:2048 sc1 lds
    buffer_load_dwordx4 v2, s[4:7], s56 offen offset:3072 sc1 lds
    s_add_u32 m0, m0, 4096
    s_add_u32 s56, s56, 4096
    buffer_load_dwordx4 v2, s[4:7], s56 offen offset:0 sc1 lds
    buffer_load_dwordx4 v2, s[4:7], s56 offen offset:1024 sc1 lds
    buffer_load_dwordx4 v2, s[4:7], s56 offen offset:2048 sc1 lds
    buffer_load_dwordx4 v2, s[4:7], s56 offen offset:3072 sc1 lds
    s_add_u32 m0, m0, 4096
    s_add_u32 s56, s56, 4096
    buffer_load_dwordx4 v2, s[4:7], s56 offen offset:0 sc1 lds
    buffer_load_dwordx4 v2, s[4:7], s56 offen offset:1024 sc1 lds
L_qq_c2:
    buffer_load_dword v4, v3, s[4:7], 0 offen sc1
    buffer_store_dwordx4 v[20:23], v2, s[4:7], s63 offen offset:0 sc1
    buffer_store_dwordx4 v[24:27], v2, s[4:7], s63 offen offset:1024 sc1
    v_pk_fma_f32 v[100:101], v[180:181], v[132:133], v[100:101] op_sel_hi:[0,1,1] neg_lo:[1,0,0] neg_hi:[1,0,0]
    v_pk_fma_f32 v[102:103], v[180:181], v[134:135], v[102:103] op_sel_hi:[0,1,1] neg_lo:[1,0,0] neg_hi:[1,0,0]
    v_pk_fma_f32 v[104:105], v[180:181], v[136:137], v[104:105] op_sel_hi:[0,1,1] neg_lo:[1,0,0] neg_hi:[1,0,0]
    v_pk_fma_f32 v[106:107], v[180:181], v[138:139], v[106:107] op_sel_hi:[0,1,1] neg_lo:[1,0,0] neg_hi:[1,0,0]
    v_pk_fma_f32 v[108:109], v[180:181], v[140:141], v[108:109] op_sel_hi:[0,1,1] neg_lo:[1,0,0] neg_hi:[1,0,0]
    v_pk_fma_f32 v[110:111], v[180:181], v[142:143], v[110:111] op_sel_hi:[0,1,1] neg_lo:[1,0,0] neg_hi:[1,0,0]
    v_pk_fma_f32 v[112:113], v[180:181], v[144:145], v[112:113] op_sel_hi:[0,1,1] neg_lo:[1,0,0] neg_hi:[1,0,0]
    v_pk_fma_f32 v[114:115], v[180:181], v[146:147], v[114:115] op_sel_hi:[0,1,1] neg_lo:[1,0,0] neg_hi:[1,0,0]
    v_pk_mul_f32 v[100:101], v[180:181], v[100:101] op_sel:[1,0]
    v_pk_mul_f32 v[102:103], v[180:181], v[102:103] op_sel:[1,0]
    v_pk_mul_f32 v[104:105], v[180:181], v[104:105] op_sel:[1,0]
    v_pk_mul_f32 v[106:107], v[180:181], v[106:107] op_sel:[1,0]
    v_pk_mul_f32 v[108:109], v[180:181], v[108:109] op_sel:[1,0]
    v_pk_mul_f32 v[110:111], v[180:181], v[110:111] op_sel:[1,0]
    v_pk_mul_f32 v[112:113], v[180:181], v[112:113] op_sel:[1,0]
    v_pk_mul_f32 v[114:115], v[180:181], v[114:115] op_sel:[1,0]
    v_cvt_pk_bf16_f32 v60, v100, v108
    v_cvt_pk_bf16_f32 v61, v101, v109
    v_cvt_pk_bf16_f32 v62, v102, v110
    v_cvt_pk_bf16_f32 v63, v103, v111
    buffer_store_dwordx4 v[60:63], v2, s[4:7], s64 offen offset:0 sc1
    v_cvt_pk_bf16_f32 v64, v104, v112
    v_cvt_pk_bf16_f32 v65, v105, v113
    v_cvt_pk_bf16_f32 v66, v106, v114
    v_cvt_pk_bf16_f32 v67, v107, v115
    buffer_store_dwordx4 v[64:67], v2, s[4:7], s64 offen offset:1024 sc1
    s_add_u32 s55, s60, 0
    s_and_b32 s55, s55, 63
    s_cselect_b32 s55, 0, 16777216
    s_sub_u32 s63, s63, s55
    s_add_u32 s63, s63, 262144
    s_cmp_lt_u32 s60, 64
    s_cbranch_scc1 L_qq_loop
    s_waitcnt vmcnt(0)
    buffer_store_dword v19, off, s[4:7], s70 sc1
    s_mov_b32 s70, 262144000
    s_endpgm
L_qq_alt:
    s_mov_b32 m0, s66
    s_mov_b32 s56, s62
    buffer_load_dwordx4 v2, s[4:7], s56 offen offset:0 sc1 lds
    buffer_load_dwordx4 v2, s[4:7], s56 offen offset:1024 sc1 lds
    buffer_load_dwordx4 v2, s[4:7], s56 offen offset:2048 sc1 lds
    buffer_load_dwordx4 v2, s[4:7], s56 offen offset:3072 sc1 lds
    s_add_u32 m0, m0, 4096
    s_add_u32 s56, s56, 4096
    buffer_load_dwordx4 v2, s[4:7], s56 offen offset:0 sc1 lds
    s_waitcnt vmcnt(4)
    ds_read_b128 v[20:23], v5 offset:0
    buffer_load_dwordx4 v2, s[4:7], s56 offen offset:1024 sc1 lds
    s_waitcnt vmcnt(4)
    ds_read_b128 v[24:27], v5 offset:1024
    s_waitcnt lgkmcnt(1)
    v_mfma_f32_32x32x16_bf16 v[84:99], a[0:3], v[20:23], 0
    buffer_load_dwordx4 v2, s[4:7], s56 offen offset:2048 sc1 lds
    v_lshlrev_b32 v16, 16, v20
    v_and_b32 v17, 0xffff0000, v20
    v_mov_b32 v12, v16
    v_mov_b32 v13, v17
    v_mul_f32 v14, v16, v16
    v_mfma_f32_32x32x16_bf16 v[100:115], a[160:163], v[20:23], 0
    s_waitcnt vmcnt(4)
    ds_read_b128 v[28:31], v5 offset:2048
    v_mul_f32 v15, v17, v17
    v_lshlrev_b32 v164, 16, v21
    v_and_b32 v165, 0xffff0000, v21
    v_add_f32 v12, v12, v164
    v_add_f32 v13, v13, v165
    s_waitcnt lgkmcnt(1)
    v_mfma_f32_32x32x16_bf16 v[84:99], a[4:7], v[24:27], v[84:99]
    buffer_load_dwordx4 v2, s[4:7], s56 offen offset:3072 sc1 lds
    v_fmac_f32 v14, v164, v164
    v_fmac_f32 v15, v165, v165
    v_lshlrev_b32 v16, 16, v22
    v_and_b32 v17, 0xffff0000, v22
    v_add_f32 v12, v12, v16
    v_mfma_f32_32x32x16_bf16 v[100:115], a[164:167], v[24:27], v[100:115]
    s_waitcnt vmcnt(4)
    ds_read_b128 v[32:35], v5 offset:3072
    v_add_f32 v13, v13, v17
    v_fmac_f32 v14, v16, v16
    v_fmac_f32 v15, v17, v17
    v_lshlrev_b32 v164, 16, v23
    v_and_b32 v165, 0xffff0000, v23
    s_waitcnt lgkmcnt(1)
    v_mfma_f32_32x32x16_bf16 v[84:99], a[8:11], v[28:31], v[84:99]
    s_add_u32 m0, m0, 4096
    s_add_u32 s56, s56, 4096
    buffer_load_dwordx4 v2, s[4:7], s56 offen offset:0 sc1 lds
    v_add_f32 v12, v12, v164
    v_add_f32 v13, v13, v165
    v_fmac_f32 v14, v164, v164
    v_fmac_f32 v15, v165, v165
    v_lshlrev_b32 v16, 16, v24
    v_mfma_f32_32x32x16_bf16 v[100:115], a[168:171], v[28:31], v[100:115]
    s_waitcnt vmcnt(4)
    ds_read_b128 v[36:39], v5 offset:4096
    v_and_b32 v17, 0xffff0000, v24
    v_add_f32 v12, v12, v16
    v_add_f32 v13, v13, v17
    v_fmac_f32 v14, v16, v16
    v_fmac_f32 v15, v17, v17
    s_waitcnt lgkmcnt(1)
    v_mfma_f32_32x32x16_bf16 v[84:99], a[12:15], v[32:35], v[84:99]
    buffer_load_dwordx4 v2, s[4:7], s56 offen offset:1024 sc1 lds
    v_lshlrev_b32 v164, 16, v25
    v_and_b32 v165, 0xffff0000, v25
    v_add_f32 v12, v12, v164
    v_add_f32 v13, v13, v165
    v_fmac_f32 v14, v164, v164
    v_mfma_f32_32x32x16_bf16 v[100:115], a[172:175], v[32:35], v[100:115]
    s_waitcnt vmcnt(4)
    ds_read_b128 v[40:43], v5 offset:5120
    v_fmac_f32 v15, v165, v165
    v_lshlrev_b32 v16, 16, v26
    v_and_b32 v17, 0xffff0000, v26
    v_add_f32 v12, v12, v16
    v_add_f32 v13, v13, v17
    s_waitcnt lgkmcnt(1)
    v_mfma_f32_32x32x16_bf16 v[84:99], a[16:19], v[36:39], v[84:99]
    s_add_u32 s55, s60, 1
    s_and_b32 s55, s55, 63
    s_cselect_b32 s55, 0, 2621440
    s_sub_u32 s62, s62, s55
    s_add_u32 s62, s62, 40960
    s_xor_b32 s66, s66, 0x10000
    s_add_u32 s57, s60, 2
    v_fmac_f32 v14, v16, v16
    v_fmac_f32 v15, v17, v17
    v_lshlrev_b32 v164, 16, v27
    v_and_b32 v165, 0xffff0000, v27
    v_add_f32 v12, v12, v164
    v_mfma_f32_32x32x16_bf16 v[100:115], a[176:179], v[36:39], v[100:115]
    s_waitcnt vmcnt(3)
    ds_read_b128 v[44:47], v5 offset:6144
    v_add_f32 v13, v13, v165
    v_fmac_f32 v14, v164, v164
    v_fmac_f32 v15, v165, v165
    v_lshlrev_b32 v16, 16, v28
    v_and_b32 v17, 0xffff0000, v28
    s_waitcnt lgkmcnt(1)
    v_mfma_f32_32x32x16_bf16 v[84:99], a[20:23], v[40:43], v[84:99]
    v_add_f32 v12, v12, v16
    v_add_f32 v13, v13, v17
    v_fmac_f32 v14, v16, v16
    v_fmac_f32 v15, v17, v17
    v_lshlrev_b32 v164, 16, v29
    v_mfma_f32_32x32x16_bf16 v[100:115], a[180:183], v[40:43], v[100:115]
    s_waitcnt vmcnt(2)
    ds_read_b128 v[48:51], v5 offset:7168
    v_and_b32 v165, 0xffff0000, v29
    v_add_f32 v12, v12, v164
    v_add_f32 v13, v13, v165
    v_fmac_f32 v14, v164, v164
    v_fmac_f32 v15, v165, v165
    s_waitcnt lgkmcnt(1)
    v_mfma_f32_32x32x16_bf16 v[84:99], a[24:27], v[44:47], v[84:99]
    s_waitcnt vmcnt(1)
    ds_read_b128 v[52:55], v5 offset:8192
    v_lshlrev_b32 v16, 16, v30
    v_and_b32 v17, 0xffff0000, v30
    v_add_f32 v12, v12, v16
    v_add_f32 v13, v13, v17
    v_fmac_f32 v14, v16, v16
    v_mfma_f32_32x32x16_bf16 v[100:115], a[184:187], v[44:47], v[100:115]
    s_waitcnt vmcnt(0)
    ds_read_b128 v[56:59], v5 offset:9216
    v_fmac_f32 v15, v17, v17
    v_lshlrev_b32 v164, 16, v31
    v_and_b32 v165, 0xffff0000, v31
    v_add_f32 v12, v12, v164
    v_add_f32 v13, v13, v165
    s_waitcnt lgkmcnt(2)
    v_mfma_f32_32x32x16_bf16 v[84:99], a[28:31], v[48:51], v[84:99]
    buffer_store_dword v19, off, s[4:7], s70 sc1
    s_mov_b32 s70, 262144000
    s_barrier
    v_fmac_f32 v14, v164, v164
    v_fmac_f32 v15, v165, v165
    v_lshlrev_b32 v16, 16, v32
    v_and_b32 v17, 0xffff0000, v32
    v_add_f32 v12, v12, v16
    v_mfma_f32_32x32x16_bf16 v[100:115], a[188:191], v[48:51], v[100:115]
    ds_read_b128 v[60:63], v6 offset:0
    v_add_f32 v13, v13, v17
    v_fmac_f32 v14, v16, v16
    v_fmac_f32 v15, v17, v17
    v_lshlrev_b32 v164, 16, v33
    v_and_b32 v165, 0xffff0000, v33
    s_waitcnt lgkmcnt(2)
    v_mfma_f32_32x32x16_bf16 v[84:99], a[32:35], v[52:55], v[84:99]
    ds_read_b128 v[64:67], v6 offset:1024
    v_add_f32 v12, v12, v164
    v_add_f32 v13, v13, v165
    v_fmac_f32 v14, v164, v164
    v_fmac_f32 v15, v165, v165
    v_lshlrev_b32 v16, 16, v34
    v_mfma_f32_32x32x16_bf16 v[100:115], a[192:195], v[52:55], v[100:115]
    ds_read_b128 v[68:71], v6 offset:2048
    v_and_b32 v17, 0xffff0000, v34
    v_add_f32 v12, v12, v16
    v_add_f32 v13, v13, v17
    v_fmac_f32 v14, v16, v16
    v_fmac_f32 v15, v17, v17
    s_waitcnt lgkmcnt(3)
    v_mfma_f32_32x32x16_bf16 v[84:99], a[36:39], v[56:59], v[84:99]
    ds_read_b128 v[72:75], v6 offset:3072
    v_lshlrev_b32 v164, 16, v35
    v_and_b32 v165, 0xffff0000, v35
    v_add_f32 v12, v12, v164
    v_add_f32 v13, v13, v165
    v_fmac_f32 v14, v164, v164
    v_mfma_f32_32x32x16_bf16 v[100:115], a[196:199], v[56:59], v[100:115]
    ds_read_b128 v[76:79], v6 offset:4096
    v_fmac_f32 v15, v165, v165
    v_lshlrev_b32 v16, 16, v36
    v_and_b32 v17, 0xffff0000, v36
    v_add_f32 v12, v12, v16
    v_add_f32 v13, v13, v17
    s_branch L_qq_join
L_role_ff1:
    s_waitcnt vmcnt(0)
    s_cmp_lg_u32 s53, 0
    s_cbranch_scc1 Ll1_20
    v_mov_b32 v2, 148
Lp_21:
    buffer_load_dword v3, v2, s[8:11], 0 offen sc1
    s_waitcnt vmcnt(0)
    v_cmp_gt_i32 vcc, 2, v3
    s_cbranch_vccz Lpd_22
    s_sleep 8
    s_mov_b32 s54, 130
    s_sub_u32 s52, s52, 1
    s_cbranch_scc1 L_abort
    s_branch Lp_21
Lpd_22:
    s_branch Llate_19
Ll1_20:
    v_mov_b32 v2, 128
Lp_23:
    buffer_load_dword v3, v2, s[8:11], 0 offen sc1
    s_waitcnt vmcnt(0)
    v_cmp_gt_i32 vcc, 1, v3
    s_cbranch_vccz Lpd_24
    s_sleep 8
    s_mov_b32 s54, 128
    s_sub_u32 s52, s52, 1
    s_cbranch_scc1 L_abort
    s_branch Lp_23
Lpd_24:
    v_mov_b32 v2, 53248
    s_cmp_eq_u32 s53, 0
    s_cselect_b32 s56, 0, 3
Lp_25:
    buffer_load_dword v3, v2, s[4:7], 0 offen sc1
    s_waitcnt vmcnt(0)
    v_cmp_gt_i32 vcc, s56, v3
    s_cbranch_vccz Lpd_26
    s_sleep 8
    s_mov_b32 s54, 129
    s_sub_u32 s52, s52, 1
    s_cbranch_scc1 L_abort
    s_branch Lp_25
Lpd_26:
Llate_19:
L_ff1_par:
    s_mov_b32 s12, s40
    s_mov_b32 s13, s41
    s_mov_b32 s14, 2211840
    s_mov_b32 s15, 0x20000
    s_mov_b32 s16, s40
    s_mov_b32 s17, s41
    s_mov_b32 s18, 2211840
    s_mov_b32 s19, 0x20000
    s_lshl_b32 s57, s51, 2
    s_add_u32 s57, s57, s3
    s_lshl_b32 s67, s57, 7
    s_add_u32 s68, s67, 64
    s_mul_i32 s63, s53, 7340032
    s_lshl_b32 s55, s57, 12
    s_add_u32 s63, s63, s55
    s_add_u32 s63, s63, 180355072
    s_lshl_b32 s65, s53, 5
    s_add_u32 s65, s65, s57
    s_add_u32 s65, s65, 160
    s_lshl_b32 s65, s65, 7
    s_add_u32 s55, s53, 2
    s_mul_i32 s62, s55, 2621440
    s_mul_i32 s55, s3, 10240
    s_add_u32 s62, s62, s55
    s_add_u32 s62, s62, 196083712
    v_lshrrev_b32 v252, 4, v1
    v_bfe_u32 v253, v1, 2, 2
    v_and_b32 v254, 3, v1
    s_mul_i32 s69, s3, 40960
    v_mov_b32 v20, 0x3f803f80
    v_mov_b32 v21, 0x3f803f80
    v_mov_b32 v22, 0x3f803f80
    v_mov_b32 v23, 0x3f803f80
    v_lshrrev_b32 v250, 1, v252
    v_lshl_add_u32 v250, v250, 3, v253
    v_lshlrev_b32 v250, 6, v250
    v_and_b32 v251, 1, v252
    v_lshl_add_u32 v250, v251, 5, v250
    v_lshl_add_u32 v250, v254, 3, v250
    v_add_u32 v190, s69, v250
    v_lshrrev_b32 v191, 2, v1
    v_mul_u32_u24 v191, 3456, v191
    v_and_b32 v251, 3, v1
    v_lshl_add_u32 v191, v251, 4, v191
    s_add_u32 s56, s3, 0
    s_and_b32 s56, s56, 3
    s_mul_i32 s56, s56, 552960
    s_add_u32 s56, s56, s67
    s_add_u32 m0, s69, 0
    s_nop 0
    buffer_load_dwordx4 v191, s[12:15], s56 offen lds
    s_add_u32 m0, m0, 1024
    s_add_u32 s56, s56, 55296
    buffer_load_dwordx4 v191, s[12:15], s56 offen lds
    s_add_u32 m0, m0, 1024
    s_add_u32 s56, s56, 55296
    buffer_load_dwordx4 v191, s[12:15], s56 offen lds
    s_add_u32 m0, m0, 1024
    s_add_u32 s56, s56, 55296
    buffer_load_dwordx4 v191, s[12:15], s56 offen lds
    s_add_u32 m0, m0, 1024
    s_add_u32 s56, s56, 55296
    buffer_load_dwordx4 v191, s[12:15], s56 offen lds
    s_add_u32 m0, m0, 1024
    s_add_u32 s56, s56, 55296
    buffer_load_dwordx4 v191, s[12:15], s56 offen lds
    s_add_u32 m0, m0, 1024
    s_add_u32 s56, s56, 55296
    buffer_load_dwordx4 v191, s[12:15], s56 offen lds
    s_add_u32 m0, m0, 1024
    s_add_u32 s56, s56, 55296
    buffer_load_dwordx4 v191, s[12:15], s56 offen lds
    s_add_u32 m0, m0, 1024
    s_add_u32 s56, s56, 55296
    buffer_load_dwordx4 v191, s[12:15], s56 offen lds
    s_add_u32 m0, m0, 1024
    s_add_u32 s56, s56, 55296
    buffer_load_dwordx4 v191, s[12:15], s56 offen lds
    s_add_u32 s56, s3, 1
    s_and_b32 s56, s56, 3
    s_mul_i32 s56, s56, 552960
    s_add_u32 s56, s56, s67
    s_add_u32 m0, s69, 10240
    s_nop 0
    buffer_load_dwordx4 v191, s[12:15], s56 offen lds
    s_add_u32 m0, m0, 1024
    s_add_u32 s56, s56, 55296
    buffer_load_dwordx4 v191, s[12:15], s56 offen lds
    s_add_u32 m0, m0, 1024
    s_add_u32 s56, s56, 55296
    buffer_load_dwordx4 v191, s[12:15], s56 offen lds
    s_add_u32 m0, m0, 1024
    s_add_u32 s56, s56, 55296
    buffer_load_dwordx4 v191, s[12:15], s56 offen lds
    s_add_u32 m0, m0, 1024
    s_add_u32 s56, s56, 55296
    buffer_load_dwordx4 v191, s[12:15], s56 offen lds
    s_add_u32 m0, m0, 1024
    s_add_u32 s56, s56, 55296
    buffer_load_dwordx4 v191, s[12:15], s56 offen lds
    s_add_u32 m0, m0, 1024
    s_add_u32 s56, s56, 55296
    buffer_load_dwordx4 v191, s[12:15], s56 offen lds
    s_add_u32 m0, m0, 1024
    s_add_u32 s56, s56, 55296
    buffer_load_dwordx4 v191, s[12:15], s56 offen lds
    s_add_u32 m0, m0, 1024
    s_add_u32 s56, s56, 55296
    buffer_load_dwordx4 v191, s[12:15], s56 offen lds
    s_add_u32 m0, m0, 1024
    s_add_u32 s56, s56, 55296
    buffer_load_dwordx4 v191, s[12:15], s56 offen lds
    s_add_u32 s56, s3, 2
    s_and_b32 s56, s56, 3
    s_mul_i32 s56, s56, 552960
    s_add_u32 s56, s56, s67
    s_add_u32 m0, s69, 20480
    s_nop 0
    buffer_load_dwordx4 v191, s[12:15], s56 offen lds
    s_add_u32 m0, m0, 1024
    s_add_u32 s56, s56, 55296
    buffer_load_dwordx4 v191, s[12:15], s56 offen lds
    s_add_u32 m0, m0, 1024
    s_add_u32 s56, s56, 55296
    buffer_load_dwordx4 v191, s[12:15], s56 offen lds
    s_add_u32 m0, m0, 1024
    s_add_u32 s56, s56, 55296
    buffer_load_dwordx4 v191, s[12:15], s56 offen lds
    s_add_u32 m0, m0, 1024
    s_add_u32 s56, s56, 55296
    buffer_load_dwordx4 v191, s[12:15], s56 offen lds
    s_add_u32 m0, m0, 1024
    s_add_u32 s56, s56, 55296
    buffer_load_dwordx4 v191, s[12:15], s56 offen lds
    s_add_u32 m0, m0, 1024
    s_add_u32 s56, s56, 55296
    buffer_load_dwordx4 v191, s[12:15], s56 offen lds
    s_add_u32 m0, m0, 1024
    s_add_u32 s56, s56, 55296
    buffer_load_dwordx4 v191, s[12:15], s56 offen lds
    s_add_u32 m0, m0, 1024
    s_add_u32 s56, s56, 55296
    buffer_load_dwordx4 v191, s[12:15], s56 offen lds
    s_add_u32 m0, m0, 1024
    s_add_u32 s56, s56, 55296
    buffer_load_dwordx4 v191, s[12:15], s56 offen lds
    s_add_u32 s56, s3, 3
    s_and_b32 s56, s56, 3
    s_mul_i32 s56, s56, 552960
    s_add_u32 s56, s56, s67
    s_add_u32 m0, s69, 30720
    s_nop 0
    buffer_load_dwordx4 v191, s[12:15], s56 offen lds
    s_add_u32 m0, m0, 1024
    s_add_u32 s56, s56, 55296
    buffer_load_dwordx4 v191, s[12:15], s56 offen lds
    s_add_u32 m0, m0, 1024
    s_add_u32 s56, s56, 55296
    buffer_load_dwordx4 v191, s[12:15], s56 offen lds
    s_add_u32 m0, m0, 1024
    s_add_u32 s56, s56, 55296
    buffer_load_dwordx4 v191, s[12:15], s56 offen lds
    s_add_u32 m0, m0, 1024
    s_add_u32 s56, s56, 55296
    buffer_load_dwordx4 v191, s[12:15], s56 offen lds
    s_add_u32 m0, m0, 1024
    s_add_u32 s56, s56, 55296
    buffer_load_dwordx4 v191, s[12:15], s56 offen lds
    s_add_u32 m0, m0, 1024
    s_add_u32 s56, s56, 55296
    buffer_load_dwordx4 v191, s[12:15], s56 offen lds
    s_add_u32 m0, m0, 1024
    s_add_u32 s56, s56, 55296
    buffer_load_dwordx4 v191, s[12:15], s56 offen lds
    s_add_u32 m0, m0, 1024
    s_add_u32 s56, s56, 55296
    buffer_load_dwordx4 v191, s[12:15], s56 offen lds
    s_add_u32 m0, m0, 1024
    s_add_u32 s56, s56, 55296
    buffer_load_dwordx4 v191, s[12:15], s56 offen lds
    s_waitcnt vmcnt(30)
    ds_read_b64_tr_b16 a[0:1], v190 offset:0
    ds_read_b64_tr_b16 a[2:3], v190 offset:256
    ds_read_b64_tr_b16 a[4:5], v190 offset:1024
    ds_read_b64_tr_b16 a[6:7], v190 offset:1280
    ds_read_b64_tr_b16 a[8:9], v190 offset:2048
    ds_read_b64_tr_b16 a[10:11], v190 offset:2304
    ds_read_b64_tr_b16 a[12:13], v190 offset:3072
    ds_read_b64_tr_b16 a[14:15], v190 offset:3328
    ds_read_b64_tr_b16 a[16:17], v190 offset:4096
    ds_read_b64_tr_b16 a[18:19], v190 offset:4352
    ds_read_b64_tr_b16 a[20:21], v190 offset:5120
    ds_read_b64_tr_b16 a[22:23], v190 offset:5376
    ds_read_b64_tr_b16 a[24:25], v190 offset:6144
    ds_read_b64_tr_b16 a[26:27], v190 offset:6400
    ds_read_b64_tr_b16 a[28:29], v190 offset:7168
    ds_read_b64_tr_b16 a[30:31], v190 offset:7424
    ds_read_b64_tr_b16 a[32:33], v190 offset:8192
    ds_read_b64_tr_b16 a[34:35], v190 offset:8448
    ds_read_b64_tr_b16 a[36:37], v190 offset:9216
    ds_read_b64_tr_b16 a[38:39], v190 offset:9472
    s_waitcnt lgkmcnt(0)
    s_add_u32 s56, s3, 0
    s_and_b32 s56, s56, 3
    s_mul_i32 s56, s56, 552960
    s_add_u32 s56, s56, s68
    s_add_u32 m0, s69, 0
    s_nop 0
    buffer_load_dwordx4 v191, s[16:19], s56 offen lds
    s_add_u32 m0, m0, 1024
    s_add_u32 s56, s56, 55296
    buffer_load_dwordx4 v191, s[16:19], s56 offen lds
    s_add_u32 m0, m0, 1024
    s_add_u32 s56, s56, 55296
    buffer_load_dwordx4 v191, s[16:19], s56 offen lds
    s_add_u32 m0, m0, 1024
    s_add_u32 s56, s56, 55296
    buffer_load_dwordx4 v191, s[16:19], s56 offen lds
    s_add_u32 m0, m0, 1024
    s_add_u32 s56, s56, 55296
    buffer_load_dwordx4 v191, s[16:19], s56 offen lds
    s_add_u32 m0, m0, 1024
    s_add_u32 s56, s56, 55296
    buffer_load_dwordx4 v191, s[16:19], s56 offen lds
    s_add_u32 m0, m0, 1024
    s_add_u32 s56, s56, 55296
    buffer_load_dwordx4 v191, s[16:19], s56 offen lds
    s_add_u32 m0, m0, 1024
    s_add_u32 s56, s56, 55296
    buffer_load_dwordx4 v191, s[16:19], s56 offen lds
    s_add_u32 m0, m0, 1024
    s_add_u32 s56, s56, 55296
    buffer_load_dwordx4 v191, s[16:19], s56 offen lds
    s_add_u32 m0, m0, 1024
    s_add_u32 s56, s56, 55296
    buffer_load_dwordx4 v191, s[16:19], s56 offen lds
    s_waitcnt vmcnt(30)
    ds_read_b64_tr_b16 a[40:41], v190 offset:10240
    ds_read_b64_tr_b16 a[42:43], v190 offset:10496
    ds_read_b64_tr_b16 a[44:45], v190 offset:11264
    ds_read_b64_tr_b16 a[46:47], v190 offset:11520
    ds_read_b64_tr_b16 a[48:49], v190 offset:12288
    ds_read_b64_tr_b16 a[50:51], v190 offset:12544
    ds_read_b64_tr_b16 a[52:53], v190 offset:13312
    ds_read_b64_tr_b16 a[54:55], v190 offset:13568
    ds_read_b64_tr_b16 a[56:57], v190 offset:14336
    ds_read_b64_tr_b16 a[58:59], v190 offset:14592
    ds_read_b64_tr_b16 a[60:61], v190 offset:15360
    ds_read_b64_tr_b16 a[62:63], v190 offset:15616
    ds_read_b64_tr_b16 a[64:65], v190 offset:16384
    ds_read_b64_tr_b16 a[66:67], v190 offset:16640
    ds_read_b64_tr_b16 a[68:69], v190 offset:17408
    ds_read_b64_tr_b16 a[70:71], v190 offset:17664
    ds_read_b64_tr_b16 a[72:73], v190 offset:18432
    ds_read_b64_tr_b16 a[74:75], v190 offset:18688
    ds_read_b64_tr_b16 a[76:77], v190 offset:19456
    ds_read_b64_tr_b16 a[78:79], v190 offset:19712
    s_waitcnt lgkmcnt(0)
    s_add_u32 s56, s3, 1
    s_and_b32 s56, s56, 3
    s_mul_i32 s56, s56, 552960
    s_add_u32 s56, s56, s68
    s_add_u32 m0, s69, 10240
    s_nop 0
    buffer_load_dwordx4 v191, s[16:19], s56 offen lds
    s_add_u32 m0, m0, 1024
    s_add_u32 s56, s56, 55296
    buffer_load_dwordx4 v191, s[16:19], s56 offen lds
    s_add_u32 m0, m0, 1024
    s_add_u32 s56, s56, 55296
    buffer_load_dwordx4 v191, s[16:19], s56 offen lds
    s_add_u32 m0, m0, 1024
    s_add_u32 s56, s56, 55296
    buffer_load_dwordx4 v191, s[16:19], s56 offen lds
    s_add_u32 m0, m0, 1024
    s_add_u32 s56, s56, 55296
    buffer_load_dwordx4 v191, s[16:19], s56 offen lds
    s_add_u32 m0, m0, 1024
    s_add_u32 s56, s56, 55296
    buffer_load_dwordx4 v191, s[16:19], s56 offen lds
    s_add_u32 m0, m0, 1024
    s_add_u32 s56, s56, 55296
    buffer_load_dwordx4 v191, s[16:19], s56 offen lds
    s_add_u32 m0, m0, 1024
    s_add_u32 s56, s56, 55296
    buffer_load_dwordx4 v191, s[16:19], s56 offen lds
    s_add_u32 m0, m0, 1024
    s_add_u32 s56, s56, 55296
    buffer_load_dwordx4 v191, s[16:19], s56 offen lds
    s_add_u32 m0, m0, 1024
    s_add_u32 s56, s56, 55296
    buffer_load_dwordx4 v191, s[16:19], s56 offen lds
    s_waitcnt vmcnt(30)
    ds_read_b64_tr_b16 a[80:81], v190 offset:20480
    ds_read_b64_tr_b16 a[82:83], v190 offset:20736
    ds_read_b64_tr_b16 a[84:85], v190 offset:21504
    ds_read_b64_tr_b16 a[86:87], v190 offset:21760
    ds_read_b64_tr_b16 a[88:89], v190 offset:22528
    ds_read_b64_tr_b16 a[90:91], v190 offset:22784
    ds_read_b64_tr_b16 a[92:93], v190 offset:23552
    ds_read_b64_tr_b16 a[94:95], v190 offset:23808
    ds_read_b64_tr_b16 a[96:97], v190 offset:24576
    ds_read_b64_tr_b16 a[98:99], v190 offset:24832
    ds_read_b64_tr_b16 a[100:101], v190 offset:25600
    ds_read_b64_tr_b16 a[102:103], v190 offset:25856
    ds_read_b64_tr_b16 a[104:105], v190 offset:26624
    ds_read_b64_tr_b16 a[106:107], v190 offset:26880
    ds_read_b64_tr_b16 a[108:109], v190 offset:27648
    ds_read_b64_tr_b16 a[110:111], v190 offset:27904
    ds_read_b64_tr_b16 a[112:113], v190 offset:28672
    ds_read_b64_tr_b16 a[114:115], v190 offset:28928
    ds_read_b64_tr_b16 a[116:117], v190 offset:29696
    ds_read_b64_tr_b16 a[118:119], v190 offset:29952
    s_waitcnt lgkmcnt(0)
    s_add_u32 s56, s3, 2
    s_and_b32 s56, s56, 3
    s_mul_i32 s56, s56, 552960
    s_add_u32 s56, s56, s68
    s_add_u32 m0, s69, 20480
    s_nop 0
    buffer_load_dwordx4 v191, s[16:19], s56 offen lds
    s_add_u32 m0, m0, 1024
    s_add_u32 s56, s56, 55296
    buffer_load_dwordx4 v191, s[16:19], s56 offen lds
    s_add_u32 m0, m0, 1024
    s_add_u32 s56, s56, 55296
    buffer_load_dwordx4 v191, s[16:19], s56 offen lds
    s_add_u32 m0, m0, 1024
    s_add_u32 s56, s56, 55296
    buffer_load_dwordx4 v191, s[16:19], s56 offen lds
    s_add_u32 m0, m0, 1024
    s_add_u32 s56, s56, 55296
    buffer_load_dwordx4 v191, s[16:19], s56 offen lds
    s_add_u32 m0, m0, 1024
    s_add_u32 s56, s56, 55296
    buffer_load_dwordx4 v191, s[16:19], s56 offen lds
    s_add_u32 m0, m0, 1024
    s_add_u32 s56, s56, 55296
    buffer_load_dwordx4 v191, s[16:19], s56 offen lds
    s_add_u32 m0, m0, 1024
    s_add_u32 s56, s56, 55296
    buffer_load_dwordx4 v191, s[16:19], s56 offen lds
    s_add_u32 m0, m0, 1024
    s_add_u32 s56, s56, 55296
    buffer_load_dwordx4 v191, s[16:19], s56 offen lds
    s_add_u32 m0, m0, 1024
    s_add_u32 s56, s56, 55296
    buffer_load_dwordx4 v191, s[16:19], s56 offen lds
    s_waitcnt vmcnt(30)
    ds_read_b64_tr_b16 a[120:121], v190 offset:30720
    ds_read_b64_tr_b16 a[122:123], v190 offset:30976
    ds_read_b64_tr_b16 a[124:125], v190 offset:31744
    ds_read_b64_tr_b16 a[126:127], v190 offset:32000
    ds_read_b64_tr_b16 a[128:129], v190 offset:32768
    ds_read_b64_tr_b16 a[130:131], v190 offset:33024
    ds_read_b64_tr_b16 a[132:133], v190 offset:33792
    ds_read_b64_tr_b16 a[134:135], v190 offset:34048
    ds_read_b64_tr_b16 a[136:137], v190 offset:34816
    ds_read_b64_tr_b16 a[138:139], v190 offset:35072
    ds_read_b64_tr_b16 a[140:141], v190 offset:35840
    ds_read_b64_tr_b16 a[142:143], v190 offset:36096
    ds_read_b64_tr_b16 a[144:145], v190 offset:36864
    ds_read_b64_tr_b16 a[146:147], v190 offset:37120
    ds_read_b64_tr_b16 a[148:149], v190 offset:37888
    ds_read_b64_tr_b16 a[150:151], v190 offset:38144
    ds_read_b64_tr_b16 a[152:153], v190 offset:38912
    ds_read_b64_tr_b16 a[154:155], v190 offset:39168
    ds_read_b64_tr_b16 a[156:157], v190 offset:39936
    ds_read_b64_tr_b16 a[158:159], v190 offset:40192
    s_waitcnt lgkmcnt(0)
    s_add_u32 s56, s3, 3
    s_and_b32 s56, s56, 3
    s_mul_i32 s56, s56, 552960
    s_add_u32 s56, s56, s68
    s_add_u32 m0, s69, 30720
    s_nop 0
    buffer_load_dwordx4 v191, s[16:19], s56 offen lds
    s_add_u32 m0, m0, 1024
    s_add_u32 s56, s56, 55296
    buffer_load_dwordx4 v191, s[16:19], s56 offen lds
    s_add_u32 m0, m0, 1024
    s_add_u32 s56, s56, 55296
    buffer_load_dwordx4 v191, s[16:19], s56 offen lds
    s_add_u32 m0, m0, 1024
    s_add_u32 s56, s56, 55296
    buffer_load_dwordx4 v191, s[16:19], s56 offen lds
    s_add_u32 m0, m0, 1024
    s_add_u32 s56, s56, 55296
    buffer_load_dwordx4 v191, s[16:19], s56 offen lds
    s_add_u32 m0, m0, 1024
    s_add_u32 s56, s56, 55296
    buffer_load_dwordx4 v191, s[16:19], s56 offen lds
    s_add_u32 m0, m0, 1024
    s_add_u32 s56, s56, 55296
    buffer_load_dwordx4 v191, s[16:19], s56 offen lds
    s_add_u32 m0, m0, 1024
    s_add_u32 s56, s56, 55296
    buffer_load_dwordx4 v191, s[16:19], s56 offen lds
    s_add_u32 m0, m0, 1024
    s_add_u32 s56, s56, 55296
    buffer_load_dwordx4 v191, s[16:19], s56 offen lds
    s_add_u32 m0, m0, 1024
    s_add_u32 s56, s56, 55296
    buffer_load_dwordx4 v191, s[16:19], s56 offen lds
    s_waitcnt vmcnt(30)
    ds_read_b64_tr_b16 a[160:161], v190 offset:0
    ds_read_b64_tr_b16 a[162:163], v190 offset:256
    ds_read_b64_tr_b16 a[164:165], v190 offset:1024
    ds_read_b64_tr_b16 a[166:167], v190 offset:1280
    ds_read_b64_tr_b16 a[168:169], v190 offset:2048
    ds_read_b64_tr_b16 a[170:171], v190 offset:2304
    ds_read_b64_tr_b16 a[172:173], v190 offset:3072
    ds_read_b64_tr_b16 a[174:175], v190 offset:3328
    ds_read_b64_tr_b16 a[176:177], v190 offset:4096
    ds_read_b64_tr_b16 a[178:179], v190 offset:4352
    ds_read_b64_tr_b16 a[180:181], v190 offset:5120
    ds_read_b64_tr_b16 a[182:183], v190 offset:5376
    ds_read_b64_tr_b16 a[184:185], v190 offset:6144
    ds_read_b64_tr_b16 a[186:187], v190 offset:6400
    ds_read_b64_tr_b16 a[188:189], v190 offset:7168
    ds_read_b64_tr_b16 a[190:191], v190 offset:7424
    ds_read_b64_tr_b16 a[192:193], v190 offset:8192
    ds_read_b64_tr_b16 a[194:195], v190 offset:8448
    ds_read_b64_tr_b16 a[196:197], v190 offset:9216
    ds_read_b64_tr_b16 a[198:199], v190 offset:9472
    s_waitcnt lgkmcnt(0)
    s_waitcnt vmcnt(20)
    ds_read_b64_tr_b16 a[200:201], v190 offset:10240
    ds_read_b64_tr_b16 a[202:203], v190 offset:10496
    ds_read_b64_tr_b16 a[204:205], v190 offset:11264
    ds_read_b64_tr_b16 a[206:207], v190 offset:11520
    ds_read_b64_tr_b16 a[208:209], v190 offset:12288
    ds_read_b64_tr_b16 a[210:211], v190 offset:12544
    ds_read_b64_tr_b16 a[212:213], v190 offset:13312
    ds_read_b64_tr_b16 a[214:215], v190 offset:13568
    ds_read_b64_tr_b16 a[216:217], v190 offset:14336
    ds_read_b64_tr_b16 a[218:219], v190 offset:14592
    ds_read_b64_tr_b16 a[220:221], v190 offset:15360
    ds_read_b64_tr_b16 a[222:223], v190 offset:15616
    ds_read_b64_tr_b16 a[224:225], v190 offset:16384
    ds_read_b64_tr_b16 a[226:227], v190 offset:16640
    ds_read_b64_tr_b16 a[228:229], v190 offset:17408
    ds_read_b64_tr_b16 a[230:231], v190 offset:17664
    ds_read_b64_tr_b16 a[232:233], v190 offset:18432
    ds_read_b64_tr_b16 a[234:235], v190 offset:18688
    ds_read_b64_tr_b16 a[236:237], v190 offset:19456
    ds_read_b64_tr_b16 a[238:239], v190 offset:19712
    s_waitcnt lgkmcnt(0)
    s_waitcnt vmcnt(10)
    ds_read_b64_tr_b16 a[240:241], v190 offset:20480
    ds_read_b64_tr_b16 a[242:243], v190 offset:20736
    ds_read_b64_tr_b16 a[244:245], v190 offset:21504
    ds_read_b64_tr_b16 a[246:247], v190 offset:21760
    ds_read_b64_tr_b16 a[248:249], v190 offset:22528
    ds_read_b64_tr_b16 a[250:251], v190 offset:22784
    ds_read_b64_tr_b16 a[252:253], v190 offset:23552
    ds_read_b64_tr_b16 a[254:255], v190 offset:23808
    ds_read_b64_tr_b16 v[192:193], v190 offset:24576
    ds_read_b64_tr_b16 v[194:195], v190 offset:24832
    ds_read_b64_tr_b16 v[196:197], v190 offset:25600
    ds_read_b64_tr_b16 v[198:199], v190 offset:25856
    ds_read_b64_tr_b16 v[200:201], v190 offset:26624
    ds_read_b64_tr_b16 v[202:203], v190 offset:26880
    ds_read_b64_tr_b16 v[204:205], v190 offset:27648
    ds_read_b64_tr_b16 v[206:207], v190 offset:27904
    ds_read_b64_tr_b16 v[208:209], v190 offset:28672
    ds_read_b64_tr_b16 v[210:211], v190 offset:28928
    ds_read_b64_tr_b16 v[212:213], v190 offset:29696
    ds_read_b64_tr_b16 v[214:215], v190 offset:29952
    s_waitcnt lgkmcnt(0)
    s_waitcnt vmcnt(0)
    ds_read_b64_tr_b16 v[216:217], v190 offset:30720
    ds_read_b64_tr_b16 v[218:219], v190 offset:30976
    ds_read_b64_tr_b16 v[220:221], v190 offset:31744
    ds_read_b64_tr_b16 v[222:223], v190 offset:32000
    ds_read_b64_tr_b16 v[224:225], v190 offset:32768
    ds_read_b64_tr_b16 v[226:227], v190 offset:33024
    ds_read_b64_tr_b16 v[228:229], v190 offset:33792
    ds_read_b64_tr_b16 v[230:231], v190 offset:34048
    ds_read_b64_tr_b16 v[232:233], v190 offset:34816
    ds_read_b64_tr_b16 v[234:235], v190 offset:35072
    ds_read_b64_tr_b16 v[236:237], v190 offset:35840
    ds_read_b64_tr_b16 v[238:239], v190 offset:36096
    ds_read_b64_tr_b16 v[240:241], v190 offset:36864
    ds_read_b64_tr_b16 v[242:243], v190 offset:37120
    ds_read_b64_tr_b16 v[244:245], v190 offset:37888
    ds_read_b64_tr_b16 v[246:247], v190 offset:38144
    ds_read_b64_tr_b16 v[248:249], v190 offset:38912
    ds_read_b64_tr_b16 v[250:251], v190 offset:39168
    ds_read_b64_tr_b16 v[252:253], v190 offset:39936
    ds_read_b64_tr_b16 v[254:255], v190 offset:40192
    s_waitcnt lgkmcnt(0)
    v_mfma_f32_32x32x16_bf16 v[116:131], a[0:3], v[20:23], 0
    v_mfma_f32_32x32x16_bf16 v[116:131], a[4:7], v[20:23], v[116:131]
    v_mfma_f32_32x32x16_bf16 v[116:131], a[8:11], v[20:23], v[116:131]
    v_mfma_f32_32x32x16_bf16 v[116:131], a[12:15], v[20:23], v[116:131]
    v_mfma_f32_32x32x16_bf16 v[116:131], a[16:19], v[20:23], v[116:131]
    v_mfma_f32_32x32x16_bf16 v[116:131], a[20:23], v[20:23], v[116:131]
    v_mfma_f32_32x32x16_bf16 v[116:131], a[24:27], v[20:23], v[116:131]
    v_mfma_f32_32x32x16_bf16 v[116:131], a[28:31], v[20:23], v[116:131]
    v_mfma_f32_32x32x16_bf16 v[116:131], a[32:35], v[20:23], v[116:131]
    v_mfma_f32_32x32x16_bf16 v[116:131], a[36:39], v[20:23], v[116:131]
    v_mfma_f32_32x32x16_bf16 v[116:131], a[40:43], v[20:23], v[116:131]
    v_mfma_f32_32x32x16_bf16 v[116:131], a[44:47], v[20:23], v[116:131]
    v_mfma_f32_32x32x16_bf16 v[116:131], a[48:51], v[20:23], v[116:131]
    v_mfma_f32_32x32x16_bf16 v[116:131], a[52:55], v[20:23], v[116:131]
    v_mfma_f32_32x32x16_bf16 v[116:131], a[56:59], v[20:23], v[116:131]
    v_mfma_f32_32x32x16_bf16 v[116:131], a[60:63], v[20:23], v[116:131]
    v_mfma_f32_32x32x16_bf16 v[116:131], a[64:67], v[20:23], v[116:131]
    v_mfma_f32_32x32x16_bf16 v[116:131], a[68:71], v[20:23], v[116:131]
    v_mfma_f32_32x32x16_bf16 v[116:131], a[72:75], v[20:23], v[116:131]
    v_mfma_f32_32x32x16_bf16 v[116:131], a[76:79], v[20:23], v[116:131]
    v_mfma_f32_32x32x16_bf16 v[116:131], a[80:83], v[20:23], v[116:131]
    v_mfma_f32_32x32x16_bf16 v[116:131], a[84:87], v[20:23], v[116:131]
    v_mfma_f32_32x32x16_bf16 v[116:131], a[88:91], v[20:23], v[116:131]
    v_mfma_f32_32x32x16_bf16 v[116:131], a[92:95], v[20:23], v[116:131]
    v_mfma_f32_32x32x16_bf16 v[116:131], a[96:99], v[20:23], v[116:131]
    v_mfma_f32_32x32x16_bf16 v[116:131], a[100:103], v[20:23], v[116:131]
    v_mfma_f32_32x32x16_bf16 v[116:131], a[104:107], v[20:23], v[116:131]
    v_mfma_f32_32x32x16_bf16 v[116:131], a[108:111], v[20:23], v[116:131]
    v_mfma_f32_32x32x16_bf16 v[116:131], a[112:115], v[20:23], v[116:131]
    v_mfma_f32_32x32x16_bf16 v[116:131], a[116:119], v[20:23], v[116:131]
    v_mfma_f32_32x32x16_bf16 v[116:131], a[120:123], v[20:23], v[116:131]
    v_mfma_f32_32x32x16_bf16 v[116:131], a[124:127], v[20:23], v[116:131]
    v_mfma_f32_32x32x16_bf16 v[116:131], a[128:131], v[20:23], v[116:131]
    v_mfma_f32_32x32x16_bf16 v[116:131], a[132:135], v[20:23], v[116:131]
    v_mfma_f32_32x32x16_bf16 v[116:131], a[136:139], v[20:23], v[116:131]
    v_mfma_f32_32x32x16_bf16 v[116:131], a[140:143], v[20:23], v[116:131]
    v_mfma_f32_32x32x16_bf16 v[116:131], a[144:147], v[20:23], v[116:131]
    v_mfma_f32_32x32x16_bf16 v[116:131], a[148:151], v[20:23], v[116:131]
    v_mfma_f32_32x32x16_bf16 v[116:131], a[152:155], v[20:23], v[116:131]
    v_mfma_f32_32x32x16_bf16 v[116:131], a[156:159], v[20:23], v[116:131]
    v_mfma_f32_32x32x16_bf16 v[132:147], a[160:163], v[20:23], 0
    v_mfma_f32_32x32x16_bf16 v[132:147], a[164:167], v[20:23], v[132:147]
    v_mfma_f32_32x32x16_bf16 v[132:147], a[168:171], v[20:23], v[132:147]
    v_mfma_f32_32x32x16_bf16 v[132:147], a[172:175], v[20:23], v[132:147]
    v_mfma_f32_32x32x16_bf16 v[132:147], a[176:179], v[20:23], v[132:147]
    v_mfma_f32_32x32x16_bf16 v[132:147], a[180:183], v[20:23], v[132:147]
    v_mfma_f32_32x32x16_bf16 v[132:147], a[184:187], v[20:23], v[132:147]
    v_mfma_f32_32x32x16_bf16 v[132:147], a[188:191], v[20:23], v[132:147]
    v_mfma_f32_32x32x16_bf16 v[132:147], a[192:195], v[20:23], v[132:147]
    v_mfma_f32_32x32x16_bf16 v[132:147], a[196:199], v[20:23], v[132:147]
    v_mfma_f32_32x32x16_bf16 v[132:147], a[200:203], v[20:23], v[132:147]
    v_mfma_f32_32x32x16_bf16 v[132:147], a[204:207], v[20:23], v[132:147]
    v_mfma_f32_32x32x16_bf16 v[132:147], a[208:211], v[20:23], v[132:147]
    v_mfma_f32_32x32x16_bf16 v[132:147], a[212:215], v[20:23], v[132:147]
    v_mfma_f32_32x32x16_bf16 v[132:147], a[216:219], v[20:23], v[132:147]
    v_mfma_f32_32x32x16_bf16 v[132:147], a[220:223], v[20:23], v[132:147]
    v_mfma_f32_32x32x16_bf16 v[132:147], a[224:227], v[20:23], v[132:147]
    v_mfma_f32_32x32x16_bf16 v[132:147], a[228:231], v[20:23], v[132:147]
    v_mfma_f32_32x32x16_bf16 v[132:147], a[232:235], v[20:23], v[132:147]
    v_mfma_f32_32x32x16_bf16 v[132:147], a[236:239], v[20:23], v[132:147]
    v_mfma_f32_32x32x16_bf16 v[132:147], a[240:243], v[20:23], v[132:147]
    v_mfma_f32_32x32x16_bf16 v[132:147], a[244:247], v[20:23], v[132:147]
    v_mfma_f32_32x32x16_bf16 v[132:147], a[248:251], v[20:23], v[132:147]
    v_mfma_f32_32x32x16_bf16 v[132:147], a[252:255], v[20:23], v[132:147]
    v_mfma_f32_32x32x16_bf16 v[132:147], v[192:195], v[20:23], v[132:147]
    v_mfma_f32_32x32x16_bf16 v[132:147], v[196:199], v[20:23], v[132:147]
    v_mfma_f32_32x32x16_bf16 v[132:147], v[200:203], v[20:23], v[132:147]
    v_mfma_f32_32x32x16_bf16 v[132:147], v[204:207], v[20:23], v[132:147]
    v_mfma_f32_32x32x16_bf16 v[132:147], v[208:211], v[20:23], v[132:147]
    v_mfma_f32_32x32x16_bf16 v[132:147], v[212:215], v[20:23], v[132:147]
    v_mfma_f32_32x32x16_bf16 v[132:147], v[216:219], v[20:23], v[132:147]
    v_mfma_f32_32x32x16_bf16 v[132:147], v[220:223], v[20:23], v[132:147]
    v_mfma_f32_32x32x16_bf16 v[132:147], v[224:227], v[20:23], v[132:147]
    v_mfma_f32_32x32x16_bf16 v[132:147], v[228:231], v[20:23], v[132:147]
    v_mfma_f32_32x32x16_bf16 v[132:147], v[232:235], v[20:23], v[132:147]
    v_mfma_f32_32x32x16_bf16 v[132:147], v[236:239], v[20:23], v[132:147]
    v_mfma_f32_32x32x16_bf16 v[132:147], v[240:243], v[20:23], v[132:147]
    v_mfma_f32_32x32x16_bf16 v[132:147], v[244:247], v[20:23], v[132:147]
    v_mfma_f32_32x32x16_bf16 v[132:147], v[248:251], v[20:23], v[132:147]
    v_mfma_f32_32x32x16_bf16 v[132:147], v[252:255], v[20:23], v[132:147]
L_ff1_con:
    v_lshlrev_b32 v2, 4, v1
    s_mul_i32 s55, s53, 40
    s_mul_i32 s56, s3, 10
    s_add_u32 s55, s55, s56
    s_add_u32 s55, s55, 80
    v_min_u32 v3, 9, v1
    v_add_u32 v3, s55, v3
    v_lshlrev_b32 v3, 7, v3
    v_mov_b32 v189, 0
    s_lshl_b32 s55, s51, 2
    s_add_u32 s55, s55, s3
    s_mul_i32 s55, s55, 37
    s_lshr_b32 s55, s55, 8
    s_mul_i32 s56, s53, 40
    s_add_u32 s55, s55, s56
    s_add_u32 s55, s55, 6432
    v_subrev_u32 v11, 10, v1
    v_min_u32 v11, 9, v11
    v_lshl_add_u32 v11, v11, 2, s55
    v_lshlrev_b32 v11, 7, v11
    v_cmp_gt_u32 vcc, 10, v1
    s_nop 1
    v_cndmask_b32 v3, v11, v3, vcc
    v_cndmask_b32 v189, 4, v189, vcc
    s_add_u32 s55, s3, 0
    s_and_b32 s55, s55, 3
    s_mul_i32 s55, s55, 10240
    v_add_u32 v5, s55, v2
    s_add_u32 s55, s3, 1
    s_and_b32 s55, s55, 3
    s_mul_i32 s55, s55, 10240
    v_add_u32 v6, s55, v2
    s_add_u32 s55, s3, 2
    s_and_b32 s55, s55, 3
    s_mul_i32 s55, s55, 10240
    v_add_u32 v7, s55, v2
    s_add_u32 s55, s3, 3
    s_and_b32 s55, s55, 3
    s_mul_i32 s55, s55, 10240
    v_add_u32 v8, s55, v2
    v_lshlrev_b32 v9, 3, v0
    v_add_u32 v9, 49152, v9
    v_and_b32 v10, 31, v1
    v_lshlrev_b32 v10, 3, v10
    v_add_u32 v10, 49152, v10
    v_mov_b32 v16, 128
Lp_27:
    buffer_load_dword v11, v16, s[8:11], 0 offen sc1
    s_waitcnt vmcnt(0)
    v_cmp_gt_i32 vcc, 1, v11
    s_cbranch_vccz Lpd_28
    s_sleep 8
    s_mov_b32 s54, 16
    s_sub_u32 s52, s52, 1
    s_cbranch_scc1 L_abort
    s_branch Lp_27
Lpd_28:
L_ff1_nw:
    s_mov_b32 s60, 0
    s_mov_b32 s61, 0
    s_mul_i32 s66, s3, 10240
    s_barrier
    s_mov_b32 s70, 262144000
    v_mov_b32 v4, -100
    v_mov_b32 v19, 0
    v_mbcnt_lo_u32_b32 v11, -1, 0
    v_and_b32 v11, 1, v11
    v_lshlrev_b32 v11, 2, v11
    s_lshl_b32 s55, s50, 3
    buffer_load_dword v11, v11, s[8:11], s55 offen sc1
    s_getreg_b32 s55, hwreg(HW_REG_XCC_ID)
    s_and_b32 s55, s55, 7
    s_lshl_b32 s55, s55, 3
    s_lshl_b64 s[56:57], 0xff, s55
    s_waitcnt vmcnt(0)
    v_readlane_b32 s96, v11, 0
    v_readlane_b32 s97, v11, 1
    s_andn2_b64 s[56:57], s[96:97], s[56:57]
    s_cselect_b32 s72, 1, 0
    v_min_u32 v187, 31, v1
    v_lshlrev_b32 v187, 7, v187
L_ff1_slow:
    s_add_u32 s57, s60, 1
    v_add_u32 v188, v189, v4
    v_cmp_gt_i32 vcc, s57, v188
    s_cbranch_vccz L_ff1_rdy
L_ff1_poll:
    buffer_load_dword v11, v3, s[4:7], 0 offen sc1
    s_waitcnt vmcnt(0)
    s_cmp_lg_u32 s72, 0
    s_cbranch_scc1 Lls_29
    buffer_store_dword v19, off, s[4:7], s70
Lld_30:
    s_mov_b32 s70, 262144000
    v_add_u32 v188, v189, v11
    v_cmp_gt_i32 vcc, s57, v188
    s_cbranch_vccz L_ff1_rdy
    s_sleep 1
    s_mov_b32 s54, 17
    s_sub_u32 s52, s52, 1
    s_cbranch_scc1 L_abort
    s_branch L_ff1_poll
L_ff1_rdy:
    s_branch L_ff1_alt
.p2align 6
L_ff1_loop:
    s_waitcnt vmcnt(4)
    s_cmp_eq_u32 s71, 262144000
    s_cbranch_scc1 L_ff1_slow
L_ff1_go:
    ds_read_b128 v[20:23], v5 offset:0
    ds_read_b128 v[24:27], v5 offset:1024
    ds_read_b128 v[28:31], v5 offset:2048
    ds_read_b128 v[32:35], v5 offset:3072
    ds_read_b128 v[36:39], v5 offset:4096
    ds_read_b128 v[40:43], v5 offset:5120
    ds_read_b128 v[44:47], v5 offset:6144
    ds_read_b128 v[48:51], v5 offset:7168
    ds_read_b128 v[52:55], v5 offset:8192
    ds_read_b128 v[56:59], v5 offset:9216
    s_add_u32 s55, s60, 1
    s_and_b32 s55, s55, 7
    s_cselect_b32 s55, 0, 327680
    s_sub_u32 s62, s62, s55
    s_add_u32 s62, s62, 40960
    s_xor_b32 s66, s66, 0x10000
    s_add_u32 s57, s60, 2
    s_waitcnt lgkmcnt(9)
    v_mfma_f32_32x32x16_bf16 v[84:99], a[0:3], v[20:23], 0
    v_lshlrev_b32 v16, 16, v20
    v_and_b32 v17, 0xffff0000, v20
    v_mov_b32 v12, v16
    v_mov_b32 v13, v17
    v_mul_f32 v14, v16, v16
    v_mfma_f32_32x32x16_bf16 v[100:115], a[160:163], v[20:23], 0
    v_mul_f32 v15, v17, v17
    v_lshlrev_b32 v164, 16, v21
    v_and_b32 v165, 0xffff0000, v21
    v_add_f32 v12, v12, v164
    v_add_f32 v13, v13, v165
    s_waitcnt lgkmcnt(8)
    v_mfma_f32_32x32x16_bf16 v[84:99], a[4:7], v[24:27], v[84:99]
    v_fmac_f32 v14, v164, v164
    v_fmac_f32 v15, v165, v165
    v_lshlrev_b32 v16, 16, v22
    v_and_b32 v17, 0xffff0000, v22
    v_add_f32 v12, v12, v16
    v_mfma_f32_32x32x16_bf16 v[100:115], a[164:167], v[24:27], v[100:115]
    v_add_f32 v13, v13, v17
    v_fmac_f32 v14, v16, v16
    v_fmac_f32 v15, v17, v17
    v_lshlrev_b32 v164, 16, v23
    v_and_b32 v165, 0xffff0000, v23
    s_waitcnt lgkmcnt(7)
    v_mfma_f32_32x32x16_bf16 v[84:99], a[8:11], v[28:31], v[84:99]
    v_add_f32 v12, v12, v164
    v_add_f32 v13, v13, v165
    v_fmac_f32 v14, v164, v164
    v_fmac_f32 v15, v165, v165
    v_lshlrev_b32 v16, 16, v24
    v_mfma_f32_32x32x16_bf16 v[100:115], a[168:171], v[28:31], v[100:115]
    v_and_b32 v17, 0xffff0000, v24
    v_add_f32 v12, v12, v16
    v_add_f32 v13, v13, v17
    v_fmac_f32 v14, v16, v16
    v_fmac_f32 v15, v17, v17
    s_waitcnt lgkmcnt(6)
    v_mfma_f32_32x32x16_bf16 v[84:99], a[12:15], v[32:35], v[84:99]
    v_lshlrev_b32 v164, 16, v25
    v_and_b32 v165, 0xffff0000, v25
    v_add_f32 v12, v12, v164
    v_add_f32 v13, v13, v165
    v_fmac_f32 v14, v164, v164
    v_mfma_f32_32x32x16_bf16 v[100:115], a[172:175], v[32:35], v[100:115]
    v_fmac_f32 v15, v165, v165
    v_lshlrev_b32 v16, 16, v26
    v_and_b32 v17, 0xffff0000, v26
    v_add_f32 v12, v12, v16
    v_add_f32 v13, v13, v17
    s_waitcnt lgkmcnt(5)
    v_mfma_f32_32x32x16_bf16 v[84:99], a[16:19], v[36:39], v[84:99]
    v_fmac_f32 v14, v16, v16
    v_fmac_f32 v15, v17, v17
    v_lshlrev_b32 v164, 16, v27
    v_and_b32 v165, 0xffff0000, v27
    v_add_f32 v12, v12, v164
    v_mfma_f32_32x32x16_bf16 v[100:115], a[176:179], v[36:39], v[100:115]
    v_add_f32 v13, v13, v165
    v_fmac_f32 v14, v164, v164
    v_fmac_f32 v15, v165, v165
    v_lshlrev_b32 v16, 16, v28
    v_and_b32 v17, 0xffff0000, v28
    s_waitcnt lgkmcnt(4)
    v_mfma_f32_32x32x16_bf16 v[84:99], a[20:23], v[40:43], v[84:99]
    s_barrier
    ds_read_b128 v[60:63], v6 offset:0
    v_add_f32 v12, v12, v16
    v_add_f32 v13, v13, v17
    v_fmac_f32 v14, v16, v16
    v_fmac_f32 v15, v17, v17
    v_lshlrev_b32 v164, 16, v29
    v_mfma_f32_32x32x16_bf16 v[100:115], a[180:183], v[40:43], v[100:115]
    s_waitcnt vmcnt(0)
    s_cmp_lg_u32 s72, 0
    s_cbranch_scc1 Lls_31
    buffer_store_dword v19, off, s[4:7], s70
Lld_32:
    s_mov_b32 s70, 262144000
    v_and_b32 v165, 0xffff0000, v29
    v_add_f32 v12, v12, v164
    v_add_f32 v13, v13, v165
    s_waitcnt lgkmcnt(4)
    v_mfma_f32_32x32x16_bf16 v[84:99], a[24:27], v[44:47], v[84:99]
    ds_read_b128 v[64:67], v6 offset:1024
    v_fmac_f32 v14, v164, v164
    v_fmac_f32 v15, v165, v165
    v_lshlrev_b32 v16, 16, v30
    v_and_b32 v17, 0xffff0000, v30
    v_add_f32 v12, v12, v16
    v_mfma_f32_32x32x16_bf16 v[100:115], a[184:187], v[44:47], v[100:115]
    v_add_f32 v13, v13, v17
    v_fmac_f32 v14, v16, v16
    v_fmac_f32 v15, v17, v17
    v_lshlrev_b32 v164, 16, v31
    v_and_b32 v165, 0xffff0000, v31
    s_waitcnt lgkmcnt(4)
    v_mfma_f32_32x32x16_bf16 v[84:99], a[28:31], v[48:51], v[84:99]
    ds_read_b128 v[68:71], v6 offset:2048
    v_add_f32 v12, v12, v164
    v_add_f32 v13, v13, v165
    v_fmac_f32 v14, v164, v164
    v_fmac_f32 v15, v165, v165
    v_lshlrev_b32 v16, 16, v32
    v_mfma_f32_32x32x16_bf16 v[100:115], a[188:191], v[48:51], v[100:115]
    v_and_b32 v17, 0xffff0000, v32
    v_add_f32 v12, v12, v16
    v_add_f32 v13, v13, v17
    v_fmac_f32 v14, v16, v16
    v_fmac_f32 v15, v17, v17
    s_waitcnt lgkmcnt(4)
    v_mfma_f32_32x32x16_bf16 v[84:99], a[32:35], v[52:55], v[84:99]
    ds_read_b128 v[72:75], v6 offset:3072
    v_lshlrev_b32 v164, 16, v33
    v_and_b32 v165, 0xffff0000, v33
    v_add_f32 v12, v12, v164
    v_add_f32 v13, v13, v165
    v_fmac_f32 v14, v164, v164
    v_mfma_f32_32x32x16_bf16 v[100:115], a[192:195], v[52:55], v[100:115]
    v_fmac_f32 v15, v165, v165
    v_lshlrev_b32 v16, 16, v34
    v_and_b32 v17, 0xffff0000, v34
    v_add_f32 v12, v12, v16
    v_add_f32 v13, v13, v17
    s_waitcnt lgkmcnt(4)
    v_mfma_f32_32x32x16_bf16 v[84:99], a[36:39], v[56:59], v[84:99]
    ds_read_b128 v[76:79], v6 offset:4096
    v_fmac_f32 v14, v16, v16
    v_fmac_f32 v15, v17, v17
    v_lshlrev_b32 v164, 16, v35
    v_and_b32 v165, 0xffff0000, v35
    v_add_f32 v12, v12, v164
    v_mfma_f32_32x32x16_bf16 v[100:115], a[196:199], v[56:59], v[100:115]
    v_add_f32 v13, v13, v165
    v_fmac_f32 v14, v164, v164
    v_fmac_f32 v15, v165, v165
    v_lshlrev_b32 v16, 16, v36
    v_and_b32 v17, 0xffff0000, v36
L_ff1_join:
    s_waitcnt lgkmcnt(4)
    v_mfma_f32_32x32x16_bf16 v[84:99], a[40:43], v[60:63], v[84:99]
    ds_read_b128 v[80:83], v6 offset:5120
    v_add_f32 v12, v12, v16
    v_add_f32 v13, v13, v17
    v_fmac_f32 v14, v16, v16
    v_fmac_f32 v15, v17, v17
    v_lshlrev_b32 v164, 16, v37
    v_mfma_f32_32x32x16_bf16 v[100:115], a[200:203], v[60:63], v[100:115]
    v_and_b32 v165, 0xffff0000, v37
    v_add_f32 v12, v12, v164
    v_add_f32 v13, v13, v165
    v_fmac_f32 v14, v164, v164
    v_fmac_f32 v15, v165, v165
    s_waitcnt lgkmcnt(4)
    v_mfma_f32_32x32x16_bf16 v[84:99], a[44:47], v[64:67], v[84:99]
    ds_read_b128 v[60:63], v6 offset:6144
    v_lshlrev_b32 v16, 16, v38
    v_and_b32 v17, 0xffff0000, v38
    v_add_f32 v12, v12, v16
    v_add_f32 v13, v13, v17
    v_fmac_f32 v14, v16, v16
    v_mfma_f32_32x32x16_bf16 v[100:115], a[204:207], v[64:67], v[100:115]
    v_fmac_f32 v15, v17, v17
    v_lshlrev_b32 v164, 16, v39
    v_and_b32 v165, 0xffff0000, v39
    v_add_f32 v12, v12, v164
    v_add_f32 v13, v13, v165
    s_waitcnt lgkmcnt(4)
    v_mfma_f32_32x32x16_bf16 v[84:99], a[48:51], v[68:71], v[84:99]
    ds_read_b128 v[64:67], v6 offset:7168
    v_fmac_f32 v14, v164, v164
    v_fmac_f32 v15, v165, v165
    v_lshlrev_b32 v16, 16, v40
    v_and_b32 v17, 0xffff0000, v40
    v_add_f32 v12, v12, v16
    s_waitcnt lgkmcnt(4)
    v_mfma_f32_32x32x16_bf16 v[84:99], a[52:55], v[72:75], v[84:99]
    ds_read_b128 v[68:71], v6 offset:8192
    v_add_f32 v13, v13, v17
    v_fmac_f32 v14, v16, v16
    v_fmac_f32 v15, v17, v17
    v_lshlrev_b32 v164, 16, v41
    v_and_b32 v165, 0xffff0000, v41
    s_waitcnt lgkmcnt(4)
    v_mfma_f32_32x32x16_bf16 v[84:99], a[56:59], v[76:79], v[84:99]
    ds_read_b128 v[72:75], v6 offset:9216
    v_add_f32 v12, v12, v164
    v_add_f32 v13, v13, v165
    v_fmac_f32 v14, v164, v164
    v_fmac_f32 v15, v165, v165
    v_lshlrev_b32 v16, 16, v42
    s_waitcnt lgkmcnt(4)
    v_mfma_f32_32x32x16_bf16 v[84:99], a[60:63], v[80:83], v[84:99]
    ds_read_b128 v[76:79], v7 offset:0
    v_and_b32 v17, 0xffff0000, v42
    v_add_f32 v12, v12, v16
    v_add_f32 v13, v13, v17
    v_fmac_f32 v14, v16, v16
    v_fmac_f32 v15, v17, v17
    s_waitcnt lgkmcnt(4)
    v_mfma_f32_32x32x16_bf16 v[84:99], a[64:67], v[60:63], v[84:99]
    ds_read_b128 v[80:83], v7 offset:1024
    v_lshlrev_b32 v164, 16, v43
    v_and_b32 v165, 0xffff0000, v43
    v_add_f32 v12, v12, v164
    v_add_f32 v13, v13, v165
    v_fmac_f32 v14, v164, v164
    s_waitcnt lgkmcnt(4)
    v_mfma_f32_32x32x16_bf16 v[84:99], a[68:71], v[64:67], v[84:99]
    ds_read_b128 v[60:63], v7 offset:2048
    v_fmac_f32 v15, v165, v165
    v_lshlrev_b32 v16, 16, v44
    v_and_b32 v17, 0xffff0000, v44
    v_add_f32 v12, v12, v16
    v_add_f32 v13, v13, v17
    s_waitcnt lgkmcnt(4)
    v_mfma_f32_32x32x16_bf16 v[84:99], a[72:75], v[68:71], v[84:99]
    ds_read_b128 v[64:67], v7 offset:3072
    v_fmac_f32 v14, v16, v16
    v_fmac_f32 v15, v17, v17
    v_lshlrev_b32 v164, 16, v45
    v_and_b32 v165, 0xffff0000, v45
    v_add_f32 v12, v12, v164
    s_waitcnt lgkmcnt(4)
    v_mfma_f32_32x32x16_bf16 v[84:99], a[76:79], v[72:75], v[84:99]
    ds_read_b128 v[68:71], v7 offset:4096
    v_add_f32 v13, v13, v165
    v_fmac_f32 v14, v164, v164
    v_fmac_f32 v15, v165, v165
    v_lshlrev_b32 v16, 16, v46
    v_and_b32 v17, 0xffff0000, v46
    s_waitcnt lgkmcnt(4)
    v_mfma_f32_32x32x16_bf16 v[84:99], a[80:83], v[76:79], v[84:99]
    ds_read_b128 v[72:75], v7 offset:5120
    v_add_f32 v12, v12, v16
    v_add_f32 v13, v13, v17
    v_fmac_f32 v14, v16, v16
    v_fmac_f32 v15, v17, v17
    v_lshlrev_b32 v164, 16, v47
    s_waitcnt lgkmcnt(4)
    v_mfma_f32_32x32x16_bf16 v[84:99], a[84:87], v[80:83], v[84:99]
    ds_read_b128 v[76:79], v7 offset:6144
    v_and_b32 v165, 0xffff0000, v47
    v_add_f32 v12, v12, v164
    v_add_f32 v13, v13, v165
    v_fmac_f32 v14, v164, v164
    v_fmac_f32 v15, v165, v165
    s_waitcnt lgkmcnt(4)
    v_mfma_f32_32x32x16_bf16 v[84:99], a[88:91], v[60:63], v[84:99]
    ds_read_b128 v[80:83], v7 offset:7168
    v_lshlrev_b32 v16, 16, v48
    v_and_b32 v17, 0xffff0000, v48
    v_add_f32 v12, v12, v16
    v_add_f32 v13, v13, v17
    v_fmac_f32 v14, v16, v16
    s_waitcnt lgkmcnt(4)
    v_mfma_f32_32x32x16_bf16 v[84:99], a[92:95], v[64:67], v[84:99]
    ds_read_b128 v[60:63], v7 offset:8192
    buffer_load_dword v11, v3, s[4:7], 0 offen sc1
    v_fmac_f32 v15, v17, v17
    v_lshlrev_b32 v164, 16, v49
    v_and_b32 v165, 0xffff0000, v49
    s_waitcnt lgkmcnt(4)
    v_mfma_f32_32x32x16_bf16 v[84:99], a[96:99], v[68:71], v[84:99]
    ds_read_b128 v[64:67], v7 offset:9216
    v_add_f32 v12, v12, v164
    v_add_f32 v13, v13, v165
    v_fmac_f32 v14, v164, v164
    v_fmac_f32 v15, v165, v165
    v_lshlrev_b32 v16, 16, v50
    s_waitcnt lgkmcnt(4)
    v_mfma_f32_32x32x16_bf16 v[84:99], a[100:103], v[72:75], v[84:99]
    ds_read_b128 v[68:71], v8 offset:0
    v_and_b32 v17, 0xffff0000, v50
    v_add_f32 v12, v12, v16
    v_add_f32 v13, v13, v17
    v_fmac_f32 v14, v16, v16
    v_fmac_f32 v15, v17, v17
    s_waitcnt lgkmcnt(4)
    v_mfma_f32_32x32x16_bf16 v[84:99], a[104:107], v[76:79], v[84:99]
    ds_read_b128 v[72:75], v8 offset:1024
    v_lshlrev_b32 v164, 16, v51
    v_and_b32 v165, 0xffff0000, v51
    v_add_f32 v12, v12, v164
    v_add_f32 v13, v13, v165
    v_fmac_f32 v14, v164, v164
    s_waitcnt lgkmcnt(4)
    v_mfma_f32_32x32x16_bf16 v[84:99], a[108:111], v[80:83], v[84:99]
    ds_read_b128 v[76:79], v8 offset:2048
    v_fmac_f32 v15, v165, v165
    v_lshlrev_b32 v16, 16, v52
    v_and_b32 v17, 0xffff0000, v52
    v_add_f32 v12, v12, v16
    v_add_f32 v13, v13, v17
    s_waitcnt lgkmcnt(4)
    v_mfma_f32_32x32x16_bf16 v[84:99], a[112:115], v[60:63], v[84:99]
    ds_read_b128 v[80:83], v8 offset:3072
    v_fmac_f32 v14, v16, v16
    v_fmac_f32 v15, v17, v17
    v_lshlrev_b32 v164, 16, v53
    v_and_b32 v165, 0xffff0000, v53
    v_add_f32 v12, v12, v164
    s_waitcnt lgkmcnt(4)
    v_mfma_f32_32x32x16_bf16 v[84:99], a[116:119], v[64:67], v[84:99]
    ds_read_b128 v[60:63], v8 offset:4096
    v_add_f32 v13, v13, v165
    v_fmac_f32 v14, v164, v164
    v_fmac_f32 v15, v165, v165
    v_lshlrev_b32 v16, 16, v54
    v_and_b32 v17, 0xffff0000, v54
    s_waitcnt lgkmcnt(4)
    v_mfma_f32_32x32x16_bf16 v[84:99], a[120:123], v[68:71], v[84:99]
    ds_read_b128 v[64:67], v8 offset:5120
    v_add_f32 v12, v12, v16
    v_add_f32 v13, v13, v17
    v_fmac_f32 v14, v16, v16
    v_fmac_f32 v15, v17, v17
    v_lshlrev_b32 v164, 16, v55
    s_waitcnt lgkmcnt(4)
    v_mfma_f32_32x32x16_bf16 v[84:99], a[124:127], v[72:75], v[84:99]
    ds_read_b128 v[68:71], v8 offset:6144
    v_and_b32 v165, 0xffff0000, v55
    v_add_f32 v12, v12, v164
    v_add_f32 v13, v13, v165
    v_fmac_f32 v14, v164, v164
    v_fmac_f32 v15, v165, v165
    s_waitcnt lgkmcnt(4)
    v_mfma_f32_32x32x16_bf16 v[84:99], a[128:131], v[76:79], v[84:99]
    ds_read_b128 v[72:75], v8 offset:7168
    v_lshlrev_b32 v16, 16, v56
    v_and_b32 v17, 0xffff0000, v56
    v_add_f32 v12, v12, v16
    v_add_f32 v13, v13, v17
    v_fmac_f32 v14, v16, v16
    s_waitcnt lgkmcnt(4)
    v_mfma_f32_32x32x16_bf16 v[84:99], a[132:135], v[80:83], v[84:99]
    ds_read_b128 v[76:79], v8 offset:8192
    v_fmac_f32 v15, v17, v17
    v_lshlrev_b32 v164, 16, v57
    v_and_b32 v165, 0xffff0000, v57
    v_add_f32 v12, v12, v164
    v_add_f32 v13, v13, v165
    s_waitcnt lgkmcnt(4)
    v_mfma_f32_32x32x16_bf16 v[84:99], a[136:139], v[60:63], v[84:99]
    ds_read_b128 v[80:83], v8 offset:9216
    v_fmac_f32 v14, v164, v164
    v_fmac_f32 v15, v165, v165
    v_lshlrev_b32 v16, 16, v58
    v_and_b32 v17, 0xffff0000, v58
    v_add_f32 v12, v12, v16
    s_waitcnt lgkmcnt(4)
    v_mfma_f32_32x32x16_bf16 v[84:99], a[140:143], v[64:67], v[84:99]
    ds_read_b128 v[60:63], v6 offset:2048
    v_add_f32 v13, v13, v17
    v_fmac_f32 v14, v16, v16
    v_fmac_f32 v15, v17, v17
    v_lshlrev_b32 v164, 16, v59
    v_and_b32 v165, 0xffff0000, v59
    s_waitcnt lgkmcnt(4)
    v_mfma_f32_32x32x16_bf16 v[84:99], a[144:147], v[68:71], v[84:99]
    ds_read_b128 v[64:67], v6 offset:3072
    v_add_f32 v12, v12, v164
    v_add_f32 v13, v13, v165
    v_fmac_f32 v14, v164, v164
    v_fmac_f32 v15, v165, v165
    v_add_f32 v12, v12, v13
    s_waitcnt lgkmcnt(4)
    v_mfma_f32_32x32x16_bf16 v[84:99], a[148:151], v[72:75], v[84:99]
    ds_read_b128 v[68:71], v6 offset:4096
    v_add_f32 v13, v14, v15
    ds_write_b64 v9, v[12:13]
    s_waitcnt lgkmcnt(5)
    v_mfma_f32_32x32x16_bf16 v[84:99], a[152:155], v[76:79], v[84:99]
    ds_read_b128 v[72:75], v6 offset:5120
    s_waitcnt lgkmcnt(5)
    v_mfma_f32_32x32x16_bf16 v[84:99], a[156:159], v[80:83], v[84:99]
    ds_read_b128 v[76:79], v6 offset:6144
    s_waitcnt lgkmcnt(2)
    s_barrier
    ds_read_b64 v[148:149], v10 offset:0
    ds_read_b64 v[150:151], v10 offset:256
    ds_read_b64 v[152:153], v10 offset:512
    ds_read_b64 v[154:155], v10 offset:768
    ds_read_b64 v[156:157], v10 offset:1024
    ds_read_b64 v[158:159], v10 offset:1280
    ds_read_b64 v[160:161], v10 offset:1536
    ds_read_b64 v[162:163], v10 offset:1792
    v_mfma_f32_32x32x16_bf16 v[100:115], a[208:211], v[60:63], v[100:115]
    ds_read_b128 v[80:83], v6 offset:7168
    v_mfma_f32_32x32x16_bf16 v[100:115], a[212:215], v[64:67], v[100:115]
    ds_read_b128 v[60:63], v6 offset:8192
    v_mfma_f32_32x32x16_bf16 v[100:115], a[216:219], v[68:71], v[100:115]
    ds_read_b128 v[64:67], v6 offset:9216
    s_waitcnt lgkmcnt(3)
    v_add_f32 v148, v148, v156
    v_add_f32 v149, v149, v157
    v_add_f32 v150, v150, v158
    v_add_f32 v151, v151, v159
    v_mfma_f32_32x32x16_bf16 v[100:115], a[220:223], v[72:75], v[100:115]
    ds_read_b128 v[68:71], v7 offset:0
    v_add_f32 v152, v152, v160
    v_add_f32 v153, v153, v161
    v_add_f32 v154, v154, v162
    v_add_f32 v155, v155, v163
    v_add_f32 v148, v148, v152
    v_mfma_f32_32x32x16_bf16 v[100:115], a[224:227], v[76:79], v[100:115]
    ds_read_b128 v[72:75], v7 offset:1024
    s_waitcnt vmcnt(0)
    v_add_u32 v188, v189, v11
    v_cmp_gt_i32 vcc, s57, v188
    v_add_f32 v149, v149, v153
    v_add_f32 v150, v150, v154
    v_add_f32 v151, v151, v155
    s_waitcnt lgkmcnt(4)
    v_mfma_f32_32x32x16_bf16 v[100:115], a[228:231], v[80:83], v[100:115]
    ds_read_b128 v[76:79], v7 offset:2048
    s_cmp_eq_u64 vcc, 0
    s_cselect_b32 s71, s62, 262144000
    buffer_load_dword v11, v3, s[4:7], 0 offen sc1
    v_add_f32 v148, v148, v150
    v_add_f32 v149, v149, v151
    v_mul_f32 v180, 0.0015625, v148
    s_waitcnt lgkmcnt(4)
    v_mfma_f32_32x32x16_bf16 v[100:115], a[232:235], v[60:63], v[100:115]
    ds_read_b128 v[80:83], v7 offset:3072
    v_mul_f32 v181, 0.0015625, v149
    v_fma_f32 v181, -v180, v180, v181
    v_max_f32 v181, 0, v181
    v_cvt_pk_bf16_f32 v181, v181, v181
    v_and_b32 v181, 0xffff0000, v181
    s_waitcnt lgkmcnt(4)
    v_mfma_f32_32x32x16_bf16 v[100:115], a[236:239], v[64:67], v[100:115]
    ds_read_b128 v[60:63], v7 offset:4096
    s_mov_b32 m0, s66
    s_mov_b32 s56, s71
    buffer_load_dwordx4 v2, s[4:7], s56 offen offset:0 sc1 lds
    v_add_f32 v181, 0x3727c5ac, v181
    v_cvt_pk_bf16_f32 v181, v181, v181
    v_and_b32 v181, 0xffff0000, v181
    s_waitcnt lgkmcnt(4)
    v_mfma_f32_32x32x16_bf16 v[100:115], a[240:243], v[68:71], v[100:115]
    ds_read_b128 v[64:67], v7 offset:5120
    v_sqrt_f32 v16, v181
    v_cvt_pk_bf16_f32 v180, v180, v180
    v_and_b32 v180, 0xffff0000, v180
    v_cvt_pk_bf16_f32 v16, v16, v16
    s_waitcnt lgkmcnt(4)
    v_mfma_f32_32x32x16_bf16 v[100:115], a[244:247], v[72:75], v[100:115]
    ds_read_b128 v[68:71], v7 offset:6144
    buffer_load_dwordx4 v2, s[4:7], s56 offen offset:1024 sc1 lds
    v_and_b32 v16, 0xffff0000, v16
    v_rcp_f32 v181, v16
    s_waitcnt lgkmcnt(4)
    v_mfma_f32_32x32x16_bf16 v[100:115], a[248:251], v[76:79], v[100:115]
    ds_read_b128 v[72:75], v7 offset:7168
    v_mul_f32 v18, 0xbfb8aa3b, v181
    v_fma_f32 v84, -v180, v116, v84
    v_fma_f32 v85, -v180, v117, v85
    v_fma_f32 v86, -v180, v118, v86
    v_fma_f32 v87, -v180, v119, v87
    s_waitcnt lgkmcnt(4)
    v_mfma_f32_32x32x16_bf16 v[100:115], a[252:255], v[80:83], v[100:115]
    ds_read_b128 v[76:79], v7 offset:8192
    buffer_load_dwordx4 v2, s[4:7], s56 offen offset:2048 sc1 lds
    v_fma_f32 v88, -v180, v120, v88
    v_fma_f32 v89, -v180, v121, v89
    v_fma_f32 v90, -v180, v122, v90
    s_waitcnt lgkmcnt(4)
    v_mfma_f32_32x32x16_bf16 v[100:115], v[192:195], v[60:63], v[100:115]
    ds_read_b128 v[80:83], v7 offset:9216
    v_fma_f32 v91, -v180, v123, v91
    v_fma_f32 v92, -v180, v124, v92
    v_fma_f32 v93, -v180, v125, v93
    v_fma_f32 v94, -v180, v126, v94
    v_fma_f32 v95, -v180, v127, v95
    s_waitcnt lgkmcnt(4)
    v_mfma_f32_32x32x16_bf16 v[100:115], v[196:199], v[64:67], v[100:115]
    ds_read_b128 v[60:63], v8 offset:0
    buffer_load_dwordx4 v2, s[4:7], s56 offen offset:3072 sc1 lds
    v_fma_f32 v96, -v180, v128, v96
    v_fma_f32 v97, -v180, v129, v97
    v_fma_f32 v98, -v180, v130, v98
    s_waitcnt lgkmcnt(4)
    v_mfma_f32_32x32x16_bf16 v[100:115], v[200:203], v[68:71], v[100:115]
    ds_read_b128 v[64:67], v8 offset:1024
    v_fma_f32 v99, -v180, v131, v99
    v_mul_f32 v148, v18, v84
    v_mul_f32 v149, v18, v85
    v_mul_f32 v150, v18, v86
    s_waitcnt lgkmcnt(4)
    v_mfma_f32_32x32x16_bf16 v[100:115], v[204:207], v[72:75], v[100:115]
    ds_read_b128 v[68:71], v8 offset:2048
    s_add_u32 m0, m0, 4096
    s_add_u32 s56, s56, 4096
    buffer_load_dwordx4 v2, s[4:7], s56 offen offset:0 sc1 lds
    v_exp_f32 v148, v148
    v_mul_f32 v151, v18, v87
    s_waitcnt lgkmcnt(4)
    v_mfma_f32_32x32x16_bf16 v[100:115], v[208:211], v[76:79], v[100:115]
    ds_read_b128 v[72:75], v8 offset:3072
    v_exp_f32 v149, v149
    v_fma_f32 v148, v148, v16, v16
    v_rcp_f32 v148, v148
    s_waitcnt lgkmcnt(4)
    v_mfma_f32_32x32x16_bf16 v[100:115], v[212:215], v[80:83], v[100:115]
    ds_read_b128 v[76:79], v8 offset:4096
    buffer_load_dwordx4 v2, s[4:7], s56 offen offset:1024 sc1 lds
    v_mul_f32 v152, v18, v88
    v_exp_f32 v150, v150
    s_waitcnt lgkmcnt(4)
    v_mfma_f32_32x32x16_bf16 v[100:115], v[216:219], v[60:63], v[100:115]
    ds_read_b128 v[80:83], v8 offset:5120
    v_fma_f32 v149, v149, v16, v16
    v_rcp_f32 v149, v149
    v_mul_f32 v84, v84, v148
    v_mul_f32 v153, v18, v89
    s_waitcnt lgkmcnt(4)
    v_mfma_f32_32x32x16_bf16 v[100:115], v[220:223], v[64:67], v[100:115]
    ds_read_b128 v[60:63], v8 offset:6144
    buffer_load_dwordx4 v2, s[4:7], s56 offen offset:2048 sc1 lds
    v_exp_f32 v151, v151
    v_fma_f32 v150, v150, v16, v16
    s_waitcnt lgkmcnt(4)
    v_mfma_f32_32x32x16_bf16 v[100:115], v[224:227], v[68:71], v[100:115]
    ds_read_b128 v[64:67], v8 offset:7168
    v_rcp_f32 v150, v150
    v_mul_f32 v85, v85, v149
    v_mul_f32 v154, v18, v90
    s_waitcnt lgkmcnt(4)
    v_mfma_f32_32x32x16_bf16 v[100:115], v[228:231], v[72:75], v[100:115]
    ds_read_b128 v[68:71], v8 offset:8192
    buffer_load_dwordx4 v2, s[4:7], s56 offen offset:3072 sc1 lds
    v_exp_f32 v152, v152
    v_fma_f32 v151, v151, v16, v16
    s_waitcnt lgkmcnt(4)
    v_mfma_f32_32x32x16_bf16 v[100:115], v[232:235], v[76:79], v[100:115]
    ds_read_b128 v[72:75], v8 offset:9216
    v_rcp_f32 v151, v151
    v_mul_f32 v86, v86, v150
    v_mul_f32 v155, v18, v91
    s_waitcnt lgkmcnt(4)
    v_mfma_f32_32x32x16_bf16 v[100:115], v[236:239], v[80:83], v[100:115]
    s_add_u32 m0, m0, 4096
    s_add_u32 s56, s56, 4096
    buffer_load_dwordx4 v2, s[4:7], s56 offen offset:0 sc1 lds
    v_exp_f32 v153, v153
    v_fma_f32 v152, v152, v16, v16
    s_waitcnt lgkmcnt(3)
    v_mfma_f32_32x32x16_bf16 v[100:115], v[240:243], v[60:63], v[100:115]
    v_rcp_f32 v152, v152
    v_mul_f32 v87, v87, v151
    v_mul_f32 v156, v18, v92
    s_waitcnt lgkmcnt(2)
    v_mfma_f32_32x32x16_bf16 v[100:115], v[244:247], v[64:67], v[100:115]
    buffer_load_dwordx4 v2, s[4:7], s56 offen offset:1024 sc1 lds
    v_exp_f32 v154, v154
    v_fma_f32 v153, v153, v16, v16
    s_waitcnt lgkmcnt(1)
    v_mfma_f32_32x32x16_bf16 v[100:115], v[248:251], v[68:71], v[100:115]
    v_rcp_f32 v153, v153
    v_mul_f32 v88, v88, v152
    v_mul_f32 v157, v18, v93
    s_waitcnt lgkmcnt(0)
    v_mfma_f32_32x32x16_bf16 v[100:115], v[252:255], v[72:75], v[100:115]
    v_exp_f32 v155, v155
    v_fma_f32 v154, v154, v16, v16
    v_rcp_f32 v154, v154
    v_mul_f32 v89, v89, v153
    v_mul_f32 v158, v18, v94
    v_exp_f32 v156, v156
    v_fma_f32 v155, v155, v16, v16
    v_rcp_f32 v155, v155
    v_mul_f32 v90, v90, v154
    v_mul_f32 v159, v18, v95
    v_exp_f32 v157, v157
    v_fma_f32 v156, v156, v16, v16
    v_rcp_f32 v156, v156
    v_mul_f32 v91, v91, v155
    v_mul_f32 v160, v18, v96
    v_exp_f32 v158, v158
    v_fma_f32 v157, v157, v16, v16
    v_rcp_f32 v157, v157
    v_mul_f32 v92, v92, v156
    v_mul_f32 v161, v18, v97
    v_exp_f32 v159, v159
    v_fma_f32 v158, v158, v16, v16
    v_rcp_f32 v158, v158
    v_mul_f32 v93, v93, v157
    v_mul_f32 v162, v18, v98
    v_exp_f32 v160, v160
    v_fma_f32 v159, v159, v16, v16
    v_rcp_f32 v159, v159
    v_mul_f32 v94, v94, v158
    v_mul_f32 v163, v18, v99
    v_exp_f32 v161, v161
    v_fma_f32 v160, v160, v16, v16
    v_rcp_f32 v160, v160
    v_mul_f32 v95, v95, v159
    v_exp_f32 v162, v162
    v_fma_f32 v161, v161, v16, v16
    v_rcp_f32 v161, v161
    v_mul_f32 v96, v96, v160
    v_exp_f32 v163, v163
    v_fma_f32 v162, v162, v16, v16
    v_rcp_f32 v162, v162
    v_mul_f32 v97, v97, v161
    v_fma_f32 v163, v163, v16, v16
    v_rcp_f32 v163, v163
    v_mul_f32 v98, v98, v162
    v_mul_f32 v99, v99, v163
    v_cvt_pk_bf16_f32 v20, v84, v85
    v_cvt_pk_bf16_f32 v21, v86, v87
    v_cvt_pk_bf16_f32 v22, v92, v93
    v_cvt_pk_bf16_f32 v23, v94, v95
    v_cvt_pk_bf16_f32 v24, v88, v89
    v_cvt_pk_bf16_f32 v25, v90, v91
    v_cvt_pk_bf16_f32 v26, v96, v97
    v_cvt_pk_bf16_f32 v27, v98, v99
    v_xor_b32 v9, 2048, v9
    v_xor_b32 v10, 2048, v10
    v_xor_b32 v5, 0x10000, v5
    v_xor_b32 v6, 0x10000, v6
    v_xor_b32 v7, 0x10000, v7
    v_xor_b32 v8, 0x10000, v8
    s_add_u32 s64, s63, 2048
    s_add_u32 s60, s60, 1
    v_mov_b32 v19, s60
    s_mov_b32 s70, s65
    s_cmp_lg_u32 s71, 262144000
    s_cbranch_scc1 L_ff1_c2
    s_waitcnt vmcnt(10)
    v_add_u32 v188, v189, v11
    v_cmp_gt_i32 vcc, s57, v188
    s_cbranch_vccnz L_ff1_c2
    s_mov_b32 s71, s62
    s_mov_b32 m0, s66
    s_mov_b32 s56, s62
    buffer_load_dwordx4 v2, s[4:7], s56 offen offset:0 sc1 lds
    buffer_load_dwordx4 v2, s[4:7], s56 offen offset:1024 sc1 lds
    buffer_load_dwordx4 v2, s[4:7], s56 offen offset:2048 sc1 lds
    buffer_load_dwordx4 v2, s[4:7], s56 offen offset:3072 sc1 lds
    s_add_u32 m0, m0, 4096
    s_add_u32 s56, s56, 4096
    buffer_load_dwordx4 v2, s[4:7], s56 offen offset:0 sc1 lds
    buffer_load_dwordx4 v2, s[4:7], s56 offen offset:1024 sc1 lds
    buffer_load_dwordx4 v2, s[4:7], s56 offen offset:2048 sc1 lds
    buffer_load_dwordx4 v2, s[4:7], s56 offen offset:3072 sc1 lds
    s_add_u32 m0, m0, 4096
    s_add_u32 s56, s56, 4096
    buffer_load_dwordx4 v2, s[4:7], s56 offen offset:0 sc1 lds
    buffer_load_dwordx4 v2, s[4:7], s56 offen offset:1024 sc1 lds
L_ff1_c2:
    buffer_load_dword v4, v3, s[4:7], 0 offen sc1
    s_cmp_lg_u32 s72, 0
    s_cbranch_scc1 Lls_33
    buffer_store_dwordx4 v[20:23], v2, s[4:7], s63 offen offset:0
Lld_34:
    s_cmp_lg_u32 s72, 0
    s_cbranch_scc1 Lls_35
    buffer_store_dwordx4 v[24:27], v2, s[4:7], s63 offen offset:1024
Lld_36:
    v_pk_fma_f32 v[100:101], v[180:181], v[132:133], v[100:101] op_sel_hi:[0,1,1] neg_lo:[1,0,0] neg_hi:[1,0,0]
    v_pk_fma_f32 v[102:103], v[180:181], v[134:135], v[102:103] op_sel_hi:[0,1,1] neg_lo:[1,0,0] neg_hi:[1,0,0]
    v_pk_fma_f32 v[104:105], v[180:181], v[136:137], v[104:105] op_sel_hi:[0,1,1] neg_lo:[1,0,0] neg_hi:[1,0,0]
    v_pk_fma_f32 v[106:107], v[180:181], v[138:139], v[106:107] op_sel_hi:[0,1,1] neg_lo:[1,0,0] neg_hi:[1,0,0]
    v_pk_fma_f32 v[108:109], v[180:181], v[140:141], v[108:109] op_sel_hi:[0,1,1] neg_lo:[1,0,0] neg_hi:[1,0,0]
    v_pk_fma_f32 v[110:111], v[180:181], v[142:143], v[110:111] op_sel_hi:[0,1,1] neg_lo:[1,0,0] neg_hi:[1,0,0]
    v_pk_fma_f32 v[112:113], v[180:181], v[144:145], v[112:113] op_sel_hi:[0,1,1] neg_lo:[1,0,0] neg_hi:[1,0,0]
    v_pk_fma_f32 v[114:115], v[180:181], v[146:147], v[114:115] op_sel_hi:[0,1,1] neg_lo:[1,0,0] neg_hi:[1,0,0]
    v_pk_mul_f32 v[148:149], v[18:19], v[100:101] op_sel_hi:[0,1]
    v_pk_mul_f32 v[150:151], v[18:19], v[102:103] op_sel_hi:[0,1]
    v_pk_mul_f32 v[152:153], v[18:19], v[104:105] op_sel_hi:[0,1]
    v_pk_mul_f32 v[154:155], v[18:19], v[106:107] op_sel_hi:[0,1]
    v_pk_mul_f32 v[156:157], v[18:19], v[108:109] op_sel_hi:[0,1]
    v_pk_mul_f32 v[158:159], v[18:19], v[110:111] op_sel_hi:[0,1]
    v_pk_mul_f32 v[160:161], v[18:19], v[112:113] op_sel_hi:[0,1]
    v_pk_mul_f32 v[162:163], v[18:19], v[114:115] op_sel_hi:[0,1]
    v_exp_f32 v148, v148
    v_exp_f32 v149, v149
    v_exp_f32 v150, v150
    v_exp_f32 v151, v151
    v_exp_f32 v152, v152
    v_exp_f32 v153, v153
    v_exp_f32 v154, v154
    v_exp_f32 v155, v155
    v_exp_f32 v156, v156
    v_exp_f32 v157, v157
    v_exp_f32 v158, v158
    v_exp_f32 v159, v159
    v_exp_f32 v160, v160
    v_exp_f32 v161, v161
    v_exp_f32 v162, v162
    v_exp_f32 v163, v163
    v_pk_fma_f32 v[148:149], v[148:149], v[16:17], v[16:17] op_sel_hi:[1,0,0]
    v_pk_fma_f32 v[150:151], v[150:151], v[16:17], v[16:17] op_sel_hi:[1,0,0]
    v_pk_fma_f32 v[152:153], v[152:153], v[16:17], v[16:17] op_sel_hi:[1,0,0]
    v_pk_fma_f32 v[154:155], v[154:155], v[16:17], v[16:17] op_sel_hi:[1,0,0]
    v_pk_fma_f32 v[156:157], v[156:157], v[16:17], v[16:17] op_sel_hi:[1,0,0]
    v_pk_fma_f32 v[158:159], v[158:159], v[16:17], v[16:17] op_sel_hi:[1,0,0]
    v_pk_fma_f32 v[160:161], v[160:161], v[16:17], v[16:17] op_sel_hi:[1,0,0]
    v_pk_fma_f32 v[162:163], v[162:163], v[16:17], v[16:17] op_sel_hi:[1,0,0]
    v_rcp_f32 v148, v148
    v_rcp_f32 v149, v149
    v_rcp_f32 v150, v150
    v_rcp_f32 v151, v151
    v_rcp_f32 v152, v152
    v_rcp_f32 v153, v153
    v_rcp_f32 v154, v154
    v_rcp_f32 v155, v155
    v_rcp_f32 v156, v156
    v_rcp_f32 v157, v157
    v_rcp_f32 v158, v158
    v_rcp_f32 v159, v159
    v_rcp_f32 v160, v160
    v_rcp_f32 v161, v161
    v_rcp_f32 v162, v162
    v_rcp_f32 v163, v163
    v_pk_mul_f32 v[100:101], v[100:101], v[148:149]
    v_pk_mul_f32 v[102:103], v[102:103], v[150:151]
    v_pk_mul_f32 v[104:105], v[104:105], v[152:153]
    v_pk_mul_f32 v[106:107], v[106:107], v[154:155]
    v_pk_mul_f32 v[108:109], v[108:109], v[156:157]
    v_pk_mul_f32 v[110:111], v[110:111], v[158:159]
    v_pk_mul_f32 v[112:113], v[112:113], v[160:161]
    v_pk_mul_f32 v[114:115], v[114:115], v[162:163]
    v_cvt_pk_bf16_f32 v60, v100, v101
    v_cvt_pk_bf16_f32 v61, v102, v103
    v_cvt_pk_bf16_f32 v62, v108, v109
    v_cvt_pk_bf16_f32 v63, v110, v111
    s_cmp_lg_u32 s72, 0
    s_cbranch_scc1 Lls_37
    buffer_store_dwordx4 v[60:63], v2, s[4:7], s64 offen offset:0
Lld_38:
    v_cvt_pk_bf16_f32 v64, v104, v105
    v_cvt_pk_bf16_f32 v65, v106, v107
    v_cvt_pk_bf16_f32 v66, v112, v113
    v_cvt_pk_bf16_f32 v67, v114, v115
    s_cmp_lg_u32 s72, 0
    s_cbranch_scc1 Lls_39
    buffer_store_dwordx4 v[64:67], v2, s[4:7], s64 offen offset:1024
Lld_40:
    s_add_u32 s55, s60, 0
    s_and_b32 s55, s55, 3
    s_cselect_b32 s55, 0, 458752
    s_sub_u32 s63, s63, s55
    s_add_u32 s63, s63, 114688
    s_cmp_lt_u32 s60, 64
    s_cbranch_scc1 L_ff1_loop
    s_waitcnt vmcnt(0)
    s_cmp_lg_u32 s72, 0
    s_cbranch_scc1 Lls_41
    buffer_store_dword v19, off, s[4:7], s70
Lld_42:
    s_mov_b32 s70, 262144000
    s_endpgm
Lls_29:
    buffer_store_dword v19, off, s[4:7], s70 sc1
    s_branch Lld_30
Lls_31:
    buffer_store_dword v19, off, s[4:7], s70 sc1
    s_branch Lld_32
L_ff1_alt:
    s_mov_b32 m0, s66
    s_mov_b32 s56, s62
    buffer_load_dwordx4 v2, s[4:7], s56 offen offset:0 sc1 lds
    buffer_load_dwordx4 v2, s[4:7], s56 offen offset:1024 sc1 lds
    buffer_load_dwordx4 v2, s[4:7], s56 offen offset:2048 sc1 lds
    buffer_load_dwordx4 v2, s[4:7], s56 offen offset:3072 sc1 lds
    s_add_u32 m0, m0, 4096
    s_add_u32 s56, s56, 4096
    buffer_load_dwordx4 v2, s[4:7], s56 offen offset:0 sc1 lds
    s_waitcnt vmcnt(4)
    ds_read_b128 v[20:23], v5 offset:0
    s_cmp_lg_u32 s72, 0
    s_cbranch_scc1 Lls_43
    buffer_store_dword v19, off, s[4:7], s70
Lld_44:
    s_mov_b32 s70, 262144000
    buffer_load_dwordx4 v2, s[4:7], s56 offen offset:1024 sc1 lds
    s_waitcnt vmcnt(5)
    ds_read_b128 v[24:27], v5 offset:1024
    s_waitcnt lgkmcnt(1)
    v_mfma_f32_32x32x16_bf16 v[84:99], a[0:3], v[20:23], 0
    buffer_load_dwordx4 v2, s[4:7], s56 offen offset:2048 sc1 lds
    v_lshlrev_b32 v16, 16, v20
    v_and_b32 v17, 0xffff0000, v20
    v_mov_b32 v12, v16
    v_mov_b32 v13, v17
    v_mul_f32 v14, v16, v16
    v_mfma_f32_32x32x16_bf16 v[100:115], a[160:163], v[20:23], 0
    s_waitcnt vmcnt(5)
    ds_read_b128 v[28:31], v5 offset:2048
    v_mul_f32 v15, v17, v17
    v_lshlrev_b32 v164, 16, v21
    v_and_b32 v165, 0xffff0000, v21
    v_add_f32 v12, v12, v164
    v_add_f32 v13, v13, v165
    s_waitcnt lgkmcnt(1)
    v_mfma_f32_32x32x16_bf16 v[84:99], a[4:7], v[24:27], v[84:99]
    buffer_load_dwordx4 v2, s[4:7], s56 offen offset:3072 sc1 lds
    v_fmac_f32 v14, v164, v164
    v_fmac_f32 v15, v165, v165
    v_lshlrev_b32 v16, 16, v22
    v_and_b32 v17, 0xffff0000, v22
    v_add_f32 v12, v12, v16
    v_mfma_f32_32x32x16_bf16 v[100:115], a[164:167], v[24:27], v[100:115]
    s_waitcnt vmcnt(5)
    ds_read_b128 v[32:35], v5 offset:3072
    v_add_f32 v13, v13, v17
    v_fmac_f32 v14, v16, v16
    v_fmac_f32 v15, v17, v17
    v_lshlrev_b32 v164, 16, v23
    v_and_b32 v165, 0xffff0000, v23
    s_waitcnt lgkmcnt(1)
    v_mfma_f32_32x32x16_bf16 v[84:99], a[8:11], v[28:31], v[84:99]
    s_add_u32 m0, m0, 4096
    s_add_u32 s56, s56, 4096
    buffer_load_dwordx4 v2, s[4:7], s56 offen offset:0 sc1 lds
    v_add_f32 v12, v12, v164
    v_add_f32 v13, v13, v165
    v_fmac_f32 v14, v164, v164
    v_fmac_f32 v15, v165, v165
    v_lshlrev_b32 v16, 16, v24
    v_mfma_f32_32x32x16_bf16 v[100:115], a[168:171], v[28:31], v[100:115]
    s_waitcnt vmcnt(5)
    ds_read_b128 v[36:39], v5 offset:4096
    v_and_b32 v17, 0xffff0000, v24
    v_add_f32 v12, v12, v16
    v_add_f32 v13, v13, v17
    v_fmac_f32 v14, v16, v16
    v_fmac_f32 v15, v17, v17
    s_waitcnt lgkmcnt(1)
    v_mfma_f32_32x32x16_bf16 v[84:99], a[12:15], v[32:35], v[84:99]
    buffer_load_dwordx4 v2, s[4:7], s56 offen offset:1024 sc1 lds
    v_lshlrev_b32 v164, 16, v25
    v_and_b32 v165, 0xffff0000, v25
    v_add_f32 v12, v12, v164
    v_add_f32 v13, v13, v165
    v_fmac_f32 v14, v164, v164
    v_mfma_f32_32x32x16_bf16 v[100:115], a[172:175], v[32:35], v[100:115]
    s_waitcnt vmcnt(4)
    ds_read_b128 v[40:43], v5 offset:5120
    v_fmac_f32 v15, v165, v165
    v_lshlrev_b32 v16, 16, v26
    v_and_b32 v17, 0xffff0000, v26
    v_add_f32 v12, v12, v16
    v_add_f32 v13, v13, v17
    s_waitcnt lgkmcnt(1)
    v_mfma_f32_32x32x16_bf16 v[84:99], a[16:19], v[36:39], v[84:99]
    s_add_u32 s55, s60, 1
    s_and_b32 s55, s55, 7
    s_cselect_b32 s55, 0, 327680
    s_sub_u32 s62, s62, s55
    s_add_u32 s62, s62, 40960
    s_xor_b32 s66, s66, 0x10000
    s_add_u32 s57, s60, 2
    v_fmac_f32 v14, v16, v16
    v_fmac_f32 v15, v17, v17
    v_lshlrev_b32 v164, 16, v27
    v_and_b32 v165, 0xffff0000, v27
    v_add_f32 v12, v12, v164
    v_mfma_f32_32x32x16_bf16 v[100:115], a[176:179], v[36:39], v[100:115]
    s_waitcnt vmcnt(3)
    ds_read_b128 v[44:47], v5 offset:6144
    v_add_f32 v13, v13, v165
    v_fmac_f32 v14, v164, v164
    v_fmac_f32 v15, v165, v165
    v_lshlrev_b32 v16, 16, v28
    v_and_b32 v17, 0xffff0000, v28
    s_waitcnt lgkmcnt(1)
    v_mfma_f32_32x32x16_bf16 v[84:99], a[20:23], v[40:43], v[84:99]
    v_add_f32 v12, v12, v16
    v_add_f32 v13, v13, v17
    v_fmac_f32 v14, v16, v16
    v_fmac_f32 v15, v17, v17
    v_lshlrev_b32 v164, 16, v29
    v_mfma_f32_32x32x16_bf16 v[100:115], a[180:183], v[40:43], v[100:115]
    s_waitcnt vmcnt(2)
    ds_read_b128 v[48:51], v5 offset:7168
    v_and_b32 v165, 0xffff0000, v29
    v_add_f32 v12, v12, v164
    v_add_f32 v13, v13, v165
    v_fmac_f32 v14, v164, v164
    v_fmac_f32 v15, v165, v165
    s_waitcnt lgkmcnt(1)
    v_mfma_f32_32x32x16_bf16 v[84:99], a[24:27], v[44:47], v[84:99]
    s_waitcnt vmcnt(1)
    ds_read_b128 v[52:55], v5 offset:8192
    v_lshlrev_b32 v16, 16, v30
    v_and_b32 v17, 0xffff0000, v30
    v_add_f32 v12, v12, v16
    v_add_f32 v13, v13, v17
    v_fmac_f32 v14, v16, v16
    v_mfma_f32_32x32x16_bf16 v[100:115], a[184:187], v[44:47], v[100:115]
    s_waitcnt vmcnt(0)
    ds_read_b128 v[56:59], v5 offset:9216
    v_fmac_f32 v15, v17, v17
    v_lshlrev_b32 v164, 16, v31
    v_and_b32 v165, 0xffff0000, v31
    v_add_f32 v12, v12, v164
    v_add_f32 v13, v13, v165
    s_waitcnt lgkmcnt(2)
    v_mfma_f32_32x32x16_bf16 v[84:99], a[28:31], v[48:51], v[84:99]
    s_barrier
    v_fmac_f32 v14, v164, v164
    v_fmac_f32 v15, v165, v165
    v_lshlrev_b32 v16, 16, v32
    v_and_b32 v17, 0xffff0000, v32
    v_add_f32 v12, v12, v16
    v_mfma_f32_32x32x16_bf16 v[100:115], a[188:191], v[48:51], v[100:115]
    ds_read_b128 v[60:63], v6 offset:0
    v_add_f32 v13, v13, v17
    v_fmac_f32 v14, v16, v16
    v_fmac_f32 v15, v17, v17
    v_lshlrev_b32 v164, 16, v33
    v_and_b32 v165, 0xffff0000, v33
    s_waitcnt lgkmcnt(2)
    v_mfma_f32_32x32x16_bf16 v[84:99], a[32:35], v[52:55], v[84:99]
    ds_read_b128 v[64:67], v6 offset:1024
    v_add_f32 v12, v12, v164
    v_add_f32 v13, v13, v165
    v_fmac_f32 v14, v164, v164
    v_fmac_f32 v15, v165, v165
    v_lshlrev_b32 v16, 16, v34
    v_mfma_f32_32x32x16_bf16 v[100:115], a[192:195], v[52:55], v[100:115]
    ds_read_b128 v[68:71], v6 offset:2048
    v_and_b32 v17, 0xffff0000, v34
    v_add_f32 v12, v12, v16
    v_add_f32 v13, v13, v17
    v_fmac_f32 v14, v16, v16
    v_fmac_f32 v15, v17, v17
    s_waitcnt lgkmcnt(3)
    v_mfma_f32_32x32x16_bf16 v[84:99], a[36:39], v[56:59], v[84:99]
    ds_read_b128 v[72:75], v6 offset:3072
    v_lshlrev_b32 v164, 16, v35
    v_and_b32 v165, 0xffff0000, v35
    v_add_f32 v12, v12, v164
    v_add_f32 v13, v13, v165
    v_fmac_f32 v14, v164, v164
    v_mfma_f32_32x32x16_bf16 v[100:115], a[196:199], v[56:59], v[100:115]
    ds_read_b128 v[76:79], v6 offset:4096
    v_fmac_f32 v15, v165, v165
    v_lshlrev_b32 v16, 16, v36
    v_and_b32 v17, 0xffff0000, v36
    s_branch L_ff1_join
Lls_33:
    buffer_store_dwordx4 v[20:23], v2, s[4:7], s63 offen offset:0 sc1
    s_branch Lld_34
Lls_35:
    buffer_store_dwordx4 v[24:27], v2, s[4:7], s63 offen offset:1024 sc1
    s_branch Lld_36
Lls_37:
    buffer_store_dwordx4 v[60:63], v2, s[4:7], s64 offen offset:0 sc1
    s_branch Lld_38
Lls_39:
    buffer_store_dwordx4 v[64:67], v2, s[4:7], s64 offen offset:1024 sc1
    s_branch Lld_40
Lls_41:
    buffer_store_dword v19, off, s[4:7], s70 sc1
    s_branch Lld_42
Lls_43:
    buffer_store_dword v19, off, s[4:7], s70 sc1
    s_branch Lld_44
L_role_spare:
    s_endpgm
L_role_att:
    s_waitcnt vmcnt(0)
    s_mul_i32 s59, s51, 3
    s_add_u32 s59, s59, s3
    s_cmp_eq_u32 s3, 3
    s_cbranch_scc1 L_end
    s_cmp_eq_u32 s59, 17
    s_cbranch_scc1 L_end
    s_cmp_eq_u32 s59, 16
    s_cselect_b32 s59, 31, s59
    s_cselect_b32 s75, 1, 0
    s_cmp_ge_u32 s51, 6
    s_cselect_b32 s55, 2, 0
    s_sub_u32 s59, s59, s55
    s_lshl_b32 s60, s53, 5
    s_add_u32 s60, s60, s59
L_att_dec:
    s_mov_b32 s69, 0
    s_mov_b32 s70, 0
L_att_real:
    v_mov_b32 v4, 128
Lp_45:
    buffer_load_dword v5, v4, s[8:11], 0 offen sc1
    s_waitcnt vmcnt(0)
    v_cmp_gt_i32 vcc, 1, v5
    s_cbranch_vccz Lpd_46
    s_sleep 8
    s_mov_b32 s54, 33
    s_sub_u32 s52, s52, 1
    s_cbranch_scc1 L_abort
    s_branch Lp_45
Lpd_46:
    s_and_b32 s55, s60, 31
    s_lshl_b32 s56, s53, 11
    s_add_u32 s56, s56, s55
    s_lshl_b32 s62, s56, 14
    s_add_u32 s62, s62, 8388608
    s_lshl_b32 s63, s56, 13
    s_add_u32 s65, s63, 109051904
    s_add_u32 s63, s63, 75497472
    s_add_u32 s66, s60, 224
    s_lshl_b32 s66, s66, 7
    s_mov_b32 s67, 1040356334
    v_lshlrev_b32 v2, 4, v1
    v_mbcnt_lo_u32_b32 v5, -1, 0
    v_and_b32 v5, 1, v5
    v_lshlrev_b32 v5, 2, v5
    s_lshl_b32 s55, s50, 3
    buffer_load_dword v5, v5, s[8:11], s55 offen sc1
    s_getreg_b32 s55, hwreg(HW_REG_XCC_ID)
    s_and_b32 s55, s55, 7
    s_lshl_b32 s55, s55, 3
    s_lshl_b64 s[56:57], 0xff, s55
    s_waitcnt vmcnt(0)
    v_readlane_b32 s96, v5, 0
    v_readlane_b32 s97, v5, 1
    s_andn2_b64 s[56:57], s[96:97], s[56:57]
    s_cselect_b32 s73, 1, 0
    s_or_b32 s73, s73, s75
    v_mov_b32 v4, 132
Lp_47:
    buffer_load_dword v5, v4, s[8:11], 0 offen sc1
    s_waitcnt vmcnt(0)
    v_cmp_gt_i32 vcc, 1, v5
    s_cbranch_vccz Lpd_48
    s_sleep 8
    s_mov_b32 s54, 112
    s_sub_u32 s52, s52, 1
    s_cbranch_scc1 L_abort
    s_branch Lp_47
Lpd_48:
    v_readfirstlane_b32 s70, v5
    s_and_b32 s70, s70, 2
    s_lshl_b32 s70, s70, 12
    s_lshr_b32 s71, s59, 1
    s_lshl_b32 s71, s71, 14
    s_and_b32 s55, s59, 1
    s_lshl_b32 s55, s55, 12
    s_add_u32 s71, s71, s55
    s_add_u32 s71, s71, s38
    s_add_u32 s71, s71, 142606336
    s_lshl_b32 s72, s53, 6
    s_lshl_b32 s55, s72, 10
    s_and_b32 s55, s55, 0x2000
    s_xor_b32 s55, s55, s70
    s_lshl_b32 s64, s72, 18
    s_add_u32 s64, s64, s55
    s_add_u32 s64, s64, s71
    s_lshl_b32 s55, s60, 2
    s_add_u32 s56, s55, 672
    s_add_u32 s57, s55, 416
    s_lshr_b32 s55, s60, 1
    s_lshl_b32 s55, s55, 2
    s_add_u32 s55, s55, 288
    v_mov_b32 v3, s55
    v_mov_b32 v5, s57
    v_cmp_gt_u32 vcc, 8, v1
    s_nop 1
    v_cndmask_b32 v3, v3, v5, vcc
    v_mov_b32 v5, s56
    v_cmp_gt_u32 vcc, 4, v1
    s_nop 1
    v_cndmask_b32 v3, v3, v5, vcc
    v_cndmask_b32 v8, 2, 1, vcc
    v_and_b32 v5, 3, v1
    v_add_u32 v3, v3, v5
    v_lshlrev_b32 v3, 7, v3
    v_and_b32 v6, 7, v1
    v_lshlrev_b32 v6, 8, v6
    v_lshrrev_b32 v5, 5, v1
    v_lshl_add_u32 v6, v5, 4, v6
    v_lshlrev_b32 v7, 8, v5
    v_bfe_u32 v9, v1, 4, 1
    v_lshl_add_u32 v7, v9, 2, v7
    v_and_b32 v9, 15, v1
    v_lshl_add_u32 v7, v9, 3, v7
    v_and_b32 v9, 31, v1
    v_lshlrev_b32 v5, 2, v5
    v_sub_u32 v9, v9, v5
    v_mov_b32 v10, 0xf149f2ca
    s_lshr_b32 s55, s59, 4
    s_lshl_b32 s55, s55, 1
    s_add_u32 s55, s55, s53
    s_mul_i32 s55, s55, 40
    s_bfe_u32 s56, s59, 0x20002
    s_add_u32 s55, s55, s56
    s_add_u32 s55, s55, 6272
    s_mul_i32 s56, s53, 40
    s_add_u32 s56, s56, 6147
    s_cmp_lg_u32 s75, 0
    s_cselect_b32 s55, s56, s55
    v_subrev_u32 v5, 12, v1
    v_min_u32 v5, 9, v5
    v_lshl_add_u32 v5, v5, 2, s55
    v_lshlrev_b32 v5, 7, v5
    v_cmp_gt_u32 vcc, 12, v1
    s_nop 1
    v_cndmask_b32 v3, v5, v3, vcc
    v_cndmask_b32 v8, -3, v8, vcc
    v_cmp_le_i32 vcc, 0, v9
    s_nop 1
    v_cndmask_b32 v96, v10, 0, vcc
    v_cmp_le_i32 vcc, 1, v9
    s_nop 1
    v_cndmask_b32 v97, v10, 0, vcc
    v_cmp_le_i32 vcc, 2, v9
    s_nop 1
    v_cndmask_b32 v98, v10, 0, vcc
    v_cmp_le_i32 vcc, 3, v9
    s_nop 1
    v_cndmask_b32 v99, v10, 0, vcc
    v_cmp_le_i32 vcc, 8, v9
    s_nop 1
    v_cndmask_b32 v100, v10, 0, vcc
    v_cmp_le_i32 vcc, 9, v9
    s_nop 1
    v_cndmask_b32 v101, v10, 0, vcc
    v_cmp_le_i32 vcc, 10, v9
    s_nop 1
    v_cndmask_b32 v102, v10, 0, vcc
    v_cmp_le_i32 vcc, 11, v9
    s_nop 1
    v_cndmask_b32 v103, v10, 0, vcc
    v_cmp_le_i32 vcc, 16, v9
    s_nop 1
    v_cndmask_b32 v104, v10, 0, vcc
    v_cmp_le_i32 vcc, 17, v9
    s_nop 1
    v_cndmask_b32 v105, v10, 0, vcc
    v_cmp_le_i32 vcc, 18, v9
    s_nop 1
    v_cndmask_b32 v106, v10, 0, vcc
    v_cmp_le_i32 vcc, 19, v9
    s_nop 1
    v_cndmask_b32 v107, v10, 0, vcc
    v_cmp_le_i32 vcc, 24, v9
    s_nop 1
    v_cndmask_b32 v108, v10, 0, vcc
    v_cmp_le_i32 vcc, 25, v9
    s_nop 1
    v_cndmask_b32 v109, v10, 0, vcc
    v_cmp_le_i32 vcc, 26, v9
    s_nop 1
    v_cndmask_b32 v110, v10, 0, vcc
    v_cmp_le_i32 vcc, 27, v9
    s_nop 1
    v_cndmask_b32 v111, v10, 0, vcc
    v_subrev_u32 v4, 1, v8
    s_mov_b32 s61, 0
Lp_49:
    buffer_load_dword v5, v3, s[4:7], 0 offen sc1
    s_waitcnt vmcnt(0)
    v_cmp_gt_i32 vcc, v4, v5
    s_cbranch_vccz Lpd_50
    s_sleep 4
    s_mov_b32 s54, 34
    s_sub_u32 s52, s52, 1
    s_cbranch_scc1 L_abort
    s_branch Lp_49
Lpd_50:
    s_add_u32 s56, s62, 0
    s_add_u32 s57, s62, 4096
    buffer_load_dwordx4 a[0:3], v2, s[4:7], s56 offen offset:0 sc1
    buffer_load_dwordx4 a[4:7], v2, s[4:7], s56 offen offset:1024 sc1
    buffer_load_dwordx4 a[8:11], v2, s[4:7], s56 offen offset:2048 sc1
    buffer_load_dwordx4 a[12:15], v2, s[4:7], s56 offen offset:3072 sc1
    buffer_load_dwordx4 a[16:19], v2, s[4:7], s57 offen offset:0 sc1
    buffer_load_dwordx4 a[20:23], v2, s[4:7], s57 offen offset:1024 sc1
    buffer_load_dwordx4 a[24:27], v2, s[4:7], s57 offen offset:2048 sc1
    buffer_load_dwordx4 a[28:31], v2, s[4:7], s57 offen offset:3072 sc1
    s_add_u32 s56, s63, 0
    s_add_u32 s57, s63, 4096
    buffer_load_dwordx4 a[32:35], v2, s[4:7], s56 offen offset:0 sc1
    buffer_load_dwordx4 a[36:39], v2, s[4:7], s56 offen offset:1024 sc1
    buffer_load_dwordx4 a[40:43], v2, s[4:7], s56 offen offset:2048 sc1
    buffer_load_dwordx4 a[44:47], v2, s[4:7], s56 offen offset:3072 sc1
    buffer_load_dwordx4 a[48:51], v2, s[4:7], s57 offen offset:0 sc1
    buffer_load_dwordx4 a[52:55], v2, s[4:7], s57 offen offset:1024 sc1
    buffer_load_dwordx4 a[56:59], v2, s[4:7], s57 offen offset:2048 sc1
    buffer_load_dwordx4 a[60:63], v2, s[4:7], s57 offen offset:3072 sc1
    s_add_u32 s56, s62, 8192
    s_add_u32 s57, s62, 12288
    buffer_load_dwordx4 a[64:67], v2, s[4:7], s56 offen offset:0 sc1
    buffer_load_dwordx4 a[68:71], v2, s[4:7], s56 offen offset:1024 sc1
    buffer_load_dwordx4 a[72:75], v2, s[4:7], s56 offen offset:2048 sc1
    buffer_load_dwordx4 a[76:79], v2, s[4:7], s56 offen offset:3072 sc1
    buffer_load_dwordx4 a[80:83], v2, s[4:7], s57 offen offset:0 sc1
    buffer_load_dwordx4 a[84:87], v2, s[4:7], s57 offen offset:1024 sc1
    buffer_load_dwordx4 a[88:91], v2, s[4:7], s57 offen offset:2048 sc1
    buffer_load_dwordx4 a[92:95], v2, s[4:7], s57 offen offset:3072 sc1
    s_waitcnt vmcnt(0)
    s_mov_b32 s68, 262144000
    v_mov_b32 v11, 0
    v_mov_b32 v4, v8
L_att_loop0:
    s_add_u32 s62, s62, 524288
    s_add_u32 s63, s63, 262144
    s_add_u32 s56, s62, 4096
    s_add_u32 s57, s62, 8192
    s_add_u32 s76, s62, 12288
    s_add_u32 s58, s65, 4096
    s_add_u32 s77, s63, 4096
    v_cmp_gt_i32 vcc, v4, v5
    s_and_b32 s78, vcc_lo, 0xff0
    s_cbranch_scc1 L_att_np0
    s_cmp_eq_u64 vcc, 0
    s_cselect_b32 s79, 1, 0
    s_cbranch_scc1 L_att_bk0
L_att_x0:
    v_mfma_f32_32x32x16_bf16 v[64:79], a[0:3], a[32:35], v[96:111]
    v_mfma_f32_32x32x16_bf16 v[64:79], a[4:7], a[36:39], v[64:79]
    buffer_load_dwordx4 a[128:131], v2, s[4:7], s63 offen offset:0 sc1
    v_mfma_f32_32x32x16_bf16 v[64:79], a[8:11], a[40:43], v[64:79]
    v_mfma_f32_32x32x16_bf16 v[64:79], a[12:15], a[44:47], v[64:79]
    buffer_load_dwordx4 a[132:135], v2, s[4:7], s63 offen offset:1024 sc1
    v_mfma_f32_32x32x16_bf16 v[64:79], a[16:19], a[48:51], v[64:79]
    v_mfma_f32_32x32x16_bf16 v[64:79], a[20:23], a[52:55], v[64:79]
    buffer_load_dwordx4 a[136:139], v2, s[4:7], s63 offen offset:2048 sc1
    v_mfma_f32_32x32x16_bf16 v[64:79], a[24:27], a[56:59], v[64:79]
    v_mfma_f32_32x32x16_bf16 v[64:79], a[28:31], a[60:63], v[64:79]
    buffer_load_dwordx4 a[140:143], v2, s[4:7], s63 offen offset:3072 sc1
    buffer_load_dwordx4 a[144:147], v2, s[4:7], s77 offen offset:0 sc1
    buffer_load_dwordx4 a[148:151], v2, s[4:7], s77 offen offset:1024 sc1
    s_nop 8
    v_max3_f32 v9, v64, v65, v66
    v_max3_f32 v9, v9, v67, v68
    v_max3_f32 v9, v9, v69, v70
    v_max3_f32 v9, v9, v71, v72
    v_max3_f32 v9, v9, v73, v74
    v_max3_f32 v9, v9, v75, v76
    v_max3_f32 v9, v9, v77, v78
    v_max_f32 v9, v9, v79
    buffer_load_dwordx4 a[152:155], v2, s[4:7], s77 offen offset:2048 sc1
    v_mov_b32 v10, v9
    s_nop 1
    v_permlane32_swap_b32 v9, v10
    v_max_f32 v9, v9, v10
    v_mul_f32 v208, s67, v9
    v_fma_f32 v64, v64, s67, -v208
    v_fma_f32 v65, v65, s67, -v208
    v_fma_f32 v66, v66, s67, -v208
    v_fma_f32 v67, v67, s67, -v208
    v_fma_f32 v68, v68, s67, -v208
    v_fma_f32 v69, v69, s67, -v208
    v_fma_f32 v70, v70, s67, -v208
    v_fma_f32 v71, v71, s67, -v208
    buffer_load_dwordx4 a[156:159], v2, s[4:7], s77 offen offset:3072 sc1
    v_fma_f32 v72, v72, s67, -v208
    v_fma_f32 v73, v73, s67, -v208
    v_fma_f32 v74, v74, s67, -v208
    v_fma_f32 v75, v75, s67, -v208
    v_fma_f32 v76, v76, s67, -v208
    v_fma_f32 v77, v77, s67, -v208
    v_fma_f32 v78, v78, s67, -v208
    v_fma_f32 v79, v79, s67, -v208
    buffer_load_dwordx4 a[96:99], v2, s[4:7], s62 offen offset:0 sc1
    v_exp_f32 v64, v64
    v_exp_f32 v65, v65
    v_exp_f32 v66, v66
    v_exp_f32 v67, v67
    buffer_load_dwordx4 a[100:103], v2, s[4:7], s62 offen offset:1024 sc1
    v_exp_f32 v68, v68
    v_exp_f32 v69, v69
    v_exp_f32 v70, v70
    v_exp_f32 v71, v71
    buffer_load_dwordx4 a[104:107], v2, s[4:7], s62 offen offset:2048 sc1
    v_exp_f32 v72, v72
    v_exp_f32 v73, v73
    v_exp_f32 v74, v74
    v_exp_f32 v75, v75
    buffer_load_dwordx4 a[108:111], v2, s[4:7], s62 offen offset:3072 sc1
    v_exp_f32 v76, v76
    v_exp_f32 v77, v77
    v_exp_f32 v78, v78
    v_exp_f32 v79, v79
    buffer_load_dwordx4 a[112:115], v2, s[4:7], s56 offen offset:0 sc1
    v_cvt_pk_bf16_f32 v12, v64, v65
    v_cvt_pk_bf16_f32 v13, v66, v67
    v_cvt_pk_bf16_f32 v14, v72, v73
    v_cvt_pk_bf16_f32 v15, v74, v75
    v_cvt_pk_bf16_f32 v16, v68, v69
    v_cvt_pk_bf16_f32 v17, v70, v71
    v_cvt_pk_bf16_f32 v18, v76, v77
    v_cvt_pk_bf16_f32 v19, v78, v79
    v_mfma_f32_32x32x16_bf16 v[112:127], a[64:67], v[12:15], 0
    v_add_f32 v209, v64, v65
    v_add_f32 v10, v66, v67
    v_add_f32 v209, v209, v68
    v_add_f32 v10, v10, v69
    buffer_load_dwordx4 a[116:119], v2, s[4:7], s56 offen offset:1024 sc1
    v_mfma_f32_32x32x16_bf16 v[112:127], a[68:71], v[16:19], v[112:127]
    buffer_load_dwordx4 a[120:123], v2, s[4:7], s56 offen offset:2048 sc1
    v_mfma_f32_32x32x16_bf16 v[128:143], a[72:75], v[12:15], 0
    v_add_f32 v209, v209, v70
    v_add_f32 v10, v10, v71
    v_add_f32 v209, v209, v72
    v_add_f32 v10, v10, v73
    buffer_load_dwordx4 a[124:127], v2, s[4:7], s56 offen offset:3072 sc1
    v_mfma_f32_32x32x16_bf16 v[128:143], a[76:79], v[16:19], v[128:143]
    buffer_load_dwordx4 a[160:163], v2, s[4:7], s57 offen offset:0 sc1
    v_mfma_f32_32x32x16_bf16 v[144:159], a[80:83], v[12:15], 0
    v_add_f32 v209, v209, v74
    v_add_f32 v10, v10, v75
    v_add_f32 v209, v209, v76
    v_add_f32 v10, v10, v77
    buffer_load_dwordx4 a[164:167], v2, s[4:7], s57 offen offset:1024 sc1
    v_mfma_f32_32x32x16_bf16 v[144:159], a[84:87], v[16:19], v[144:159]
    buffer_load_dwordx4 a[168:171], v2, s[4:7], s57 offen offset:2048 sc1
    v_mfma_f32_32x32x16_bf16 v[160:175], a[88:91], v[12:15], 0
    v_add_f32 v209, v209, v78
    v_add_f32 v10, v10, v79
    v_add_f32 v209, v209, v10
    buffer_load_dwordx4 a[172:175], v2, s[4:7], s57 offen offset:3072 sc1
    v_mfma_f32_32x32x16_bf16 v[160:175], a[92:95], v[16:19], v[160:175]
    buffer_load_dwordx4 a[176:179], v2, s[4:7], s76 offen offset:0 sc1
    buffer_load_dwordx4 a[180:183], v2, s[4:7], s76 offen offset:1024 sc1
    buffer_load_dwordx4 a[184:187], v2, s[4:7], s76 offen offset:2048 sc1
    buffer_load_dwordx4 a[188:191], v2, s[4:7], s76 offen offset:3072 sc1
    s_cmp_lg_u32 s79, 0
    s_cbranch_scc1 L_att_m0
L_att_w0:
Lp_51:
    buffer_load_dword v5, v3, s[4:7], 0 offen sc1
    s_waitcnt vmcnt(0)
    v_cmp_gt_i32 vcc, v4, v5
    s_cbranch_vccz Lpd_52
    s_sleep 1
    s_mov_b32 s54, 35
    s_sub_u32 s52, s52, 1
    s_cbranch_scc1 L_abort
    s_branch Lp_51
Lpd_52:
    s_mov_b32 exec_lo, 0xff
    s_mov_b32 exec_hi, 0xff
    buffer_load_dwordx4 v[24:27], v6, s[4:7], s64 offen offset:0 sc1
    buffer_load_dwordx4 v[28:31], v6, s[4:7], s64 offen offset:32 sc1
    buffer_load_dwordx4 v[32:35], v6, s[4:7], s64 offen offset:64 sc1
    buffer_load_dwordx4 v[36:39], v6, s[4:7], s64 offen offset:96 sc1
    buffer_load_dwordx4 v[40:43], v6, s[4:7], s64 offen offset:128 sc1
    buffer_load_dwordx4 v[44:47], v6, s[4:7], s64 offen offset:160 sc1
    buffer_load_dwordx4 v[48:51], v6, s[4:7], s64 offen offset:192 sc1
    buffer_load_dwordx4 v[52:55], v6, s[4:7], s64 offen offset:224 sc1
    s_mov_b64 exec, -1
    buffer_load_dword v56, v7, s[4:7], s64 offen offset:2048 sc1
    buffer_load_dword v57, v7, s[4:7], s64 offen offset:2176 sc1
    buffer_load_dword v58, v7, s[4:7], s64 offen offset:2560 sc1
    buffer_load_dword v59, v7, s[4:7], s64 offen offset:2688 sc1
    buffer_load_dword v60, v7, s[4:7], s64 offen offset:3072 sc1
    buffer_load_dword v61, v7, s[4:7], s64 offen offset:3200 sc1
    buffer_load_dword v62, v7, s[4:7], s64 offen offset:3584 sc1
    buffer_load_dword v63, v7, s[4:7], s64 offen offset:3712 sc1
L_att_m0:
    s_add_u32 s72, s72, 1
    s_lshl_b32 s55, s72, 10
    s_and_b32 s55, s55, 0x2000
    s_xor_b32 s55, s55, s70
    s_lshl_b32 s64, s72, 18
    s_add_u32 s64, s64, s55
    s_add_u32 s64, s64, s71
    s_waitcnt vmcnt(15)
    v_mfma_f32_32x32x16_bf16 v[80:95], v[24:27], a[32:35], 0
    s_waitcnt vmcnt(14)
    v_mfma_f32_32x32x16_bf16 v[80:95], v[28:31], a[36:39], v[80:95]
    s_waitcnt vmcnt(13)
    v_mfma_f32_32x32x16_bf16 v[80:95], v[32:35], a[40:43], v[80:95]
    s_waitcnt vmcnt(12)
    v_mfma_f32_32x32x16_bf16 v[80:95], v[36:39], a[44:47], v[80:95]
    s_waitcnt vmcnt(11)
    v_mfma_f32_32x32x16_bf16 v[80:95], v[40:43], a[48:51], v[80:95]
    s_waitcnt vmcnt(10)
    v_mfma_f32_32x32x16_bf16 v[80:95], v[44:47], a[52:55], v[80:95]
    s_waitcnt vmcnt(9)
    v_mfma_f32_32x32x16_bf16 v[80:95], v[48:51], a[56:59], v[80:95]
    s_waitcnt vmcnt(8)
    v_mfma_f32_32x32x16_bf16 v[80:95], v[52:55], a[60:63], v[80:95]
    s_add_u32 s61, s61, 1
    v_mov_b32 v11, s61
    v_add_u32 v4, s61, v8
    v_min_i32 v4, 64, v4
    s_nop 7
    v_max3_f32 v9, v80, v81, v82
    v_max_f32 v9, v9, v83
    v_mov_b32 v10, v9
    s_nop 1
    v_permlane32_swap_b32 v9, v10
    v_max_f32 v9, v9, v10
    v_mul_f32 v9, s67, v9
    v_max_f32 v9, v9, v208
    v_sub_f32 v210, v208, v9
    v_fma_f32 v80, v80, s67, -v9
    v_fma_f32 v81, v81, s67, -v9
    v_fma_f32 v82, v82, s67, -v9
    v_fma_f32 v83, v83, s67, -v9
    v_exp_f32 v210, v210
    v_exp_f32 v80, v80
    v_exp_f32 v81, v81
    v_exp_f32 v82, v82
    v_exp_f32 v83, v83
    v_fma_f32 v9, v209, v210, v80
    v_add_f32 v10, v81, v82
    v_add_f32 v9, v9, v83
    v_add_f32 v9, v9, v10
    v_mov_b32 v10, v9
    s_nop 1
    v_permlane32_swap_b32 v9, v10
    v_add_f32 v9, v9, v10
    v_rcp_f32 v213, v9
    s_nop 0
    v_mul_f32 v212, v210, v213
    v_pk_mul_f32 v[80:81], v[80:81], v[212:213] op_sel:[0,1]
    v_pk_mul_f32 v[82:83], v[82:83], v[212:213] op_sel:[0,1]
    v_cvt_pk_bf16_f32 v20, v80, v81
    v_cvt_pk_bf16_f32 v21, v82, v83
    v_pk_mul_f32 v[112:113], v[112:113], v[212:213] op_sel_hi:[1,0]
    v_pk_mul_f32 v[114:115], v[114:115], v[212:213] op_sel_hi:[1,0]
    v_pk_mul_f32 v[116:117], v[116:117], v[212:213] op_sel_hi:[1,0]
    v_pk_mul_f32 v[118:119], v[118:119], v[212:213] op_sel_hi:[1,0]
    v_pk_mul_f32 v[120:121], v[120:121], v[212:213] op_sel_hi:[1,0]
    v_pk_mul_f32 v[122:123], v[122:123], v[212:213] op_sel_hi:[1,0]
    v_pk_mul_f32 v[124:125], v[124:125], v[212:213] op_sel_hi:[1,0]
    v_pk_mul_f32 v[126:127], v[126:127], v[212:213] op_sel_hi:[1,0]
    v_pk_mul_f32 v[128:129], v[128:129], v[212:213] op_sel_hi:[1,0]
    v_pk_mul_f32 v[130:131], v[130:131], v[212:213] op_sel_hi:[1,0]
    v_pk_mul_f32 v[132:133], v[132:133], v[212:213] op_sel_hi:[1,0]
    v_pk_mul_f32 v[134:135], v[134:135], v[212:213] op_sel_hi:[1,0]
    v_pk_mul_f32 v[136:137], v[136:137], v[212:213] op_sel_hi:[1,0]
    v_pk_mul_f32 v[138:139], v[138:139], v[212:213] op_sel_hi:[1,0]
    v_pk_mul_f32 v[140:141], v[140:141], v[212:213] op_sel_hi:[1,0]
    v_pk_mul_f32 v[142:143], v[142:143], v[212:213] op_sel_hi:[1,0]
    v_pk_mul_f32 v[144:145], v[144:145], v[212:213] op_sel_hi:[1,0]
    v_pk_mul_f32 v[146:147], v[146:147], v[212:213] op_sel_hi:[1,0]
    v_pk_mul_f32 v[148:149], v[148:149], v[212:213] op_sel_hi:[1,0]
    v_pk_mul_f32 v[150:151], v[150:151], v[212:213] op_sel_hi:[1,0]
    v_pk_mul_f32 v[152:153], v[152:153], v[212:213] op_sel_hi:[1,0]
    v_pk_mul_f32 v[154:155], v[154:155], v[212:213] op_sel_hi:[1,0]
    v_pk_mul_f32 v[156:157], v[156:157], v[212:213] op_sel_hi:[1,0]
    v_pk_mul_f32 v[158:159], v[158:159], v[212:213] op_sel_hi:[1,0]
    v_pk_mul_f32 v[160:161], v[160:161], v[212:213] op_sel_hi:[1,0]
    v_pk_mul_f32 v[162:163], v[162:163], v[212:213] op_sel_hi:[1,0]
    v_pk_mul_f32 v[164:165], v[164:165], v[212:213] op_sel_hi:[1,0]
    v_pk_mul_f32 v[166:167], v[166:167], v[212:213] op_sel_hi:[1,0]
    v_pk_mul_f32 v[168:169], v[168:169], v[212:213] op_sel_hi:[1,0]
    v_pk_mul_f32 v[170:171], v[170:171], v[212:213] op_sel_hi:[1,0]
    v_pk_mul_f32 v[172:173], v[172:173], v[212:213] op_sel_hi:[1,0]
    v_pk_mul_f32 v[174:175], v[174:175], v[212:213] op_sel_hi:[1,0]
    s_waitcnt vmcnt(0)
    v_mfma_f32_32x32x8_bf16 v[112:127], v[56:57], v[20:21], v[112:127]
    v_mfma_f32_32x32x8_bf16 v[128:143], v[58:59], v[20:21], v[128:143]
    v_mfma_f32_32x32x8_bf16 v[144:159], v[60:61], v[20:21], v[144:159]
    v_mfma_f32_32x32x8_bf16 v[160:175], v[62:63], v[20:21], v[160:175]
    s_nop 8
    v_cvt_pk_bf16_f32 v176, v112, v113
    v_cvt_pk_bf16_f32 v177, v114, v115
    v_cvt_pk_bf16_f32 v178, v120, v121
    v_cvt_pk_bf16_f32 v179, v122, v123
    v_cvt_pk_bf16_f32 v180, v116, v117
    v_cvt_pk_bf16_f32 v181, v118, v119
    v_cvt_pk_bf16_f32 v182, v124, v125
    v_cvt_pk_bf16_f32 v183, v126, v127
    s_cmp_lg_u32 s73, 0
    s_cbranch_scc1 Lls_53
    buffer_store_dwordx4 v[176:179], v2, s[4:7], s65 offen offset:0
    buffer_store_dwordx4 v[180:183], v2, s[4:7], s65 offen offset:1024
Lld_54:
    v_cvt_pk_bf16_f32 v184, v128, v129
    v_cvt_pk_bf16_f32 v185, v130, v131
    v_cvt_pk_bf16_f32 v186, v136, v137
    v_cvt_pk_bf16_f32 v187, v138, v139
    v_cvt_pk_bf16_f32 v188, v132, v133
    v_cvt_pk_bf16_f32 v189, v134, v135
    v_cvt_pk_bf16_f32 v190, v140, v141
    v_cvt_pk_bf16_f32 v191, v142, v143
    s_cmp_lg_u32 s73, 0
    s_cbranch_scc1 Lls_55
    buffer_store_dwordx4 v[184:187], v2, s[4:7], s65 offen offset:2048
    buffer_store_dwordx4 v[188:191], v2, s[4:7], s65 offen offset:3072
Lld_56:
    v_cvt_pk_bf16_f32 v192, v144, v145
    v_cvt_pk_bf16_f32 v193, v146, v147
    v_cvt_pk_bf16_f32 v194, v152, v153
    v_cvt_pk_bf16_f32 v195, v154, v155
    v_cvt_pk_bf16_f32 v196, v148, v149
    v_cvt_pk_bf16_f32 v197, v150, v151
    v_cvt_pk_bf16_f32 v198, v156, v157
    v_cvt_pk_bf16_f32 v199, v158, v159
    s_cmp_lg_u32 s73, 0
    s_cbranch_scc1 Lls_57
    buffer_store_dwordx4 v[192:195], v2, s[4:7], s58 offen offset:0
    buffer_store_dwordx4 v[196:199], v2, s[4:7], s58 offen offset:1024
Lld_58:
    v_cvt_pk_bf16_f32 v200, v160, v161
    v_cvt_pk_bf16_f32 v201, v162, v163
    v_cvt_pk_bf16_f32 v202, v168, v169
    v_cvt_pk_bf16_f32 v203, v170, v171
    v_cvt_pk_bf16_f32 v204, v164, v165
    v_cvt_pk_bf16_f32 v205, v166, v167
    v_cvt_pk_bf16_f32 v206, v172, v173
    v_cvt_pk_bf16_f32 v207, v174, v175
    s_cmp_lg_u32 s73, 0
    s_cbranch_scc1 Lls_59
    buffer_store_dwordx4 v[200:203], v2, s[4:7], s58 offen offset:2048
    buffer_store_dwordx4 v[204:207], v2, s[4:7], s58 offen offset:3072
Lld_60:
    buffer_load_dword v5, v3, s[4:7], 0 offen sc1
    s_add_u32 s55, s61, 0
    s_and_b32 s55, s55, 3
    s_cselect_b32 s55, 0, 1048576
    s_sub_u32 s65, s65, s55
    s_add_u32 s65, s65, 262144
    s_waitcnt vmcnt(1)
    s_cmp_lg_u32 s73, 0
    s_cbranch_scc1 Lls_61
    buffer_store_dword v11, off, s[4:7], s66
Lld_62:
    s_cmp_lg_u32 s78, 0
    s_cbranch_scc1 L_att_late0
    s_waitcnt vmcnt(1)
L_att_loop1:
    s_add_u32 s62, s62, 524288
    s_add_u32 s63, s63, 262144
    s_add_u32 s56, s62, 4096
    s_add_u32 s57, s62, 8192
    s_add_u32 s76, s62, 12288
    s_add_u32 s58, s65, 4096
    s_add_u32 s77, s63, 4096
    v_cmp_gt_i32 vcc, v4, v5
    s_and_b32 s78, vcc_lo, 0xff0
    s_cbranch_scc1 L_att_np1
    s_cmp_eq_u64 vcc, 0
    s_cselect_b32 s79, 1, 0
    s_cbranch_scc1 L_att_bk1
L_att_x1:
    v_mfma_f32_32x32x16_bf16 v[64:79], a[96:99], a[128:131], v[96:111]
    v_mfma_f32_32x32x16_bf16 v[64:79], a[100:103], a[132:135], v[64:79]
    buffer_load_dwordx4 a[32:35], v2, s[4:7], s63 offen offset:0 sc1
    v_mfma_f32_32x32x16_bf16 v[64:79], a[104:107], a[136:139], v[64:79]
    v_mfma_f32_32x32x16_bf16 v[64:79], a[108:111], a[140:143], v[64:79]
    buffer_load_dwordx4 a[36:39], v2, s[4:7], s63 offen offset:1024 sc1
    v_mfma_f32_32x32x16_bf16 v[64:79], a[112:115], a[144:147], v[64:79]
    v_mfma_f32_32x32x16_bf16 v[64:79], a[116:119], a[148:151], v[64:79]
    buffer_load_dwordx4 a[40:43], v2, s[4:7], s63 offen offset:2048 sc1
    v_mfma_f32_32x32x16_bf16 v[64:79], a[120:123], a[152:155], v[64:79]
    v_mfma_f32_32x32x16_bf16 v[64:79], a[124:127], a[156:159], v[64:79]
    buffer_load_dwordx4 a[44:47], v2, s[4:7], s63 offen offset:3072 sc1
    buffer_load_dwordx4 a[48:51], v2, s[4:7], s77 offen offset:0 sc1
    buffer_load_dwordx4 a[52:55], v2, s[4:7], s77 offen offset:1024 sc1
    s_nop 8
    v_max3_f32 v9, v64, v65, v66
    v_max3_f32 v9, v9, v67, v68
    v_max3_f32 v9, v9, v69, v70
    v_max3_f32 v9, v9, v71, v72
    v_max3_f32 v9, v9, v73, v74
    v_max3_f32 v9, v9, v75, v76
    v_max3_f32 v9, v9, v77, v78
    v_max_f32 v9, v9, v79
    buffer_load_dwordx4 a[56:59], v2, s[4:7], s77 offen offset:2048 sc1
    v_mov_b32 v10, v9
    s_nop 1
    v_permlane32_swap_b32 v9, v10
    v_max_f32 v9, v9, v10
    v_mul_f32 v208, s67, v9
    v_fma_f32 v64, v64, s67, -v208
    v_fma_f32 v65, v65, s67, -v208
    v_fma_f32 v66, v66, s67, -v208
    v_fma_f32 v67, v67, s67, -v208
    v_fma_f32 v68, v68, s67, -v208
    v_fma_f32 v69, v69, s67, -v208
    v_fma_f32 v70, v70, s67, -v208
    v_fma_f32 v71, v71, s67, -v208
    buffer_load_dwordx4 a[60:63], v2, s[4:7], s77 offen offset:3072 sc1
    v_fma_f32 v72, v72, s67, -v208
    v_fma_f32 v73, v73, s67, -v208
    v_fma_f32 v74, v74, s67, -v208
    v_fma_f32 v75, v75, s67, -v208
    v_fma_f32 v76, v76, s67, -v208
    v_fma_f32 v77, v77, s67, -v208
    v_fma_f32 v78, v78, s67, -v208
    v_fma_f32 v79, v79, s67, -v208
    buffer_load_dwordx4 a[0:3], v2, s[4:7], s62 offen offset:0 sc1
    v_exp_f32 v64, v64
    v_exp_f32 v65, v65
    v_exp_f32 v66, v66
    v_exp_f32 v67, v67
    buffer_load_dwordx4 a[4:7], v2, s[4:7], s62 offen offset:1024 sc1
    v_exp_f32 v68, v68
    v_exp_f32 v69, v69
    v_exp_f32 v70, v70
    v_exp_f32 v71, v71
    buffer_load_dwordx4 a[8:11], v2, s[4:7], s62 offen offset:2048 sc1
    v_exp_f32 v72, v72
    v_exp_f32 v73, v73
    v_exp_f32 v74, v74
    v_exp_f32 v75, v75
    buffer_load_dwordx4 a[12:15], v2, s[4:7], s62 offen offset:3072 sc1
    v_exp_f32 v76, v76
    v_exp_f32 v77, v77
    v_exp_f32 v78, v78
    v_exp_f32 v79, v79
    buffer_load_dwordx4 a[16:19], v2, s[4:7], s56 offen offset:0 sc1
    v_cvt_pk_bf16_f32 v12, v64, v65
    v_cvt_pk_bf16_f32 v13, v66, v67
    v_cvt_pk_bf16_f32 v14, v72, v73
    v_cvt_pk_bf16_f32 v15, v74, v75
    v_cvt_pk_bf16_f32 v16, v68, v69
    v_cvt_pk_bf16_f32 v17, v70, v71
    v_cvt_pk_bf16_f32 v18, v76, v77
    v_cvt_pk_bf16_f32 v19, v78, v79
    v_mfma_f32_32x32x16_bf16 v[112:127], a[160:163], v[12:15], 0
    v_add_f32 v209, v64, v65
    v_add_f32 v10, v66, v67
    v_add_f32 v209, v209, v68
    v_add_f32 v10, v10, v69
    buffer_load_dwordx4 a[20:23], v2, s[4:7], s56 offen offset:1024 sc1
    v_mfma_f32_32x32x16_bf16 v[112:127], a[164:167], v[16:19], v[112:127]
    buffer_load_dwordx4 a[24:27], v2, s[4:7], s56 offen offset:2048 sc1
    v_mfma_f32_32x32x16_bf16 v[128:143], a[168:171], v[12:15], 0
    v_add_f32 v209, v209, v70
    v_add_f32 v10, v10, v71
    v_add_f32 v209, v209, v72
    v_add_f32 v10, v10, v73
    buffer_load_dwordx4 a[28:31], v2, s[4:7], s56 offen offset:3072 sc1
    v_mfma_f32_32x32x16_bf16 v[128:143], a[172:175], v[16:19], v[128:143]
    buffer_load_dwordx4 a[64:67], v2, s[4:7], s57 offen offset:0 sc1
    v_mfma_f32_32x32x16_bf16 v[144:159], a[176:179], v[12:15], 0
    v_add_f32 v209, v209, v74
    v_add_f32 v10, v10, v75
    v_add_f32 v209, v209, v76
    v_add_f32 v10, v10, v77
    buffer_load_dwordx4 a[68:71], v2, s[4:7], s57 offen offset:1024 sc1
    v_mfma_f32_32x32x16_bf16 v[144:159], a[180:183], v[16:19], v[144:159]
    buffer_load_dwordx4 a[72:75], v2, s[4:7], s57 offen offset:2048 sc1
    v_mfma_f32_32x32x16_bf16 v[160:175], a[184:187], v[12:15], 0
    v_add_f32 v209, v209, v78
    v_add_f32 v10, v10, v79
    v_add_f32 v209, v209, v10
    buffer_load_dwordx4 a[76:79], v2, s[4:7], s57 offen offset:3072 sc1
    v_mfma_f32_32x32x16_bf16 v[160:175], a[188:191], v[16:19], v[160:175]
    buffer_load_dwordx4 a[80:83], v2, s[4:7], s76 offen offset:0 sc1
    buffer_load_dwordx4 a[84:87], v2, s[4:7], s76 offen offset:1024 sc1
    buffer_load_dwordx4 a[88:91], v2, s[4:7], s76 offen offset:2048 sc1
    buffer_load_dwordx4 a[92:95], v2, s[4:7], s76 offen offset:3072 sc1
    s_cmp_lg_u32 s79, 0
    s_cbranch_scc1 L_att_m1
L_att_w1:
Lp_63:
    buffer_load_dword v5, v3, s[4:7], 0 offen sc1
    s_waitcnt vmcnt(0)
    v_cmp_gt_i32 vcc, v4, v5
    s_cbranch_vccz Lpd_64
    s_sleep 1
    s_mov_b32 s54, 35
    s_sub_u32 s52, s52, 1
    s_cbranch_scc1 L_abort
    s_branch Lp_63
Lpd_64:
    s_mov_b32 exec_lo, 0xff
    s_mov_b32 exec_hi, 0xff
    buffer_load_dwordx4 v[24:27], v6, s[4:7], s64 offen offset:0 sc1
    buffer_load_dwordx4 v[28:31], v6, s[4:7], s64 offen offset:32 sc1
    buffer_load_dwordx4 v[32:35], v6, s[4:7], s64 offen offset:64 sc1
    buffer_load_dwordx4 v[36:39], v6, s[4:7], s64 offen offset:96 sc1
    buffer_load_dwordx4 v[40:43], v6, s[4:7], s64 offen offset:128 sc1
    buffer_load_dwordx4 v[44:47], v6, s[4:7], s64 offen offset:160 sc1
    buffer_load_dwordx4 v[48:51], v6, s[4:7], s64 offen offset:192 sc1
    buffer_load_dwordx4 v[52:55], v6, s[4:7], s64 offen offset:224 sc1
    s_mov_b64 exec, -1
    buffer_load_dword v56, v7, s[4:7], s64 offen offset:2048 sc1
    buffer_load_dword v57, v7, s[4:7], s64 offen offset:2176 sc1
    buffer_load_dword v58, v7, s[4:7], s64 offen offset:2560 sc1
    buffer_load_dword v59, v7, s[4:7], s64 offen offset:2688 sc1
    buffer_load_dword v60, v7, s[4:7], s64 offen offset:3072 sc1
    buffer_load_dword v61, v7, s[4:7], s64 offen offset:3200 sc1
    buffer_load_dword v62, v7, s[4:7], s64 offen offset:3584 sc1
    buffer_load_dword v63, v7, s[4:7], s64 offen offset:3712 sc1
L_att_m1:
    s_add_u32 s72, s72, 1
    s_lshl_b32 s55, s72, 10
    s_and_b32 s55, s55, 0x2000
    s_xor_b32 s55, s55, s70
    s_lshl_b32 s64, s72, 18
    s_add_u32 s64, s64, s55
    s_add_u32 s64, s64, s71
    s_waitcnt vmcnt(15)
    v_mfma_f32_32x32x16_bf16 v[80:95], v[24:27], a[128:131], 0
    s_waitcnt vmcnt(14)
    v_mfma_f32_32x32x16_bf16 v[80:95], v[28:31], a[132:135], v[80:95]
    s_waitcnt vmcnt(13)
    v_mfma_f32_32x32x16_bf16 v[80:95], v[32:35], a[136:139], v[80:95]
    s_waitcnt vmcnt(12)
    v_mfma_f32_32x32x16_bf16 v[80:95], v[36:39], a[140:143], v[80:95]
    s_waitcnt vmcnt(11)
    v_mfma_f32_32x32x16_bf16 v[80:95], v[40:43], a[144:147], v[80:95]
    s_waitcnt vmcnt(10)
    v_mfma_f32_32x32x16_bf16 v[80:95], v[44:47], a[148:151], v[80:95]
    s_waitcnt vmcnt(9)
    v_mfma_f32_32x32x16_bf16 v[80:95], v[48:51], a[152:155], v[80:95]
    s_waitcnt vmcnt(8)
    v_mfma_f32_32x32x16_bf16 v[80:95], v[52:55], a[156:159], v[80:95]
    s_add_u32 s61, s61, 1
    v_mov_b32 v11, s61
    v_add_u32 v4, s61, v8
    v_min_i32 v4, 64, v4
    s_nop 7
    v_max3_f32 v9, v80, v81, v82
    v_max_f32 v9, v9, v83
    v_mov_b32 v10, v9
    s_nop 1
    v_permlane32_swap_b32 v9, v10
    v_max_f32 v9, v9, v10
    v_mul_f32 v9, s67, v9
    v_max_f32 v9, v9, v208
    v_sub_f32 v210, v208, v9
    v_fma_f32 v80, v80, s67, -v9
    v_fma_f32 v81, v81, s67, -v9
    v_fma_f32 v82, v82, s67, -v9
    v_fma_f32 v83, v83, s67, -v9
    v_exp_f32 v210, v210
    v_exp_f32 v80, v80
    v_exp_f32 v81, v81
    v_exp_f32 v82, v82
    v_exp_f32 v83, v83
    v_fma_f32 v9, v209, v210, v80
    v_add_f32 v10, v81, v82
    v_add_f32 v9, v9, v83
    v_add_f32 v9, v9, v10
    v_mov_b32 v10, v9
    s_nop 1
    v_permlane32_swap_b32 v9, v10
    v_add_f32 v9, v9, v10
    v_rcp_f32 v213, v9
    s_nop 0
    v_mul_f32 v212, v210, v213
    v_pk_mul_f32 v[80:81], v[80:81], v[212:213] op_sel:[0,1]
    v_pk_mul_f32 v[82:83], v[82:83], v[212:213] op_sel:[0,1]
    v_cvt_pk_bf16_f32 v20, v80, v81
    v_cvt_pk_bf16_f32 v21, v82, v83
    v_pk_mul_f32 v[112:113], v[112:113], v[212:213] op_sel_hi:[1,0]
    v_pk_mul_f32 v[114:115], v[114:115], v[212:213] op_sel_hi:[1,0]
    v_pk_mul_f32 v[116:117], v[116:117], v[212:213] op_sel_hi:[1,0]
    v_pk_mul_f32 v[118:119], v[118:119], v[212:213] op_sel_hi:[1,0]
    v_pk_mul_f32 v[120:121], v[120:121], v[212:213] op_sel_hi:[1,0]
    v_pk_mul_f32 v[122:123], v[122:123], v[212:213] op_sel_hi:[1,0]
    v_pk_mul_f32 v[124:125], v[124:125], v[212:213] op_sel_hi:[1,0]
    v_pk_mul_f32 v[126:127], v[126:127], v[212:213] op_sel_hi:[1,0]
    v_pk_mul_f32 v[128:129], v[128:129], v[212:213] op_sel_hi:[1,0]
    v_pk_mul_f32 v[130:131], v[130:131], v[212:213] op_sel_hi:[1,0]
    v_pk_mul_f32 v[132:133], v[132:133], v[212:213] op_sel_hi:[1,0]
    v_pk_mul_f32 v[134:135], v[134:135], v[212:213] op_sel_hi:[1,0]
    v_pk_mul_f32 v[136:137], v[136:137], v[212:213] op_sel_hi:[1,0]
    v_pk_mul_f32 v[138:139], v[138:139], v[212:213] op_sel_hi:[1,0]
    v_pk_mul_f32 v[140:141], v[140:141], v[212:213] op_sel_hi:[1,0]
    v_pk_mul_f32 v[142:143], v[142:143], v[212:213] op_sel_hi:[1,0]
    v_pk_mul_f32 v[144:145], v[144:145], v[212:213] op_sel_hi:[1,0]
    v_pk_mul_f32 v[146:147], v[146:147], v[212:213] op_sel_hi:[1,0]
    v_pk_mul_f32 v[148:149], v[148:149], v[212:213] op_sel_hi:[1,0]
    v_pk_mul_f32 v[150:151], v[150:151], v[212:213] op_sel_hi:[1,0]
    v_pk_mul_f32 v[152:153], v[152:153], v[212:213] op_sel_hi:[1,0]
    v_pk_mul_f32 v[154:155], v[154:155], v[212:213] op_sel_hi:[1,0]
    v_pk_mul_f32 v[156:157], v[156:157], v[212:213] op_sel_hi:[1,0]
    v_pk_mul_f32 v[158:159], v[158:159], v[212:213] op_sel_hi:[1,0]
    v_pk_mul_f32 v[160:161], v[160:161], v[212:213] op_sel_hi:[1,0]
    v_pk_mul_f32 v[162:163], v[162:163], v[212:213] op_sel_hi:[1,0]
    v_pk_mul_f32 v[164:165], v[164:165], v[212:213] op_sel_hi:[1,0]
    v_pk_mul_f32 v[166:167], v[166:167], v[212:213] op_sel_hi:[1,0]
    v_pk_mul_f32 v[168:169], v[168:169], v[212:213] op_sel_hi:[1,0]
    v_pk_mul_f32 v[170:171], v[170:171], v[212:213] op_sel_hi:[1,0]
    v_pk_mul_f32 v[172:173], v[172:173], v[212:213] op_sel_hi:[1,0]
    v_pk_mul_f32 v[174:175], v[174:175], v[212:213] op_sel_hi:[1,0]
    s_waitcnt vmcnt(0)
    v_mfma_f32_32x32x8_bf16 v[112:127], v[56:57], v[20:21], v[112:127]
    v_mfma_f32_32x32x8_bf16 v[128:143], v[58:59], v[20:21], v[128:143]
    v_mfma_f32_32x32x8_bf16 v[144:159], v[60:61], v[20:21], v[144:159]
    v_mfma_f32_32x32x8_bf16 v[160:175], v[62:63], v[20:21], v[160:175]
    s_nop 8
    v_cvt_pk_bf16_f32 v176, v112, v113
    v_cvt_pk_bf16_f32 v177, v114, v115
    v_cvt_pk_bf16_f32 v178, v120, v121
    v_cvt_pk_bf16_f32 v179, v122, v123
    v_cvt_pk_bf16_f32 v180, v116, v117
    v_cvt_pk_bf16_f32 v181, v118, v119
    v_cvt_pk_bf16_f32 v182, v124, v125
    v_cvt_pk_bf16_f32 v183, v126, v127
    s_cmp_lg_u32 s73, 0
    s_cbranch_scc1 Lls_65
    buffer_store_dwordx4 v[176:179], v2, s[4:7], s65 offen offset:0
    buffer_store_dwordx4 v[180:183], v2, s[4:7], s65 offen offset:1024
Lld_66:
    v_cvt_pk_bf16_f32 v184, v128, v129
    v_cvt_pk_bf16_f32 v185, v130, v131
    v_cvt_pk_bf16_f32 v186, v136, v137
    v_cvt_pk_bf16_f32 v187, v138, v139
    v_cvt_pk_bf16_f32 v188, v132, v133
    v_cvt_pk_bf16_f32 v189, v134, v135
    v_cvt_pk_bf16_f32 v190, v140, v141
    v_cvt_pk_bf16_f32 v191, v142, v143
    s_cmp_lg_u32 s73, 0
    s_cbranch_scc1 Lls_67
    buffer_store_dwordx4 v[184:187], v2, s[4:7], s65 offen offset:2048
    buffer_store_dwordx4 v[188:191], v2, s[4:7], s65 offen offset:3072
Lld_68:
    v_cvt_pk_bf16_f32 v192, v144, v145
    v_cvt_pk_bf16_f32 v193, v146, v147
    v_cvt_pk_bf16_f32 v194, v152, v153
    v_cvt_pk_bf16_f32 v195, v154, v155
    v_cvt_pk_bf16_f32 v196, v148, v149
    v_cvt_pk_bf16_f32 v197, v150, v151
    v_cvt_pk_bf16_f32 v198, v156, v157
    v_cvt_pk_bf16_f32 v199, v158, v159
    s_cmp_lg_u32 s73, 0
    s_cbranch_scc1 Lls_69
    buffer_store_dwordx4 v[192:195], v2, s[4:7], s58 offen offset:0
    buffer_store_dwordx4 v[196:199], v2, s[4:7], s58 offen offset:1024
Lld_70:
    v_cvt_pk_bf16_f32 v200, v160, v161
    v_cvt_pk_bf16_f32 v201, v162, v163
    v_cvt_pk_bf16_f32 v202, v168, v169
    v_cvt_pk_bf16_f32 v203, v170, v171
    v_cvt_pk_bf16_f32 v204, v164, v165
    v_cvt_pk_bf16_f32 v205, v166, v167
    v_cvt_pk_bf16_f32 v206, v172, v173
    v_cvt_pk_bf16_f32 v207, v174, v175
    s_cmp_lg_u32 s73, 0
    s_cbranch_scc1 Lls_71
    buffer_store_dwordx4 v[200:203], v2, s[4:7], s58 offen offset:2048
    buffer_store_dwordx4 v[204:207], v2, s[4:7], s58 offen offset:3072
Lld_72:
    buffer_load_dword v5, v3, s[4:7], 0 offen sc1
    s_add_u32 s55, s61, 0
    s_and_b32 s55, s55, 3
    s_cselect_b32 s55, 0, 1048576
    s_sub_u32 s65, s65, s55
    s_add_u32 s65, s65, 262144
    s_waitcnt vmcnt(1)
    s_cmp_lg_u32 s73, 0
    s_cbranch_scc1 Lls_73
    buffer_store_dword v11, off, s[4:7], s66
Lld_74:
    s_cmp_ge_u32 s61, 64
    s_cbranch_scc1 L_att_fin
    s_cmp_lg_u32 s78, 0
    s_cbranch_scc1 L_att_late1
    s_waitcnt vmcnt(1)
    s_branch L_att_loop0
L_att_fin:
    s_endpgm
L_role_wos:
    s_waitcnt vmcnt(0)
    s_cmp_lg_u32 s53, 0
    s_cbranch_scc1 Ll1_76
    v_mov_b32 v2, 148
Lp_77:
    buffer_load_dword v3, v2, s[8:11], 0 offen sc1
    s_waitcnt vmcnt(0)
    v_cmp_gt_i32 vcc, 2, v3
    s_cbranch_vccz Lpd_78
    s_sleep 8
    s_mov_b32 s54, 130
    s_sub_u32 s52, s52, 1
    s_cbranch_scc1 L_abort
    s_branch Lp_77
Lpd_78:
    s_branch Llate_75
Ll1_76:
    v_mov_b32 v2, 128
Lp_79:
    buffer_load_dword v3, v2, s[8:11], 0 offen sc1
    s_waitcnt vmcnt(0)
    v_cmp_gt_i32 vcc, 1, v3
    s_cbranch_vccz Lpd_80
    s_sleep 8
    s_mov_b32 s54, 128
    s_sub_u32 s52, s52, 1
    s_cbranch_scc1 L_abort
    s_branch Lp_79
Lpd_80:
    v_mov_b32 v2, 53248
    s_cmp_eq_u32 s53, 0
    s_cselect_b32 s56, 0, 3
Lp_81:
    buffer_load_dword v3, v2, s[4:7], 0 offen sc1
    s_waitcnt vmcnt(0)
    v_cmp_gt_i32 vcc, s56, v3
    s_cbranch_vccz Lpd_82
    s_sleep 8
    s_mov_b32 s54, 129
    s_sub_u32 s52, s52, 1
    s_cbranch_scc1 L_abort
    s_branch Lp_81
Lpd_82:
Llate_75:
L_wos_par:
    s_mov_b32 s60, s51
    s_mov_b32 s12, s34
    s_mov_b32 s13, s35
    s_mov_b32 s14, 5242880
    s_mov_b32 s15, 0x20000
    s_mul_i32 s69, s3, 655360
    s_add_u32 s69, s69, 0
    s_lshl_b32 s62, s53, 24
    s_lshl_b32 s55, s3, 15
    s_add_u32 s62, s62, s55
    s_add_u32 s62, s62, 109051904
    s_lshl_b32 s55, s60, 7
    s_add_u32 s69, s69, s55
    v_lshrrev_b32 v252, 4, v1
    v_bfe_u32 v253, v1, 2, 2
    v_and_b32 v254, 3, v1
    s_mul_i32 s67, s3, 40960
    v_lshrrev_b32 v250, 1, v252
    v_lshl_add_u32 v250, v250, 2, v253
    v_lshlrev_b32 v250, 7, v250
    v_and_b32 v251, 1, v252
    v_lshl_add_u32 v250, v251, 5, v250
    v_lshl_add_u32 v250, v254, 3, v250
    v_add_u32 v250, s67, v250
    v_lshrrev_b32 v249, 3, v1
    v_mul_u32_u24 v249, 1280, v249
    v_and_b32 v251, 7, v1
    v_lshl_add_u32 v249, v251, 4, v249
    s_add_u32 s56, s69, 0
    s_add_u32 m0, s67, 0
    s_nop 0
    buffer_load_dwordx4 v249, s[12:15], s56 offen lds
    s_add_u32 m0, m0, 1024
    s_add_u32 s56, s56, 10240
    buffer_load_dwordx4 v249, s[12:15], s56 offen lds
    s_add_u32 m0, m0, 1024
    s_add_u32 s56, s56, 10240
    buffer_load_dwordx4 v249, s[12:15], s56 offen lds
    s_add_u32 m0, m0, 1024
    s_add_u32 s56, s56, 10240
    buffer_load_dwordx4 v249, s[12:15], s56 offen lds
    s_add_u32 m0, m0, 1024
    s_add_u32 s56, s56, 10240
    buffer_load_dwordx4 v249, s[12:15], s56 offen lds
    s_add_u32 m0, m0, 1024
    s_add_u32 s56, s56, 10240
    buffer_load_dwordx4 v249, s[12:15], s56 offen lds
    s_add_u32 m0, m0, 1024
    s_add_u32 s56, s56, 10240
    buffer_load_dwordx4 v249, s[12:15], s56 offen lds
    s_add_u32 m0, m0, 1024
    s_add_u32 s56, s56, 10240
    buffer_load_dwordx4 v249, s[12:15], s56 offen lds
    s_add_u32 s56, s69, 81920
    s_add_u32 m0, s67, 8192
    s_nop 0
    buffer_load_dwordx4 v249, s[12:15], s56 offen lds
    s_add_u32 m0, m0, 1024
    s_add_u32 s56, s56, 10240
    buffer_load_dwordx4 v249, s[12:15], s56 offen lds
    s_add_u32 m0, m0, 1024
    s_add_u32 s56, s56, 10240
    buffer_load_dwordx4 v249, s[12:15], s56 offen lds
    s_add_u32 m0, m0, 1024
    s_add_u32 s56, s56, 10240
    buffer_load_dwordx4 v249, s[12:15], s56 offen lds
    s_add_u32 m0, m0, 1024
    s_add_u32 s56, s56, 10240
    buffer_load_dwordx4 v249, s[12:15], s56 offen lds
    s_add_u32 m0, m0, 1024
    s_add_u32 s56, s56, 10240
    buffer_load_dwordx4 v249, s[12:15], s56 offen lds
    s_add_u32 m0, m0, 1024
    s_add_u32 s56, s56, 10240
    buffer_load_dwordx4 v249, s[12:15], s56 offen lds
    s_add_u32 m0, m0, 1024
    s_add_u32 s56, s56, 10240
    buffer_load_dwordx4 v249, s[12:15], s56 offen lds
    s_add_u32 s56, s69, 163840
    s_add_u32 m0, s67, 16384
    s_nop 0
    buffer_load_dwordx4 v249, s[12:15], s56 offen lds
    s_add_u32 m0, m0, 1024
    s_add_u32 s56, s56, 10240
    buffer_load_dwordx4 v249, s[12:15], s56 offen lds
    s_add_u32 m0, m0, 1024
    s_add_u32 s56, s56, 10240
    buffer_load_dwordx4 v249, s[12:15], s56 offen lds
    s_add_u32 m0, m0, 1024
    s_add_u32 s56, s56, 10240
    buffer_load_dwordx4 v249, s[12:15], s56 offen lds
    s_add_u32 m0, m0, 1024
    s_add_u32 s56, s56, 10240
    buffer_load_dwordx4 v249, s[12:15], s56 offen lds
    s_add_u32 m0, m0, 1024
    s_add_u32 s56, s56, 10240
    buffer_load_dwordx4 v249, s[12:15], s56 offen lds
    s_add_u32 m0, m0, 1024
    s_add_u32 s56, s56, 10240
    buffer_load_dwordx4 v249, s[12:15], s56 offen lds
    s_add_u32 m0, m0, 1024
    s_add_u32 s56, s56, 10240
    buffer_load_dwordx4 v249, s[12:15], s56 offen lds
    s_add_u32 s56, s69, 245760
    s_add_u32 m0, s67, 24576
    s_nop 0
    buffer_load_dwordx4 v249, s[12:15], s56 offen lds
    s_add_u32 m0, m0, 1024
    s_add_u32 s56, s56, 10240
    buffer_load_dwordx4 v249, s[12:15], s56 offen lds
    s_add_u32 m0, m0, 1024
    s_add_u32 s56, s56, 10240
    buffer_load_dwordx4 v249, s[12:15], s56 offen lds
    s_add_u32 m0, m0, 1024
    s_add_u32 s56, s56, 10240
    buffer_load_dwordx4 v249, s[12:15], s56 offen lds
    s_add_u32 m0, m0, 1024
    s_add_u32 s56, s56, 10240
    buffer_load_dwordx4 v249, s[12:15], s56 offen lds
    s_add_u32 m0, m0, 1024
    s_add_u32 s56, s56, 10240
    buffer_load_dwordx4 v249, s[12:15], s56 offen lds
    s_add_u32 m0, m0, 1024
    s_add_u32 s56, s56, 10240
    buffer_load_dwordx4 v249, s[12:15], s56 offen lds
    s_add_u32 m0, m0, 1024
    s_add_u32 s56, s56, 10240
    buffer_load_dwordx4 v249, s[12:15], s56 offen lds
    s_add_u32 s56, s69, 327680
    s_add_u32 m0, s67, 32768
    s_nop 0
    buffer_load_dwordx4 v249, s[12:15], s56 offen lds
    s_add_u32 m0, m0, 1024
    s_add_u32 s56, s56, 10240
    buffer_load_dwordx4 v249, s[12:15], s56 offen lds
    s_add_u32 m0, m0, 1024
    s_add_u32 s56, s56, 10240
    buffer_load_dwordx4 v249, s[12:15], s56 offen lds
    s_add_u32 m0, m0, 1024
    s_add_u32 s56, s56, 10240
    buffer_load_dwordx4 v249, s[12:15], s56 offen lds
    s_add_u32 m0, m0, 1024
    s_add_u32 s56, s56, 10240
    buffer_load_dwordx4 v249, s[12:15], s56 offen lds
    s_add_u32 m0, m0, 1024
    s_add_u32 s56, s56, 10240
    buffer_load_dwordx4 v249, s[12:15], s56 offen lds
    s_add_u32 m0, m0, 1024
    s_add_u32 s56, s56, 10240
    buffer_load_dwordx4 v249, s[12:15], s56 offen lds
    s_add_u32 m0, m0, 1024
    s_add_u32 s56, s56, 10240
    buffer_load_dwordx4 v249, s[12:15], s56 offen lds
    s_waitcnt vmcnt(32)
    ds_read_b64_tr_b16 a[0:1], v250 offset:0
    ds_read_b64_tr_b16 a[2:3], v250 offset:2048
    ds_read_b64_tr_b16 a[4:5], v250 offset:64
    ds_read_b64_tr_b16 a[6:7], v250 offset:2112
    ds_read_b64_tr_b16 a[8:9], v250 offset:1024
    ds_read_b64_tr_b16 a[10:11], v250 offset:3072
    ds_read_b64_tr_b16 a[12:13], v250 offset:1088
    ds_read_b64_tr_b16 a[14:15], v250 offset:3136
    ds_read_b64_tr_b16 a[16:17], v250 offset:4096
    ds_read_b64_tr_b16 a[18:19], v250 offset:6144
    ds_read_b64_tr_b16 a[20:21], v250 offset:4160
    ds_read_b64_tr_b16 a[22:23], v250 offset:6208
    ds_read_b64_tr_b16 a[24:25], v250 offset:5120
    ds_read_b64_tr_b16 a[26:27], v250 offset:7168
    ds_read_b64_tr_b16 a[28:29], v250 offset:5184
    ds_read_b64_tr_b16 a[30:31], v250 offset:7232
    s_waitcnt lgkmcnt(0)
    s_add_u32 s56, s69, 409600
    s_add_u32 m0, s67, 0
    s_nop 0
    buffer_load_dwordx4 v249, s[12:15], s56 offen lds
    s_add_u32 m0, m0, 1024
    s_add_u32 s56, s56, 10240
    buffer_load_dwordx4 v249, s[12:15], s56 offen lds
    s_add_u32 m0, m0, 1024
    s_add_u32 s56, s56, 10240
    buffer_load_dwordx4 v249, s[12:15], s56 offen lds
    s_add_u32 m0, m0, 1024
    s_add_u32 s56, s56, 10240
    buffer_load_dwordx4 v249, s[12:15], s56 offen lds
    s_add_u32 m0, m0, 1024
    s_add_u32 s56, s56, 10240
    buffer_load_dwordx4 v249, s[12:15], s56 offen lds
    s_add_u32 m0, m0, 1024
    s_add_u32 s56, s56, 10240
    buffer_load_dwordx4 v249, s[12:15], s56 offen lds
    s_add_u32 m0, m0, 1024
    s_add_u32 s56, s56, 10240
    buffer_load_dwordx4 v249, s[12:15], s56 offen lds
    s_add_u32 m0, m0, 1024
    s_add_u32 s56, s56, 10240
    buffer_load_dwordx4 v249, s[12:15], s56 offen lds
    s_waitcnt vmcnt(32)
    ds_read_b64_tr_b16 a[32:33], v250 offset:8192
    ds_read_b64_tr_b16 a[34:35], v250 offset:10240
    ds_read_b64_tr_b16 a[36:37], v250 offset:8256
    ds_read_b64_tr_b16 a[38:39], v250 offset:10304
    ds_read_b64_tr_b16 a[40:41], v250 offset:9216
    ds_read_b64_tr_b16 a[42:43], v250 offset:11264
    ds_read_b64_tr_b16 a[44:45], v250 offset:9280
    ds_read_b64_tr_b16 a[46:47], v250 offset:11328
    ds_read_b64_tr_b16 a[48:49], v250 offset:12288
    ds_read_b64_tr_b16 a[50:51], v250 offset:14336
    ds_read_b64_tr_b16 a[52:53], v250 offset:12352
    ds_read_b64_tr_b16 a[54:55], v250 offset:14400
    ds_read_b64_tr_b16 a[56:57], v250 offset:13312
    ds_read_b64_tr_b16 a[58:59], v250 offset:15360
    ds_read_b64_tr_b16 a[60:61], v250 offset:13376
    ds_read_b64_tr_b16 a[62:63], v250 offset:15424
    s_waitcnt lgkmcnt(0)
    s_add_u32 s56, s69, 491520
    s_add_u32 m0, s67, 8192
    s_nop 0
    buffer_load_dwordx4 v249, s[12:15], s56 offen lds
    s_add_u32 m0, m0, 1024
    s_add_u32 s56, s56, 10240
    buffer_load_dwordx4 v249, s[12:15], s56 offen lds
    s_add_u32 m0, m0, 1024
    s_add_u32 s56, s56, 10240
    buffer_load_dwordx4 v249, s[12:15], s56 offen lds
    s_add_u32 m0, m0, 1024
    s_add_u32 s56, s56, 10240
    buffer_load_dwordx4 v249, s[12:15], s56 offen lds
    s_add_u32 m0, m0, 1024
    s_add_u32 s56, s56, 10240
    buffer_load_dwordx4 v249, s[12:15], s56 offen lds
    s_add_u32 m0, m0, 1024
    s_add_u32 s56, s56, 10240
    buffer_load_dwordx4 v249, s[12:15], s56 offen lds
    s_add_u32 m0, m0, 1024
    s_add_u32 s56, s56, 10240
    buffer_load_dwordx4 v249, s[12:15], s56 offen lds
    s_add_u32 m0, m0, 1024
    s_add_u32 s56, s56, 10240
    buffer_load_dwordx4 v249, s[12:15], s56 offen lds
    s_waitcnt vmcnt(32)
    ds_read_b64_tr_b16 a[64:65], v250 offset:16384
    ds_read_b64_tr_b16 a[66:67], v250 offset:18432
    ds_read_b64_tr_b16 a[68:69], v250 offset:16448
    ds_read_b64_tr_b16 a[70:71], v250 offset:18496
    ds_read_b64_tr_b16 a[72:73], v250 offset:17408
    ds_read_b64_tr_b16 a[74:75], v250 offset:19456
    ds_read_b64_tr_b16 a[76:77], v250 offset:17472
    ds_read_b64_tr_b16 a[78:79], v250 offset:19520
    ds_read_b64_tr_b16 a[80:81], v250 offset:20480
    ds_read_b64_tr_b16 a[82:83], v250 offset:22528
    ds_read_b64_tr_b16 a[84:85], v250 offset:20544
    ds_read_b64_tr_b16 a[86:87], v250 offset:22592
    ds_read_b64_tr_b16 a[88:89], v250 offset:21504
    ds_read_b64_tr_b16 a[90:91], v250 offset:23552
    ds_read_b64_tr_b16 a[92:93], v250 offset:21568
    ds_read_b64_tr_b16 a[94:95], v250 offset:23616
    s_waitcnt lgkmcnt(0)
    s_add_u32 s56, s69, 573440
    s_add_u32 m0, s67, 16384
    s_nop 0
    buffer_load_dwordx4 v249, s[12:15], s56 offen lds
    s_add_u32 m0, m0, 1024
    s_add_u32 s56, s56, 10240
    buffer_load_dwordx4 v249, s[12:15], s56 offen lds
    s_add_u32 m0, m0, 1024
    s_add_u32 s56, s56, 10240
    buffer_load_dwordx4 v249, s[12:15], s56 offen lds
    s_add_u32 m0, m0, 1024
    s_add_u32 s56, s56, 10240
    buffer_load_dwordx4 v249, s[12:15], s56 offen lds
    s_add_u32 m0, m0, 1024
    s_add_u32 s56, s56, 10240
    buffer_load_dwordx4 v249, s[12:15], s56 offen lds
    s_add_u32 m0, m0, 1024
    s_add_u32 s56, s56, 10240
    buffer_load_dwordx4 v249, s[12:15], s56 offen lds
    s_add_u32 m0, m0, 1024
    s_add_u32 s56, s56, 10240
    buffer_load_dwordx4 v249, s[12:15], s56 offen lds
    s_add_u32 m0, m0, 1024
    s_add_u32 s56, s56, 10240
    buffer_load_dwordx4 v249, s[12:15], s56 offen lds
    s_waitcnt vmcnt(32)
    ds_read_b64_tr_b16 a[96:97], v250 offset:24576
    ds_read_b64_tr_b16 a[98:99], v250 offset:26624
    ds_read_b64_tr_b16 a[100:101], v250 offset:24640
    ds_read_b64_tr_b16 a[102:103], v250 offset:26688
    ds_read_b64_tr_b16 a[104:105], v250 offset:25600
    ds_read_b64_tr_b16 a[106:107], v250 offset:27648
    ds_read_b64_tr_b16 a[108:109], v250 offset:25664
    ds_read_b64_tr_b16 a[110:111], v250 offset:27712
    ds_read_b64_tr_b16 a[112:113], v250 offset:28672
    ds_read_b64_tr_b16 a[114:115], v250 offset:30720
    ds_read_b64_tr_b16 a[116:117], v250 offset:28736
    ds_read_b64_tr_b16 a[118:119], v250 offset:30784
    ds_read_b64_tr_b16 a[120:121], v250 offset:29696
    ds_read_b64_tr_b16 a[122:123], v250 offset:31744
    ds_read_b64_tr_b16 a[124:125], v250 offset:29760
    ds_read_b64_tr_b16 a[126:127], v250 offset:31808
    s_waitcnt lgkmcnt(0)
    s_waitcnt vmcnt(24)
    ds_read_b64_tr_b16 a[128:129], v250 offset:32768
    ds_read_b64_tr_b16 a[130:131], v250 offset:34816
    ds_read_b64_tr_b16 a[132:133], v250 offset:32832
    ds_read_b64_tr_b16 a[134:135], v250 offset:34880
    ds_read_b64_tr_b16 a[136:137], v250 offset:33792
    ds_read_b64_tr_b16 a[138:139], v250 offset:35840
    ds_read_b64_tr_b16 a[140:141], v250 offset:33856
    ds_read_b64_tr_b16 a[142:143], v250 offset:35904
    ds_read_b64_tr_b16 a[144:145], v250 offset:36864
    ds_read_b64_tr_b16 a[146:147], v250 offset:38912
    ds_read_b64_tr_b16 a[148:149], v250 offset:36928
    ds_read_b64_tr_b16 a[150:151], v250 offset:38976
    ds_read_b64_tr_b16 a[152:153], v250 offset:37888
    ds_read_b64_tr_b16 a[154:155], v250 offset:39936
    ds_read_b64_tr_b16 a[156:157], v250 offset:37952
    ds_read_b64_tr_b16 a[158:159], v250 offset:40000
    s_waitcnt lgkmcnt(0)
    s_waitcnt vmcnt(16)
    ds_read_b64_tr_b16 a[160:161], v250 offset:0
    ds_read_b64_tr_b16 a[162:163], v250 offset:2048
    ds_read_b64_tr_b16 a[164:165], v250 offset:64
    ds_read_b64_tr_b16 a[166:167], v250 offset:2112
    ds_read_b64_tr_b16 a[168:169], v250 offset:1024
    ds_read_b64_tr_b16 a[170:171], v250 offset:3072
    ds_read_b64_tr_b16 a[172:173], v250 offset:1088
    ds_read_b64_tr_b16 a[174:175], v250 offset:3136
    ds_read_b64_tr_b16 a[176:177], v250 offset:4096
    ds_read_b64_tr_b16 a[178:179], v250 offset:6144
    ds_read_b64_tr_b16 a[180:181], v250 offset:4160
    ds_read_b64_tr_b16 a[182:183], v250 offset:6208
    ds_read_b64_tr_b16 a[184:185], v250 offset:5120
    ds_read_b64_tr_b16 a[186:187], v250 offset:7168
    ds_read_b64_tr_b16 a[188:189], v250 offset:5184
    ds_read_b64_tr_b16 a[190:191], v250 offset:7232
    s_waitcnt lgkmcnt(0)
    s_waitcnt vmcnt(8)
    ds_read_b64_tr_b16 a[192:193], v250 offset:8192
    ds_read_b64_tr_b16 a[194:195], v250 offset:10240
    ds_read_b64_tr_b16 a[196:197], v250 offset:8256
    ds_read_b64_tr_b16 a[198:199], v250 offset:10304
    ds_read_b64_tr_b16 a[200:201], v250 offset:9216
    ds_read_b64_tr_b16 a[202:203], v250 offset:11264
    ds_read_b64_tr_b16 a[204:205], v250 offset:9280
    ds_read_b64_tr_b16 a[206:207], v250 offset:11328
    ds_read_b64_tr_b16 a[208:209], v250 offset:12288
    ds_read_b64_tr_b16 a[210:211], v250 offset:14336
    ds_read_b64_tr_b16 a[212:213], v250 offset:12352
    ds_read_b64_tr_b16 a[214:215], v250 offset:14400
    ds_read_b64_tr_b16 a[216:217], v250 offset:13312
    ds_read_b64_tr_b16 a[218:219], v250 offset:15360
    ds_read_b64_tr_b16 a[220:221], v250 offset:13376
    ds_read_b64_tr_b16 a[222:223], v250 offset:15424
    s_waitcnt lgkmcnt(0)
    s_waitcnt vmcnt(0)
    ds_read_b64_tr_b16 a[224:225], v250 offset:16384
    ds_read_b64_tr_b16 a[226:227], v250 offset:18432
    ds_read_b64_tr_b16 a[228:229], v250 offset:16448
    ds_read_b64_tr_b16 a[230:231], v250 offset:18496
    ds_read_b64_tr_b16 a[232:233], v250 offset:17408
    ds_read_b64_tr_b16 a[234:235], v250 offset:19456
    ds_read_b64_tr_b16 a[236:237], v250 offset:17472
    ds_read_b64_tr_b16 a[238:239], v250 offset:19520
    ds_read_b64_tr_b16 a[240:241], v250 offset:20480
    ds_read_b64_tr_b16 a[242:243], v250 offset:22528
    ds_read_b64_tr_b16 a[244:245], v250 offset:20544
    ds_read_b64_tr_b16 a[246:247], v250 offset:22592
    ds_read_b64_tr_b16 a[248:249], v250 offset:21504
    ds_read_b64_tr_b16 a[250:251], v250 offset:23552
    ds_read_b64_tr_b16 a[252:253], v250 offset:21568
    ds_read_b64_tr_b16 a[254:255], v250 offset:23616
    s_waitcnt lgkmcnt(0)
L_wos_con:
    v_lshlrev_b32 v2, 4, v1
    s_lshl_b32 s58, s60, 2
    s_add_u32 s58, s58, s3
    s_lshl_b32 s55, s53, 5
    s_lshl_b32 s56, s3, 2
    s_add_u32 s55, s55, s56
    s_add_u32 s55, s55, 224
    v_min_u32 v3, 3, v1
    v_add_u32 v3, s55, v3
    v_lshlrev_b32 v3, 7, v3
    v_mov_b32 v6, 1
    s_mul_i32 s55, s53, 40
    s_add_u32 s55, s55, s58
    s_add_u32 s55, s55, 6144
    s_lshl_b32 s55, s55, 7
    v_mov_b32 v5, s55
    v_cmp_gt_u32 vcc, 4, v1
    s_nop 1
    v_cndmask_b32 v3, v5, v3, vcc
    v_cndmask_b32 v6, -3, v6, vcc
    s_mul_i32 s66, s53, 10
    s_add_u32 s66, s66, s60
    s_lshl_b32 s66, s66, 15
    s_lshl_b32 s55, s3, 11
    s_add_u32 s66, s66, s55
    s_add_u32 s66, s66, 131072
    s_add_u32 s55, s53, 0
    s_mul_i32 s63, s55, 2621440
    s_lshl_b32 s55, s58, 10
    s_add_u32 s63, s63, s55
    s_add_u32 s63, s63, 196083712
    v_and_b32 v7, 31, v1
    v_mul_u32_u24 v7, 272, v7
    v_lshrrev_b32 v5, 5, v1
    v_lshl_add_u32 v8, v5, 5, v7
    v_lshl_add_u32 v7, v5, 4, v7
    s_mul_i32 s55, s3, 8704
    v_add_u32 v7, s55, v7
    s_lshl_b32 s55, s3, 6
    v_add_u32 v8, s55, v8
    v_mov_b32 v12, 128
Lp_83:
    buffer_load_dword v5, v12, s[8:11], 0 offen sc1
    s_waitcnt vmcnt(0)
    v_cmp_gt_i32 vcc, 1, v5
    s_cbranch_vccz Lpd_84
    s_sleep 8
    s_mov_b32 s54, 48
    s_sub_u32 s52, s52, 1
    s_cbranch_scc1 L_abort
    s_branch Lp_83
Lpd_84:
    s_mov_b32 s61, 0
    s_barrier
    s_mov_b32 s70, 262144000
    v_mov_b32 v10, 0x80000000
    v_mov_b32 v11, 0
    v_mov_b32 v4, 132
Lp_85:
    buffer_load_dword v5, v4, s[8:11], 0 offen sc1
    s_waitcnt vmcnt(0)
    v_cmp_gt_i32 vcc, 1, v5
    s_cbranch_vccz Lpd_86
    s_sleep 8
    s_mov_b32 s54, 112
    s_sub_u32 s52, s52, 1
    s_cbranch_scc1 L_abort
    s_branch Lp_85
Lpd_86:
    v_readfirstlane_b32 s74, v5
    s_and_b32 s74, s74, 2
    s_lshl_b32 s74, s74, 12
    s_mul_i32 s66, s53, 1982464
    s_lshl_b32 s55, s60, 16
    s_add_u32 s66, s66, s55
    s_lshl_b32 s55, s3, 11
    s_add_u32 s66, s66, s55
    s_add_u32 s66, s66, s74
    s_add_u32 s66, s66, s38
    s_add_u32 s66, s66, 917504
    v_mbcnt_lo_u32_b32 v5, -1, 0
    v_and_b32 v5, 1, v5
    v_lshlrev_b32 v5, 2, v5
    s_lshl_b32 s55, s50, 3
    buffer_load_dword v5, v5, s[8:11], s55 offen sc1
    s_getreg_b32 s55, hwreg(HW_REG_XCC_ID)
    s_and_b32 s55, s55, 7
    s_lshl_b32 s55, s55, 3
    s_lshl_b64 s[56:57], 0xff, s55
    s_waitcnt vmcnt(0)
    v_readlane_b32 s96, v5, 0
    v_readlane_b32 s97, v5, 1
    s_andn2_b64 s[56:57], s[96:97], s[56:57]
    s_cselect_b32 s72, 1, 0
    s_add_u32 s73, s53, 0
    s_mul_i32 s73, s73, 40
    s_lshl_b32 s55, s60, 2
    s_add_u32 s73, s73, s55
    s_add_u32 s73, s73, s3
    s_add_u32 s73, s73, 6272
    s_lshl_b32 s73, s73, 7
    v_min_u32 v58, 25, v1
    s_mul_i32 s55, s60, 26
    v_add_u32 v58, s55, v58
    v_min_u32 v58, 255, v58
    v_lshlrev_b32 v58, 7, v58
    s_add_u32 s59, s62, 0
    buffer_load_dword v59, v58, s[4:7], s59 offen sc1
    s_add_u32 s59, s62, 262144
    buffer_load_dword v59, v58, s[4:7], s59 offen sc1
    s_add_u32 s59, s62, 524288
    buffer_load_dword v59, v58, s[4:7], s59 offen sc1
    s_add_u32 s59, s62, 786432
    buffer_load_dword v59, v58, s[4:7], s59 offen sc1
    s_mov_b32 s71, 0
L_wos_loop:
    v_add_u32 v4, s61, v6
    s_cmp_lg_u32 s71, 0
    s_cbranch_scc1 L_wos_go
    v_cmp_gt_i32 vcc, v4, v10
    s_cbranch_vccz L_wos_rdy
L_wos_poll:
    buffer_load_dword v5, v3, s[4:7], 0 offen sc1
    s_waitcnt vmcnt(0)
    v_cmp_gt_i32 vcc, v4, v5
    s_cbranch_vccz L_wos_rdy
    s_sleep 1
    s_mov_b32 s54, 49
    s_sub_u32 s52, s52, 1
    s_cbranch_scc1 L_abort
    s_branch L_wos_poll
L_wos_rdy:
    s_mov_b32 s56, s62
    buffer_load_dwordx4 v[64:67], v2, s[4:7], s56 offen offset:0 sc1
    buffer_load_dwordx4 v[68:71], v2, s[4:7], s56 offen offset:1024 sc1
    buffer_load_dwordx4 v[72:75], v2, s[4:7], s56 offen offset:2048 sc1
    buffer_load_dwordx4 v[76:79], v2, s[4:7], s56 offen offset:3072 sc1
    s_add_u32 s56, s56, 4096
    buffer_load_dwordx4 v[80:83], v2, s[4:7], s56 offen offset:0 sc1
    buffer_load_dwordx4 v[84:87], v2, s[4:7], s56 offen offset:1024 sc1
    buffer_load_dwordx4 v[88:91], v2, s[4:7], s56 offen offset:2048 sc1
    buffer_load_dwordx4 v[92:95], v2, s[4:7], s56 offen offset:3072 sc1
L_wos_go:
    s_add_u32 s55, s61, 1
    s_and_b32 s55, s55, 3
    s_cselect_b32 s55, 0, 1048576
    s_sub_u32 s62, s62, s55
    s_add_u32 s62, s62, 262144
    v_add_u32 v4, 1, v4
    buffer_load_dword v5, v3, s[4:7], 0 offen sc1
    s_add_u32 s56, s56, 4096
    buffer_load_dwordx4 v[96:99], v2, s[4:7], s56 offen offset:0 sc1
    s_waitcnt vmcnt(9)
    v_mfma_f32_32x32x16_bf16 v[24:39], a[0:3], v[64:67], 0
    v_mfma_f32_32x32x16_bf16 v[40:55], a[4:7], v[64:67], 0
    buffer_load_dwordx4 v[100:103], v2, s[4:7], s56 offen offset:1024 sc1
    s_waitcnt vmcnt(9)
    v_mfma_f32_32x32x16_bf16 v[24:39], a[8:11], v[68:71], v[24:39]
    v_mfma_f32_32x32x16_bf16 v[40:55], a[12:15], v[68:71], v[40:55]
    buffer_load_dwordx4 v[104:107], v2, s[4:7], s56 offen offset:2048 sc1
    s_waitcnt vmcnt(9)
    v_mfma_f32_32x32x16_bf16 v[24:39], a[16:19], v[72:75], v[24:39]
    v_mfma_f32_32x32x16_bf16 v[40:55], a[20:23], v[72:75], v[40:55]
    buffer_load_dwordx4 v[108:111], v2, s[4:7], s56 offen offset:3072 sc1
    s_waitcnt vmcnt(9)
    v_mfma_f32_32x32x16_bf16 v[24:39], a[24:27], v[76:79], v[24:39]
    v_mfma_f32_32x32x16_bf16 v[40:55], a[28:31], v[76:79], v[40:55]
    s_add_u32 s56, s56, 4096
    buffer_load_dwordx4 v[112:115], v2, s[4:7], s56 offen offset:0 sc1
    s_waitcnt vmcnt(9)
    v_mfma_f32_32x32x16_bf16 v[24:39], a[32:35], v[80:83], v[24:39]
    v_mfma_f32_32x32x16_bf16 v[40:55], a[36:39], v[80:83], v[40:55]
    buffer_load_dwordx4 v[116:119], v2, s[4:7], s56 offen offset:1024 sc1
    s_waitcnt vmcnt(9)
    v_mfma_f32_32x32x16_bf16 v[24:39], a[40:43], v[84:87], v[24:39]
    v_mfma_f32_32x32x16_bf16 v[40:55], a[44:47], v[84:87], v[40:55]
    buffer_load_dwordx4 v[120:123], v2, s[4:7], s56 offen offset:2048 sc1
    s_waitcnt vmcnt(9)
    v_mfma_f32_32x32x16_bf16 v[24:39], a[48:51], v[88:91], v[24:39]
    v_mfma_f32_32x32x16_bf16 v[40:55], a[52:55], v[88:91], v[40:55]
    buffer_load_dwordx4 v[124:127], v2, s[4:7], s56 offen offset:3072 sc1
    s_waitcnt vmcnt(9)
    v_mfma_f32_32x32x16_bf16 v[24:39], a[56:59], v[92:95], v[24:39]
    v_mfma_f32_32x32x16_bf16 v[40:55], a[60:63], v[92:95], v[40:55]
    s_add_u32 s56, s56, 4096
    buffer_load_dwordx4 v[128:131], v2, s[4:7], s56 offen offset:0 sc1
    s_waitcnt vmcnt(8)
    v_mfma_f32_32x32x16_bf16 v[24:39], a[64:67], v[96:99], v[24:39]
    v_mfma_f32_32x32x16_bf16 v[40:55], a[68:71], v[96:99], v[40:55]
    buffer_load_dwordx4 v[132:135], v2, s[4:7], s56 offen offset:1024 sc1
    s_waitcnt vmcnt(8)
    v_mfma_f32_32x32x16_bf16 v[24:39], a[72:75], v[100:103], v[24:39]
    v_mfma_f32_32x32x16_bf16 v[40:55], a[76:79], v[100:103], v[40:55]
    buffer_load_dwordx4 v[136:139], v2, s[4:7], s56 offen offset:2048 sc1
    s_waitcnt vmcnt(8)
    v_mfma_f32_32x32x16_bf16 v[24:39], a[80:83], v[104:107], v[24:39]
    v_mfma_f32_32x32x16_bf16 v[40:55], a[84:87], v[104:107], v[40:55]
    buffer_load_dwordx4 v[140:143], v2, s[4:7], s56 offen offset:3072 sc1
    s_waitcnt vmcnt(8)
    v_mfma_f32_32x32x16_bf16 v[24:39], a[88:91], v[108:111], v[24:39]
    v_mfma_f32_32x32x16_bf16 v[40:55], a[92:95], v[108:111], v[40:55]
    s_add_u32 s56, s56, 4096
    buffer_load_dwordx4 v[144:147], v2, s[4:7], s56 offen offset:0 sc1
    s_waitcnt vmcnt(8)
    v_mfma_f32_32x32x16_bf16 v[24:39], a[96:99], v[112:115], v[24:39]
    v_mfma_f32_32x32x16_bf16 v[40:55], a[100:103], v[112:115], v[40:55]
    buffer_load_dwordx4 v[148:151], v2, s[4:7], s56 offen offset:1024 sc1
    s_waitcnt vmcnt(8)
    v_mfma_f32_32x32x16_bf16 v[24:39], a[104:107], v[116:119], v[24:39]
    v_mfma_f32_32x32x16_bf16 v[40:55], a[108:111], v[116:119], v[40:55]
    buffer_load_dwordx4 v[152:155], v2, s[4:7], s56 offen offset:2048 sc1
    s_waitcnt vmcnt(8)
    v_mfma_f32_32x32x16_bf16 v[24:39], a[112:115], v[120:123], v[24:39]
    v_mfma_f32_32x32x16_bf16 v[40:55], a[116:119], v[120:123], v[40:55]
    buffer_load_dwordx4 v[156:159], v2, s[4:7], s56 offen offset:3072 sc1
    s_waitcnt vmcnt(8)
    v_mfma_f32_32x32x16_bf16 v[24:39], a[120:123], v[124:127], v[24:39]
    v_mfma_f32_32x32x16_bf16 v[40:55], a[124:127], v[124:127], v[40:55]
    s_add_u32 s56, s56, 4096
    buffer_load_dwordx4 v[160:163], v2, s[4:7], s56 offen offset:0 sc1
    s_waitcnt vmcnt(8)
    v_mfma_f32_32x32x16_bf16 v[24:39], a[128:131], v[128:131], v[24:39]
    v_mfma_f32_32x32x16_bf16 v[40:55], a[132:135], v[128:131], v[40:55]
    buffer_load_dwordx4 v[164:167], v2, s[4:7], s56 offen offset:1024 sc1
    s_waitcnt vmcnt(8)
    v_mfma_f32_32x32x16_bf16 v[24:39], a[136:139], v[132:135], v[24:39]
    v_mfma_f32_32x32x16_bf16 v[40:55], a[140:143], v[132:135], v[40:55]
    buffer_load_dwordx4 v[168:171], v2, s[4:7], s56 offen offset:2048 sc1
    s_waitcnt vmcnt(8)
    v_mfma_f32_32x32x16_bf16 v[24:39], a[144:147], v[136:139], v[24:39]
    v_mfma_f32_32x32x16_bf16 v[40:55], a[148:151], v[136:139], v[40:55]
    buffer_load_dwordx4 v[172:175], v2, s[4:7], s56 offen offset:3072 sc1
    s_waitcnt vmcnt(8)
    v_mfma_f32_32x32x16_bf16 v[24:39], a[152:155], v[140:143], v[24:39]
    v_mfma_f32_32x32x16_bf16 v[40:55], a[156:159], v[140:143], v[40:55]
    s_add_u32 s56, s56, 4096
    buffer_load_dwordx4 v[176:179], v2, s[4:7], s56 offen offset:0 sc1
    s_waitcnt vmcnt(8)
    v_mfma_f32_32x32x16_bf16 v[24:39], a[160:163], v[144:147], v[24:39]
    v_mfma_f32_32x32x16_bf16 v[40:55], a[164:167], v[144:147], v[40:55]
    buffer_load_dwordx4 v[180:183], v2, s[4:7], s56 offen offset:1024 sc1
    s_waitcnt vmcnt(8)
    v_mfma_f32_32x32x16_bf16 v[24:39], a[168:171], v[148:151], v[24:39]
    v_mfma_f32_32x32x16_bf16 v[40:55], a[172:175], v[148:151], v[40:55]
    buffer_load_dwordx4 v[184:187], v2, s[4:7], s56 offen offset:2048 sc1
    s_waitcnt vmcnt(8)
    v_mfma_f32_32x32x16_bf16 v[24:39], a[176:179], v[152:155], v[24:39]
    v_mfma_f32_32x32x16_bf16 v[40:55], a[180:183], v[152:155], v[40:55]
    buffer_load_dwordx4 v[188:191], v2, s[4:7], s56 offen offset:3072 sc1
    s_waitcnt vmcnt(8)
    v_mfma_f32_32x32x16_bf16 v[24:39], a[184:187], v[156:159], v[24:39]
    v_mfma_f32_32x32x16_bf16 v[40:55], a[188:191], v[156:159], v[40:55]
    s_add_u32 s55, s61, 1
    s_and_b32 s55, s55, 63
    s_cselect_b32 s55, 0, 2621440
    s_sub_u32 s63, s63, s55
    s_add_u32 s63, s63, 40960
    s_and_b32 s57, s61, 3
    s_lshl_b32 s57, s57, 14
    s_add_u32 s57, s57, s66
    s_add_u32 s61, s61, 1
    v_cmp_gt_i32 vcc, v4, v5
    s_mov_b32 s71, 0
    s_cbranch_vccnz L_wos_nostr
    s_mov_b32 s71, 1
    s_waitcnt vmcnt(7)
    v_mfma_f32_32x32x16_bf16 v[24:39], a[192:195], v[160:163], v[24:39]
    v_mfma_f32_32x32x16_bf16 v[40:55], a[196:199], v[160:163], v[40:55]
    s_mov_b32 s56, s62
    buffer_load_dwordx4 v[64:67], v2, s[4:7], s56 offen offset:0 sc1
    s_waitcnt vmcnt(7)
    v_mfma_f32_32x32x16_bf16 v[24:39], a[200:203], v[164:167], v[24:39]
    v_mfma_f32_32x32x16_bf16 v[40:55], a[204:207], v[164:167], v[40:55]
    buffer_load_dwordx4 v[68:71], v2, s[4:7], s56 offen offset:1024 sc1
    s_waitcnt vmcnt(7)
    v_mfma_f32_32x32x16_bf16 v[24:39], a[208:211], v[168:171], v[24:39]
    v_mfma_f32_32x32x16_bf16 v[40:55], a[212:215], v[168:171], v[40:55]
    buffer_load_dwordx4 v[72:75], v2, s[4:7], s56 offen offset:2048 sc1
    s_waitcnt vmcnt(7)
    v_mfma_f32_32x32x16_bf16 v[24:39], a[216:219], v[172:175], v[24:39]
    v_mfma_f32_32x32x16_bf16 v[40:55], a[220:223], v[172:175], v[40:55]
    buffer_load_dwordx4 v[76:79], v2, s[4:7], s56 offen offset:3072 sc1
    s_waitcnt vmcnt(7)
    v_mfma_f32_32x32x16_bf16 v[24:39], a[224:227], v[176:179], v[24:39]
    v_mfma_f32_32x32x16_bf16 v[40:55], a[228:231], v[176:179], v[40:55]
    s_add_u32 s56, s56, 4096
    buffer_load_dwordx4 v[80:83], v2, s[4:7], s56 offen offset:0 sc1
    s_waitcnt vmcnt(7)
    v_mfma_f32_32x32x16_bf16 v[24:39], a[232:235], v[180:183], v[24:39]
    v_mfma_f32_32x32x16_bf16 v[40:55], a[236:239], v[180:183], v[40:55]
    buffer_load_dwordx4 v[84:87], v2, s[4:7], s56 offen offset:1024 sc1
    s_waitcnt vmcnt(7)
    v_mfma_f32_32x32x16_bf16 v[24:39], a[240:243], v[184:187], v[24:39]
    v_mfma_f32_32x32x16_bf16 v[40:55], a[244:247], v[184:187], v[40:55]
    buffer_load_dwordx4 v[88:91], v2, s[4:7], s56 offen offset:2048 sc1
    s_waitcnt vmcnt(7)
    v_mfma_f32_32x32x16_bf16 v[24:39], a[248:251], v[188:191], v[24:39]
    v_mfma_f32_32x32x16_bf16 v[40:55], a[252:255], v[188:191], v[40:55]
    buffer_load_dwordx4 v[92:95], v2, s[4:7], s56 offen offset:3072 sc1
    s_branch L_wos_epi
L_wos_nostr:
    s_waitcnt vmcnt(7)
    v_mfma_f32_32x32x16_bf16 v[24:39], a[192:195], v[160:163], v[24:39]
    v_mfma_f32_32x32x16_bf16 v[40:55], a[196:199], v[160:163], v[40:55]
    s_waitcnt vmcnt(6)
    v_mfma_f32_32x32x16_bf16 v[24:39], a[200:203], v[164:167], v[24:39]
    v_mfma_f32_32x32x16_bf16 v[40:55], a[204:207], v[164:167], v[40:55]
    s_waitcnt vmcnt(5)
    v_mfma_f32_32x32x16_bf16 v[24:39], a[208:211], v[168:171], v[24:39]
    v_mfma_f32_32x32x16_bf16 v[40:55], a[212:215], v[168:171], v[40:55]
    s_waitcnt vmcnt(4)
    v_mfma_f32_32x32x16_bf16 v[24:39], a[216:219], v[172:175], v[24:39]
    v_mfma_f32_32x32x16_bf16 v[40:55], a[220:223], v[172:175], v[40:55]
    s_waitcnt vmcnt(3)
    v_mfma_f32_32x32x16_bf16 v[24:39], a[224:227], v[176:179], v[24:39]
    v_mfma_f32_32x32x16_bf16 v[40:55], a[228:231], v[176:179], v[40:55]
    s_waitcnt vmcnt(2)
    v_mfma_f32_32x32x16_bf16 v[24:39], a[232:235], v[180:183], v[24:39]
    v_mfma_f32_32x32x16_bf16 v[40:55], a[236:239], v[180:183], v[40:55]
    s_waitcnt vmcnt(1)
    v_mfma_f32_32x32x16_bf16 v[24:39], a[240:243], v[184:187], v[24:39]
    v_mfma_f32_32x32x16_bf16 v[40:55], a[244:247], v[184:187], v[40:55]
    s_waitcnt vmcnt(0)
    v_mfma_f32_32x32x16_bf16 v[24:39], a[248:251], v[188:191], v[24:39]
    v_mfma_f32_32x32x16_bf16 v[40:55], a[252:255], v[188:191], v[40:55]
L_wos_epi:
    v_mov_b32 v59, s61
    s_cmp_lg_u32 s72, 0
    s_cbranch_scc1 Lls_87
    buffer_store_dword v59, off, s[4:7], s73
Lld_88:
    buffer_load_dword v10, v3, s[4:7], 0 offen sc1
    s_nop 5
    ds_write_b128 v7, v[24:27] offset:0
    ds_write_b128 v7, v[28:31] offset:32
    ds_write_b128 v7, v[32:35] offset:64
    ds_write_b128 v7, v[36:39] offset:96
    ds_write_b128 v7, v[40:43] offset:128
    ds_write_b128 v7, v[44:47] offset:160
    ds_write_b128 v7, v[48:51] offset:192
    ds_write_b128 v7, v[52:55] offset:224
    s_waitcnt lgkmcnt(0)
    s_barrier
    ds_read_b128 v[192:195], v8 offset:0
    ds_read_b128 v[196:199], v8 offset:16
    ds_read_b128 v[200:203], v8 offset:8704
    ds_read_b128 v[204:207], v8 offset:8720
    ds_read_b128 v[208:211], v8 offset:17408
    ds_read_b128 v[212:215], v8 offset:17424
    ds_read_b128 v[216:219], v8 offset:26112
    ds_read_b128 v[220:223], v8 offset:26128
    v_xor_b32 v7, 0x10000, v7
    v_xor_b32 v8, 0x10000, v8
    s_waitcnt lgkmcnt(4)
    v_add_f32 v192, v192, v200
    v_add_f32 v193, v193, v201
    v_add_f32 v194, v194, v202
    v_add_f32 v195, v195, v203
    v_add_f32 v196, v196, v204
    v_add_f32 v197, v197, v205
    v_add_f32 v198, v198, v206
    v_add_f32 v199, v199, v207
    s_waitcnt lgkmcnt(0)
    v_add_f32 v208, v208, v216
    v_add_f32 v209, v209, v217
    v_add_f32 v210, v210, v218
    v_add_f32 v211, v211, v219
    v_add_f32 v212, v212, v220
    v_add_f32 v213, v213, v221
    v_add_f32 v214, v214, v222
    v_add_f32 v215, v215, v223
    v_add_f32 v192, v192, v208
    v_add_f32 v193, v193, v209
    v_add_f32 v194, v194, v210
    v_add_f32 v195, v195, v211
    v_add_f32 v196, v196, v212
    v_add_f32 v197, v197, v213
    v_add_f32 v198, v198, v214
    v_add_f32 v199, v199, v215
    v_mov_b32 v5, s61
    s_movk_i32 s58, 0x7f
    v_bfi_b32 v192, s58, v5, v192
    v_bfi_b32 v193, s58, v5, v193
    v_bfi_b32 v194, s58, v5, v194
    v_bfi_b32 v195, s58, v5, v195
    v_bfi_b32 v196, s58, v5, v196
    v_bfi_b32 v197, s58, v5, v197
    v_bfi_b32 v198, s58, v5, v198
    v_bfi_b32 v199, s58, v5, v199
    buffer_store_dwordx4 v[192:195], v2, s[4:7], s57 offen sc1
    buffer_store_dwordx4 v[196:199], v2, s[4:7], s57 offen offset:1024 sc1
    s_waitcnt vmcnt(2)
    s_cmp_lt_u32 s61, 64
    s_cbranch_scc1 L_wos_loop
    s_waitcnt vmcnt(0)
    s_endpgm
L_role_wor:
    s_waitcnt vmcnt(0)
    s_cmp_lg_u32 s53, 0
    s_cbranch_scc1 Ll1_90
    v_mov_b32 v2, 148
Lp_91:
    buffer_load_dword v3, v2, s[8:11], 0 offen sc1
    s_waitcnt vmcnt(0)
    v_cmp_gt_i32 vcc, 2, v3
    s_cbranch_vccz Lpd_92
    s_sleep 8
    s_mov_b32 s54, 130
    s_sub_u32 s52, s52, 1
    s_cbranch_scc1 L_abort
    s_branch Lp_91
Lpd_92:
    s_branch Llate_89
Ll1_90:
    v_mov_b32 v2, 128
Lp_93:
    buffer_load_dword v3, v2, s[8:11], 0 offen sc1
    s_waitcnt vmcnt(0)
    v_cmp_gt_i32 vcc, 1, v3
    s_cbranch_vccz Lpd_94
    s_sleep 8
    s_mov_b32 s54, 128
    s_sub_u32 s52, s52, 1
    s_cbranch_scc1 L_abort
    s_branch Lp_93
Lpd_94:
    v_mov_b32 v2, 53248
    s_cmp_eq_u32 s53, 0
    s_cselect_b32 s56, 0, 3
Lp_95:
    buffer_load_dword v3, v2, s[4:7], 0 offen sc1
    s_waitcnt vmcnt(0)
    v_cmp_gt_i32 vcc, s56, v3
    s_cbranch_vccz Lpd_96
    s_sleep 8
    s_mov_b32 s54, 129
    s_sub_u32 s52, s52, 1
    s_cbranch_scc1 L_abort
    s_branch Lp_95
Lpd_96:
Llate_89:
L_wor_par:
    s_mov_b32 s60, s51
    s_mov_b32 s12, s34
    s_mov_b32 s13, s35
    s_mov_b32 s14, 5242880
    s_mov_b32 s15, 0x20000
    s_mul_i32 s69, s3, 655360
    s_add_u32 s69, s69, 2621440
    s_lshl_b32 s62, s53, 24
    s_lshl_b32 s55, s3, 15
    s_add_u32 s62, s62, s55
    s_add_u32 s62, s62, 109182976
    s_lshl_b32 s55, s60, 7
    s_add_u32 s69, s69, s55
    v_lshrrev_b32 v252, 4, v1
    v_bfe_u32 v253, v1, 2, 2
    v_and_b32 v254, 3, v1
    s_mul_i32 s67, s3, 40960
    v_lshrrev_b32 v250, 1, v252
    v_lshl_add_u32 v250, v250, 2, v253
    v_lshlrev_b32 v250, 7, v250
    v_and_b32 v251, 1, v252
    v_lshl_add_u32 v250, v251, 5, v250
    v_lshl_add_u32 v250, v254, 3, v250
    v_add_u32 v250, s67, v250
    v_lshrrev_b32 v249, 3, v1
    v_mul_u32_u24 v249, 1280, v249
    v_and_b32 v251, 7, v1
    v_lshl_add_u32 v249, v251, 4, v249
    s_add_u32 s56, s69, 0
    s_add_u32 m0, s67, 0
    s_nop 0
    buffer_load_dwordx4 v249, s[12:15], s56 offen lds
    s_add_u32 m0, m0, 1024
    s_add_u32 s56, s56, 10240
    buffer_load_dwordx4 v249, s[12:15], s56 offen lds
    s_add_u32 m0, m0, 1024
    s_add_u32 s56, s56, 10240
    buffer_load_dwordx4 v249, s[12:15], s56 offen lds
    s_add_u32 m0, m0, 1024
    s_add_u32 s56, s56, 10240
    buffer_load_dwordx4 v249, s[12:15], s56 offen lds
    s_add_u32 m0, m0, 1024
    s_add_u32 s56, s56, 10240
    buffer_load_dwordx4 v249, s[12:15], s56 offen lds
    s_add_u32 m0, m0, 1024
    s_add_u32 s56, s56, 10240
    buffer_load_dwordx4 v249, s[12:15], s56 offen lds
    s_add_u32 m0, m0, 1024
    s_add_u32 s56, s56, 10240
    buffer_load_dwordx4 v249, s[12:15], s56 offen lds
    s_add_u32 m0, m0, 1024
    s_add_u32 s56, s56, 10240
    buffer_load_dwordx4 v249, s[12:15], s56 offen lds
    s_add_u32 s56, s69, 81920
    s_add_u32 m0, s67, 8192
    s_nop 0
    buffer_load_dwordx4 v249, s[12:15], s56 offen lds
    s_add_u32 m0, m0, 1024
    s_add_u32 s56, s56, 10240
    buffer_load_dwordx4 v249, s[12:15], s56 offen lds
    s_add_u32 m0, m0, 1024
    s_add_u32 s56, s56, 10240
    buffer_load_dwordx4 v249, s[12:15], s56 offen lds
    s_add_u32 m0, m0, 1024
    s_add_u32 s56, s56, 10240
    buffer_load_dwordx4 v249, s[12:15], s56 offen lds
    s_add_u32 m0, m0, 1024
    s_add_u32 s56, s56, 10240
    buffer_load_dwordx4 v249, s[12:15], s56 offen lds
    s_add_u32 m0, m0, 1024
    s_add_u32 s56, s56, 10240
    buffer_load_dwordx4 v249, s[12:15], s56 offen lds
    s_add_u32 m0, m0, 1024
    s_add_u32 s56, s56, 10240
    buffer_load_dwordx4 v249, s[12:15], s56 offen lds
    s_add_u32 m0, m0, 1024
    s_add_u32 s56, s56, 10240
    buffer_load_dwordx4 v249, s[12:15], s56 offen lds
    s_add_u32 s56, s69, 163840
    s_add_u32 m0, s67, 16384
    s_nop 0
    buffer_load_dwordx4 v249, s[12:15], s56 offen lds
    s_add_u32 m0, m0, 1024
    s_add_u32 s56, s56, 10240
    buffer_load_dwordx4 v249, s[12:15], s56 offen lds
    s_add_u32 m0, m0, 1024
    s_add_u32 s56, s56, 10240
    buffer_load_dwordx4 v249, s[12:15], s56 offen lds
    s_add_u32 m0, m0, 1024
    s_add_u32 s56, s56, 10240
    buffer_load_dwordx4 v249, s[12:15], s56 offen lds
    s_add_u32 m0, m0, 1024
    s_add_u32 s56, s56, 10240
    buffer_load_dwordx4 v249, s[12:15], s56 offen lds
    s_add_u32 m0, m0, 1024
    s_add_u32 s56, s56, 10240
    buffer_load_dwordx4 v249, s[12:15], s56 offen lds
    s_add_u32 m0, m0, 1024
    s_add_u32 s56, s56, 10240
    buffer_load_dwordx4 v249, s[12:15], s56 offen lds
    s_add_u32 m0, m0, 1024
    s_add_u32 s56, s56, 10240
    buffer_load_dwordx4 v249, s[12:15], s56 offen lds
    s_add_u32 s56, s69, 245760
    s_add_u32 m0, s67, 24576
    s_nop 0
    buffer_load_dwordx4 v249, s[12:15], s56 offen lds
    s_add_u32 m0, m0, 1024
    s_add_u32 s56, s56, 10240
    buffer_load_dwordx4 v249, s[12:15], s56 offen lds
    s_add_u32 m0, m0, 1024
    s_add_u32 s56, s56, 10240
    buffer_load_dwordx4 v249, s[12:15], s56 offen lds
    s_add_u32 m0, m0, 1024
    s_add_u32 s56, s56, 10240
    buffer_load_dwordx4 v249, s[12:15], s56 offen lds
    s_add_u32 m0, m0, 1024
    s_add_u32 s56, s56, 10240
    buffer_load_dwordx4 v249, s[12:15], s56 offen lds
    s_add_u32 m0, m0, 1024
    s_add_u32 s56, s56, 10240
    buffer_load_dwordx4 v249, s[12:15], s56 offen lds
    s_add_u32 m0, m0, 1024
    s_add_u32 s56, s56, 10240
    buffer_load_dwordx4 v249, s[12:15], s56 offen lds
    s_add_u32 m0, m0, 1024
    s_add_u32 s56, s56, 10240
    buffer_load_dwordx4 v249, s[12:15], s56 offen lds
    s_add_u32 s56, s69, 327680
    s_add_u32 m0, s67, 32768
    s_nop 0
    buffer_load_dwordx4 v249, s[12:15], s56 offen lds
    s_add_u32 m0, m0, 1024
    s_add_u32 s56, s56, 10240
    buffer_load_dwordx4 v249, s[12:15], s56 offen lds
    s_add_u32 m0, m0, 1024
    s_add_u32 s56, s56, 10240
    buffer_load_dwordx4 v249, s[12:15], s56 offen lds
    s_add_u32 m0, m0, 1024
    s_add_u32 s56, s56, 10240
    buffer_load_dwordx4 v249, s[12:15], s56 offen lds
    s_add_u32 m0, m0, 1024
    s_add_u32 s56, s56, 10240
    buffer_load_dwordx4 v249, s[12:15], s56 offen lds
    s_add_u32 m0, m0, 1024
    s_add_u32 s56, s56, 10240
    buffer_load_dwordx4 v249, s[12:15], s56 offen lds
    s_add_u32 m0, m0, 1024
    s_add_u32 s56, s56, 10240
    buffer_load_dwordx4 v249, s[12:15], s56 offen lds
    s_add_u32 m0, m0, 1024
    s_add_u32 s56, s56, 10240
    buffer_load_dwordx4 v249, s[12:15], s56 offen lds
    s_waitcnt vmcnt(32)
    ds_read_b64_tr_b16 a[0:1], v250 offset:0
    ds_read_b64_tr_b16 a[2:3], v250 offset:2048
    ds_read_b64_tr_b16 a[4:5], v250 offset:64
    ds_read_b64_tr_b16 a[6:7], v250 offset:2112
    ds_read_b64_tr_b16 a[8:9], v250 offset:1024
    ds_read_b64_tr_b16 a[10:11], v250 offset:3072
    ds_read_b64_tr_b16 a[12:13], v250 offset:1088
    ds_read_b64_tr_b16 a[14:15], v250 offset:3136
    ds_read_b64_tr_b16 a[16:17], v250 offset:4096
    ds_read_b64_tr_b16 a[18:19], v250 offset:6144
    ds_read_b64_tr_b16 a[20:21], v250 offset:4160
    ds_read_b64_tr_b16 a[22:23], v250 offset:6208
    ds_read_b64_tr_b16 a[24:25], v250 offset:5120
    ds_read_b64_tr_b16 a[26:27], v250 offset:7168
    ds_read_b64_tr_b16 a[28:29], v250 offset:5184
    ds_read_b64_tr_b16 a[30:31], v250 offset:7232
    s_waitcnt lgkmcnt(0)
    s_add_u32 s56, s69, 409600
    s_add_u32 m0, s67, 0
    s_nop 0
    buffer_load_dwordx4 v249, s[12:15], s56 offen lds
    s_add_u32 m0, m0, 1024
    s_add_u32 s56, s56, 10240
    buffer_load_dwordx4 v249, s[12:15], s56 offen lds
    s_add_u32 m0, m0, 1024
    s_add_u32 s56, s56, 10240
    buffer_load_dwordx4 v249, s[12:15], s56 offen lds
    s_add_u32 m0, m0, 1024
    s_add_u32 s56, s56, 10240
    buffer_load_dwordx4 v249, s[12:15], s56 offen lds
    s_add_u32 m0, m0, 1024
    s_add_u32 s56, s56, 10240
    buffer_load_dwordx4 v249, s[12:15], s56 offen lds
    s_add_u32 m0, m0, 1024
    s_add_u32 s56, s56, 10240
    buffer_load_dwordx4 v249, s[12:15], s56 offen lds
    s_add_u32 m0, m0, 1024
    s_add_u32 s56, s56, 10240
    buffer_load_dwordx4 v249, s[12:15], s56 offen lds
    s_add_u32 m0, m0, 1024
    s_add_u32 s56, s56, 10240
    buffer_load_dwordx4 v249, s[12:15], s56 offen lds
    s_waitcnt vmcnt(32)
    ds_read_b64_tr_b16 a[32:33], v250 offset:8192
    ds_read_b64_tr_b16 a[34:35], v250 offset:10240
    ds_read_b64_tr_b16 a[36:37], v250 offset:8256
    ds_read_b64_tr_b16 a[38:39], v250 offset:10304
    ds_read_b64_tr_b16 a[40:41], v250 offset:9216
    ds_read_b64_tr_b16 a[42:43], v250 offset:11264
    ds_read_b64_tr_b16 a[44:45], v250 offset:9280
    ds_read_b64_tr_b16 a[46:47], v250 offset:11328
    ds_read_b64_tr_b16 a[48:49], v250 offset:12288
    ds_read_b64_tr_b16 a[50:51], v250 offset:14336
    ds_read_b64_tr_b16 a[52:53], v250 offset:12352
    ds_read_b64_tr_b16 a[54:55], v250 offset:14400
    ds_read_b64_tr_b16 a[56:57], v250 offset:13312
    ds_read_b64_tr_b16 a[58:59], v250 offset:15360
    ds_read_b64_tr_b16 a[60:61], v250 offset:13376
    ds_read_b64_tr_b16 a[62:63], v250 offset:15424
    s_waitcnt lgkmcnt(0)
    s_add_u32 s56, s69, 491520
    s_add_u32 m0, s67, 8192
    s_nop 0
    buffer_load_dwordx4 v249, s[12:15], s56 offen lds
    s_add_u32 m0, m0, 1024
    s_add_u32 s56, s56, 10240
    buffer_load_dwordx4 v249, s[12:15], s56 offen lds
    s_add_u32 m0, m0, 1024
    s_add_u32 s56, s56, 10240
    buffer_load_dwordx4 v249, s[12:15], s56 offen lds
    s_add_u32 m0, m0, 1024
    s_add_u32 s56, s56, 10240
    buffer_load_dwordx4 v249, s[12:15], s56 offen lds
    s_add_u32 m0, m0, 1024
    s_add_u32 s56, s56, 10240
    buffer_load_dwordx4 v249, s[12:15], s56 offen lds
    s_add_u32 m0, m0, 1024
    s_add_u32 s56, s56, 10240
    buffer_load_dwordx4 v249, s[12:15], s56 offen lds
    s_add_u32 m0, m0, 1024
    s_add_u32 s56, s56, 10240
    buffer_load_dwordx4 v249, s[12:15], s56 offen lds
    s_add_u32 m0, m0, 1024
    s_add_u32 s56, s56, 10240
    buffer_load_dwordx4 v249, s[12:15], s56 offen lds
    s_waitcnt vmcnt(32)
    ds_read_b64_tr_b16 a[64:65], v250 offset:16384
    ds_read_b64_tr_b16 a[66:67], v250 offset:18432
    ds_read_b64_tr_b16 a[68:69], v250 offset:16448
    ds_read_b64_tr_b16 a[70:71], v250 offset:18496
    ds_read_b64_tr_b16 a[72:73], v250 offset:17408
    ds_read_b64_tr_b16 a[74:75], v250 offset:19456
    ds_read_b64_tr_b16 a[76:77], v250 offset:17472
    ds_read_b64_tr_b16 a[78:79], v250 offset:19520
    ds_read_b64_tr_b16 a[80:81], v250 offset:20480
    ds_read_b64_tr_b16 a[82:83], v250 offset:22528
    ds_read_b64_tr_b16 a[84:85], v250 offset:20544
    ds_read_b64_tr_b16 a[86:87], v250 offset:22592
    ds_read_b64_tr_b16 a[88:89], v250 offset:21504
    ds_read_b64_tr_b16 a[90:91], v250 offset:23552
    ds_read_b64_tr_b16 a[92:93], v250 offset:21568
    ds_read_b64_tr_b16 a[94:95], v250 offset:23616
    s_waitcnt lgkmcnt(0)
    s_add_u32 s56, s69, 573440
    s_add_u32 m0, s67, 16384
    s_nop 0
    buffer_load_dwordx4 v249, s[12:15], s56 offen lds
    s_add_u32 m0, m0, 1024
    s_add_u32 s56, s56, 10240
    buffer_load_dwordx4 v249, s[12:15], s56 offen lds
    s_add_u32 m0, m0, 1024
    s_add_u32 s56, s56, 10240
    buffer_load_dwordx4 v249, s[12:15], s56 offen lds
    s_add_u32 m0, m0, 1024
    s_add_u32 s56, s56, 10240
    buffer_load_dwordx4 v249, s[12:15], s56 offen lds
    s_add_u32 m0, m0, 1024
    s_add_u32 s56, s56, 10240
    buffer_load_dwordx4 v249, s[12:15], s56 offen lds
    s_add_u32 m0, m0, 1024
    s_add_u32 s56, s56, 10240
    buffer_load_dwordx4 v249, s[12:15], s56 offen lds
    s_add_u32 m0, m0, 1024
    s_add_u32 s56, s56, 10240
    buffer_load_dwordx4 v249, s[12:15], s56 offen lds
    s_add_u32 m0, m0, 1024
    s_add_u32 s56, s56, 10240
    buffer_load_dwordx4 v249, s[12:15], s56 offen lds
    s_waitcnt vmcnt(32)
    ds_read_b64_tr_b16 a[96:97], v250 offset:24576
    ds_read_b64_tr_b16 a[98:99], v250 offset:26624
    ds_read_b64_tr_b16 a[100:101], v250 offset:24640
    ds_read_b64_tr_b16 a[102:103], v250 offset:26688
    ds_read_b64_tr_b16 a[104:105], v250 offset:25600
    ds_read_b64_tr_b16 a[106:107], v250 offset:27648
    ds_read_b64_tr_b16 a[108:109], v250 offset:25664
    ds_read_b64_tr_b16 a[110:111], v250 offset:27712
    ds_read_b64_tr_b16 a[112:113], v250 offset:28672
    ds_read_b64_tr_b16 a[114:115], v250 offset:30720
    ds_read_b64_tr_b16 a[116:117], v250 offset:28736
    ds_read_b64_tr_b16 a[118:119], v250 offset:30784
    ds_read_b64_tr_b16 a[120:121], v250 offset:29696
    ds_read_b64_tr_b16 a[122:123], v250 offset:31744
    ds_read_b64_tr_b16 a[124:125], v250 offset:29760
    ds_read_b64_tr_b16 a[126:127], v250 offset:31808
    s_waitcnt lgkmcnt(0)
    s_waitcnt vmcnt(24)
    ds_read_b64_tr_b16 a[128:129], v250 offset:32768
    ds_read_b64_tr_b16 a[130:131], v250 offset:34816
    ds_read_b64_tr_b16 a[132:133], v250 offset:32832
    ds_read_b64_tr_b16 a[134:135], v250 offset:34880
    ds_read_b64_tr_b16 a[136:137], v250 offset:33792
    ds_read_b64_tr_b16 a[138:139], v250 offset:35840
    ds_read_b64_tr_b16 a[140:141], v250 offset:33856
    ds_read_b64_tr_b16 a[142:143], v250 offset:35904
    ds_read_b64_tr_b16 a[144:145], v250 offset:36864
    ds_read_b64_tr_b16 a[146:147], v250 offset:38912
    ds_read_b64_tr_b16 a[148:149], v250 offset:36928
    ds_read_b64_tr_b16 a[150:151], v250 offset:38976
    ds_read_b64_tr_b16 a[152:153], v250 offset:37888
    ds_read_b64_tr_b16 a[154:155], v250 offset:39936
    ds_read_b64_tr_b16 a[156:157], v250 offset:37952
    ds_read_b64_tr_b16 a[158:159], v250 offset:40000
    s_waitcnt lgkmcnt(0)
    s_waitcnt vmcnt(16)
    ds_read_b64_tr_b16 a[160:161], v250 offset:0
    ds_read_b64_tr_b16 a[162:163], v250 offset:2048
    ds_read_b64_tr_b16 a[164:165], v250 offset:64
    ds_read_b64_tr_b16 a[166:167], v250 offset:2112
    ds_read_b64_tr_b16 a[168:169], v250 offset:1024
    ds_read_b64_tr_b16 a[170:171], v250 offset:3072
    ds_read_b64_tr_b16 a[172:173], v250 offset:1088
    ds_read_b64_tr_b16 a[174:175], v250 offset:3136
    ds_read_b64_tr_b16 a[176:177], v250 offset:4096
    ds_read_b64_tr_b16 a[178:179], v250 offset:6144
    ds_read_b64_tr_b16 a[180:181], v250 offset:4160
    ds_read_b64_tr_b16 a[182:183], v250 offset:6208
    ds_read_b64_tr_b16 a[184:185], v250 offset:5120
    ds_read_b64_tr_b16 a[186:187], v250 offset:7168
    ds_read_b64_tr_b16 a[188:189], v250 offset:5184
    ds_read_b64_tr_b16 a[190:191], v250 offset:7232
    s_waitcnt lgkmcnt(0)
    s_waitcnt vmcnt(8)
    ds_read_b64_tr_b16 a[192:193], v250 offset:8192
    ds_read_b64_tr_b16 a[194:195], v250 offset:10240
    ds_read_b64_tr_b16 a[196:197], v250 offset:8256
    ds_read_b64_tr_b16 a[198:199], v250 offset:10304
    ds_read_b64_tr_b16 a[200:201], v250 offset:9216
    ds_read_b64_tr_b16 a[202:203], v250 offset:11264
    ds_read_b64_tr_b16 a[204:205], v250 offset:9280
    ds_read_b64_tr_b16 a[206:207], v250 offset:11328
    ds_read_b64_tr_b16 a[208:209], v250 offset:12288
    ds_read_b64_tr_b16 a[210:211], v250 offset:14336
    ds_read_b64_tr_b16 a[212:213], v250 offset:12352
    ds_read_b64_tr_b16 a[214:215], v250 offset:14400
    ds_read_b64_tr_b16 a[216:217], v250 offset:13312
    ds_read_b64_tr_b16 a[218:219], v250 offset:15360
    ds_read_b64_tr_b16 a[220:221], v250 offset:13376
    ds_read_b64_tr_b16 a[222:223], v250 offset:15424
    s_waitcnt lgkmcnt(0)
    s_waitcnt vmcnt(0)
    ds_read_b64_tr_b16 a[224:225], v250 offset:16384
    ds_read_b64_tr_b16 a[226:227], v250 offset:18432
    ds_read_b64_tr_b16 a[228:229], v250 offset:16448
    ds_read_b64_tr_b16 a[230:231], v250 offset:18496
    ds_read_b64_tr_b16 a[232:233], v250 offset:17408
    ds_read_b64_tr_b16 a[234:235], v250 offset:19456
    ds_read_b64_tr_b16 a[236:237], v250 offset:17472
    ds_read_b64_tr_b16 a[238:239], v250 offset:19520
    ds_read_b64_tr_b16 a[240:241], v250 offset:20480
    ds_read_b64_tr_b16 a[242:243], v250 offset:22528
    ds_read_b64_tr_b16 a[244:245], v250 offset:20544
    ds_read_b64_tr_b16 a[246:247], v250 offset:22592
    ds_read_b64_tr_b16 a[248:249], v250 offset:21504
    ds_read_b64_tr_b16 a[250:251], v250 offset:23552
    ds_read_b64_tr_b16 a[252:253], v250 offset:21568
    ds_read_b64_tr_b16 a[254:255], v250 offset:23616
    s_waitcnt lgkmcnt(0)
L_wor_con:
    v_lshlrev_b32 v2, 4, v1
    s_lshl_b32 s58, s60, 2
    s_add_u32 s58, s58, s3
    s_lshl_b32 s55, s53, 5
    s_lshl_b32 s56, s3, 2
    s_add_u32 s55, s55, s56
    s_add_u32 s55, s55, 240
    v_min_u32 v3, 3, v1
    v_add_u32 v3, s55, v3
    v_lshlrev_b32 v3, 7, v3
    v_mov_b32 v6, 1
    s_mul_i32 s55, s53, 920
    s_add_u32 s55, s55, 40
    s_add_u32 s55, s55, s58
    s_lshl_b32 s55, s55, 7
    v_mov_b32 v5, s55
    v_cmp_gt_u32 vcc, 4, v1
    s_nop 1
    v_cndmask_b32 v3, v5, v3, vcc
    v_cndmask_b32 v6, -7, v6, vcc
    s_mul_i32 s66, s53, 10
    s_add_u32 s66, s66, s60
    s_lshl_b32 s66, s66, 15
    s_lshl_b32 s55, s3, 11
    s_add_u32 s66, s66, s55
    s_add_u32 s66, s66, 131072
    s_add_u32 s55, s53, 0
    s_mul_i32 s63, s55, 2621440
    s_lshl_b32 s55, s58, 10
    s_add_u32 s63, s63, s55
    s_add_u32 s63, s63, 196083712
    s_add_u32 s64, s63, 5242880
    s_mul_i32 s65, s53, 40
    s_add_u32 s65, s65, s58
    s_add_u32 s65, s65, 80
    s_lshl_b32 s65, s65, 7
    v_and_b32 v7, 31, v1
    v_mul_u32_u24 v7, 272, v7
    v_lshrrev_b32 v5, 5, v1
    v_lshl_add_u32 v8, v5, 5, v7
    v_lshl_add_u32 v7, v5, 4, v7
    s_mul_i32 s55, s3, 8704
    v_add_u32 v7, s55, v7
    s_lshl_b32 s55, s3, 6
    v_add_u32 v8, s55, v8
    v_mov_b32 v12, 128
Lp_97:
    buffer_load_dword v5, v12, s[8:11], 0 offen sc1
    s_waitcnt vmcnt(0)
    v_cmp_gt_i32 vcc, 1, v5
    s_cbranch_vccz Lpd_98
    s_sleep 8
    s_mov_b32 s54, 48
    s_sub_u32 s52, s52, 1
    s_cbranch_scc1 L_abort
    s_branch Lp_97
Lpd_98:
    s_mov_b32 s61, 0
    s_barrier
    s_mov_b32 s70, 262144000
    v_mov_b32 v10, 0x80000000
    v_mov_b32 v11, 0
    v_mov_b32 v4, 132
Lp_99:
    buffer_load_dword v5, v4, s[8:11], 0 offen sc1
    s_waitcnt vmcnt(0)
    v_cmp_gt_i32 vcc, 1, v5
    s_cbranch_vccz Lpd_100
    s_sleep 8
    s_mov_b32 s54, 112
    s_sub_u32 s52, s52, 1
    s_cbranch_scc1 L_abort
    s_branch Lp_99
Lpd_100:
    v_readfirstlane_b32 s74, v5
    s_and_b32 s74, s74, 2
    s_lshl_b32 s74, s74, 12
    s_mul_i32 s66, s53, 1982464
    s_lshl_b32 s55, s60, 16
    s_add_u32 s66, s66, s55
    s_lshl_b32 s55, s3, 11
    s_add_u32 s66, s66, s55
    s_add_u32 s66, s66, s74
    s_add_u32 s66, s66, s38
    s_add_u32 s66, s66, 917504
    v_mbcnt_lo_u32_b32 v5, -1, 0
    v_and_b32 v5, 1, v5
    v_lshlrev_b32 v5, 2, v5
    s_lshl_b32 s55, s50, 3
    buffer_load_dword v5, v5, s[8:11], s55 offen sc1
    s_getreg_b32 s55, hwreg(HW_REG_XCC_ID)
    s_and_b32 s55, s55, 7
    s_lshl_b32 s55, s55, 3
    s_lshl_b64 s[56:57], 0xff, s55
    s_waitcnt vmcnt(0)
    v_readlane_b32 s96, v5, 0
    v_readlane_b32 s97, v5, 1
    s_andn2_b64 s[56:57], s[96:97], s[56:57]
    s_cselect_b32 s72, 1, 0
    s_add_u32 s73, s53, 2
    s_mul_i32 s73, s73, 40
    s_lshl_b32 s55, s60, 2
    s_add_u32 s73, s73, s55
    s_add_u32 s73, s73, s3
    s_add_u32 s73, s73, 6272
    s_lshl_b32 s73, s73, 7
    v_min_u32 v56, 7, v1
    v_lshlrev_b32 v56, 7, v56
    s_add_u32 s59, s64, 0
    buffer_load_dword v57, v56, s[4:7], s59 offen sc1
    s_add_u32 s59, s64, 40960
    buffer_load_dword v57, v56, s[4:7], s59 offen sc1
    s_add_u32 s59, s64, 81920
    buffer_load_dword v57, v56, s[4:7], s59 offen sc1
    s_add_u32 s59, s64, 122880
    buffer_load_dword v57, v56, s[4:7], s59 offen sc1
    s_add_u32 s59, s64, 163840
    buffer_load_dword v57, v56, s[4:7], s59 offen sc1
    s_add_u32 s59, s64, 204800
    buffer_load_dword v57, v56, s[4:7], s59 offen sc1
    s_add_u32 s59, s64, 245760
    buffer_load_dword v57, v56, s[4:7], s59 offen sc1
    s_add_u32 s59, s64, 286720
    buffer_load_dword v57, v56, s[4:7], s59 offen sc1
    v_min_u32 v58, 25, v1
    s_mul_i32 s55, s60, 26
    v_add_u32 v58, s55, v58
    v_min_u32 v58, 255, v58
    v_lshlrev_b32 v58, 7, v58
    s_add_u32 s59, s62, 0
    buffer_load_dword v59, v58, s[4:7], s59 offen sc1
    s_add_u32 s59, s62, 262144
    buffer_load_dword v59, v58, s[4:7], s59 offen sc1
    s_add_u32 s59, s62, 524288
    buffer_load_dword v59, v58, s[4:7], s59 offen sc1
    s_add_u32 s59, s62, 786432
    buffer_load_dword v59, v58, s[4:7], s59 offen sc1
    s_mov_b32 s71, 0
L_wor_loop:
    v_add_u32 v4, s61, v6
    s_cmp_lg_u32 s71, 0
    s_cbranch_scc1 L_wor_go
    v_cmp_gt_i32 vcc, v4, v10
    s_bitset0_b32 vcc_lo, 3
    s_cmp_eq_u64 vcc, 0
    s_cbranch_scc1 L_wor_rdy
L_wor_poll:
    buffer_load_dword v5, v3, s[4:7], 0 offen sc1
    s_waitcnt vmcnt(0)
    s_cmp_lg_u32 s72, 0
    s_cbranch_scc1 Lls_101
    buffer_store_dword v11, off, s[4:7], s70
Lld_102:
    s_mov_b32 s70, 262144000
    v_cmp_gt_i32 vcc, v4, v5
    s_bitset0_b32 vcc_lo, 3
    s_cmp_eq_u64 vcc, 0
    s_cbranch_scc1 L_wor_rdy
    s_sleep 1
    s_mov_b32 s54, 49
    s_sub_u32 s52, s52, 1
    s_cbranch_scc1 L_abort
    s_branch L_wor_poll
L_wor_rdy:
    s_mov_b32 s56, s62
    buffer_load_dwordx4 v[64:67], v2, s[4:7], s56 offen offset:0 sc1
    buffer_load_dwordx4 v[68:71], v2, s[4:7], s56 offen offset:1024 sc1
    buffer_load_dwordx4 v[72:75], v2, s[4:7], s56 offen offset:2048 sc1
    buffer_load_dwordx4 v[76:79], v2, s[4:7], s56 offen offset:3072 sc1
    s_add_u32 s56, s56, 4096
    buffer_load_dwordx4 v[80:83], v2, s[4:7], s56 offen offset:0 sc1
    s_waitcnt vmcnt(5)
    s_cmp_lg_u32 s72, 0
    s_cbranch_scc1 Lls_103
    buffer_store_dword v11, off, s[4:7], s70
Lld_104:
    s_mov_b32 s70, 262144000
    buffer_load_dwordx4 v[84:87], v2, s[4:7], s56 offen offset:1024 sc1
    buffer_load_dwordx4 v[88:91], v2, s[4:7], s56 offen offset:2048 sc1
    buffer_load_dwordx4 v[92:95], v2, s[4:7], s56 offen offset:3072 sc1
L_wor_go:
    s_add_u32 s55, s61, 1
    s_and_b32 s55, s55, 3
    s_cselect_b32 s55, 0, 1048576
    s_sub_u32 s62, s62, s55
    s_add_u32 s62, s62, 262144
    v_add_u32 v4, 1, v4
    s_add_u32 s56, s56, 4096
    buffer_load_dwordx4 v[96:99], v2, s[4:7], s56 offen offset:0 sc1
    s_waitcnt vmcnt(8)
    v_mfma_f32_32x32x16_bf16 v[24:39], a[0:3], v[64:67], 0
    v_mfma_f32_32x32x16_bf16 v[40:55], a[4:7], v[64:67], 0
    buffer_load_dwordx4 v[100:103], v2, s[4:7], s56 offen offset:1024 sc1
    s_waitcnt vmcnt(8)
    v_mfma_f32_32x32x16_bf16 v[24:39], a[8:11], v[68:71], v[24:39]
    v_mfma_f32_32x32x16_bf16 v[40:55], a[12:15], v[68:71], v[40:55]
    buffer_load_dwordx4 v[104:107], v2, s[4:7], s56 offen offset:2048 sc1
    s_waitcnt vmcnt(8)
    v_mfma_f32_32x32x16_bf16 v[24:39], a[16:19], v[72:75], v[24:39]
    v_mfma_f32_32x32x16_bf16 v[40:55], a[20:23], v[72:75], v[40:55]
    buffer_load_dwordx4 v[108:111], v2, s[4:7], s56 offen offset:3072 sc1
    s_waitcnt vmcnt(8)
    v_mfma_f32_32x32x16_bf16 v[24:39], a[24:27], v[76:79], v[24:39]
    v_mfma_f32_32x32x16_bf16 v[40:55], a[28:31], v[76:79], v[40:55]
    s_add_u32 s56, s56, 4096
    buffer_load_dwordx4 v[112:115], v2, s[4:7], s56 offen offset:0 sc1
    s_waitcnt vmcnt(8)
    v_mfma_f32_32x32x16_bf16 v[24:39], a[32:35], v[80:83], v[24:39]
    v_mfma_f32_32x32x16_bf16 v[40:55], a[36:39], v[80:83], v[40:55]
    s_cmp_eq_u32 s70, 262144000
    s_cbranch_scc1 L_wor_np
    s_waitcnt vmcnt(5)
    s_cmp_lg_u32 s72, 0
    s_cbranch_scc1 Lls_105
    buffer_store_dword v11, off, s[4:7], s70
Lld_106:
    s_mov_b32 s70, 262144000
L_wor_np:
    buffer_load_dwordx4 v[116:119], v2, s[4:7], s56 offen offset:1024 sc1
    s_waitcnt vmcnt(8)
    v_mfma_f32_32x32x16_bf16 v[24:39], a[40:43], v[84:87], v[24:39]
    v_mfma_f32_32x32x16_bf16 v[40:55], a[44:47], v[84:87], v[40:55]
    buffer_load_dwordx4 v[120:123], v2, s[4:7], s56 offen offset:2048 sc1
    s_waitcnt vmcnt(8)
    v_mfma_f32_32x32x16_bf16 v[24:39], a[48:51], v[88:91], v[24:39]
    v_mfma_f32_32x32x16_bf16 v[40:55], a[52:55], v[88:91], v[40:55]
    buffer_load_dwordx4 v[124:127], v2, s[4:7], s56 offen offset:3072 sc1
    s_waitcnt vmcnt(8)
    v_mfma_f32_32x32x16_bf16 v[24:39], a[56:59], v[92:95], v[24:39]
    v_mfma_f32_32x32x16_bf16 v[40:55], a[60:63], v[92:95], v[40:55]
    buffer_load_dword v5, v3, s[4:7], 0 offen sc1
    s_add_u32 s56, s56, 4096
    buffer_load_dwordx4 v[128:131], v2, s[4:7], s56 offen offset:0 sc1
    s_waitcnt vmcnt(9)
    v_mfma_f32_32x32x16_bf16 v[24:39], a[64:67], v[96:99], v[24:39]
    v_mfma_f32_32x32x16_bf16 v[40:55], a[68:71], v[96:99], v[40:55]
    buffer_load_dwordx4 v[132:135], v2, s[4:7], s56 offen offset:1024 sc1
    s_waitcnt vmcnt(9)
    v_mfma_f32_32x32x16_bf16 v[24:39], a[72:75], v[100:103], v[24:39]
    v_mfma_f32_32x32x16_bf16 v[40:55], a[76:79], v[100:103], v[40:55]
    buffer_load_dwordx4 v[136:139], v2, s[4:7], s56 offen offset:2048 sc1
    s_waitcnt vmcnt(9)
    v_mfma_f32_32x32x16_bf16 v[24:39], a[80:83], v[104:107], v[24:39]
    v_mfma_f32_32x32x16_bf16 v[40:55], a[84:87], v[104:107], v[40:55]
    buffer_load_dwordx4 v[140:143], v2, s[4:7], s56 offen offset:3072 sc1
    s_waitcnt vmcnt(9)
    v_mfma_f32_32x32x16_bf16 v[24:39], a[88:91], v[108:111], v[24:39]
    v_mfma_f32_32x32x16_bf16 v[40:55], a[92:95], v[108:111], v[40:55]
    s_add_u32 s56, s56, 4096
    buffer_load_dwordx4 v[144:147], v2, s[4:7], s56 offen offset:0 sc1
    s_waitcnt vmcnt(9)
    v_mfma_f32_32x32x16_bf16 v[24:39], a[96:99], v[112:115], v[24:39]
    v_mfma_f32_32x32x16_bf16 v[40:55], a[100:103], v[112:115], v[40:55]
    buffer_load_dwordx4 v[148:151], v2, s[4:7], s56 offen offset:1024 sc1
    s_waitcnt vmcnt(9)
    v_mfma_f32_32x32x16_bf16 v[24:39], a[104:107], v[116:119], v[24:39]
    v_mfma_f32_32x32x16_bf16 v[40:55], a[108:111], v[116:119], v[40:55]
    buffer_load_dwordx4 v[152:155], v2, s[4:7], s56 offen offset:2048 sc1
    s_waitcnt vmcnt(9)
    v_mfma_f32_32x32x16_bf16 v[24:39], a[112:115], v[120:123], v[24:39]
    v_mfma_f32_32x32x16_bf16 v[40:55], a[116:119], v[120:123], v[40:55]
    buffer_load_dwordx4 v[156:159], v2, s[4:7], s56 offen offset:3072 sc1
    s_waitcnt vmcnt(9)
    v_mfma_f32_32x32x16_bf16 v[24:39], a[120:123], v[124:127], v[24:39]
    v_mfma_f32_32x32x16_bf16 v[40:55], a[124:127], v[124:127], v[40:55]
    s_waitcnt vmcnt(8)
L_wor_h3:
    v_readlane_b32 s59, v5, 3
    s_cmp_le_i32 s59, s61
    s_cbranch_scc1 L_wor_h3w
    s_add_u32 s56, s56, 4096
    buffer_load_dwordx4 v[160:163], v2, s[4:7], s56 offen offset:0 sc1
    s_waitcnt vmcnt(8)
    v_mfma_f32_32x32x16_bf16 v[24:39], a[128:131], v[128:131], v[24:39]
    v_mfma_f32_32x32x16_bf16 v[40:55], a[132:135], v[128:131], v[40:55]
    buffer_load_dwordx4 v[164:167], v2, s[4:7], s56 offen offset:1024 sc1
    s_waitcnt vmcnt(8)
    v_mfma_f32_32x32x16_bf16 v[24:39], a[136:139], v[132:135], v[24:39]
    v_mfma_f32_32x32x16_bf16 v[40:55], a[140:143], v[132:135], v[40:55]
    buffer_load_dwordx4 v[168:171], v2, s[4:7], s56 offen offset:2048 sc1
    s_waitcnt vmcnt(8)
    v_mfma_f32_32x32x16_bf16 v[24:39], a[144:147], v[136:139], v[24:39]
    v_mfma_f32_32x32x16_bf16 v[40:55], a[148:151], v[136:139], v[40:55]
    buffer_load_dwordx4 v[172:175], v2, s[4:7], s56 offen offset:3072 sc1
    s_waitcnt vmcnt(8)
    v_mfma_f32_32x32x16_bf16 v[24:39], a[152:155], v[140:143], v[24:39]
    v_mfma_f32_32x32x16_bf16 v[40:55], a[156:159], v[140:143], v[40:55]
    s_add_u32 s56, s56, 4096
    buffer_load_dwordx4 v[176:179], v2, s[4:7], s56 offen offset:0 sc1
    s_waitcnt vmcnt(8)
    v_mfma_f32_32x32x16_bf16 v[24:39], a[160:163], v[144:147], v[24:39]
    v_mfma_f32_32x32x16_bf16 v[40:55], a[164:167], v[144:147], v[40:55]
    buffer_load_dwordx4 v[180:183], v2, s[4:7], s56 offen offset:1024 sc1
    s_waitcnt vmcnt(8)
    v_mfma_f32_32x32x16_bf16 v[24:39], a[168:171], v[148:151], v[24:39]
    v_mfma_f32_32x32x16_bf16 v[40:55], a[172:175], v[148:151], v[40:55]
    buffer_load_dwordx4 v[184:187], v2, s[4:7], s56 offen offset:2048 sc1
    s_waitcnt vmcnt(8)
    v_mfma_f32_32x32x16_bf16 v[24:39], a[176:179], v[152:155], v[24:39]
    v_mfma_f32_32x32x16_bf16 v[40:55], a[180:183], v[152:155], v[40:55]
    buffer_load_dwordx4 v[188:191], v2, s[4:7], s56 offen offset:3072 sc1
    s_waitcnt vmcnt(8)
    v_mfma_f32_32x32x16_bf16 v[24:39], a[184:187], v[156:159], v[24:39]
    v_mfma_f32_32x32x16_bf16 v[40:55], a[188:191], v[156:159], v[40:55]
    buffer_load_dwordx4 v[12:15], v2, s[4:7], s63 offen sc1
    s_add_u32 s55, s61, 1
    s_and_b32 s55, s55, 63
    s_cselect_b32 s55, 0, 2621440
    s_sub_u32 s63, s63, s55
    s_add_u32 s63, s63, 40960
    s_and_b32 s57, s61, 3
    s_lshl_b32 s57, s57, 14
    s_add_u32 s57, s57, s66
    s_add_u32 s61, s61, 1
    s_cmp_lg_u32 s72, 0
    s_cbranch_scc1 Lls_107
    buffer_store_dword v11, off, s[4:7], s70
Lld_108:
    s_mov_b32 s70, 262144000
    v_cmp_gt_i32 vcc, v4, v5
    s_mov_b32 s71, 0
    s_bitset0_b32 vcc_lo, 3
    s_cmp_eq_u64 vcc, 0
    s_cbranch_scc0 L_wor_nostr
    s_mov_b32 s71, 1
    s_waitcnt vmcnt(9)
    v_mfma_f32_32x32x16_bf16 v[24:39], a[192:195], v[160:163], v[24:39]
    v_mfma_f32_32x32x16_bf16 v[40:55], a[196:199], v[160:163], v[40:55]
    s_mov_b32 s56, s62
    buffer_load_dwordx4 v[64:67], v2, s[4:7], s56 offen offset:0 sc1
    s_waitcnt vmcnt(9)
    v_mfma_f32_32x32x16_bf16 v[24:39], a[200:203], v[164:167], v[24:39]
    v_mfma_f32_32x32x16_bf16 v[40:55], a[204:207], v[164:167], v[40:55]
    buffer_load_dwordx4 v[68:71], v2, s[4:7], s56 offen offset:1024 sc1
    s_waitcnt vmcnt(9)
    v_mfma_f32_32x32x16_bf16 v[24:39], a[208:211], v[168:171], v[24:39]
    v_mfma_f32_32x32x16_bf16 v[40:55], a[212:215], v[168:171], v[40:55]
    buffer_load_dwordx4 v[72:75], v2, s[4:7], s56 offen offset:2048 sc1
    s_waitcnt vmcnt(9)
    v_mfma_f32_32x32x16_bf16 v[24:39], a[216:219], v[172:175], v[24:39]
    v_mfma_f32_32x32x16_bf16 v[40:55], a[220:223], v[172:175], v[40:55]
    buffer_load_dwordx4 v[76:79], v2, s[4:7], s56 offen offset:3072 sc1
    s_waitcnt vmcnt(9)
    v_mfma_f32_32x32x16_bf16 v[24:39], a[224:227], v[176:179], v[24:39]
    v_mfma_f32_32x32x16_bf16 v[40:55], a[228:231], v[176:179], v[40:55]
    s_add_u32 s56, s56, 4096
    buffer_load_dwordx4 v[80:83], v2, s[4:7], s56 offen offset:0 sc1
    s_waitcnt vmcnt(9)
    v_mfma_f32_32x32x16_bf16 v[24:39], a[232:235], v[180:183], v[24:39]
    v_mfma_f32_32x32x16_bf16 v[40:55], a[236:239], v[180:183], v[40:55]
    buffer_load_dwordx4 v[84:87], v2, s[4:7], s56 offen offset:1024 sc1
    s_waitcnt vmcnt(9)
    v_mfma_f32_32x32x16_bf16 v[24:39], a[240:243], v[184:187], v[24:39]
    v_mfma_f32_32x32x16_bf16 v[40:55], a[244:247], v[184:187], v[40:55]
    buffer_load_dwordx4 v[88:91], v2, s[4:7], s56 offen offset:2048 sc1
    s_waitcnt vmcnt(9)
    v_mfma_f32_32x32x16_bf16 v[24:39], a[248:251], v[188:191], v[24:39]
    v_mfma_f32_32x32x16_bf16 v[40:55], a[252:255], v[188:191], v[40:55]
    buffer_load_dwordx4 v[92:95], v2, s[4:7], s56 offen offset:3072 sc1
    s_branch L_wor_epi
L_wor_nostr:
    s_waitcnt vmcnt(9)
    v_mfma_f32_32x32x16_bf16 v[24:39], a[192:195], v[160:163], v[24:39]
    v_mfma_f32_32x32x16_bf16 v[40:55], a[196:199], v[160:163], v[40:55]
    s_waitcnt vmcnt(8)
    v_mfma_f32_32x32x16_bf16 v[24:39], a[200:203], v[164:167], v[24:39]
    v_mfma_f32_32x32x16_bf16 v[40:55], a[204:207], v[164:167], v[40:55]
    s_waitcnt vmcnt(7)
    v_mfma_f32_32x32x16_bf16 v[24:39], a[208:211], v[168:171], v[24:39]
    v_mfma_f32_32x32x16_bf16 v[40:55], a[212:215], v[168:171], v[40:55]
    s_waitcnt vmcnt(6)
    v_mfma_f32_32x32x16_bf16 v[24:39], a[216:219], v[172:175], v[24:39]
    v_mfma_f32_32x32x16_bf16 v[40:55], a[220:223], v[172:175], v[40:55]
    s_waitcnt vmcnt(5)
    v_mfma_f32_32x32x16_bf16 v[24:39], a[224:227], v[176:179], v[24:39]
    v_mfma_f32_32x32x16_bf16 v[40:55], a[228:231], v[176:179], v[40:55]
    s_waitcnt vmcnt(4)
    v_mfma_f32_32x32x16_bf16 v[24:39], a[232:235], v[180:183], v[24:39]
    v_mfma_f32_32x32x16_bf16 v[40:55], a[236:239], v[180:183], v[40:55]
    s_waitcnt vmcnt(3)
    v_mfma_f32_32x32x16_bf16 v[24:39], a[240:243], v[184:187], v[24:39]
    v_mfma_f32_32x32x16_bf16 v[40:55], a[244:247], v[184:187], v[40:55]
    s_waitcnt vmcnt(2)
    v_mfma_f32_32x32x16_bf16 v[24:39], a[248:251], v[188:191], v[24:39]
    v_mfma_f32_32x32x16_bf16 v[40:55], a[252:255], v[188:191], v[40:55]
L_wor_epi:
    v_mov_b32 v59, s61
    s_cmp_lg_u32 s72, 0
    s_cbranch_scc1 Lls_109
    buffer_store_dword v59, off, s[4:7], s73
Lld_110:
    buffer_load_dwordx4 v[16:19], v2, s[4:7], s57 offen sc1
    buffer_load_dwordx4 v[20:23], v2, s[4:7], s57 offen offset:1024 sc1
    buffer_load_dword v10, v3, s[4:7], 0 offen sc1
    s_add_u32 s59, s65, 776192
    buffer_store_dword v11, off, s[4:7], s59 sc1
    s_nop 1
    ds_write_b128 v7, v[24:27] offset:0
    ds_write_b128 v7, v[28:31] offset:32
    ds_write_b128 v7, v[32:35] offset:64
    ds_write_b128 v7, v[36:39] offset:96
    ds_write_b128 v7, v[40:43] offset:128
    ds_write_b128 v7, v[44:47] offset:160
    ds_write_b128 v7, v[48:51] offset:192
    ds_write_b128 v7, v[52:55] offset:224
    s_waitcnt lgkmcnt(0)
    s_barrier
    ds_read_b128 v[192:195], v8 offset:0
    ds_read_b128 v[196:199], v8 offset:16
    ds_read_b128 v[200:203], v8 offset:8704
    ds_read_b128 v[204:207], v8 offset:8720
    ds_read_b128 v[208:211], v8 offset:17408
    ds_read_b128 v[212:215], v8 offset:17424
    ds_read_b128 v[216:219], v8 offset:26112
    ds_read_b128 v[220:223], v8 offset:26128
    v_xor_b32 v7, 0x10000, v7
    v_xor_b32 v8, 0x10000, v8
    s_waitcnt lgkmcnt(4)
    v_add_f32 v192, v192, v200
    v_add_f32 v193, v193, v201
    v_add_f32 v194, v194, v202
    v_add_f32 v195, v195, v203
    v_add_f32 v196, v196, v204
    v_add_f32 v197, v197, v205
    v_add_f32 v198, v198, v206
    v_add_f32 v199, v199, v207
    s_waitcnt lgkmcnt(0)
    v_add_f32 v208, v208, v216
    v_add_f32 v209, v209, v217
    v_add_f32 v210, v210, v218
    v_add_f32 v211, v211, v219
    v_add_f32 v212, v212, v220
    v_add_f32 v213, v213, v221
    v_add_f32 v214, v214, v222
    v_add_f32 v215, v215, v223
    v_add_f32 v192, v192, v208
    v_add_f32 v193, v193, v209
    v_add_f32 v194, v194, v210
    v_add_f32 v195, v195, v211
    v_add_f32 v196, v196, v212
    v_add_f32 v197, v197, v213
    v_add_f32 v198, v198, v214
    v_add_f32 v199, v199, v215
    s_waitcnt vmcnt(2)
L_wor_chk:
    v_xor_b32 v5, s61, v16
    v_xor_b32 v4, s61, v17
    v_or_b32 v5, v5, v4
    v_xor_b32 v4, s61, v18
    v_or_b32 v5, v5, v4
    v_xor_b32 v4, s61, v19
    v_or_b32 v5, v5, v4
    v_xor_b32 v4, s61, v20
    v_or_b32 v5, v5, v4
    v_xor_b32 v4, s61, v21
    v_or_b32 v5, v5, v4
    v_xor_b32 v4, s61, v22
    v_or_b32 v5, v5, v4
    v_xor_b32 v4, s61, v23
    v_or_b32 v5, v5, v4
    v_and_b32 v5, 0x7f, v5
    v_cmp_ne_u32 vcc, 0, v5
    s_cbranch_vccz L_wor_ok
    s_mov_b32 s54, 50
    s_sub_u32 s52, s52, 1
    s_cbranch_scc1 L_abort
    buffer_load_dwordx4 v[16:19], v2, s[4:7], s57 offen sc1
    buffer_load_dwordx4 v[20:23], v2, s[4:7], s57 offen offset:1024 sc1
    s_waitcnt vmcnt(0)
    s_branch L_wor_chk
L_wor_ok:
    v_add_f32 v192, v192, v16
    v_add_f32 v193, v193, v17
    v_add_f32 v194, v194, v18
    v_add_f32 v195, v195, v19
    v_add_f32 v196, v196, v20
    v_add_f32 v197, v197, v21
    v_add_f32 v198, v198, v22
    v_add_f32 v199, v199, v23
    v_cvt_pk_bf16_f32 v200, v192, v193
    v_cvt_pk_bf16_f32 v201, v194, v195
    v_cvt_pk_bf16_f32 v202, v196, v197
    v_cvt_pk_bf16_f32 v203, v198, v199
    v_lshlrev_b32 v192, 16, v200
    v_and_b32 v193, 0xffff0000, v200
    v_lshlrev_b32 v208, 16, v12
    v_and_b32 v209, 0xffff0000, v12
    v_lshlrev_b32 v194, 16, v201
    v_and_b32 v195, 0xffff0000, v201
    v_lshlrev_b32 v210, 16, v13
    v_and_b32 v211, 0xffff0000, v13
    v_lshlrev_b32 v196, 16, v202
    v_and_b32 v197, 0xffff0000, v202
    v_lshlrev_b32 v212, 16, v14
    v_and_b32 v213, 0xffff0000, v14
    v_lshlrev_b32 v198, 16, v203
    v_and_b32 v199, 0xffff0000, v203
    v_lshlrev_b32 v214, 16, v15
    v_and_b32 v215, 0xffff0000, v15
    v_add_f32 v192, v192, v208
    v_add_f32 v193, v193, v209
    v_add_f32 v194, v194, v210
    v_add_f32 v195, v195, v211
    v_add_f32 v196, v196, v212
    v_add_f32 v197, v197, v213
    v_add_f32 v198, v198, v214
    v_add_f32 v199, v199, v215
    v_cvt_pk_bf16_f32 v200, v192, v193
    v_cvt_pk_bf16_f32 v201, v194, v195
    v_cvt_pk_bf16_f32 v202, v196, v197
    v_cvt_pk_bf16_f32 v203, v198, v199
    s_cmp_lg_u32 s72, 0
    s_cbranch_scc1 Lls_111
    buffer_store_dwordx4 v[200:203], v2, s[4:7], s64 offen
Lld_112:
    s_add_u32 s55, s61, 0
    s_and_b32 s55, s55, 7
    s_cselect_b32 s55, 0, 327680
    s_sub_u32 s64, s64, s55
    s_add_u32 s64, s64, 40960
    v_mov_b32 v11, s61
    s_mov_b32 s70, s65
    s_waitcnt vmcnt(2)
    s_cmp_lt_u32 s61, 64
    s_cbranch_scc1 L_wor_loop
    s_waitcnt vmcnt(0)
    s_cmp_lg_u32 s72, 0
    s_cbranch_scc1 Lls_113
    buffer_store_dword v11, off, s[4:7], s70
Lld_114:
    s_mov_b32 s70, 262144000
    s_endpgm
L_role_ff2:
    s_waitcnt vmcnt(0)
    s_cmp_lg_u32 s53, 0
    s_cbranch_scc1 Ll1_116
    v_mov_b32 v2, 148
Lp_117:
    buffer_load_dword v3, v2, s[8:11], 0 offen sc1
    s_waitcnt vmcnt(0)
    v_cmp_gt_i32 vcc, 2, v3
    s_cbranch_vccz Lpd_118
    s_sleep 8
    s_mov_b32 s54, 130
    s_sub_u32 s52, s52, 1
    s_cbranch_scc1 L_abort
    s_branch Lp_117
Lpd_118:
    s_branch Llate_115
Ll1_116:
    v_mov_b32 v2, 128
Lp_119:
    buffer_load_dword v3, v2, s[8:11], 0 offen sc1
    s_waitcnt vmcnt(0)
    v_cmp_gt_i32 vcc, 1, v3
    s_cbranch_vccz Lpd_120
    s_sleep 8
    s_mov_b32 s54, 128
    s_sub_u32 s52, s52, 1
    s_cbranch_scc1 L_abort
    s_branch Lp_119
Lpd_120:
    v_mov_b32 v2, 53248
    s_cmp_eq_u32 s53, 0
    s_cselect_b32 s56, 0, 3
Lp_121:
    buffer_load_dword v3, v2, s[4:7], 0 offen sc1
    s_waitcnt vmcnt(0)
    v_cmp_gt_i32 vcc, s56, v3
    s_cbranch_vccz Lpd_122
    s_sleep 8
    s_mov_b32 s54, 129
    s_sub_u32 s52, s52, 1
    s_cbranch_scc1 L_abort
    s_branch Lp_121
Lpd_122:
Llate_115:
L_ff2_par:
    s_mov_b32 s60, s51
    s_mov_b32 s12, s42
    s_mov_b32 s13, s43
    s_mov_b32 s14, 2211840
    s_mov_b32 s15, 0x20000
    s_mul_i32 s69, s3, 573440
    s_mul_i32 s62, s53, 7340032
    s_mul_i32 s55, s3, 28672
    s_add_u32 s62, s62, s55
    s_add_u32 s62, s62, 180355072
    s_lshl_b32 s55, s60, 7
    s_add_u32 s69, s69, s55
    v_lshrrev_b32 v252, 4, v1
    v_bfe_u32 v253, v1, 2, 2
    v_and_b32 v254, 3, v1
    s_mul_i32 s67, s3, 40960
    v_lshrrev_b32 v250, 1, v252
    v_lshl_add_u32 v250, v250, 2, v253
    v_lshlrev_b32 v250, 7, v250
    v_and_b32 v251, 1, v252
    v_lshl_add_u32 v250, v251, 5, v250
    v_lshl_add_u32 v250, v254, 3, v250
    v_add_u32 v250, s67, v250
    v_lshrrev_b32 v249, 3, v1
    v_mul_u32_u24 v249, 1280, v249
    v_and_b32 v251, 7, v1
    v_lshl_add_u32 v249, v251, 4, v249
    s_add_u32 s56, s69, 0
    s_add_u32 m0, s67, 0
    s_nop 0
    buffer_load_dwordx4 v249, s[12:15], s56 offen lds
    s_add_u32 m0, m0, 1024
    s_add_u32 s56, s56, 10240
    buffer_load_dwordx4 v249, s[12:15], s56 offen lds
    s_add_u32 m0, m0, 1024
    s_add_u32 s56, s56, 10240
    buffer_load_dwordx4 v249, s[12:15], s56 offen lds
    s_add_u32 m0, m0, 1024
    s_add_u32 s56, s56, 10240
    buffer_load_dwordx4 v249, s[12:15], s56 offen lds
    s_add_u32 m0, m0, 1024
    s_add_u32 s56, s56, 10240
    buffer_load_dwordx4 v249, s[12:15], s56 offen lds
    s_add_u32 m0, m0, 1024
    s_add_u32 s56, s56, 10240
    buffer_load_dwordx4 v249, s[12:15], s56 offen lds
    s_add_u32 m0, m0, 1024
    s_add_u32 s56, s56, 10240
    buffer_load_dwordx4 v249, s[12:15], s56 offen lds
    s_add_u32 m0, m0, 1024
    s_add_u32 s56, s56, 10240
    buffer_load_dwordx4 v249, s[12:15], s56 offen lds
    s_add_u32 s56, s69, 81920
    s_add_u32 m0, s67, 8192
    s_nop 0
    buffer_load_dwordx4 v249, s[12:15], s56 offen lds
    s_add_u32 m0, m0, 1024
    s_add_u32 s56, s56, 10240
    buffer_load_dwordx4 v249, s[12:15], s56 offen lds
    s_add_u32 m0, m0, 1024
    s_add_u32 s56, s56, 10240
    buffer_load_dwordx4 v249, s[12:15], s56 offen lds
    s_add_u32 m0, m0, 1024
    s_add_u32 s56, s56, 10240
    buffer_load_dwordx4 v249, s[12:15], s56 offen lds
    s_add_u32 m0, m0, 1024
    s_add_u32 s56, s56, 10240
    buffer_load_dwordx4 v249, s[12:15], s56 offen lds
    s_add_u32 m0, m0, 1024
    s_add_u32 s56, s56, 10240
    buffer_load_dwordx4 v249, s[12:15], s56 offen lds
    s_add_u32 m0, m0, 1024
    s_add_u32 s56, s56, 10240
    buffer_load_dwordx4 v249, s[12:15], s56 offen lds
    s_add_u32 m0, m0, 1024
    s_add_u32 s56, s56, 10240
    buffer_load_dwordx4 v249, s[12:15], s56 offen lds
    s_add_u32 s56, s69, 163840
    s_add_u32 m0, s67, 16384
    s_nop 0
    buffer_load_dwordx4 v249, s[12:15], s56 offen lds
    s_add_u32 m0, m0, 1024
    s_add_u32 s56, s56, 10240
    buffer_load_dwordx4 v249, s[12:15], s56 offen lds
    s_add_u32 m0, m0, 1024
    s_add_u32 s56, s56, 10240
    buffer_load_dwordx4 v249, s[12:15], s56 offen lds
    s_add_u32 m0, m0, 1024
    s_add_u32 s56, s56, 10240
    buffer_load_dwordx4 v249, s[12:15], s56 offen lds
    s_add_u32 m0, m0, 1024
    s_add_u32 s56, s56, 10240
    buffer_load_dwordx4 v249, s[12:15], s56 offen lds
    s_add_u32 m0, m0, 1024
    s_add_u32 s56, s56, 10240
    buffer_load_dwordx4 v249, s[12:15], s56 offen lds
    s_add_u32 m0, m0, 1024
    s_add_u32 s56, s56, 10240
    buffer_load_dwordx4 v249, s[12:15], s56 offen lds
    s_add_u32 m0, m0, 1024
    s_add_u32 s56, s56, 10240
    buffer_load_dwordx4 v249, s[12:15], s56 offen lds
    s_add_u32 s56, s69, 245760
    s_add_u32 m0, s67, 24576
    s_nop 0
    buffer_load_dwordx4 v249, s[12:15], s56 offen lds
    s_add_u32 m0, m0, 1024
    s_add_u32 s56, s56, 10240
    buffer_load_dwordx4 v249, s[12:15], s56 offen lds
    s_add_u32 m0, m0, 1024
    s_add_u32 s56, s56, 10240
    buffer_load_dwordx4 v249, s[12:15], s56 offen lds
    s_add_u32 m0, m0, 1024
    s_add_u32 s56, s56, 10240
    buffer_load_dwordx4 v249, s[12:15], s56 offen lds
    s_add_u32 m0, m0, 1024
    s_add_u32 s56, s56, 10240
    buffer_load_dwordx4 v249, s[12:15], s56 offen lds
    s_add_u32 m0, m0, 1024
    s_add_u32 s56, s56, 10240
    buffer_load_dwordx4 v249, s[12:15], s56 offen lds
    s_add_u32 m0, m0, 1024
    s_add_u32 s56, s56, 10240
    buffer_load_dwordx4 v249, s[12:15], s56 offen lds
    s_add_u32 m0, m0, 1024
    s_add_u32 s56, s56, 10240
    buffer_load_dwordx4 v249, s[12:15], s56 offen lds
    s_add_u32 s56, s69, 327680
    s_add_u32 m0, s67, 32768
    s_nop 0
    buffer_load_dwordx4 v249, s[12:15], s56 offen lds
    s_add_u32 m0, m0, 1024
    s_add_u32 s56, s56, 10240
    buffer_load_dwordx4 v249, s[12:15], s56 offen lds
    s_add_u32 m0, m0, 1024
    s_add_u32 s56, s56, 10240
    buffer_load_dwordx4 v249, s[12:15], s56 offen lds
    s_add_u32 m0, m0, 1024
    s_add_u32 s56, s56, 10240
    buffer_load_dwordx4 v249, s[12:15], s56 offen lds
    s_add_u32 m0, m0, 1024
    s_add_u32 s56, s56, 10240
    buffer_load_dwordx4 v249, s[12:15], s56 offen lds
    s_add_u32 m0, m0, 1024
    s_add_u32 s56, s56, 10240
    buffer_load_dwordx4 v249, s[12:15], s56 offen lds
    s_add_u32 m0, m0, 1024
    s_add_u32 s56, s56, 10240
    buffer_load_dwordx4 v249, s[12:15], s56 offen lds
    s_add_u32 m0, m0, 1024
    s_add_u32 s56, s56, 10240
    buffer_load_dwordx4 v249, s[12:15], s56 offen lds
    s_waitcnt vmcnt(32)
    ds_read_b64_tr_b16 a[0:1], v250 offset:0
    ds_read_b64_tr_b16 a[2:3], v250 offset:2048
    ds_read_b64_tr_b16 a[4:5], v250 offset:64
    ds_read_b64_tr_b16 a[6:7], v250 offset:2112
    ds_read_b64_tr_b16 a[8:9], v250 offset:1024
    ds_read_b64_tr_b16 a[10:11], v250 offset:3072
    ds_read_b64_tr_b16 a[12:13], v250 offset:1088
    ds_read_b64_tr_b16 a[14:15], v250 offset:3136
    ds_read_b64_tr_b16 a[16:17], v250 offset:4096
    ds_read_b64_tr_b16 a[18:19], v250 offset:6144
    ds_read_b64_tr_b16 a[20:21], v250 offset:4160
    ds_read_b64_tr_b16 a[22:23], v250 offset:6208
    ds_read_b64_tr_b16 a[24:25], v250 offset:5120
    ds_read_b64_tr_b16 a[26:27], v250 offset:7168
    ds_read_b64_tr_b16 a[28:29], v250 offset:5184
    ds_read_b64_tr_b16 a[30:31], v250 offset:7232
    s_waitcnt lgkmcnt(0)
    s_add_u32 s56, s69, 409600
    s_add_u32 m0, s67, 0
    s_nop 0
    buffer_load_dwordx4 v249, s[12:15], s56 offen lds
    s_add_u32 m0, m0, 1024
    s_add_u32 s56, s56, 10240
    buffer_load_dwordx4 v249, s[12:15], s56 offen lds
    s_add_u32 m0, m0, 1024
    s_add_u32 s56, s56, 10240
    buffer_load_dwordx4 v249, s[12:15], s56 offen lds
    s_add_u32 m0, m0, 1024
    s_add_u32 s56, s56, 10240
    buffer_load_dwordx4 v249, s[12:15], s56 offen lds
    s_add_u32 m0, m0, 1024
    s_add_u32 s56, s56, 10240
    buffer_load_dwordx4 v249, s[12:15], s56 offen lds
    s_add_u32 m0, m0, 1024
    s_add_u32 s56, s56, 10240
    buffer_load_dwordx4 v249, s[12:15], s56 offen lds
    s_add_u32 m0, m0, 1024
    s_add_u32 s56, s56, 10240
    buffer_load_dwordx4 v249, s[12:15], s56 offen lds
    s_add_u32 m0, m0, 1024
    s_add_u32 s56, s56, 10240
    buffer_load_dwordx4 v249, s[12:15], s56 offen lds
    s_waitcnt vmcnt(32)
    ds_read_b64_tr_b16 a[32:33], v250 offset:8192
    ds_read_b64_tr_b16 a[34:35], v250 offset:10240
    ds_read_b64_tr_b16 a[36:37], v250 offset:8256
    ds_read_b64_tr_b16 a[38:39], v250 offset:10304
    ds_read_b64_tr_b16 a[40:41], v250 offset:9216
    ds_read_b64_tr_b16 a[42:43], v250 offset:11264
    ds_read_b64_tr_b16 a[44:45], v250 offset:9280
    ds_read_b64_tr_b16 a[46:47], v250 offset:11328
    ds_read_b64_tr_b16 a[48:49], v250 offset:12288
    ds_read_b64_tr_b16 a[50:51], v250 offset:14336
    ds_read_b64_tr_b16 a[52:53], v250 offset:12352
    ds_read_b64_tr_b16 a[54:55], v250 offset:14400
    ds_read_b64_tr_b16 a[56:57], v250 offset:13312
    ds_read_b64_tr_b16 a[58:59], v250 offset:15360
    ds_read_b64_tr_b16 a[60:61], v250 offset:13376
    ds_read_b64_tr_b16 a[62:63], v250 offset:15424
    s_waitcnt lgkmcnt(0)
    s_add_u32 s56, s69, 491520
    s_add_u32 m0, s67, 8192
    s_nop 0
    buffer_load_dwordx4 v249, s[12:15], s56 offen lds
    s_add_u32 m0, m0, 1024
    s_add_u32 s56, s56, 10240
    buffer_load_dwordx4 v249, s[12:15], s56 offen lds
    s_add_u32 m0, m0, 1024
    s_add_u32 s56, s56, 10240
    buffer_load_dwordx4 v249, s[12:15], s56 offen lds
    s_add_u32 m0, m0, 1024
    s_add_u32 s56, s56, 10240
    buffer_load_dwordx4 v249, s[12:15], s56 offen lds
    s_add_u32 m0, m0, 1024
    s_add_u32 s56, s56, 10240
    buffer_load_dwordx4 v249, s[12:15], s56 offen lds
    s_add_u32 m0, m0, 1024
    s_add_u32 s56, s56, 10240
    buffer_load_dwordx4 v249, s[12:15], s56 offen lds
    s_add_u32 m0, m0, 1024
    s_add_u32 s56, s56, 10240
    buffer_load_dwordx4 v249, s[12:15], s56 offen lds
    s_add_u32 m0, m0, 1024
    s_add_u32 s56, s56, 10240
    buffer_load_dwordx4 v249, s[12:15], s56 offen lds
    s_waitcnt vmcnt(32)
    ds_read_b64_tr_b16 a[64:65], v250 offset:16384
    ds_read_b64_tr_b16 a[66:67], v250 offset:18432
    ds_read_b64_tr_b16 a[68:69], v250 offset:16448
    ds_read_b64_tr_b16 a[70:71], v250 offset:18496
    ds_read_b64_tr_b16 a[72:73], v250 offset:17408
    ds_read_b64_tr_b16 a[74:75], v250 offset:19456
    ds_read_b64_tr_b16 a[76:77], v250 offset:17472
    ds_read_b64_tr_b16 a[78:79], v250 offset:19520
    ds_read_b64_tr_b16 a[80:81], v250 offset:20480
    ds_read_b64_tr_b16 a[82:83], v250 offset:22528
    ds_read_b64_tr_b16 a[84:85], v250 offset:20544
    ds_read_b64_tr_b16 a[86:87], v250 offset:22592
    ds_read_b64_tr_b16 a[88:89], v250 offset:21504
    ds_read_b64_tr_b16 a[90:91], v250 offset:23552
    ds_read_b64_tr_b16 a[92:93], v250 offset:21568
    ds_read_b64_tr_b16 a[94:95], v250 offset:23616
    s_waitcnt lgkmcnt(0)
    s_waitcnt vmcnt(24)
    ds_read_b64_tr_b16 a[96:97], v250 offset:24576
    ds_read_b64_tr_b16 a[98:99], v250 offset:26624
    ds_read_b64_tr_b16 a[100:101], v250 offset:24640
    ds_read_b64_tr_b16 a[102:103], v250 offset:26688
    ds_read_b64_tr_b16 a[104:105], v250 offset:25600
    ds_read_b64_tr_b16 a[106:107], v250 offset:27648
    ds_read_b64_tr_b16 a[108:109], v250 offset:25664
    ds_read_b64_tr_b16 a[110:111], v250 offset:27712
    ds_read_b64_tr_b16 a[112:113], v250 offset:28672
    ds_read_b64_tr_b16 a[114:115], v250 offset:30720
    ds_read_b64_tr_b16 a[116:117], v250 offset:28736
    ds_read_b64_tr_b16 a[118:119], v250 offset:30784
    ds_read_b64_tr_b16 a[120:121], v250 offset:29696
    ds_read_b64_tr_b16 a[122:123], v250 offset:31744
    ds_read_b64_tr_b16 a[124:125], v250 offset:29760
    ds_read_b64_tr_b16 a[126:127], v250 offset:31808
    s_waitcnt lgkmcnt(0)
    s_waitcnt vmcnt(16)
    ds_read_b64_tr_b16 a[128:129], v250 offset:32768
    ds_read_b64_tr_b16 a[130:131], v250 offset:34816
    ds_read_b64_tr_b16 a[132:133], v250 offset:32832
    ds_read_b64_tr_b16 a[134:135], v250 offset:34880
    ds_read_b64_tr_b16 a[136:137], v250 offset:33792
    ds_read_b64_tr_b16 a[138:139], v250 offset:35840
    ds_read_b64_tr_b16 a[140:141], v250 offset:33856
    ds_read_b64_tr_b16 a[142:143], v250 offset:35904
    ds_read_b64_tr_b16 a[144:145], v250 offset:36864
    ds_read_b64_tr_b16 a[146:147], v250 offset:38912
    ds_read_b64_tr_b16 a[148:149], v250 offset:36928
    ds_read_b64_tr_b16 a[150:151], v250 offset:38976
    ds_read_b64_tr_b16 a[152:153], v250 offset:37888
    ds_read_b64_tr_b16 a[154:155], v250 offset:39936
    ds_read_b64_tr_b16 a[156:157], v250 offset:37952
    ds_read_b64_tr_b16 a[158:159], v250 offset:40000
    s_waitcnt lgkmcnt(0)
    s_waitcnt vmcnt(8)
    ds_read_b64_tr_b16 a[160:161], v250 offset:0
    ds_read_b64_tr_b16 a[162:163], v250 offset:2048
    ds_read_b64_tr_b16 a[164:165], v250 offset:64
    ds_read_b64_tr_b16 a[166:167], v250 offset:2112
    ds_read_b64_tr_b16 a[168:169], v250 offset:1024
    ds_read_b64_tr_b16 a[170:171], v250 offset:3072
    ds_read_b64_tr_b16 a[172:173], v250 offset:1088
    ds_read_b64_tr_b16 a[174:175], v250 offset:3136
    ds_read_b64_tr_b16 a[176:177], v250 offset:4096
    ds_read_b64_tr_b16 a[178:179], v250 offset:6144
    ds_read_b64_tr_b16 a[180:181], v250 offset:4160
    ds_read_b64_tr_b16 a[182:183], v250 offset:6208
    ds_read_b64_tr_b16 a[184:185], v250 offset:5120
    ds_read_b64_tr_b16 a[186:187], v250 offset:7168
    ds_read_b64_tr_b16 a[188:189], v250 offset:5184
    ds_read_b64_tr_b16 a[190:191], v250 offset:7232
    s_waitcnt lgkmcnt(0)
    s_waitcnt vmcnt(0)
    ds_read_b64_tr_b16 a[192:193], v250 offset:8192
    ds_read_b64_tr_b16 a[194:195], v250 offset:10240
    ds_read_b64_tr_b16 a[196:197], v250 offset:8256
    ds_read_b64_tr_b16 a[198:199], v250 offset:10304
    ds_read_b64_tr_b16 a[200:201], v250 offset:9216
    ds_read_b64_tr_b16 a[202:203], v250 offset:11264
    ds_read_b64_tr_b16 a[204:205], v250 offset:9280
    ds_read_b64_tr_b16 a[206:207], v250 offset:11328
    ds_read_b64_tr_b16 a[208:209], v250 offset:12288
    ds_read_b64_tr_b16 a[210:211], v250 offset:14336
    ds_read_b64_tr_b16 a[212:213], v250 offset:12352
    ds_read_b64_tr_b16 a[214:215], v250 offset:14400
    ds_read_b64_tr_b16 a[216:217], v250 offset:13312
    ds_read_b64_tr_b16 a[218:219], v250 offset:15360
    ds_read_b64_tr_b16 a[220:221], v250 offset:13376
    ds_read_b64_tr_b16 a[222:223], v250 offset:15424
    s_waitcnt lgkmcnt(0)
L_ff2_con:
    v_lshlrev_b32 v2, 4, v1
    s_lshl_b32 s58, s60, 2
    s_add_u32 s58, s58, s3
    s_lshl_b32 s55, s53, 5
    s_mul_i32 s56, s3, 7
    s_add_u32 s55, s55, s56
    s_add_u32 s55, s55, 160
    v_min_u32 v3, 6, v1
    v_add_u32 v3, s55, v3
    v_lshlrev_b32 v3, 7, v3
    v_mov_b32 v6, 1
    s_add_u32 s55, s53, 2
    s_mul_i32 s63, s55, 2621440
    s_lshl_b32 s55, s58, 10
    s_add_u32 s63, s63, s55
    s_add_u32 s63, s63, 196083712
    s_mov_b32 s20, s48
    s_mov_b32 s21, s49
    s_mov_b32 s22, 260046848
    s_mov_b32 s23, 0x20000
    s_sub_u32 s64, s63, 2621440
    v_mov_b32 v9, v2
    s_add_u32 s65, s58, 40
    s_cmp_eq_u32 s53, 0
    s_cbranch_scc1 L_ff2_c0
    s_mov_b32 s20, s44
    s_mov_b32 s21, s45
    s_mov_b32 s22, 2621440
    s_mov_b32 s23, 0x20000
    s_lshl_b32 s64, s58, 5
    v_and_b32 v9, 31, v1
    v_mul_u32_u24 v9, 1280, v9
    v_lshrrev_b32 v5, 5, v1
    v_lshl_add_u32 v9, v5, 4, v9
    s_add_u32 s65, s58, 960
L_ff2_c0:
    s_lshl_b32 s65, s65, 7
    v_and_b32 v7, 31, v1
    v_mul_u32_u24 v7, 272, v7
    v_lshrrev_b32 v5, 5, v1
    v_lshl_add_u32 v8, v5, 5, v7
    v_lshl_add_u32 v7, v5, 4, v7
    s_mul_i32 s55, s3, 8704
    v_add_u32 v7, s55, v7
    s_lshl_b32 s55, s3, 6
    v_add_u32 v8, s55, v8
    v_mov_b32 v12, 128
Lp_123:
    buffer_load_dword v5, v12, s[8:11], 0 offen sc1
    s_waitcnt vmcnt(0)
    v_cmp_gt_i32 vcc, 1, v5
    s_cbranch_vccz Lpd_124
    s_sleep 8
    s_mov_b32 s54, 48
    s_sub_u32 s52, s52, 1
    s_cbranch_scc1 L_abort
    s_branch Lp_123
Lpd_124:
    s_mov_b32 s61, 0
    s_barrier
    s_mov_b32 s70, 262144000
    v_mov_b32 v10, 0x80000000
    v_mov_b32 v11, 0
    v_mbcnt_lo_u32_b32 v5, -1, 0
    v_and_b32 v5, 1, v5
    v_lshlrev_b32 v5, 2, v5
    s_lshl_b32 s55, s50, 3
    buffer_load_dword v5, v5, s[8:11], s55 offen sc1
    s_getreg_b32 s55, hwreg(HW_REG_XCC_ID)
    s_and_b32 s55, s55, 7
    s_lshl_b32 s55, s55, 3
    s_lshl_b64 s[56:57], 0xff, s55
    s_waitcnt vmcnt(0)
    v_readlane_b32 s96, v5, 0
    v_readlane_b32 s97, v5, 1
    s_andn2_b64 s[56:57], s[96:97], s[56:57]
    s_cselect_b32 s72, 1, 0
    s_add_u32 s73, s53, 4
    s_mul_i32 s73, s73, 40
    s_lshl_b32 s55, s60, 2
    s_add_u32 s73, s73, s55
    s_add_u32 s73, s73, s3
    s_add_u32 s73, s73, 6272
    s_lshl_b32 s73, s73, 7
    v_min_u32 v58, 22, v1
    s_mul_i32 s55, s60, 23
    v_add_u32 v58, s55, v58
    v_min_u32 v58, 223, v58
    v_lshlrev_b32 v58, 7, v58
    s_add_u32 s59, s62, 0
    buffer_load_dword v59, v58, s[4:7], s59 offen sc1
    s_add_u32 s59, s62, 114688
    buffer_load_dword v59, v58, s[4:7], s59 offen sc1
    s_add_u32 s59, s62, 229376
    buffer_load_dword v59, v58, s[4:7], s59 offen sc1
    s_add_u32 s59, s62, 344064
    buffer_load_dword v59, v58, s[4:7], s59 offen sc1
    s_mov_b32 s71, 0
L_ff2_loop:
    v_add_u32 v4, s61, v6
    s_cmp_lg_u32 s71, 0
    s_cbranch_scc1 L_ff2_go
    v_cmp_gt_i32 vcc, v4, v10
    s_cbranch_vccz L_ff2_rdy
L_ff2_poll:
    buffer_load_dword v5, v3, s[4:7], 0 offen sc1
    s_waitcnt vmcnt(0)
    buffer_store_dword v11, off, s[4:7], s70 sc1
    s_mov_b32 s70, 262144000
    v_cmp_gt_i32 vcc, v4, v5
    s_cbranch_vccz L_ff2_rdy
    s_sleep 1
    s_mov_b32 s54, 49
    s_sub_u32 s52, s52, 1
    s_cbranch_scc1 L_abort
    s_branch L_ff2_poll
L_ff2_rdy:
    s_mov_b32 s56, s62
    buffer_load_dwordx4 v[64:67], v2, s[4:7], s56 offen offset:0 sc1
    buffer_load_dwordx4 v[68:71], v2, s[4:7], s56 offen offset:1024 sc1
    buffer_load_dwordx4 v[72:75], v2, s[4:7], s56 offen offset:2048 sc1
    buffer_load_dwordx4 v[76:79], v2, s[4:7], s56 offen offset:3072 sc1
    s_add_u32 s56, s56, 4096
    buffer_load_dwordx4 v[80:83], v2, s[4:7], s56 offen offset:0 sc1
    buffer_load_dwordx4 v[84:87], v2, s[4:7], s56 offen offset:1024 sc1
    buffer_load_dwordx4 v[88:91], v2, s[4:7], s56 offen offset:2048 sc1
    buffer_load_dwordx4 v[92:95], v2, s[4:7], s56 offen offset:3072 sc1
    s_waitcnt vmcnt(8)
    buffer_store_dword v11, off, s[4:7], s70 sc1
    s_mov_b32 s70, 262144000
L_ff2_go:
    s_add_u32 s55, s61, 1
    s_and_b32 s55, s55, 3
    s_cselect_b32 s55, 0, 458752
    s_sub_u32 s62, s62, s55
    s_add_u32 s62, s62, 114688
    v_add_u32 v4, 1, v4
    buffer_load_dword v5, v3, s[4:7], 0 offen sc1
    s_add_u32 s56, s56, 4096
    buffer_load_dwordx4 v[96:99], v2, s[4:7], s56 offen offset:0 sc1
    s_waitcnt vmcnt(9)
    v_mfma_f32_32x32x16_bf16 v[24:39], a[0:3], v[64:67], 0
    v_mfma_f32_32x32x16_bf16 v[40:55], a[4:7], v[64:67], 0
    buffer_load_dwordx4 v[100:103], v2, s[4:7], s56 offen offset:1024 sc1
    s_waitcnt vmcnt(9)
    v_mfma_f32_32x32x16_bf16 v[24:39], a[8:11], v[68:71], v[24:39]
    v_mfma_f32_32x32x16_bf16 v[40:55], a[12:15], v[68:71], v[40:55]
    buffer_load_dwordx4 v[104:107], v2, s[4:7], s56 offen offset:2048 sc1
    s_waitcnt vmcnt(9)
    v_mfma_f32_32x32x16_bf16 v[24:39], a[16:19], v[72:75], v[24:39]
    v_mfma_f32_32x32x16_bf16 v[40:55], a[20:23], v[72:75], v[40:55]
    buffer_load_dwordx4 v[108:111], v2, s[4:7], s56 offen offset:3072 sc1
    s_waitcnt vmcnt(9)
    v_mfma_f32_32x32x16_bf16 v[24:39], a[24:27], v[76:79], v[24:39]
    v_mfma_f32_32x32x16_bf16 v[40:55], a[28:31], v[76:79], v[40:55]
    s_add_u32 s56, s56, 4096
    buffer_load_dwordx4 v[112:115], v2, s[4:7], s56 offen offset:0 sc1
    s_waitcnt vmcnt(9)
    v_mfma_f32_32x32x16_bf16 v[24:39], a[32:35], v[80:83], v[24:39]
    v_mfma_f32_32x32x16_bf16 v[40:55], a[36:39], v[80:83], v[40:55]
    buffer_load_dwordx4 v[116:119], v2, s[4:7], s56 offen offset:1024 sc1
    s_waitcnt vmcnt(9)
    v_mfma_f32_32x32x16_bf16 v[24:39], a[40:43], v[84:87], v[24:39]
    v_mfma_f32_32x32x16_bf16 v[40:55], a[44:47], v[84:87], v[40:55]
    buffer_load_dwordx4 v[120:123], v2, s[4:7], s56 offen offset:2048 sc1
    s_waitcnt vmcnt(9)
    v_mfma_f32_32x32x16_bf16 v[24:39], a[48:51], v[88:91], v[24:39]
    v_mfma_f32_32x32x16_bf16 v[40:55], a[52:55], v[88:91], v[40:55]
    buffer_load_dwordx4 v[124:127], v2, s[4:7], s56 offen offset:3072 sc1
    s_waitcnt vmcnt(9)
    v_mfma_f32_32x32x16_bf16 v[24:39], a[56:59], v[92:95], v[24:39]
    v_mfma_f32_32x32x16_bf16 v[40:55], a[60:63], v[92:95], v[40:55]
    s_add_u32 s56, s56, 4096
    buffer_load_dwordx4 v[128:131], v2, s[4:7], s56 offen offset:0 sc1
    s_waitcnt vmcnt(8)
    v_mfma_f32_32x32x16_bf16 v[24:39], a[64:67], v[96:99], v[24:39]
    v_mfma_f32_32x32x16_bf16 v[40:55], a[68:71], v[96:99], v[40:55]
    buffer_load_dwordx4 v[132:135], v2, s[4:7], s56 offen offset:1024 sc1
    s_waitcnt vmcnt(8)
    v_mfma_f32_32x32x16_bf16 v[24:39], a[72:75], v[100:103], v[24:39]
    v_mfma_f32_32x32x16_bf16 v[40:55], a[76:79], v[100:103], v[40:55]
    s_cmp_eq_u32 s70, 262144000
    s_cbranch_scc1 L_ff2_np
    s_waitcnt vmcnt(11)
    buffer_store_dword v11, off, s[4:7], s70 sc1
    s_mov_b32 s70, 262144000
L_ff2_np:
    buffer_load_dwordx4 v[136:139], v2, s[4:7], s56 offen offset:2048 sc1
    s_waitcnt vmcnt(8)
    v_mfma_f32_32x32x16_bf16 v[24:39], a[80:83], v[104:107], v[24:39]
    v_mfma_f32_32x32x16_bf16 v[40:55], a[84:87], v[104:107], v[40:55]
    buffer_load_dwordx4 v[140:143], v2, s[4:7], s56 offen offset:3072 sc1
    s_waitcnt vmcnt(8)
    v_mfma_f32_32x32x16_bf16 v[24:39], a[88:91], v[108:111], v[24:39]
    v_mfma_f32_32x32x16_bf16 v[40:55], a[92:95], v[108:111], v[40:55]
    s_add_u32 s56, s56, 4096
    buffer_load_dwordx4 v[144:147], v2, s[4:7], s56 offen offset:0 sc1
    s_waitcnt vmcnt(8)
    v_mfma_f32_32x32x16_bf16 v[24:39], a[96:99], v[112:115], v[24:39]
    v_mfma_f32_32x32x16_bf16 v[40:55], a[100:103], v[112:115], v[40:55]
    buffer_load_dwordx4 v[148:151], v2, s[4:7], s56 offen offset:1024 sc1
    s_waitcnt vmcnt(8)
    v_mfma_f32_32x32x16_bf16 v[24:39], a[104:107], v[116:119], v[24:39]
    v_mfma_f32_32x32x16_bf16 v[40:55], a[108:111], v[116:119], v[40:55]
    buffer_load_dwordx4 v[152:155], v2, s[4:7], s56 offen offset:2048 sc1
    s_waitcnt vmcnt(8)
    v_mfma_f32_32x32x16_bf16 v[24:39], a[112:115], v[120:123], v[24:39]
    v_mfma_f32_32x32x16_bf16 v[40:55], a[116:119], v[120:123], v[40:55]
    buffer_load_dwordx4 v[156:159], v2, s[4:7], s56 offen offset:3072 sc1
    s_waitcnt vmcnt(8)
    v_mfma_f32_32x32x16_bf16 v[24:39], a[120:123], v[124:127], v[24:39]
    v_mfma_f32_32x32x16_bf16 v[40:55], a[124:127], v[124:127], v[40:55]
    s_add_u32 s56, s56, 4096
    buffer_load_dwordx4 v[160:163], v2, s[4:7], s56 offen offset:0 sc1
    s_waitcnt vmcnt(8)
    v_mfma_f32_32x32x16_bf16 v[24:39], a[128:131], v[128:131], v[24:39]
    v_mfma_f32_32x32x16_bf16 v[40:55], a[132:135], v[128:131], v[40:55]
    buffer_load_dwordx4 v[164:167], v2, s[4:7], s56 offen offset:1024 sc1
    s_waitcnt vmcnt(8)
    v_mfma_f32_32x32x16_bf16 v[24:39], a[136:139], v[132:135], v[24:39]
    v_mfma_f32_32x32x16_bf16 v[40:55], a[140:143], v[132:135], v[40:55]
    buffer_load_dwordx4 v[168:171], v2, s[4:7], s56 offen offset:2048 sc1
    s_waitcnt vmcnt(8)
    v_mfma_f32_32x32x16_bf16 v[24:39], a[144:147], v[136:139], v[24:39]
    v_mfma_f32_32x32x16_bf16 v[40:55], a[148:151], v[136:139], v[40:55]
    buffer_load_dwordx4 v[172:175], v2, s[4:7], s56 offen offset:3072 sc1
    s_waitcnt vmcnt(8)
    v_mfma_f32_32x32x16_bf16 v[24:39], a[152:155], v[140:143], v[24:39]
    v_mfma_f32_32x32x16_bf16 v[40:55], a[156:159], v[140:143], v[40:55]
    buffer_load_dwordx4 v[12:15], v2, s[4:7], s63 offen sc1
    s_add_u32 s55, s61, 1
    s_and_b32 s55, s55, 7
    s_cselect_b32 s55, 0, 327680
    s_sub_u32 s63, s63, s55
    s_add_u32 s63, s63, 40960
    s_add_u32 s61, s61, 1
    buffer_store_dword v11, off, s[4:7], s70 sc1
    s_mov_b32 s70, 262144000
    v_cmp_gt_i32 vcc, v4, v5
    s_mov_b32 s71, 0
    s_cbranch_vccnz L_ff2_nostr
    s_mov_b32 s71, 1
    s_waitcnt vmcnt(9)
    v_mfma_f32_32x32x16_bf16 v[24:39], a[160:163], v[144:147], v[24:39]
    v_mfma_f32_32x32x16_bf16 v[40:55], a[164:167], v[144:147], v[40:55]
    s_mov_b32 s56, s62
    buffer_load_dwordx4 v[64:67], v2, s[4:7], s56 offen offset:0 sc1
    s_waitcnt vmcnt(9)
    v_mfma_f32_32x32x16_bf16 v[24:39], a[168:171], v[148:151], v[24:39]
    v_mfma_f32_32x32x16_bf16 v[40:55], a[172:175], v[148:151], v[40:55]
    buffer_load_dwordx4 v[68:71], v2, s[4:7], s56 offen offset:1024 sc1
    s_waitcnt vmcnt(9)
    v_mfma_f32_32x32x16_bf16 v[24:39], a[176:179], v[152:155], v[24:39]
    v_mfma_f32_32x32x16_bf16 v[40:55], a[180:183], v[152:155], v[40:55]
    buffer_load_dwordx4 v[72:75], v2, s[4:7], s56 offen offset:2048 sc1
    s_waitcnt vmcnt(9)
    v_mfma_f32_32x32x16_bf16 v[24:39], a[184:187], v[156:159], v[24:39]
    v_mfma_f32_32x32x16_bf16 v[40:55], a[188:191], v[156:159], v[40:55]
    buffer_load_dwordx4 v[76:79], v2, s[4:7], s56 offen offset:3072 sc1
    s_waitcnt vmcnt(9)
    v_mfma_f32_32x32x16_bf16 v[24:39], a[192:195], v[160:163], v[24:39]
    v_mfma_f32_32x32x16_bf16 v[40:55], a[196:199], v[160:163], v[40:55]
    s_add_u32 s56, s56, 4096
    buffer_load_dwordx4 v[80:83], v2, s[4:7], s56 offen offset:0 sc1
    s_waitcnt vmcnt(9)
    v_mfma_f32_32x32x16_bf16 v[24:39], a[200:203], v[164:167], v[24:39]
    v_mfma_f32_32x32x16_bf16 v[40:55], a[204:207], v[164:167], v[40:55]
    buffer_load_dwordx4 v[84:87], v2, s[4:7], s56 offen offset:1024 sc1
    s_waitcnt vmcnt(9)
    v_mfma_f32_32x32x16_bf16 v[24:39], a[208:211], v[168:171], v[24:39]
    v_mfma_f32_32x32x16_bf16 v[40:55], a[212:215], v[168:171], v[40:55]
    buffer_load_dwordx4 v[88:91], v2, s[4:7], s56 offen offset:2048 sc1
    s_waitcnt vmcnt(9)
    v_mfma_f32_32x32x16_bf16 v[24:39], a[216:219], v[172:175], v[24:39]
    v_mfma_f32_32x32x16_bf16 v[40:55], a[220:223], v[172:175], v[40:55]
    buffer_load_dwordx4 v[92:95], v2, s[4:7], s56 offen offset:3072 sc1
    s_branch L_ff2_epi
L_ff2_nostr:
    s_waitcnt vmcnt(9)
    v_mfma_f32_32x32x16_bf16 v[24:39], a[160:163], v[144:147], v[24:39]
    v_mfma_f32_32x32x16_bf16 v[40:55], a[164:167], v[144:147], v[40:55]
    s_waitcnt vmcnt(8)
    v_mfma_f32_32x32x16_bf16 v[24:39], a[168:171], v[148:151], v[24:39]
    v_mfma_f32_32x32x16_bf16 v[40:55], a[172:175], v[148:151], v[40:55]
    s_waitcnt vmcnt(7)
    v_mfma_f32_32x32x16_bf16 v[24:39], a[176:179], v[152:155], v[24:39]
    v_mfma_f32_32x32x16_bf16 v[40:55], a[180:183], v[152:155], v[40:55]
    s_waitcnt vmcnt(6)
    v_mfma_f32_32x32x16_bf16 v[24:39], a[184:187], v[156:159], v[24:39]
    v_mfma_f32_32x32x16_bf16 v[40:55], a[188:191], v[156:159], v[40:55]
    s_waitcnt vmcnt(5)
    v_mfma_f32_32x32x16_bf16 v[24:39], a[192:195], v[160:163], v[24:39]
    v_mfma_f32_32x32x16_bf16 v[40:55], a[196:199], v[160:163], v[40:55]
    s_waitcnt vmcnt(4)
    v_mfma_f32_32x32x16_bf16 v[24:39], a[200:203], v[164:167], v[24:39]
    v_mfma_f32_32x32x16_bf16 v[40:55], a[204:207], v[164:167], v[40:55]
    s_waitcnt vmcnt(3)
    v_mfma_f32_32x32x16_bf16 v[24:39], a[208:211], v[168:171], v[24:39]
    v_mfma_f32_32x32x16_bf16 v[40:55], a[212:215], v[168:171], v[40:55]
    s_waitcnt vmcnt(2)
    v_mfma_f32_32x32x16_bf16 v[24:39], a[216:219], v[172:175], v[24:39]
    v_mfma_f32_32x32x16_bf16 v[40:55], a[220:223], v[172:175], v[40:55]
L_ff2_epi:
    v_mov_b32 v59, s61
    s_cmp_lg_u32 s72, 0
    s_cbranch_scc1 Lls_125
    buffer_store_dword v59, off, s[4:7], s73
Lld_126:
    buffer_load_dword v10, v3, s[4:7], 0 offen sc1
    s_nop 5
    ds_write_b128 v7, v[24:27] offset:0
    ds_write_b128 v7, v[28:31] offset:32
    ds_write_b128 v7, v[32:35] offset:64
    ds_write_b128 v7, v[36:39] offset:96
    ds_write_b128 v7, v[40:43] offset:128
    ds_write_b128 v7, v[44:47] offset:160
    ds_write_b128 v7, v[48:51] offset:192
    ds_write_b128 v7, v[52:55] offset:224
    s_waitcnt lgkmcnt(0)
    s_barrier
    ds_read_b128 v[192:195], v8 offset:0
    ds_read_b128 v[196:199], v8 offset:16
    ds_read_b128 v[200:203], v8 offset:8704
    ds_read_b128 v[204:207], v8 offset:8720
    ds_read_b128 v[208:211], v8 offset:17408
    ds_read_b128 v[212:215], v8 offset:17424
    ds_read_b128 v[216:219], v8 offset:26112
    ds_read_b128 v[220:223], v8 offset:26128
    v_xor_b32 v7, 0x10000, v7
    v_xor_b32 v8, 0x10000, v8
    s_waitcnt lgkmcnt(4)
    v_add_f32 v192, v192, v200
    v_add_f32 v193, v193, v201
    v_add_f32 v194, v194, v202
    v_add_f32 v195, v195, v203
    v_add_f32 v196, v196, v204
    v_add_f32 v197, v197, v205
    v_add_f32 v198, v198, v206
    v_add_f32 v199, v199, v207
    s_waitcnt lgkmcnt(0)
    v_add_f32 v208, v208, v216
    v_add_f32 v209, v209, v217
    v_add_f32 v210, v210, v218
    v_add_f32 v211, v211, v219
    v_add_f32 v212, v212, v220
    v_add_f32 v213, v213, v221
    v_add_f32 v214, v214, v222
    v_add_f32 v215, v215, v223
    v_add_f32 v192, v192, v208
    v_add_f32 v193, v193, v209
    v_add_f32 v194, v194, v210
    v_add_f32 v195, v195, v211
    v_add_f32 v196, v196, v212
    v_add_f32 v197, v197, v213
    v_add_f32 v198, v198, v214
    v_add_f32 v199, v199, v215
    s_waitcnt vmcnt(1)
    v_cvt_pk_bf16_f32 v200, v192, v193
    v_cvt_pk_bf16_f32 v201, v194, v195
    v_cvt_pk_bf16_f32 v202, v196, v197
    v_cvt_pk_bf16_f32 v203, v198, v199
    v_lshlrev_b32 v192, 16, v200
    v_and_b32 v193, 0xffff0000, v200
    v_lshlrev_b32 v208, 16, v12
    v_and_b32 v209, 0xffff0000, v12
    v_lshlrev_b32 v194, 16, v201
    v_and_b32 v195, 0xffff0000, v201
    v_lshlrev_b32 v210, 16, v13
    v_and_b32 v211, 0xffff0000, v13
    v_lshlrev_b32 v196, 16, v202
    v_and_b32 v197, 0xffff0000, v202
    v_lshlrev_b32 v212, 16, v14
    v_and_b32 v213, 0xffff0000, v14
    v_lshlrev_b32 v198, 16, v203
    v_and_b32 v199, 0xffff0000, v203
    v_lshlrev_b32 v214, 16, v15
    v_and_b32 v215, 0xffff0000, v15
    v_add_f32 v192, v192, v208
    v_add_f32 v193, v193, v209
    v_add_f32 v194, v194, v210
    v_add_f32 v195, v195, v211
    v_add_f32 v196, v196, v212
    v_add_f32 v197, v197, v213
    v_add_f32 v198, v198, v214
    v_add_f32 v199, v199, v215
    v_cvt_pk_bf16_f32 v200, v192, v193
    v_cvt_pk_bf16_f32 v201, v194, v195
    v_cvt_pk_bf16_f32 v202, v196, v197
    v_cvt_pk_bf16_f32 v203, v198, v199
    s_xor_b32 s58, s53, 1
    s_cmp_lg_u32 s58, 0
    s_cbranch_scc1 Lls_127
    buffer_store_dwordx4 v[200:203], v9, s[20:23], s64 offen
Lld_128:
    s_add_u32 s55, s61, 0
    s_and_b32 s55, s55, 63
    s_cselect_b32 s55, 0, 2621440
    s_sub_u32 s64, s64, s55
    s_add_u32 s64, s64, 40960
    v_mov_b32 v11, s61
    s_mov_b32 s70, s65
    s_waitcnt vmcnt(1)
    s_cmp_lt_u32 s61, 64
    s_cbranch_scc1 L_ff2_loop
    s_waitcnt vmcnt(0)
    buffer_store_dword v11, off, s[4:7], s70 sc1
    s_mov_b32 s70, 262144000
    s_endpgm
L_role_woc:
    s_mov_b32 s12, s34
    s_mov_b32 s13, s35
    s_mov_b32 s14, 5242880
    s_mov_b32 s15, 0x20000
    s_sub_u32 s60, s51, 16
    v_lshrrev_b32 v252, 4, v1
    v_bfe_u32 v253, v1, 2, 2
    v_and_b32 v254, 3, v1
    v_mov_b32 v2, 0x4444
    v_mov_b32 v5, 0xeeee
    v_and_b32 v251, 2, v1
    v_cmp_ne_u32 vcc, 0, v251
    s_nop 1
    v_cndmask_b32 v2, v2, v5, vcc
    s_mul_i32 s63, s3, 40960
    v_and_b32 v250, 1, v252
    v_lshlrev_b32 v250, 4, v250
    v_lshrrev_b32 v251, 1, v252
    v_lshl_add_u32 v250, v251, 3, v250
    v_lshrrev_b32 v251, 1, v253
    v_lshl_add_u32 v250, v251, 2, v250
    v_and_b32 v251, 1, v253
    v_add_u32 v250, v251, v250
    v_lshlrev_b32 v250, 7, v250
    v_lshl_add_u32 v250, v254, 3, v250
    v_add_u32 v120, s63, v250
    v_lshlrev_b32 v3, 4, v1
    v_lshrrev_b32 v121, 3, v1
    v_mul_u32_u24 v121, 1280, v121
    v_and_b32 v251, 7, v1
    v_lshl_add_u32 v121, v251, 4, v121
    s_mul_i32 s58, s3, 655360
    s_mul_i32 s55, s60, 96
    s_add_u32 s58, s58, s55
    s_xor_b32 s55, s50, 1
    s_mul_i32 s55, s55, 2621440
    s_add_u32 s59, s58, s55
    s_mul_i32 s55, s50, 2621440
    s_add_u32 s58, s58, s55
    s_add_u32 s56, s58, 0
    s_add_u32 m0, s63, 0
    s_nop 0
    buffer_load_dwordx4 v121, s[12:15], s56 offen lds
    s_add_u32 m0, m0, 1024
    s_add_u32 s56, s56, 10240
    buffer_load_dwordx4 v121, s[12:15], s56 offen lds
    s_add_u32 m0, m0, 1024
    s_add_u32 s56, s56, 10240
    buffer_load_dwordx4 v121, s[12:15], s56 offen lds
    s_add_u32 m0, m0, 1024
    s_add_u32 s56, s56, 10240
    buffer_load_dwordx4 v121, s[12:15], s56 offen lds
    s_add_u32 m0, m0, 1024
    s_add_u32 s56, s56, 10240
    buffer_load_dwordx4 v121, s[12:15], s56 offen lds
    s_add_u32 m0, m0, 1024
    s_add_u32 s56, s56, 10240
    buffer_load_dwordx4 v121, s[12:15], s56 offen lds
    s_add_u32 m0, m0, 1024
    s_add_u32 s56, s56, 10240
    buffer_load_dwordx4 v121, s[12:15], s56 offen lds
    s_add_u32 m0, m0, 1024
    s_add_u32 s56, s56, 10240
    buffer_load_dwordx4 v121, s[12:15], s56 offen lds
    s_add_u32 s56, s58, 81920
    s_add_u32 m0, s63, 8192
    s_nop 0
    buffer_load_dwordx4 v121, s[12:15], s56 offen lds
    s_add_u32 m0, m0, 1024
    s_add_u32 s56, s56, 10240
    buffer_load_dwordx4 v121, s[12:15], s56 offen lds
    s_add_u32 m0, m0, 1024
    s_add_u32 s56, s56, 10240
    buffer_load_dwordx4 v121, s[12:15], s56 offen lds
    s_add_u32 m0, m0, 1024
    s_add_u32 s56, s56, 10240
    buffer_load_dwordx4 v121, s[12:15], s56 offen lds
    s_add_u32 m0, m0, 1024
    s_add_u32 s56, s56, 10240
    buffer_load_dwordx4 v121, s[12:15], s56 offen lds
    s_add_u32 m0, m0, 1024
    s_add_u32 s56, s56, 10240
    buffer_load_dwordx4 v121, s[12:15], s56 offen lds
    s_add_u32 m0, m0, 1024
    s_add_u32 s56, s56, 10240
    buffer_load_dwordx4 v121, s[12:15], s56 offen lds
    s_add_u32 m0, m0, 1024
    s_add_u32 s56, s56, 10240
    buffer_load_dwordx4 v121, s[12:15], s56 offen lds
    s_add_u32 s56, s58, 163840
    s_add_u32 m0, s63, 16384
    s_nop 0
    buffer_load_dwordx4 v121, s[12:15], s56 offen lds
    s_add_u32 m0, m0, 1024
    s_add_u32 s56, s56, 10240
    buffer_load_dwordx4 v121, s[12:15], s56 offen lds
    s_add_u32 m0, m0, 1024
    s_add_u32 s56, s56, 10240
    buffer_load_dwordx4 v121, s[12:15], s56 offen lds
    s_add_u32 m0, m0, 1024
    s_add_u32 s56, s56, 10240
    buffer_load_dwordx4 v121, s[12:15], s56 offen lds
    s_add_u32 m0, m0, 1024
    s_add_u32 s56, s56, 10240
    buffer_load_dwordx4 v121, s[12:15], s56 offen lds
    s_add_u32 m0, m0, 1024
    s_add_u32 s56, s56, 10240
    buffer_load_dwordx4 v121, s[12:15], s56 offen lds
    s_add_u32 m0, m0, 1024
    s_add_u32 s56, s56, 10240
    buffer_load_dwordx4 v121, s[12:15], s56 offen lds
    s_add_u32 m0, m0, 1024
    s_add_u32 s56, s56, 10240
    buffer_load_dwordx4 v121, s[12:15], s56 offen lds
    s_add_u32 s56, s58, 245760
    s_add_u32 m0, s63, 24576
    s_nop 0
    buffer_load_dwordx4 v121, s[12:15], s56 offen lds
    s_add_u32 m0, m0, 1024
    s_add_u32 s56, s56, 10240
    buffer_load_dwordx4 v121, s[12:15], s56 offen lds
    s_add_u32 m0, m0, 1024
    s_add_u32 s56, s56, 10240
    buffer_load_dwordx4 v121, s[12:15], s56 offen lds
    s_add_u32 m0, m0, 1024
    s_add_u32 s56, s56, 10240
    buffer_load_dwordx4 v121, s[12:15], s56 offen lds
    s_add_u32 m0, m0, 1024
    s_add_u32 s56, s56, 10240
    buffer_load_dwordx4 v121, s[12:15], s56 offen lds
    s_add_u32 m0, m0, 1024
    s_add_u32 s56, s56, 10240
    buffer_load_dwordx4 v121, s[12:15], s56 offen lds
    s_add_u32 m0, m0, 1024
    s_add_u32 s56, s56, 10240
    buffer_load_dwordx4 v121, s[12:15], s56 offen lds
    s_add_u32 m0, m0, 1024
    s_add_u32 s56, s56, 10240
    buffer_load_dwordx4 v121, s[12:15], s56 offen lds
    s_add_u32 s56, s58, 327680
    s_add_u32 m0, s63, 32768
    s_nop 0
    buffer_load_dwordx4 v121, s[12:15], s56 offen lds
    s_add_u32 m0, m0, 1024
    s_add_u32 s56, s56, 10240
    buffer_load_dwordx4 v121, s[12:15], s56 offen lds
    s_add_u32 m0, m0, 1024
    s_add_u32 s56, s56, 10240
    buffer_load_dwordx4 v121, s[12:15], s56 offen lds
    s_add_u32 m0, m0, 1024
    s_add_u32 s56, s56, 10240
    buffer_load_dwordx4 v121, s[12:15], s56 offen lds
    s_add_u32 m0, m0, 1024
    s_add_u32 s56, s56, 10240
    buffer_load_dwordx4 v121, s[12:15], s56 offen lds
    s_add_u32 m0, m0, 1024
    s_add_u32 s56, s56, 10240
    buffer_load_dwordx4 v121, s[12:15], s56 offen lds
    s_add_u32 m0, m0, 1024
    s_add_u32 s56, s56, 10240
    buffer_load_dwordx4 v121, s[12:15], s56 offen lds
    s_add_u32 m0, m0, 1024
    s_add_u32 s56, s56, 10240
    buffer_load_dwordx4 v121, s[12:15], s56 offen lds
    s_waitcnt vmcnt(32)
    ds_read_b64_tr_b16 a[0:1], v120 offset:0
    ds_read_b64_tr_b16 a[2:3], v120 offset:256
    ds_read_b64_tr_b16 a[4:5], v120 offset:4096
    ds_read_b64_tr_b16 a[6:7], v120 offset:4352
    ds_read_b64_tr_b16 a[8:9], v120 offset:32
    ds_read_b64_tr_b16 a[10:11], v120 offset:288
    ds_read_b64_tr_b16 a[12:13], v120 offset:4128
    ds_read_b64_tr_b16 a[14:15], v120 offset:4384
    ds_read_b64_tr_b16 a[16:17], v120 offset:64
    ds_read_b64_tr_b16 a[18:19], v120 offset:320
    ds_read_b64_tr_b16 a[20:21], v120 offset:4160
    ds_read_b64_tr_b16 a[22:23], v120 offset:4416
    s_waitcnt lgkmcnt(0)
    s_add_u32 s56, s58, 409600
    s_add_u32 m0, s63, 0
    s_nop 0
    buffer_load_dwordx4 v121, s[12:15], s56 offen lds
    s_add_u32 m0, m0, 1024
    s_add_u32 s56, s56, 10240
    buffer_load_dwordx4 v121, s[12:15], s56 offen lds
    s_add_u32 m0, m0, 1024
    s_add_u32 s56, s56, 10240
    buffer_load_dwordx4 v121, s[12:15], s56 offen lds
    s_add_u32 m0, m0, 1024
    s_add_u32 s56, s56, 10240
    buffer_load_dwordx4 v121, s[12:15], s56 offen lds
    s_add_u32 m0, m0, 1024
    s_add_u32 s56, s56, 10240
    buffer_load_dwordx4 v121, s[12:15], s56 offen lds
    s_add_u32 m0, m0, 1024
    s_add_u32 s56, s56, 10240
    buffer_load_dwordx4 v121, s[12:15], s56 offen lds
    s_add_u32 m0, m0, 1024
    s_add_u32 s56, s56, 10240
    buffer_load_dwordx4 v121, s[12:15], s56 offen lds
    s_add_u32 m0, m0, 1024
    s_add_u32 s56, s56, 10240
    buffer_load_dwordx4 v121, s[12:15], s56 offen lds
    s_waitcnt vmcnt(32)
    ds_read_b64_tr_b16 a[24:25], v120 offset:8192
    ds_read_b64_tr_b16 a[26:27], v120 offset:8448
    ds_read_b64_tr_b16 a[28:29], v120 offset:12288
    ds_read_b64_tr_b16 a[30:31], v120 offset:12544
    ds_read_b64_tr_b16 a[32:33], v120 offset:8224
    ds_read_b64_tr_b16 a[34:35], v120 offset:8480
    ds_read_b64_tr_b16 a[36:37], v120 offset:12320
    ds_read_b64_tr_b16 a[38:39], v120 offset:12576
    ds_read_b64_tr_b16 a[40:41], v120 offset:8256
    ds_read_b64_tr_b16 a[42:43], v120 offset:8512
    ds_read_b64_tr_b16 a[44:45], v120 offset:12352
    ds_read_b64_tr_b16 a[46:47], v120 offset:12608
    s_waitcnt lgkmcnt(0)
    s_add_u32 s56, s58, 491520
    s_add_u32 m0, s63, 8192
    s_nop 0
    buffer_load_dwordx4 v121, s[12:15], s56 offen lds
    s_add_u32 m0, m0, 1024
    s_add_u32 s56, s56, 10240
    buffer_load_dwordx4 v121, s[12:15], s56 offen lds
    s_add_u32 m0, m0, 1024
    s_add_u32 s56, s56, 10240
    buffer_load_dwordx4 v121, s[12:15], s56 offen lds
    s_add_u32 m0, m0, 1024
    s_add_u32 s56, s56, 10240
    buffer_load_dwordx4 v121, s[12:15], s56 offen lds
    s_add_u32 m0, m0, 1024
    s_add_u32 s56, s56, 10240
    buffer_load_dwordx4 v121, s[12:15], s56 offen lds
    s_add_u32 m0, m0, 1024
    s_add_u32 s56, s56, 10240
    buffer_load_dwordx4 v121, s[12:15], s56 offen lds
    s_add_u32 m0, m0, 1024
    s_add_u32 s56, s56, 10240
    buffer_load_dwordx4 v121, s[12:15], s56 offen lds
    s_add_u32 m0, m0, 1024
    s_add_u32 s56, s56, 10240
    buffer_load_dwordx4 v121, s[12:15], s56 offen lds
    s_waitcnt vmcnt(32)
    ds_read_b64_tr_b16 a[48:49], v120 offset:16384
    ds_read_b64_tr_b16 a[50:51], v120 offset:16640
    ds_read_b64_tr_b16 a[52:53], v120 offset:20480
    ds_read_b64_tr_b16 a[54:55], v120 offset:20736
    ds_read_b64_tr_b16 a[56:57], v120 offset:16416
    ds_read_b64_tr_b16 a[58:59], v120 offset:16672
    ds_read_b64_tr_b16 a[60:61], v120 offset:20512
    ds_read_b64_tr_b16 a[62:63], v120 offset:20768
    ds_read_b64_tr_b16 a[64:65], v120 offset:16448
    ds_read_b64_tr_b16 a[66:67], v120 offset:16704
    ds_read_b64_tr_b16 a[68:69], v120 offset:20544
    ds_read_b64_tr_b16 a[70:71], v120 offset:20800
    s_waitcnt lgkmcnt(0)
    s_add_u32 s56, s58, 573440
    s_add_u32 m0, s63, 16384
    s_nop 0
    buffer_load_dwordx4 v121, s[12:15], s56 offen lds
    s_add_u32 m0, m0, 1024
    s_add_u32 s56, s56, 10240
    buffer_load_dwordx4 v121, s[12:15], s56 offen lds
    s_add_u32 m0, m0, 1024
    s_add_u32 s56, s56, 10240
    buffer_load_dwordx4 v121, s[12:15], s56 offen lds
    s_add_u32 m0, m0, 1024
    s_add_u32 s56, s56, 10240
    buffer_load_dwordx4 v121, s[12:15], s56 offen lds
    s_add_u32 m0, m0, 1024
    s_add_u32 s56, s56, 10240
    buffer_load_dwordx4 v121, s[12:15], s56 offen lds
    s_add_u32 m0, m0, 1024
    s_add_u32 s56, s56, 10240
    buffer_load_dwordx4 v121, s[12:15], s56 offen lds
    s_add_u32 m0, m0, 1024
    s_add_u32 s56, s56, 10240
    buffer_load_dwordx4 v121, s[12:15], s56 offen lds
    s_add_u32 m0, m0, 1024
    s_add_u32 s56, s56, 10240
    buffer_load_dwordx4 v121, s[12:15], s56 offen lds
    s_waitcnt vmcnt(32)
    ds_read_b64_tr_b16 a[72:73], v120 offset:24576
    ds_read_b64_tr_b16 a[74:75], v120 offset:24832
    ds_read_b64_tr_b16 a[76:77], v120 offset:28672
    ds_read_b64_tr_b16 a[78:79], v120 offset:28928
    ds_read_b64_tr_b16 a[80:81], v120 offset:24608
    ds_read_b64_tr_b16 a[82:83], v120 offset:24864
    ds_read_b64_tr_b16 a[84:85], v120 offset:28704
    ds_read_b64_tr_b16 a[86:87], v120 offset:28960
    ds_read_b64_tr_b16 a[88:89], v120 offset:24640
    ds_read_b64_tr_b16 a[90:91], v120 offset:24896
    ds_read_b64_tr_b16 a[92:93], v120 offset:28736
    ds_read_b64_tr_b16 a[94:95], v120 offset:28992
    s_waitcnt lgkmcnt(0)
    s_waitcnt vmcnt(24)
    ds_read_b64_tr_b16 a[96:97], v120 offset:32768
    ds_read_b64_tr_b16 a[98:99], v120 offset:33024
    ds_read_b64_tr_b16 a[100:101], v120 offset:36864
    ds_read_b64_tr_b16 a[102:103], v120 offset:37120
    ds_read_b64_tr_b16 a[104:105], v120 offset:32800
    ds_read_b64_tr_b16 a[106:107], v120 offset:33056
    ds_read_b64_tr_b16 a[108:109], v120 offset:36896
    ds_read_b64_tr_b16 a[110:111], v120 offset:37152
    ds_read_b64_tr_b16 a[112:113], v120 offset:32832
    ds_read_b64_tr_b16 a[114:115], v120 offset:33088
    ds_read_b64_tr_b16 a[116:117], v120 offset:36928
    ds_read_b64_tr_b16 a[118:119], v120 offset:37184
    s_waitcnt lgkmcnt(0)
    s_waitcnt vmcnt(16)
    ds_read_b64_tr_b16 a[120:121], v120 offset:0
    ds_read_b64_tr_b16 a[122:123], v120 offset:256
    ds_read_b64_tr_b16 a[124:125], v120 offset:4096
    ds_read_b64_tr_b16 a[126:127], v120 offset:4352
    ds_read_b64_tr_b16 a[128:129], v120 offset:32
    ds_read_b64_tr_b16 a[130:131], v120 offset:288
    ds_read_b64_tr_b16 a[132:133], v120 offset:4128
    ds_read_b64_tr_b16 a[134:135], v120 offset:4384
    ds_read_b64_tr_b16 a[136:137], v120 offset:64
    ds_read_b64_tr_b16 a[138:139], v120 offset:320
    ds_read_b64_tr_b16 a[140:141], v120 offset:4160
    ds_read_b64_tr_b16 a[142:143], v120 offset:4416
    s_waitcnt lgkmcnt(0)
    s_waitcnt vmcnt(8)
    ds_read_b64_tr_b16 a[144:145], v120 offset:8192
    ds_read_b64_tr_b16 a[146:147], v120 offset:8448
    ds_read_b64_tr_b16 a[148:149], v120 offset:12288
    ds_read_b64_tr_b16 a[150:151], v120 offset:12544
    ds_read_b64_tr_b16 a[152:153], v120 offset:8224
    ds_read_b64_tr_b16 a[154:155], v120 offset:8480
    ds_read_b64_tr_b16 a[156:157], v120 offset:12320
    ds_read_b64_tr_b16 a[158:159], v120 offset:12576
    ds_read_b64_tr_b16 a[160:161], v120 offset:8256
    ds_read_b64_tr_b16 a[162:163], v120 offset:8512
    ds_read_b64_tr_b16 a[164:165], v120 offset:12352
    ds_read_b64_tr_b16 a[166:167], v120 offset:12608
    s_waitcnt lgkmcnt(0)
    s_waitcnt vmcnt(0)
    ds_read_b64_tr_b16 a[168:169], v120 offset:16384
    ds_read_b64_tr_b16 a[170:171], v120 offset:16640
    ds_read_b64_tr_b16 a[172:173], v120 offset:20480
    ds_read_b64_tr_b16 a[174:175], v120 offset:20736
    ds_read_b64_tr_b16 a[176:177], v120 offset:16416
    ds_read_b64_tr_b16 a[178:179], v120 offset:16672
    ds_read_b64_tr_b16 a[180:181], v120 offset:20512
    ds_read_b64_tr_b16 a[182:183], v120 offset:20768
    ds_read_b64_tr_b16 a[184:185], v120 offset:16448
    ds_read_b64_tr_b16 a[186:187], v120 offset:16704
    ds_read_b64_tr_b16 a[188:189], v120 offset:20544
    ds_read_b64_tr_b16 a[190:191], v120 offset:20800
    s_waitcnt lgkmcnt(0)
    v_min_u32 v4, 15, v1
    v_lshlrev_b32 v4, 2, v4
    v_lshlrev_b32 v6, 3, v1
    s_mul_i32 s55, s3, 1536
    v_add_u32 v6, s55, v6
    v_lshlrev_b32 v7, 3, v1
    s_lshl_b32 s55, s3, 9
    v_add_u32 v7, s55, v7
    s_mul_i32 s55, s60, 3
    s_add_u32 s55, s55, s3
    s_cmp_lt_u32 s55, 40
    s_cselect_b32 s55, s55, 44
    s_lshl_b32 s55, s55, 8
    v_lshlrev_b32 v8, 2, v1
    v_add_u32 v8, s55, v8
    v_mov_b32 v108, -1
    v_and_b32 v6, 15, v1
    v_lshlrev_b32 v6, 3, v6
    v_lshrrev_b32 v5, 4, v1
    v_mul_u32_u24 v5, 136, v5
    v_add_u32 v6, v5, v6
    s_mul_i32 s55, s3, 1632
    v_add_u32 v6, s55, v6
    v_and_b32 v7, 3, v1
    v_lshl_add_u32 v7, v7, 5, v5
    v_bfe_u32 v5, v1, 3, 1
    v_lshl_add_u32 v7, v5, 4, v7
    v_and_b32 v5, 4, v1
    v_add_u32 v7, v5, v7
    s_mul_i32 s55, s3, 544
    v_add_u32 v7, s55, v7
    v_mov_b32 v9, 128
Lp_129:
    buffer_load_dword v5, v9, s[8:11], 0 offen sc1
    s_waitcnt vmcnt(0)
    v_cmp_gt_i32 vcc, 1, v5
    s_cbranch_vccz Lpd_130
    s_sleep 8
    s_mov_b32 s54, 64
    s_sub_u32 s52, s52, 1
    s_cbranch_scc1 L_abort
    s_branch Lp_129
Lpd_130:
    v_mbcnt_lo_u32_b32 v5, -1, 0
    v_and_b32 v5, 1, v5
    v_lshlrev_b32 v5, 2, v5
    s_lshl_b32 s55, s50, 3
    buffer_load_dword v5, v5, s[8:11], s55 offen sc1
    s_getreg_b32 s55, hwreg(HW_REG_XCC_ID)
    s_and_b32 s55, s55, 7
    s_lshl_b32 s55, s55, 3
    s_lshl_b64 s[56:57], 0xff, s55
    s_waitcnt vmcnt(0)
    v_readlane_b32 s96, v5, 0
    v_readlane_b32 s97, v5, 1
    s_andn2_b64 s[56:57], s[96:97], s[56:57]
    s_cselect_b32 s62, 1, 0
    v_mov_b32 v9, 132
Lp_131:
    buffer_load_dword v5, v9, s[8:11], 0 offen sc1
    s_waitcnt vmcnt(0)
    v_cmp_gt_i32 vcc, 1, v5
    s_cbranch_vccz Lpd_132
    s_sleep 8
    s_mov_b32 s54, 112
    s_sub_u32 s52, s52, 1
    s_cbranch_scc1 L_abort
    s_branch Lp_131
Lpd_132:
    v_readfirstlane_b32 s68, v5
    s_and_b32 s68, s68, 2
    s_lshl_b32 s68, s68, 12
    s_lshl_b32 s55, s50, 2
    s_add_u32 s55, s55, s3
    s_lshl_b32 s71, s55, 13
    s_add_u32 s71, s71, s38
    s_add_u32 s71, s71, 2097152
    s_lshl_b32 s55, s60, 14
    s_add_u32 s55, s55, s38
    s_add_u32 s55, s55, s68
    s_mul_i32 s56, s50, 229376
    s_add_u32 s77, s55, s56
    s_sub_u32 s56, 229376, s56
    s_add_u32 s72, s55, s56
    v_readfirstlane_b32 s57, v5
    s_and_b32 s57, s57, 4
    s_lshl_b32 s57, s57, 12
    s_xor_b32 s55, s50, 0
    s_mul_i32 s55, s55, 14
    s_add_u32 s55, s55, s60
    s_lshl_b32 s56, s55, 10
    s_and_b32 s56, s56, 0x4000
    s_xor_b32 s56, s56, s57
    s_xor_b32 s58, s50, 1
    s_lshl_b32 s58, s58, 14
    s_xor_b32 s56, s56, s58
    s_lshl_b32 s58, s56, 1
    s_sub_u32 s24, 0x4000, s58
    s_lshl_b32 s55, s55, 15
    s_add_u32 s55, s55, s56
    s_add_u32 s55, s55, s68
    s_add_u32 s77, s55, s38
    s_xor_b32 s55, s50, 1
    s_mul_i32 s55, s55, 14
    s_add_u32 s55, s55, s60
    s_lshl_b32 s56, s55, 10
    s_and_b32 s56, s56, 0x4000
    s_xor_b32 s56, s56, s57
    s_xor_b32 s58, s50, 0
    s_lshl_b32 s58, s58, 14
    s_xor_b32 s56, s56, s58
    s_lshl_b32 s58, s56, 1
    s_sub_u32 s25, 0x4000, s58
    s_lshl_b32 s55, s55, 15
    s_add_u32 s55, s55, s56
    s_add_u32 s55, s55, s68
    s_add_u32 s72, s55, s38
    s_lshl_b32 s56, s3, 9
    s_add_u32 s77, s77, s56
    s_add_u32 s72, s72, s56
    v_lshlrev_b32 v110, 3, v1
    s_lshl_b32 s73, s50, 14
    s_add_u32 s73, s73, s38
    s_add_u32 s73, s73, 2621440
    s_lshl_b32 s55, s3, 6
    s_add_u32 s74, s73, s55
    s_add_u32 s74, s74, 12288
    s_mul_i32 s55, s60, 3
    s_add_u32 s55, s55, s3
    s_lshl_b32 s55, s55, 2
    s_add_u32 s75, s73, s55
    s_add_u32 s75, s75, 12800
    s_mov_b32 s61, 0
    s_mov_b32 s67, 0
    s_barrier
    s_sub_u32 s67, s60, 1
    s_add_u32 s67, s67, 1
    s_and_b32 s55, s67, 7
    s_lshl_b32 s55, s55, 16
    s_add_u32 s64, s71, s55
    s_add_u32 s58, s64, 4096
    buffer_load_dwordx4 v[36:39], v3, s[4:7], s64 offen offset:0 sc1
    buffer_load_dwordx4 v[40:43], v3, s[4:7], s64 offen offset:1024 sc1
    buffer_load_dwordx4 v[44:47], v3, s[4:7], s64 offen offset:2048 sc1
    buffer_load_dwordx4 v[48:51], v3, s[4:7], s64 offen offset:3072 sc1
    buffer_load_dwordx4 v[52:55], v3, s[4:7], s58 offen offset:0 sc1
    buffer_load_dwordx4 v[56:59], v3, s[4:7], s58 offen offset:1024 sc1
    buffer_load_dwordx4 v[60:63], v3, s[4:7], s58 offen offset:2048 sc1
    buffer_load_dwordx4 v[64:67], v3, s[4:7], s58 offen offset:3072 sc1
    s_mov_b32 s67, -1
    s_mov_b32 s69, 0
    s_movk_i32 s79, 0x7f
    s_add_u32 s67, s67, 1
    s_and_b32 s55, s67, 7
    s_lshl_b32 s55, s55, 16
    s_add_u32 s64, s71, s55
    s_add_u32 s58, s64, 4096
.p2align 6
L_woc_wait:
    buffer_load_dword v5, v4, s[4:7], s74 offen sc1
    s_sleep 2
L_woc_probe:
    buffer_load_dword v11, v4, s[4:7], s74 offen sc1
    s_waitcnt vmcnt(1)
    v_cmp_gt_i32 vcc, s67, v5
    s_cbranch_vccnz L_woc_p0
    buffer_load_dwordx4 v[36:39], v3, s[4:7], s64 offen offset:0 sc1
    buffer_load_dwordx4 v[40:43], v3, s[4:7], s64 offen offset:1024 sc1
    buffer_load_dwordx4 v[44:47], v3, s[4:7], s64 offen offset:2048 sc1
    buffer_load_dwordx4 v[48:51], v3, s[4:7], s64 offen offset:3072 sc1
    buffer_load_dwordx4 v[52:55], v3, s[4:7], s58 offen offset:0 sc1
    buffer_load_dwordx4 v[56:59], v3, s[4:7], s58 offen offset:1024 sc1
    buffer_load_dwordx4 v[60:63], v3, s[4:7], s58 offen offset:2048 sc1
    buffer_load_dwordx4 v[64:67], v3, s[4:7], s58 offen offset:3072 sc1
    s_branch L_woc_gone
L_woc_p0:
    buffer_load_dword v5, v4, s[4:7], s74 offen sc1
    s_mov_b32 s54, 65
    s_sub_u32 s52, s52, 1
    s_cbranch_scc1 L_abort
    s_waitcnt vmcnt(1)
    v_cmp_gt_i32 vcc, s67, v11
    s_cbranch_vccnz L_woc_probe
L_woc_go:
    buffer_load_dwordx4 v[36:39], v3, s[4:7], s64 offen offset:0 sc1
    buffer_load_dwordx4 v[40:43], v3, s[4:7], s64 offen offset:1024 sc1
    buffer_load_dwordx4 v[44:47], v3, s[4:7], s64 offen offset:2048 sc1
    buffer_load_dwordx4 v[48:51], v3, s[4:7], s64 offen offset:3072 sc1
    buffer_load_dwordx4 v[52:55], v3, s[4:7], s58 offen offset:0 sc1
    buffer_load_dwordx4 v[56:59], v3, s[4:7], s58 offen offset:1024 sc1
    buffer_load_dwordx4 v[60:63], v3, s[4:7], s58 offen offset:2048 sc1
    buffer_load_dwordx4 v[64:67], v3, s[4:7], s58 offen offset:3072 sc1
L_woc_gone:
    s_mov_b32 s61, s69
    s_add_u32 s55, s61, 55
    s_sub_u32 s56, s61, 54
    s_cmp_lt_u32 s61, 64
    s_cselect_b32 s55, s55, s56
    s_sub_u32 s56, s61, 9
    s_cmp_lt_u32 s56, 109
    s_cselect_b32 s55, s55, 0
    s_add_u32 s56, s61, 1
    s_cmp_lg_u32 s55, 0
    s_cselect_b32 s69, s55, s56
    s_min_u32 s69, s69, 128
    s_and_b32 s56, s67, 3
    s_mul_i32 s56, s56, 2048
    s_and_b32 s57, s67, 0
    s_lshl_b32 s57, s57, 9
    s_add_u32 s56, s56, s57
    s_add_u32 s65, s72, s56
    s_add_u32 s59, s77, s56
    s_add_u32 s26, s59, s24
    s_add_u32 s27, s65, s25
    s_and_b32 s55, s67, 7
    s_lshl_b32 s56, s55, 15
    s_add_u32 s70, s73, s56
    s_xor_b32 s56, s61, s69
    s_bitcmp0_b32 s56, 6
    s_cselect_b32 s56, 1, 2
    s_add_u32 s56, s56, s67
    v_mov_b32 v109, s56
    s_and_b32 s56, s56, 7
    s_lshl_b32 s56, s56, 15
    s_add_u32 s66, s73, s56
    s_and_b32 s78, s67, 63
    v_mov_b32 v111, s78
    v_xor_b32 v6, 0x2000, v6
    v_xor_b32 v7, 0x2000, v7
    v_add_u32 v124, 1632, v7
    v_add_u32 v125, 3264, v7
    v_add_u32 v126, 4896, v7
L_woc_comp:
    v_mov_b64 v[12:13], 0
    v_mov_b64 v[14:15], 0
    v_mov_b64 v[16:17], 0
    v_mov_b64 v[18:19], 0
    v_mov_b64 v[20:21], 0
    v_mov_b64 v[22:23], 0
    s_waitcnt vmcnt(7)
    v_smfmac_f32_16x16x64_bf16 v[12:15], v[36:39], a[0:7], v2
    v_smfmac_f32_16x16x64_bf16 v[16:19], v[36:39], a[8:15], v2
    v_smfmac_f32_16x16x64_bf16 v[20:23], v[36:39], a[16:23], v2
    s_waitcnt vmcnt(6)
    v_smfmac_f32_16x16x64_bf16 v[12:15], v[40:43], a[24:31], v2
    v_smfmac_f32_16x16x64_bf16 v[16:19], v[40:43], a[32:39], v2
    v_smfmac_f32_16x16x64_bf16 v[20:23], v[40:43], a[40:47], v2
    s_waitcnt vmcnt(5)
    v_smfmac_f32_16x16x64_bf16 v[12:15], v[44:47], a[48:55], v2
    v_smfmac_f32_16x16x64_bf16 v[16:19], v[44:47], a[56:63], v2
    v_smfmac_f32_16x16x64_bf16 v[20:23], v[44:47], a[64:71], v2
    s_waitcnt vmcnt(4)
    v_smfmac_f32_16x16x64_bf16 v[12:15], v[48:51], a[72:79], v2
    v_smfmac_f32_16x16x64_bf16 v[16:19], v[48:51], a[80:87], v2
    v_smfmac_f32_16x16x64_bf16 v[20:23], v[48:51], a[88:95], v2
    s_waitcnt vmcnt(3)
    v_smfmac_f32_16x16x64_bf16 v[12:15], v[52:55], a[96:103], v2
    v_smfmac_f32_16x16x64_bf16 v[16:19], v[52:55], a[104:111], v2
    v_smfmac_f32_16x16x64_bf16 v[20:23], v[52:55], a[112:119], v2
    s_waitcnt vmcnt(2)
    v_smfmac_f32_16x16x64_bf16 v[12:15], v[56:59], a[120:127], v2
    v_smfmac_f32_16x16x64_bf16 v[16:19], v[56:59], a[128:135], v2
    v_smfmac_f32_16x16x64_bf16 v[20:23], v[56:59], a[136:143], v2
    s_waitcnt vmcnt(1)
    v_smfmac_f32_16x16x64_bf16 v[12:15], v[60:63], a[144:151], v2
    v_smfmac_f32_16x16x64_bf16 v[16:19], v[60:63], a[152:159], v2
    v_smfmac_f32_16x16x64_bf16 v[20:23], v[60:63], a[160:167], v2
    s_waitcnt vmcnt(0)
    v_smfmac_f32_16x16x64_bf16 v[12:15], v[64:67], a[168:175], v2
    s_nop 2
    v_smfmac_f32_16x16x64_bf16 v[16:19], v[64:67], a[176:183], v2
    s_nop 2
    v_smfmac_f32_16x16x64_bf16 v[20:23], v[64:67], a[184:191], v2
    v_add_f32 v12, v12, v14
    v_add_f32 v13, v13, v15
    v_cmp_u_f32 vcc, v12, v13
    ds_write_b64 v6, v[12:13] offset:0
    v_add_f32 v16, v16, v18
    v_add_f32 v17, v17, v19
    ds_write_b64 v6, v[16:17] offset:544
    s_nop 0
    v_add_f32 v20, v20, v22
    v_add_f32 v21, v21, v23
    ds_write_b64 v6, v[20:21] offset:1088
    s_cbranch_vccnz L_woc_nan
L_woc_ok:
    s_cmp_eq_u32 s61, 63
    s_cselect_b32 s55, 3, s3
    s_cmp_eq_u32 s55, 3
    s_waitcnt lgkmcnt(0)
    s_barrier
    s_cbranch_scc1 L_woc_skip
    ds_read2_b32 v[100:101], v7 offset0:0 offset1:2
    ds_read2_b32 v[102:103], v124 offset0:0 offset1:2
    ds_read2_b32 v[104:105], v125 offset0:0 offset1:2
    ds_read2_b32 v[106:107], v126 offset0:0 offset1:2
    s_waitcnt lgkmcnt(2)
    v_pk_add_f32 v[100:101], v[100:101], v[102:103]
    s_waitcnt lgkmcnt(0)
    v_pk_add_f32 v[104:105], v[104:105], v[106:107]
    v_pk_add_f32 v[100:101], v[100:101], v[104:105]
    v_bfi_b32 v100, s79, v111, v100
    v_bfi_b32 v101, s79, v111, v101
    buffer_store_dwordx2 v[100:101], v110, s[4:7], s59 offen sc1
    s_cmp_lg_u32 s62, 0
    s_cbranch_scc1 Lls_133
    buffer_store_dword v108, v8, s[4:7], s70 offen
Lld_134:
    s_add_u32 s67, s67, 1
    s_and_b32 s55, s67, 7
    s_lshl_b32 s55, s55, 16
    s_add_u32 s64, s71, s55
    s_add_u32 s58, s64, 4096
    s_sleep 4
    buffer_load_dword v5, v4, s[4:7], s74 offen sc1
    buffer_load_dwordx2 v[112:113], v110, s[4:7], s65 offen sc1
    s_sleep 2
    buffer_load_dword v11, v4, s[4:7], s74 offen sc1
    buffer_load_dwordx2 v[114:115], v110, s[4:7], s65 offen sc1
    s_sleep 2
L_woc_x:
    buffer_load_dword v10, v4, s[4:7], s74 offen sc1
    buffer_load_dwordx2 v[116:117], v110, s[4:7], s65 offen sc1
    s_cmp_lg_u32 s62, 0
    s_waitcnt vmcnt(4)
    v_bitop3_b32 v104, v112, v113, v111 bitop3:0x7e
    v_and_b32 v104, 0x7f, v104
    v_cmp_ne_u32 vcc, 0, v104
    v_pk_add_f32 v[102:103], v[100:101], v[112:113]
    v_cvt_pk_bf16_f32 v102, v102, v103
    s_cbranch_vccnz L_woc_x1
    s_cbranch_scc1 L_woc_fs0
    buffer_store_dword v109, off, s[4:7], s75
    v_min_u32 v102, -2, v102
    buffer_store_dword v102, v8, s[4:7], s66 offen
L_woc_fd0:
    v_cmp_gt_i32 vcc, s67, v5
    s_branch L_woc_xok
L_woc_x1:
    buffer_load_dword v5, v4, s[4:7], s74 offen sc1
    buffer_load_dwordx2 v[112:113], v110, s[4:7], s65 offen sc1
    s_cmp_lg_u32 s62, 0
    s_waitcnt vmcnt(4)
    v_bitop3_b32 v104, v114, v115, v111 bitop3:0x7e
    v_and_b32 v104, 0x7f, v104
    v_cmp_ne_u32 vcc, 0, v104
    v_pk_add_f32 v[102:103], v[100:101], v[114:115]
    v_cvt_pk_bf16_f32 v102, v102, v103
    s_cbranch_vccnz L_woc_x2
    s_cbranch_scc1 L_woc_fs1
    buffer_store_dword v109, off, s[4:7], s75
    v_min_u32 v102, -2, v102
    buffer_store_dword v102, v8, s[4:7], s66 offen
L_woc_fd1:
    v_cmp_gt_i32 vcc, s67, v11
    s_branch L_woc_xok
L_woc_x2:
    buffer_load_dword v11, v4, s[4:7], s74 offen sc1
    buffer_load_dwordx2 v[114:115], v110, s[4:7], s65 offen sc1
    s_mov_b32 s54, 68
    s_sub_u32 s52, s52, 1
    s_cbranch_scc1 L_abort
    s_cmp_lg_u32 s62, 0
    s_waitcnt vmcnt(4)
    v_bitop3_b32 v104, v116, v117, v111 bitop3:0x7e
    v_and_b32 v104, 0x7f, v104
    v_cmp_ne_u32 vcc, 0, v104
    v_pk_add_f32 v[102:103], v[100:101], v[116:117]
    v_cvt_pk_bf16_f32 v102, v102, v103
    s_cbranch_vccnz L_woc_x
    s_cbranch_scc1 L_woc_fs2
    buffer_store_dword v109, off, s[4:7], s75
    v_min_u32 v102, -2, v102
    buffer_store_dword v102, v8, s[4:7], s66 offen
L_woc_fd2:
    v_cmp_gt_i32 vcc, s67, v10
    s_branch L_woc_xok
L_woc_xok:
    s_cmp_ge_u32 s69, 127
    s_cbranch_scc1 L_end
    s_cbranch_vccz L_woc_go
    s_branch L_woc_wait
L_woc_skip:
    s_cmp_eq_u32 s3, 3
    s_cbranch_scc1 L_woc_skip2
    s_cmp_lg_u32 s62, 0
    s_cbranch_scc1 Lls_135
    buffer_store_dword v108, v8, s[4:7], s70 offen
Lld_136:
L_woc_skip2:
    s_cmp_lg_u32 s3, 3
    s_cbranch_scc1 L_woc_nd
    s_cmp_eq_u32 s69, 63
    s_cbranch_scc1 L_woc_nd
    s_add_u32 s55, s67, 2
    s_and_b32 s55, s55, 3
    s_lshl_b32 s55, s55, 11
    s_add_u32 s55, s55, s72
    s_sub_u32 s55, s55, 1536
    v_mov_b64 v[112:113], -1
    v_mov_b64 v[114:115], -1
    s_sleep 2
    buffer_store_dwordx4 v[112:115], v3, s[4:7], s55 offen sc1
    buffer_store_dwordx2 v[112:113], v110, s[4:7], s55 offen offset:1024 sc1
L_woc_nd:
    s_add_u32 s67, s67, 1
    s_and_b32 s55, s67, 7
    s_lshl_b32 s55, s55, 16
    s_add_u32 s64, s71, s55
    s_add_u32 s58, s64, 4096
    s_cmp_lt_u32 s69, 127
    s_cbranch_scc1 L_woc_wait
    s_endpgm
L_role_help:
    s_lshl_b32 s59, s51, 3
    s_add_u32 s59, s59, s50
    s_cmp_lg_u32 s59, 240
    s_cbranch_scc1 L_help2
    s_cmp_lg_u32 s3, 0
    s_cbranch_scc1 L_help2
    v_lshlrev_b32 v2, 2, v1
    v_mov_b32 v3, 0
    s_add_u32 s60, s38, 1835008
    s_add_u32 s61, s60, 0
    buffer_store_dword v3, v2, s[4:7], s61 offen sc1
    s_add_u32 s61, s60, 8192
    buffer_store_dword v3, v2, s[4:7], s61 offen sc1
    s_add_u32 s61, s60, 16384
    buffer_store_dword v3, v2, s[4:7], s61 offen sc1
    s_add_u32 s61, s60, 24576
    buffer_store_dword v3, v2, s[4:7], s61 offen sc1
    s_add_u32 s61, s60, 37376
    buffer_store_dword v3, v2, s[4:7], s61 offen sc1
    s_add_u32 s61, s60, 45568
    buffer_store_dword v3, v2, s[4:7], s61 offen sc1
    s_add_u32 s61, s60, 53760
    buffer_store_dword v3, v2, s[4:7], s61 offen sc1
    s_add_u32 s61, s60, 61952
    buffer_store_dword v3, v2, s[4:7], s61 offen sc1
    s_add_u32 s61, s60, 66560
    buffer_store_dword v3, v2, s[4:7], s61 offen sc1
    s_add_u32 s61, s60, 74752
    buffer_store_dword v3, v2, s[4:7], s61 offen sc1
    s_add_u32 s61, s60, 82944
    buffer_store_dword v3, v2, s[4:7], s61 offen sc1
    s_add_u32 s61, s60, 91136
    buffer_store_dword v3, v2, s[4:7], s61 offen sc1
    s_add_u32 s61, s60, 103936
    buffer_store_dword v3, v2, s[4:7], s61 offen sc1
    s_add_u32 s61, s60, 112128
    buffer_store_dword v3, v2, s[4:7], s61 offen sc1
    s_add_u32 s61, s60, 120320
    buffer_store_dword v3, v2, s[4:7], s61 offen sc1
    s_add_u32 s61, s60, 128512
    buffer_store_dword v3, v2, s[4:7], s61 offen sc1
    s_add_u32 s61, s60, 133120
    buffer_store_dword v3, v2, s[4:7], s61 offen sc1
    s_add_u32 s61, s60, 141312
    buffer_store_dword v3, v2, s[4:7], s61 offen sc1
    s_add_u32 s61, s60, 149504
    buffer_store_dword v3, v2, s[4:7], s61 offen sc1
    s_add_u32 s61, s60, 157696
    buffer_store_dword v3, v2, s[4:7], s61 offen sc1
    s_waitcnt vmcnt(0)
    s_mov_b64 s[68:69], -1
    s_mov_b64 s[70:71], -1
    s_add_u32 s61, s60, 0
    s_memtime s[64:65]
    s_waitcnt lgkmcnt(0)
    buffer_load_dword v3, v2, s[4:7], s61 offen sc1
    s_waitcnt vmcnt(0)
    s_memtime s[66:67]
    s_waitcnt lgkmcnt(0)
    s_sub_u32 s64, s66, s64
    s_min_u32 s68, s68, s64
    s_add_u32 s61, s60, 8192
    s_memtime s[64:65]
    s_waitcnt lgkmcnt(0)
    buffer_load_dword v3, v2, s[4:7], s61 offen sc1
    s_waitcnt vmcnt(0)
    s_memtime s[66:67]
    s_waitcnt lgkmcnt(0)
    s_sub_u32 s64, s66, s64
    s_min_u32 s69, s69, s64
    s_add_u32 s61, s60, 16384
    s_memtime s[64:65]
    s_waitcnt lgkmcnt(0)
    buffer_load_dword v3, v2, s[4:7], s61 offen sc1
    s_waitcnt vmcnt(0)
    s_memtime s[66:67]
    s_waitcnt lgkmcnt(0)
    s_sub_u32 s64, s66, s64
    s_min_u32 s70, s70, s64
    s_add_u32 s61, s60, 24576
    s_memtime s[64:65]
    s_waitcnt lgkmcnt(0)
    buffer_load_dword v3, v2, s[4:7], s61 offen sc1
    s_waitcnt vmcnt(0)
    s_memtime s[66:67]
    s_waitcnt lgkmcnt(0)
    s_sub_u32 s64, s66, s64
    s_min_u32 s71, s71, s64
    s_add_u32 s61, s60, 37376
    s_memtime s[64:65]
    s_waitcnt lgkmcnt(0)
    buffer_load_dword v3, v2, s[4:7], s61 offen sc1
    s_waitcnt vmcnt(0)
    s_memtime s[66:67]
    s_waitcnt lgkmcnt(0)
    s_sub_u32 s64, s66, s64
    s_min_u32 s68, s68, s64
    s_add_u32 s61, s60, 45568
    s_memtime s[64:65]
    s_waitcnt lgkmcnt(0)
    buffer_load_dword v3, v2, s[4:7], s61 offen sc1
    s_waitcnt vmcnt(0)
    s_memtime s[66:67]
    s_waitcnt lgkmcnt(0)
    s_sub_u32 s64, s66, s64
    s_min_u32 s69, s69, s64
    s_add_u32 s61, s60, 53760
    s_memtime s[64:65]
    s_waitcnt lgkmcnt(0)
    buffer_load_dword v3, v2, s[4:7], s61 offen sc1
    s_waitcnt vmcnt(0)
    s_memtime s[66:67]
    s_waitcnt lgkmcnt(0)
    s_sub_u32 s64, s66, s64
    s_min_u32 s70, s70, s64
    s_add_u32 s61, s60, 61952
    s_memtime s[64:65]
    s_waitcnt lgkmcnt(0)
    buffer_load_dword v3, v2, s[4:7], s61 offen sc1
    s_waitcnt vmcnt(0)
    s_memtime s[66:67]
    s_waitcnt lgkmcnt(0)
    s_sub_u32 s64, s66, s64
    s_min_u32 s71, s71, s64
    s_add_u32 s61, s60, 66560
    s_memtime s[64:65]
    s_waitcnt lgkmcnt(0)
    buffer_load_dword v3, v2, s[4:7], s61 offen sc1
    s_waitcnt vmcnt(0)
    s_memtime s[66:67]
    s_waitcnt lgkmcnt(0)
    s_sub_u32 s64, s66, s64
    s_min_u32 s68, s68, s64
    s_add_u32 s61, s60, 74752
    s_memtime s[64:65]
    s_waitcnt lgkmcnt(0)
    buffer_load_dword v3, v2, s[4:7], s61 offen sc1
    s_waitcnt vmcnt(0)
    s_memtime s[66:67]
    s_waitcnt lgkmcnt(0)
    s_sub_u32 s64, s66, s64
    s_min_u32 s69, s69, s64
    s_add_u32 s61, s60, 82944
    s_memtime s[64:65]
    s_waitcnt lgkmcnt(0)
    buffer_load_dword v3, v2, s[4:7], s61 offen sc1
    s_waitcnt vmcnt(0)
    s_memtime s[66:67]
    s_waitcnt lgkmcnt(0)
    s_sub_u32 s64, s66, s64
    s_min_u32 s70, s70, s64
    s_add_u32 s61, s60, 91136
    s_memtime s[64:65]
    s_waitcnt lgkmcnt(0)
    buffer_load_dword v3, v2, s[4:7], s61 offen sc1
    s_waitcnt vmcnt(0)
    s_memtime s[66:67]
    s_waitcnt lgkmcnt(0)
    s_sub_u32 s64, s66, s64
    s_min_u32 s71, s71, s64
    s_add_u32 s61, s60, 103936
    s_memtime s[64:65]
    s_waitcnt lgkmcnt(0)
    buffer_load_dword v3, v2, s[4:7], s61 offen sc1
    s_waitcnt vmcnt(0)
    s_memtime s[66:67]
    s_waitcnt lgkmcnt(0)
    s_sub_u32 s64, s66, s64
    s_min_u32 s68, s68, s64
    s_add_u32 s61, s60, 112128
    s_memtime s[64:65]
    s_waitcnt lgkmcnt(0)
    buffer_load_dword v3, v2, s[4:7], s61 offen sc1
    s_waitcnt vmcnt(0)
    s_memtime s[66:67]
    s_waitcnt lgkmcnt(0)
    s_sub_u32 s64, s66, s64
    s_min_u32 s69, s69, s64
    s_add_u32 s61, s60, 120320
    s_memtime s[64:65]
    s_waitcnt lgkmcnt(0)
    buffer_load_dword v3, v2, s[4:7], s61 offen sc1
    s_waitcnt vmcnt(0)
    s_memtime s[66:67]
    s_waitcnt lgkmcnt(0)
    s_sub_u32 s64, s66, s64
    s_min_u32 s70, s70, s64
    s_add_u32 s61, s60, 128512
    s_memtime s[64:65]
    s_waitcnt lgkmcnt(0)
    buffer_load_dword v3, v2, s[4:7], s61 offen sc1
    s_waitcnt vmcnt(0)
    s_memtime s[66:67]
    s_waitcnt lgkmcnt(0)
    s_sub_u32 s64, s66, s64
    s_min_u32 s71, s71, s64
    s_add_u32 s61, s60, 133120
    s_memtime s[64:65]
    s_waitcnt lgkmcnt(0)
    buffer_load_dword v3, v2, s[4:7], s61 offen sc1
    s_waitcnt vmcnt(0)
    s_memtime s[66:67]
    s_waitcnt lgkmcnt(0)
    s_sub_u32 s64, s66, s64
    s_min_u32 s68, s68, s64
    s_add_u32 s61, s60, 141312
    s_memtime s[64:65]
    s_waitcnt lgkmcnt(0)
    buffer_load_dword v3, v2, s[4:7], s61 offen sc1
    s_waitcnt vmcnt(0)
    s_memtime s[66:67]
    s_waitcnt lgkmcnt(0)
    s_sub_u32 s64, s66, s64
    s_min_u32 s69, s69, s64
    s_add_u32 s61, s60, 149504
    s_memtime s[64:65]
    s_waitcnt lgkmcnt(0)
    buffer_load_dword v3, v2, s[4:7], s61 offen sc1
    s_waitcnt vmcnt(0)
    s_memtime s[66:67]
    s_waitcnt lgkmcnt(0)
    s_sub_u32 s64, s66, s64
    s_min_u32 s70, s70, s64
    s_add_u32 s61, s60, 157696
    s_memtime s[64:65]
    s_waitcnt lgkmcnt(0)
    buffer_load_dword v3, v2, s[4:7], s61 offen sc1
    s_waitcnt vmcnt(0)
    s_memtime s[66:67]
    s_waitcnt lgkmcnt(0)
    s_sub_u32 s64, s66, s64
    s_min_u32 s71, s71, s64
    s_min_u32 s62, s68, s70
    s_min_u32 s63, s69, s71
    s_cmp_lt_u32 s63, s62
    s_cselect_b32 s64, 3, 1
    s_min_u32 s62, s68, s69
    s_min_u32 s63, s70, s71
    s_cmp_lt_u32 s63, s62
    s_cselect_b32 s65, 0, 4
    s_or_b32 s64, s64, s65
    v_mov_b32 v4, s64
    s_mov_b64 exec, 1
    buffer_atomic_or v4, off, s[8:11], 0 offset:132 sc1
    s_mov_b64 exec, -1
L_help2:
    s_cmp_lg_u32 s59, 248
    s_cbranch_scc1 L_help3
    s_cmp_lg_u32 s3, 1
    s_cbranch_scc1 L_help3
    v_min_u32 v2, 16, v1
    v_lshlrev_b32 v2, 2, v2
L_mon:
    buffer_load_dword v3, v2, s[8:11], 0 offen sc1
    s_waitcnt vmcnt(0)
    v_sad_u8 v3, v3, 0, 0
    s_mov_b32 s60, 0
    v_readlane_b32 s61, v3, 0
    s_add_u32 s60, s60, s61
    v_readlane_b32 s61, v3, 1
    s_add_u32 s60, s60, s61
    v_readlane_b32 s61, v3, 2
    s_add_u32 s60, s60, s61
    v_readlane_b32 s61, v3, 3
    s_add_u32 s60, s60, s61
    v_readlane_b32 s61, v3, 4
    s_add_u32 s60, s60, s61
    v_readlane_b32 s61, v3, 5
    s_add_u32 s60, s60, s61
    v_readlane_b32 s61, v3, 6
    s_add_u32 s60, s60, s61
    v_readlane_b32 s61, v3, 7
    s_add_u32 s60, s60, s61
    v_readlane_b32 s61, v3, 8
    s_add_u32 s60, s60, s61
    v_readlane_b32 s61, v3, 9
    s_add_u32 s60, s60, s61
    v_readlane_b32 s61, v3, 10
    s_add_u32 s60, s60, s61
    v_readlane_b32 s61, v3, 11
    s_add_u32 s60, s60, s61
    v_readlane_b32 s61, v3, 12
    s_add_u32 s60, s60, s61
    v_readlane_b32 s61, v3, 13
    s_add_u32 s60, s60, s61
    v_readlane_b32 s61, v3, 14
    s_add_u32 s60, s60, s61
    v_readlane_b32 s61, v3, 15
    s_add_u32 s60, s60, s61
    s_cmp_ge_u32 s60, 208
    s_cbranch_scc1 L_mon_go
    s_sleep 2
    s_mov_b32 s54, 99
    s_sub_u32 s52, s52, 1
    s_cbranch_scc1 L_abort
    s_branch L_mon
L_mon_go:
    v_mov_b32 v3, 1
    buffer_store_dword v3, off, s[8:11], 0 offset:128 sc1
L_help3:
    s_endpgm
Lls_53:
    buffer_store_dwordx4 v[176:179], v2, s[4:7], s65 offen offset:0 sc1
    buffer_store_dwordx4 v[180:183], v2, s[4:7], s65 offen offset:1024 sc1
    s_branch Lld_54
Lls_55:
    buffer_store_dwordx4 v[184:187], v2, s[4:7], s65 offen offset:2048 sc1
    buffer_store_dwordx4 v[188:191], v2, s[4:7], s65 offen offset:3072 sc1
    s_branch Lld_56
Lls_57:
    buffer_store_dwordx4 v[192:195], v2, s[4:7], s58 offen offset:0 sc1
    buffer_store_dwordx4 v[196:199], v2, s[4:7], s58 offen offset:1024 sc1
    s_branch Lld_58
Lls_59:
    buffer_store_dwordx4 v[200:203], v2, s[4:7], s58 offen offset:2048 sc1
    buffer_store_dwordx4 v[204:207], v2, s[4:7], s58 offen offset:3072 sc1
    s_branch Lld_60
Lls_61:
    buffer_store_dword v11, off, s[4:7], s66 sc1
    s_branch Lld_62
L_att_np0:
    v_mfma_f32_32x32x16_bf16 v[64:79], a[0:3], a[32:35], v[96:111]
    v_mfma_f32_32x32x16_bf16 v[64:79], a[4:7], a[36:39], v[64:79]
    v_mfma_f32_32x32x16_bf16 v[64:79], a[8:11], a[40:43], v[64:79]
    v_mfma_f32_32x32x16_bf16 v[64:79], a[12:15], a[44:47], v[64:79]
    v_mfma_f32_32x32x16_bf16 v[64:79], a[16:19], a[48:51], v[64:79]
    v_mfma_f32_32x32x16_bf16 v[64:79], a[20:23], a[52:55], v[64:79]
    v_mfma_f32_32x32x16_bf16 v[64:79], a[24:27], a[56:59], v[64:79]
    v_mfma_f32_32x32x16_bf16 v[64:79], a[28:31], a[60:63], v[64:79]
    s_nop 11
    v_max3_f32 v9, v64, v65, v66
    v_max3_f32 v9, v9, v67, v68
    v_max3_f32 v9, v9, v69, v70
    v_max3_f32 v9, v9, v71, v72
    v_max3_f32 v9, v9, v73, v74
    v_max3_f32 v9, v9, v75, v76
    v_max3_f32 v9, v9, v77, v78
    v_max_f32 v9, v9, v79
    v_mov_b32 v10, v9
    s_nop 1
    v_permlane32_swap_b32 v9, v10
    v_max_f32 v9, v9, v10
    v_mul_f32 v208, s67, v9
    v_fma_f32 v64, v64, s67, -v208
    v_fma_f32 v65, v65, s67, -v208
    v_fma_f32 v66, v66, s67, -v208
    v_fma_f32 v67, v67, s67, -v208
    v_fma_f32 v68, v68, s67, -v208
    v_fma_f32 v69, v69, s67, -v208
    v_fma_f32 v70, v70, s67, -v208
    v_fma_f32 v71, v71, s67, -v208
    v_fma_f32 v72, v72, s67, -v208
    v_fma_f32 v73, v73, s67, -v208
    v_fma_f32 v74, v74, s67, -v208
    v_fma_f32 v75, v75, s67, -v208
    v_fma_f32 v76, v76, s67, -v208
    v_fma_f32 v77, v77, s67, -v208
    v_fma_f32 v78, v78, s67, -v208
    v_fma_f32 v79, v79, s67, -v208
    v_exp_f32 v64, v64
    v_exp_f32 v65, v65
    v_exp_f32 v66, v66
    v_exp_f32 v67, v67
    v_exp_f32 v68, v68
    v_exp_f32 v69, v69
    v_exp_f32 v70, v70
    v_exp_f32 v71, v71
    v_exp_f32 v72, v72
    v_exp_f32 v73, v73
    v_exp_f32 v74, v74
    v_exp_f32 v75, v75
    v_exp_f32 v76, v76
    v_exp_f32 v77, v77
    v_exp_f32 v78, v78
    v_exp_f32 v79, v79
    v_cvt_pk_bf16_f32 v12, v64, v65
    v_cvt_pk_bf16_f32 v13, v66, v67
    v_cvt_pk_bf16_f32 v14, v72, v73
    v_cvt_pk_bf16_f32 v15, v74, v75
    v_cvt_pk_bf16_f32 v16, v68, v69
    v_cvt_pk_bf16_f32 v17, v70, v71
    v_cvt_pk_bf16_f32 v18, v76, v77
    v_cvt_pk_bf16_f32 v19, v78, v79
    v_mfma_f32_32x32x16_bf16 v[112:127], a[64:67], v[12:15], 0
    v_add_f32 v209, v64, v65
    v_add_f32 v10, v66, v67
    v_add_f32 v209, v209, v68
    v_add_f32 v10, v10, v69
    v_mfma_f32_32x32x16_bf16 v[112:127], a[68:71], v[16:19], v[112:127]
    v_mfma_f32_32x32x16_bf16 v[128:143], a[72:75], v[12:15], 0
    v_add_f32 v209, v209, v70
    v_add_f32 v10, v10, v71
    v_add_f32 v209, v209, v72
    v_add_f32 v10, v10, v73
    v_mfma_f32_32x32x16_bf16 v[128:143], a[76:79], v[16:19], v[128:143]
    v_mfma_f32_32x32x16_bf16 v[144:159], a[80:83], v[12:15], 0
    v_add_f32 v209, v209, v74
    v_add_f32 v10, v10, v75
    v_add_f32 v209, v209, v76
    v_add_f32 v10, v10, v77
    v_mfma_f32_32x32x16_bf16 v[144:159], a[84:87], v[16:19], v[144:159]
    v_mfma_f32_32x32x16_bf16 v[160:175], a[88:91], v[12:15], 0
    v_add_f32 v209, v209, v78
    v_add_f32 v10, v10, v79
    v_add_f32 v209, v209, v10
    v_mfma_f32_32x32x16_bf16 v[160:175], a[92:95], v[16:19], v[160:175]
    s_branch L_att_w0
L_att_bk0:
    s_mov_b32 exec_lo, 0xff
    s_mov_b32 exec_hi, 0xff
    buffer_load_dwordx4 v[24:27], v6, s[4:7], s64 offen offset:0 sc1
    buffer_load_dwordx4 v[28:31], v6, s[4:7], s64 offen offset:32 sc1
    buffer_load_dwordx4 v[32:35], v6, s[4:7], s64 offen offset:64 sc1
    buffer_load_dwordx4 v[36:39], v6, s[4:7], s64 offen offset:96 sc1
    buffer_load_dwordx4 v[40:43], v6, s[4:7], s64 offen offset:128 sc1
    buffer_load_dwordx4 v[44:47], v6, s[4:7], s64 offen offset:160 sc1
    buffer_load_dwordx4 v[48:51], v6, s[4:7], s64 offen offset:192 sc1
    buffer_load_dwordx4 v[52:55], v6, s[4:7], s64 offen offset:224 sc1
    s_mov_b64 exec, -1
    buffer_load_dword v56, v7, s[4:7], s64 offen offset:2048 sc1
    buffer_load_dword v57, v7, s[4:7], s64 offen offset:2176 sc1
    buffer_load_dword v58, v7, s[4:7], s64 offen offset:2560 sc1
    buffer_load_dword v59, v7, s[4:7], s64 offen offset:2688 sc1
    buffer_load_dword v60, v7, s[4:7], s64 offen offset:3072 sc1
    buffer_load_dword v61, v7, s[4:7], s64 offen offset:3200 sc1
    buffer_load_dword v62, v7, s[4:7], s64 offen offset:3584 sc1
    buffer_load_dword v63, v7, s[4:7], s64 offen offset:3712 sc1
    s_branch L_att_x0
L_att_late0:
    buffer_load_dwordx4 a[128:131], v2, s[4:7], s63 offen offset:0 sc1
    buffer_load_dwordx4 a[132:135], v2, s[4:7], s63 offen offset:1024 sc1
    buffer_load_dwordx4 a[136:139], v2, s[4:7], s63 offen offset:2048 sc1
    buffer_load_dwordx4 a[140:143], v2, s[4:7], s63 offen offset:3072 sc1
    buffer_load_dwordx4 a[144:147], v2, s[4:7], s77 offen offset:0 sc1
    buffer_load_dwordx4 a[148:151], v2, s[4:7], s77 offen offset:1024 sc1
    buffer_load_dwordx4 a[152:155], v2, s[4:7], s77 offen offset:2048 sc1
    buffer_load_dwordx4 a[156:159], v2, s[4:7], s77 offen offset:3072 sc1
    buffer_load_dwordx4 a[96:99], v2, s[4:7], s62 offen offset:0 sc1
    buffer_load_dwordx4 a[100:103], v2, s[4:7], s62 offen offset:1024 sc1
    buffer_load_dwordx4 a[104:107], v2, s[4:7], s62 offen offset:2048 sc1
    buffer_load_dwordx4 a[108:111], v2, s[4:7], s62 offen offset:3072 sc1
    buffer_load_dwordx4 a[112:115], v2, s[4:7], s56 offen offset:0 sc1
    buffer_load_dwordx4 a[116:119], v2, s[4:7], s56 offen offset:1024 sc1
    buffer_load_dwordx4 a[120:123], v2, s[4:7], s56 offen offset:2048 sc1
    buffer_load_dwordx4 a[124:127], v2, s[4:7], s56 offen offset:3072 sc1
    buffer_load_dwordx4 a[160:163], v2, s[4:7], s57 offen offset:0 sc1
    buffer_load_dwordx4 a[164:167], v2, s[4:7], s57 offen offset:1024 sc1
    buffer_load_dwordx4 a[168:171], v2, s[4:7], s57 offen offset:2048 sc1
    buffer_load_dwordx4 a[172:175], v2, s[4:7], s57 offen offset:3072 sc1
    buffer_load_dwordx4 a[176:179], v2, s[4:7], s76 offen offset:0 sc1
    buffer_load_dwordx4 a[180:183], v2, s[4:7], s76 offen offset:1024 sc1
    buffer_load_dwordx4 a[184:187], v2, s[4:7], s76 offen offset:2048 sc1
    buffer_load_dwordx4 a[188:191], v2, s[4:7], s76 offen offset:3072 sc1
    s_waitcnt vmcnt(0)
    s_branch L_att_loop1
Lls_65:
    buffer_store_dwordx4 v[176:179], v2, s[4:7], s65 offen offset:0 sc1
    buffer_store_dwordx4 v[180:183], v2, s[4:7], s65 offen offset:1024 sc1
    s_branch Lld_66
Lls_67:
    buffer_store_dwordx4 v[184:187], v2, s[4:7], s65 offen offset:2048 sc1
    buffer_store_dwordx4 v[188:191], v2, s[4:7], s65 offen offset:3072 sc1
    s_branch Lld_68
Lls_69:
    buffer_store_dwordx4 v[192:195], v2, s[4:7], s58 offen offset:0 sc1
    buffer_store_dwordx4 v[196:199], v2, s[4:7], s58 offen offset:1024 sc1
    s_branch Lld_70
Lls_71:
    buffer_store_dwordx4 v[200:203], v2, s[4:7], s58 offen offset:2048 sc1
    buffer_store_dwordx4 v[204:207], v2, s[4:7], s58 offen offset:3072 sc1
    s_branch Lld_72
Lls_73:
    buffer_store_dword v11, off, s[4:7], s66 sc1
    s_branch Lld_74
L_att_np1:
    v_mfma_f32_32x32x16_bf16 v[64:79], a[96:99], a[128:131], v[96:111]
    v_mfma_f32_32x32x16_bf16 v[64:79], a[100:103], a[132:135], v[64:79]
    v_mfma_f32_32x32x16_bf16 v[64:79], a[104:107], a[136:139], v[64:79]
    v_mfma_f32_32x32x16_bf16 v[64:79], a[108:111], a[140:143], v[64:79]
    v_mfma_f32_32x32x16_bf16 v[64:79], a[112:115], a[144:147], v[64:79]
    v_mfma_f32_32x32x16_bf16 v[64:79], a[116:119], a[148:151], v[64:79]
    v_mfma_f32_32x32x16_bf16 v[64:79], a[120:123], a[152:155], v[64:79]
    v_mfma_f32_32x32x16_bf16 v[64:79], a[124:127], a[156:159], v[64:79]
    s_nop 11
    v_max3_f32 v9, v64, v65, v66
    v_max3_f32 v9, v9, v67, v68
    v_max3_f32 v9, v9, v69, v70
    v_max3_f32 v9, v9, v71, v72
    v_max3_f32 v9, v9, v73, v74
    v_max3_f32 v9, v9, v75, v76
    v_max3_f32 v9, v9, v77, v78
    v_max_f32 v9, v9, v79
    v_mov_b32 v10, v9
    s_nop 1
    v_permlane32_swap_b32 v9, v10
    v_max_f32 v9, v9, v10
    v_mul_f32 v208, s67, v9
    v_fma_f32 v64, v64, s67, -v208
    v_fma_f32 v65, v65, s67, -v208
    v_fma_f32 v66, v66, s67, -v208
    v_fma_f32 v67, v67, s67, -v208
    v_fma_f32 v68, v68, s67, -v208
    v_fma_f32 v69, v69, s67, -v208
    v_fma_f32 v70, v70, s67, -v208
    v_fma_f32 v71, v71, s67, -v208
    v_fma_f32 v72, v72, s67, -v208
    v_fma_f32 v73, v73, s67, -v208
    v_fma_f32 v74, v74, s67, -v208
    v_fma_f32 v75, v75, s67, -v208
    v_fma_f32 v76, v76, s67, -v208
    v_fma_f32 v77, v77, s67, -v208
    v_fma_f32 v78, v78, s67, -v208
    v_fma_f32 v79, v79, s67, -v208
    v_exp_f32 v64, v64
    v_exp_f32 v65, v65
    v_exp_f32 v66, v66
    v_exp_f32 v67, v67
    v_exp_f32 v68, v68
    v_exp_f32 v69, v69
    v_exp_f32 v70, v70
    v_exp_f32 v71, v71
    v_exp_f32 v72, v72
    v_exp_f32 v73, v73
    v_exp_f32 v74, v74
    v_exp_f32 v75, v75
    v_exp_f32 v76, v76
    v_exp_f32 v77, v77
    v_exp_f32 v78, v78
    v_exp_f32 v79, v79
    v_cvt_pk_bf16_f32 v12, v64, v65
    v_cvt_pk_bf16_f32 v13, v66, v67
    v_cvt_pk_bf16_f32 v14, v72, v73
    v_cvt_pk_bf16_f32 v15, v74, v75
    v_cvt_pk_bf16_f32 v16, v68, v69
    v_cvt_pk_bf16_f32 v17, v70, v71
    v_cvt_pk_bf16_f32 v18, v76, v77
    v_cvt_pk_bf16_f32 v19, v78, v79
    v_mfma_f32_32x32x16_bf16 v[112:127], a[160:163], v[12:15], 0
    v_add_f32 v209, v64, v65
    v_add_f32 v10, v66, v67
    v_add_f32 v209, v209, v68
    v_add_f32 v10, v10, v69
    v_mfma_f32_32x32x16_bf16 v[112:127], a[164:167], v[16:19], v[112:127]
    v_mfma_f32_32x32x16_bf16 v[128:143], a[168:171], v[12:15], 0
    v_add_f32 v209, v209, v70
    v_add_f32 v10, v10, v71
    v_add_f32 v209, v209, v72
    v_add_f32 v10, v10, v73
    v_mfma_f32_32x32x16_bf16 v[128:143], a[172:175], v[16:19], v[128:143]
    v_mfma_f32_32x32x16_bf16 v[144:159], a[176:179], v[12:15], 0
    v_add_f32 v209, v209, v74
    v_add_f32 v10, v10, v75
    v_add_f32 v209, v209, v76
    v_add_f32 v10, v10, v77
    v_mfma_f32_32x32x16_bf16 v[144:159], a[180:183], v[16:19], v[144:159]
    v_mfma_f32_32x32x16_bf16 v[160:175], a[184:187], v[12:15], 0
    v_add_f32 v209, v209, v78
    v_add_f32 v10, v10, v79
    v_add_f32 v209, v209, v10
    v_mfma_f32_32x32x16_bf16 v[160:175], a[188:191], v[16:19], v[160:175]
    s_branch L_att_w1
L_att_bk1:
    s_mov_b32 exec_lo, 0xff
    s_mov_b32 exec_hi, 0xff
    buffer_load_dwordx4 v[24:27], v6, s[4:7], s64 offen offset:0 sc1
    buffer_load_dwordx4 v[28:31], v6, s[4:7], s64 offen offset:32 sc1
    buffer_load_dwordx4 v[32:35], v6, s[4:7], s64 offen offset:64 sc1
    buffer_load_dwordx4 v[36:39], v6, s[4:7], s64 offen offset:96 sc1
    buffer_load_dwordx4 v[40:43], v6, s[4:7], s64 offen offset:128 sc1
    buffer_load_dwordx4 v[44:47], v6, s[4:7], s64 offen offset:160 sc1
    buffer_load_dwordx4 v[48:51], v6, s[4:7], s64 offen offset:192 sc1
    buffer_load_dwordx4 v[52:55], v6, s[4:7], s64 offen offset:224 sc1
    s_mov_b64 exec, -1
    buffer_load_dword v56, v7, s[4:7], s64 offen offset:2048 sc1
    buffer_load_dword v57, v7, s[4:7], s64 offen offset:2176 sc1
    buffer_load_dword v58, v7, s[4:7], s64 offen offset:2560 sc1
    buffer_load_dword v59, v7, s[4:7], s64 offen offset:2688 sc1
    buffer_load_dword v60, v7, s[4:7], s64 offen offset:3072 sc1
    buffer_load_dword v61, v7, s[4:7], s64 offen offset:3200 sc1
    buffer_load_dword v62, v7, s[4:7], s64 offen offset:3584 sc1
    buffer_load_dword v63, v7, s[4:7], s64 offen offset:3712 sc1
    s_branch L_att_x1
L_att_late1:
    buffer_load_dwordx4 a[32:35], v2, s[4:7], s63 offen offset:0 sc1
    buffer_load_dwordx4 a[36:39], v2, s[4:7], s63 offen offset:1024 sc1
    buffer_load_dwordx4 a[40:43], v2, s[4:7], s63 offen offset:2048 sc1
    buffer_load_dwordx4 a[44:47], v2, s[4:7], s63 offen offset:3072 sc1
    buffer_load_dwordx4 a[48:51], v2, s[4:7], s77 offen offset:0 sc1
    buffer_load_dwordx4 a[52:55], v2, s[4:7], s77 offen offset:1024 sc1
    buffer_load_dwordx4 a[56:59], v2, s[4:7], s77 offen offset:2048 sc1
    buffer_load_dwordx4 a[60:63], v2, s[4:7], s77 offen offset:3072 sc1
    buffer_load_dwordx4 a[0:3], v2, s[4:7], s62 offen offset:0 sc1
    buffer_load_dwordx4 a[4:7], v2, s[4:7], s62 offen offset:1024 sc1
    buffer_load_dwordx4 a[8:11], v2, s[4:7], s62 offen offset:2048 sc1
    buffer_load_dwordx4 a[12:15], v2, s[4:7], s62 offen offset:3072 sc1
    buffer_load_dwordx4 a[16:19], v2, s[4:7], s56 offen offset:0 sc1
    buffer_load_dwordx4 a[20:23], v2, s[4:7], s56 offen offset:1024 sc1
    buffer_load_dwordx4 a[24:27], v2, s[4:7], s56 offen offset:2048 sc1
    buffer_load_dwordx4 a[28:31], v2, s[4:7], s56 offen offset:3072 sc1
    buffer_load_dwordx4 a[64:67], v2, s[4:7], s57 offen offset:0 sc1
    buffer_load_dwordx4 a[68:71], v2, s[4:7], s57 offen offset:1024 sc1
    buffer_load_dwordx4 a[72:75], v2, s[4:7], s57 offen offset:2048 sc1
    buffer_load_dwordx4 a[76:79], v2, s[4:7], s57 offen offset:3072 sc1
    buffer_load_dwordx4 a[80:83], v2, s[4:7], s76 offen offset:0 sc1
    buffer_load_dwordx4 a[84:87], v2, s[4:7], s76 offen offset:1024 sc1
    buffer_load_dwordx4 a[88:91], v2, s[4:7], s76 offen offset:2048 sc1
    buffer_load_dwordx4 a[92:95], v2, s[4:7], s76 offen offset:3072 sc1
    s_waitcnt vmcnt(0)
    s_branch L_att_loop0
Lls_87:
    buffer_store_dword v59, off, s[4:7], s73 sc1
    s_branch Lld_88
Lls_101:
    buffer_store_dword v11, off, s[4:7], s70 sc1
    s_branch Lld_102
Lls_103:
    buffer_store_dword v11, off, s[4:7], s70 sc1
    s_branch Lld_104
Lls_105:
    buffer_store_dword v11, off, s[4:7], s70 sc1
    s_branch Lld_106
L_wor_h3w:
    s_mov_b32 s54, 51
    s_sub_u32 s52, s52, 1
    s_cbranch_scc1 L_abort
    buffer_load_dword v5, v3, s[4:7], 0 offen sc1
    s_waitcnt vmcnt(0)
    s_branch L_wor_h3
Lls_107:
    buffer_store_dword v11, off, s[4:7], s70 sc1
    s_branch Lld_108
Lls_109:
    buffer_store_dword v59, off, s[4:7], s73 sc1
    s_branch Lld_110
Lls_111:
    buffer_store_dwordx4 v[200:203], v2, s[4:7], s64 offen sc1
    s_branch Lld_112
Lls_113:
    buffer_store_dword v11, off, s[4:7], s70 sc1
    s_branch Lld_114
Lls_125:
    buffer_store_dword v59, off, s[4:7], s73 sc1
    s_branch Lld_126
Lls_127:
    buffer_store_dwordx4 v[200:203], v9, s[20:23], s64 offen sc1
    s_branch Lld_128
L_woc_nan:
    v_max_u32 v9, v36, v37
    v_max3_u32 v9, v9, v38, v39
    v_max3_u32 v9, v9, v40, v41
    v_max3_u32 v9, v9, v42, v43
    v_max3_u32 v9, v9, v44, v45
    v_max3_u32 v9, v9, v46, v47
    v_max3_u32 v9, v9, v48, v49
    v_max3_u32 v9, v9, v50, v51
    v_max3_u32 v9, v9, v52, v53
    v_max3_u32 v9, v9, v54, v55
    v_max3_u32 v9, v9, v56, v57
    v_max3_u32 v9, v9, v58, v59
    v_max3_u32 v9, v9, v60, v61
    v_max3_u32 v9, v9, v62, v63
    v_max3_u32 v9, v9, v64, v65
    v_max3_u32 v9, v9, v66, v67
    v_cmp_eq_u32 vcc, -1, v9
    s_cbranch_vccz L_woc_ok
    buffer_load_dwordx4 v[36:39], v3, s[4:7], s64 offen offset:0 sc1
    buffer_load_dwordx4 v[40:43], v3, s[4:7], s64 offen offset:1024 sc1
    buffer_load_dwordx4 v[44:47], v3, s[4:7], s64 offen offset:2048 sc1
    buffer_load_dwordx4 v[48:51], v3, s[4:7], s64 offen offset:3072 sc1
    buffer_load_dwordx4 v[52:55], v3, s[4:7], s58 offen offset:0 sc1
    buffer_load_dwordx4 v[56:59], v3, s[4:7], s58 offen offset:1024 sc1
    buffer_load_dwordx4 v[60:63], v3, s[4:7], s58 offen offset:2048 sc1
    buffer_load_dwordx4 v[64:67], v3, s[4:7], s58 offen offset:3072 sc1
    s_mov_b32 s54, 66
    s_sub_u32 s52, s52, 1
    s_cbranch_scc1 L_abort
    s_branch L_woc_comp
Lls_133:
    buffer_store_dword v108, v8, s[4:7], s70 offen sc1
    s_branch Lld_134
L_woc_fs0:
    buffer_store_dword v109, off, s[4:7], s75 sc1
    v_min_u32 v102, -2, v102
    buffer_store_dword v102, v8, s[4:7], s66 offen sc1
    s_branch L_woc_fd0
L_woc_fs1:
    buffer_store_dword v109, off, s[4:7], s75 sc1
    v_min_u32 v102, -2, v102
    buffer_store_dword v102, v8, s[4:7], s66 offen sc1
    s_branch L_woc_fd1
L_woc_fs2:
    buffer_store_dword v109, off, s[4:7], s75 sc1
    v_min_u32 v102, -2, v102
    buffer_store_dword v102, v8, s[4:7], s66 offen sc1
    s_branch L_woc_fd2
Lls_135:
    buffer_store_dword v108, v8, s[4:7], s70 offen sc1
    s_branch Lld_136
L_role_head:
    s_mov_b32 s12, s28
    s_mov_b32 s13, s29
    s_mov_b32 s14, 5242880
    s_mov_b32 s15, 0x20000
    s_mov_b32 s16, s30
    s_mov_b32 s17, s31
    s_mov_b32 s18, 5242880
    s_mov_b32 s19, 0x20000
    s_mov_b32 s20, s32
    s_mov_b32 s21, s33
    s_mov_b32 s22, 5242880
    s_mov_b32 s23, 0x20000
    s_lshl_b32 s60, s50, 4
    s_add_u32 s60, s60, s51
    v_lshrrev_b32 v252, 4, v1
    v_bfe_u32 v253, v1, 2, 2
    v_and_b32 v254, 3, v1
    v_mov_b32 v2, 0x4444
    v_mov_b32 v14, 0xeeee
    v_and_b32 v251, 2, v1
    v_cmp_ne_u32 vcc, 0, v251
    s_nop 1
    v_cndmask_b32 v2, v2, v14, vcc
    v_lshlrev_b32 v3, 4, v1
    v_lshlrev_b32 v11, 3, v1
    s_mul_i32 s55, s3, 20480
    s_add_u32 s55, s55, 65536
    v_add_u32 v4, s55, v3
    v_and_b32 v250, 15, v1
    v_lshrrev_b32 v251, 1, v252
    v_lshlrev_b32 v5, 10, v251
    v_lshl_add_u32 v5, v250, 4, v5
    v_and_b32 v251, 1, v252
    v_lshl_add_u32 v5, v251, 9, v5
    v_add_u32 v5, 32768, v5
    s_lshl_b32 s55, s3, 11
    v_add_u32 v6, s55, v5
    v_mul_u32_u24 v7, 1088, v252
    v_lshl_add_u32 v7, v250, 2, v7
    s_lshl_b32 s55, s3, 6
    s_add_u32 s55, s55, 10240
    v_add_u32 v7, s55, v7
    v_and_b32 v251, 1, v1
    v_lshl_add_u32 v251, v253, 1, v251
    v_mul_u32_u24 v8, 544, v251
    v_lshl_add_u32 v8, v252, 4, v8
    v_add_u32 v8, 10240, v8
    v_and_b32 v10, 13, v1
    v_and_b32 v251, 1, v252
    v_lshl_add_u32 v10, v251, 1, v10
    v_lshrrev_b32 v251, 1, v252
    v_lshl_add_u32 v10, v251, 4, v10
    v_lshlrev_b32 v10, 4, v10
    v_and_b32 v251, 2, v1
    v_lshl_add_u32 v10, v251, 2, v10
    s_mov_b32 s46, 0xcccccccc
    s_mov_b32 s47, 0xcccccccc
    v_lshrrev_b32 v251, 5, v1
    v_mul_u32_u24 v12, 544, v251
    v_and_b32 v251, 31, v1
    v_lshl_add_u32 v12, v251, 3, v12
    s_mul_i32 s55, s3, 1088
    s_add_u32 s55, s55, 10496
    v_add_u32 v12, s55, v12
    s_mov_b32 s70, 1040356334
    s_mov_b32 s71, 1040356334
    s_lshl_b32 s55, s60, 2
    s_add_u32 s55, s55, 416
    v_min_u32 v13, 3, v1
    v_add_u32 v13, s55, v13
    v_lshlrev_b32 v13, 7, v13
    v_lshrrev_b32 v251, 4, v1
    v_mul_u32_u24 v111, 8192, v251
    v_lshlrev_b32 v251, 2, v251
    v_and_b32 v250, 15, v1
    v_xor_b32 v251, v251, v250
    v_lshl_add_u32 v111, v251, 4, v111
    s_lshl_b32 s65, s3, 12
    v_lshl_add_u32 v250, v252, 3, v253
    v_lshlrev_b32 v250, 8, v250
    v_lshl_add_u32 v250, v254, 3, v250
    v_xor_b32 v251, s3, v253
    v_lshl_add_u32 v110, v251, 6, v250
    s_lshl_b32 s58, s60, 8
    s_lshl_b32 s55, s3, 17
    s_add_u32 s58, s58, s55
    s_cmp_lg_u32 s3, 0
    s_cbranch_scc1 L_head_ld1
    s_add_u32 s56, s58, 0
    s_add_u32 m0, s65, 0
    s_nop 0
    buffer_load_dwordx4 v111, s[16:19], s56 offen lds
    s_add_u32 m0, m0, 1024
    s_add_u32 s56, s56, 32768
    buffer_load_dwordx4 v111, s[16:19], s56 offen lds
    s_add_u32 m0, m0, 1024
    s_add_u32 s56, s56, 32768
    buffer_load_dwordx4 v111, s[16:19], s56 offen lds
    s_add_u32 m0, m0, 1024
    s_add_u32 s56, s56, 32768
    buffer_load_dwordx4 v111, s[16:19], s56 offen lds
    s_add_u32 s56, s58, 524288
    s_add_u32 m0, s65, 16384
    s_nop 0
    buffer_load_dwordx4 v111, s[16:19], s56 offen lds
    s_add_u32 m0, m0, 1024
    s_add_u32 s56, s56, 32768
    buffer_load_dwordx4 v111, s[16:19], s56 offen lds
    s_add_u32 m0, m0, 1024
    s_add_u32 s56, s56, 32768
    buffer_load_dwordx4 v111, s[16:19], s56 offen lds
    s_add_u32 m0, m0, 1024
    s_add_u32 s56, s56, 32768
    buffer_load_dwordx4 v111, s[16:19], s56 offen lds
    s_add_u32 s56, s58, 1048576
    s_add_u32 m0, s65, 32768
    s_nop 0
    buffer_load_dwordx4 v111, s[16:19], s56 offen lds
    s_add_u32 m0, m0, 1024
    s_add_u32 s56, s56, 32768
    buffer_load_dwordx4 v111, s[16:19], s56 offen lds
    s_add_u32 m0, m0, 1024
    s_add_u32 s56, s56, 32768
    buffer_load_dwordx4 v111, s[16:19], s56 offen lds
    s_add_u32 m0, m0, 1024
    s_add_u32 s56, s56, 32768
    buffer_load_dwordx4 v111, s[16:19], s56 offen lds
    s_add_u32 s56, s58, 1572864
    s_add_u32 m0, s65, 49152
    s_nop 0
    buffer_load_dwordx4 v111, s[16:19], s56 offen lds
    s_add_u32 m0, m0, 1024
    s_add_u32 s56, s56, 32768
    buffer_load_dwordx4 v111, s[16:19], s56 offen lds
    s_add_u32 m0, m0, 1024
    s_add_u32 s56, s56, 32768
    buffer_load_dwordx4 v111, s[16:19], s56 offen lds
    s_add_u32 m0, m0, 1024
    s_add_u32 s56, s56, 32768
    buffer_load_dwordx4 v111, s[16:19], s56 offen lds
    s_add_u32 s56, s58, 2097152
    s_add_u32 m0, s65, 65536
    s_nop 0
    buffer_load_dwordx4 v111, s[16:19], s56 offen lds
    s_add_u32 m0, m0, 1024
    s_add_u32 s56, s56, 32768
    buffer_load_dwordx4 v111, s[16:19], s56 offen lds
    s_add_u32 m0, m0, 1024
    s_add_u32 s56, s56, 32768
    buffer_load_dwordx4 v111, s[16:19], s56 offen lds
    s_add_u32 m0, m0, 1024
    s_add_u32 s56, s56, 32768
    buffer_load_dwordx4 v111, s[16:19], s56 offen lds
    s_add_u32 s56, s58, 2621440
    s_add_u32 m0, s65, 81920
    s_nop 0
    buffer_load_dwordx4 v111, s[16:19], s56 offen lds
    s_add_u32 m0, m0, 1024
    s_add_u32 s56, s56, 32768
    buffer_load_dwordx4 v111, s[16:19], s56 offen lds
    s_add_u32 m0, m0, 1024
    s_add_u32 s56, s56, 32768
    buffer_load_dwordx4 v111, s[16:19], s56 offen lds
    s_add_u32 m0, m0, 1024
    s_add_u32 s56, s56, 32768
    buffer_load_dwordx4 v111, s[16:19], s56 offen lds
    s_add_u32 s56, s58, 3145728
    s_add_u32 m0, s65, 98304
    s_nop 0
    buffer_load_dwordx4 v111, s[16:19], s56 offen lds
    s_add_u32 m0, m0, 1024
    s_add_u32 s56, s56, 32768
    buffer_load_dwordx4 v111, s[16:19], s56 offen lds
    s_add_u32 m0, m0, 1024
    s_add_u32 s56, s56, 32768
    buffer_load_dwordx4 v111, s[16:19], s56 offen lds
    s_add_u32 m0, m0, 1024
    s_add_u32 s56, s56, 32768
    buffer_load_dwordx4 v111, s[16:19], s56 offen lds
    s_add_u32 s56, s58, 3670016
    s_add_u32 m0, s65, 114688
    s_nop 0
    buffer_load_dwordx4 v111, s[16:19], s56 offen lds
    s_add_u32 m0, m0, 1024
    s_add_u32 s56, s56, 32768
    buffer_load_dwordx4 v111, s[16:19], s56 offen lds
    s_add_u32 m0, m0, 1024
    s_add_u32 s56, s56, 32768
    buffer_load_dwordx4 v111, s[16:19], s56 offen lds
    s_add_u32 m0, m0, 1024
    s_add_u32 s56, s56, 32768
    buffer_load_dwordx4 v111, s[16:19], s56 offen lds
    s_add_u32 s56, s58, 4194304
    s_add_u32 m0, s65, 131072
    s_nop 0
    buffer_load_dwordx4 v111, s[16:19], s56 offen lds
    s_add_u32 m0, m0, 1024
    s_add_u32 s56, s56, 32768
    buffer_load_dwordx4 v111, s[16:19], s56 offen lds
    s_add_u32 m0, m0, 1024
    s_add_u32 s56, s56, 32768
    buffer_load_dwordx4 v111, s[16:19], s56 offen lds
    s_add_u32 m0, m0, 1024
    s_add_u32 s56, s56, 32768
    buffer_load_dwordx4 v111, s[16:19], s56 offen lds
    s_waitcnt vmcnt(32)
    s_waitcnt lgkmcnt(0)
    s_barrier
    s_add_u32 s56, s58, 4718592
    s_add_u32 m0, s65, 147456
    s_nop 0
    buffer_load_dwordx4 v111, s[16:19], s56 offen lds
    s_add_u32 m0, m0, 1024
    s_add_u32 s56, s56, 32768
    buffer_load_dwordx4 v111, s[16:19], s56 offen lds
    s_add_u32 m0, m0, 1024
    s_add_u32 s56, s56, 32768
    buffer_load_dwordx4 v111, s[16:19], s56 offen lds
    s_add_u32 m0, m0, 1024
    s_add_u32 s56, s56, 32768
    buffer_load_dwordx4 v111, s[16:19], s56 offen lds
    ds_read_b64_tr_b16 a[160:161], v110 offset:0
    ds_read_b64_tr_b16 a[162:163], v110 offset:1024
    ds_read_b64_tr_b16 a[164:165], v110 offset:8192
    ds_read_b64_tr_b16 a[166:167], v110 offset:9216
    ds_read_b64_tr_b16 v[18:19], v110 offset:32
    ds_read_b64_tr_b16 v[20:21], v110 offset:1056
    ds_read_b64_tr_b16 v[22:23], v110 offset:8224
    ds_read_b64_tr_b16 v[24:25], v110 offset:9248
    s_waitcnt vmcnt(32)
    s_waitcnt lgkmcnt(0)
    s_barrier
    s_add_u32 s56, s58, 0
    s_add_u32 m0, s65, 0
    s_nop 0
    buffer_load_dwordx4 v111, s[20:23], s56 offen lds
    s_add_u32 m0, m0, 1024
    s_add_u32 s56, s56, 32768
    buffer_load_dwordx4 v111, s[20:23], s56 offen lds
    s_add_u32 m0, m0, 1024
    s_add_u32 s56, s56, 32768
    buffer_load_dwordx4 v111, s[20:23], s56 offen lds
    s_add_u32 m0, m0, 1024
    s_add_u32 s56, s56, 32768
    buffer_load_dwordx4 v111, s[20:23], s56 offen lds
    ds_read_b64_tr_b16 a[168:169], v110 offset:16384
    ds_read_b64_tr_b16 a[170:171], v110 offset:17408
    ds_read_b64_tr_b16 a[172:173], v110 offset:24576
    ds_read_b64_tr_b16 a[174:175], v110 offset:25600
    ds_read_b64_tr_b16 v[26:27], v110 offset:16416
    ds_read_b64_tr_b16 v[28:29], v110 offset:17440
    ds_read_b64_tr_b16 v[30:31], v110 offset:24608
    ds_read_b64_tr_b16 v[32:33], v110 offset:25632
    s_waitcnt vmcnt(32)
    s_waitcnt lgkmcnt(0)
    s_barrier
    s_add_u32 s56, s58, 524288
    s_add_u32 m0, s65, 16384
    s_nop 0
    buffer_load_dwordx4 v111, s[20:23], s56 offen lds
    s_add_u32 m0, m0, 1024
    s_add_u32 s56, s56, 32768
    buffer_load_dwordx4 v111, s[20:23], s56 offen lds
    s_add_u32 m0, m0, 1024
    s_add_u32 s56, s56, 32768
    buffer_load_dwordx4 v111, s[20:23], s56 offen lds
    s_add_u32 m0, m0, 1024
    s_add_u32 s56, s56, 32768
    buffer_load_dwordx4 v111, s[20:23], s56 offen lds
    ds_read_b64_tr_b16 a[176:177], v110 offset:32768
    ds_read_b64_tr_b16 a[178:179], v110 offset:33792
    ds_read_b64_tr_b16 a[180:181], v110 offset:40960
    ds_read_b64_tr_b16 a[182:183], v110 offset:41984
    ds_read_b64_tr_b16 v[34:35], v110 offset:32800
    ds_read_b64_tr_b16 v[36:37], v110 offset:33824
    ds_read_b64_tr_b16 v[38:39], v110 offset:40992
    ds_read_b64_tr_b16 v[40:41], v110 offset:42016
    s_waitcnt vmcnt(32)
    s_waitcnt lgkmcnt(0)
    s_barrier
    s_add_u32 s56, s58, 1048576
    s_add_u32 m0, s65, 32768
    s_nop 0
    buffer_load_dwordx4 v111, s[20:23], s56 offen lds
    s_add_u32 m0, m0, 1024
    s_add_u32 s56, s56, 32768
    buffer_load_dwordx4 v111, s[20:23], s56 offen lds
    s_add_u32 m0, m0, 1024
    s_add_u32 s56, s56, 32768
    buffer_load_dwordx4 v111, s[20:23], s56 offen lds
    s_add_u32 m0, m0, 1024
    s_add_u32 s56, s56, 32768
    buffer_load_dwordx4 v111, s[20:23], s56 offen lds
    v_add_u32 v110, 49152, v110
    ds_read_b64_tr_b16 a[184:185], v110 offset:0
    ds_read_b64_tr_b16 a[186:187], v110 offset:1024
    ds_read_b64_tr_b16 a[188:189], v110 offset:8192
    ds_read_b64_tr_b16 a[190:191], v110 offset:9216
    ds_read_b64_tr_b16 v[42:43], v110 offset:32
    ds_read_b64_tr_b16 v[44:45], v110 offset:1056
    ds_read_b64_tr_b16 v[46:47], v110 offset:8224
    ds_read_b64_tr_b16 v[48:49], v110 offset:9248
    s_waitcnt vmcnt(32)
    s_waitcnt lgkmcnt(0)
    s_barrier
    s_add_u32 s56, s58, 1572864
    s_add_u32 m0, s65, 49152
    s_nop 0
    buffer_load_dwordx4 v111, s[20:23], s56 offen lds
    s_add_u32 m0, m0, 1024
    s_add_u32 s56, s56, 32768
    buffer_load_dwordx4 v111, s[20:23], s56 offen lds
    s_add_u32 m0, m0, 1024
    s_add_u32 s56, s56, 32768
    buffer_load_dwordx4 v111, s[20:23], s56 offen lds
    s_add_u32 m0, m0, 1024
    s_add_u32 s56, s56, 32768
    buffer_load_dwordx4 v111, s[20:23], s56 offen lds
    ds_read_b64_tr_b16 a[192:193], v110 offset:16384
    ds_read_b64_tr_b16 a[194:195], v110 offset:17408
    ds_read_b64_tr_b16 a[196:197], v110 offset:24576
    ds_read_b64_tr_b16 a[198:199], v110 offset:25600
    ds_read_b64_tr_b16 v[50:51], v110 offset:16416
    ds_read_b64_tr_b16 v[52:53], v110 offset:17440
    ds_read_b64_tr_b16 v[54:55], v110 offset:24608
    ds_read_b64_tr_b16 v[56:57], v110 offset:25632
    s_waitcnt vmcnt(32)
    s_waitcnt lgkmcnt(0)
    s_barrier
    s_add_u32 s56, s58, 2097152
    s_add_u32 m0, s65, 65536
    s_nop 0
    buffer_load_dwordx4 v111, s[20:23], s56 offen lds
    s_add_u32 m0, m0, 1024
    s_add_u32 s56, s56, 32768
    buffer_load_dwordx4 v111, s[20:23], s56 offen lds
    s_add_u32 m0, m0, 1024
    s_add_u32 s56, s56, 32768
    buffer_load_dwordx4 v111, s[20:23], s56 offen lds
    s_add_u32 m0, m0, 1024
    s_add_u32 s56, s56, 32768
    buffer_load_dwordx4 v111, s[20:23], s56 offen lds
    ds_read_b64_tr_b16 a[200:201], v110 offset:32768
    ds_read_b64_tr_b16 a[202:203], v110 offset:33792
    ds_read_b64_tr_b16 a[204:205], v110 offset:40960
    ds_read_b64_tr_b16 a[206:207], v110 offset:41984
    ds_read_b64_tr_b16 v[58:59], v110 offset:32800
    ds_read_b64_tr_b16 v[60:61], v110 offset:33824
    ds_read_b64_tr_b16 v[62:63], v110 offset:40992
    ds_read_b64_tr_b16 v[64:65], v110 offset:42016
    s_waitcnt vmcnt(32)
    s_waitcnt lgkmcnt(0)
    s_barrier
    s_add_u32 s56, s58, 2621440
    s_add_u32 m0, s65, 81920
    s_nop 0
    buffer_load_dwordx4 v111, s[20:23], s56 offen lds
    s_add_u32 m0, m0, 1024
    s_add_u32 s56, s56, 32768
    buffer_load_dwordx4 v111, s[20:23], s56 offen lds
    s_add_u32 m0, m0, 1024
    s_add_u32 s56, s56, 32768
    buffer_load_dwordx4 v111, s[20:23], s56 offen lds
    s_add_u32 m0, m0, 1024
    s_add_u32 s56, s56, 32768
    buffer_load_dwordx4 v111, s[20:23], s56 offen lds
    v_add_u32 v110, 49152, v110
    ds_read_b64_tr_b16 a[208:209], v110 offset:0
    ds_read_b64_tr_b16 a[210:211], v110 offset:1024
    ds_read_b64_tr_b16 a[212:213], v110 offset:8192
    ds_read_b64_tr_b16 a[214:215], v110 offset:9216
    ds_read_b64_tr_b16 v[66:67], v110 offset:32
    ds_read_b64_tr_b16 v[68:69], v110 offset:1056
    ds_read_b64_tr_b16 v[70:71], v110 offset:8224
    ds_read_b64_tr_b16 v[72:73], v110 offset:9248
    s_waitcnt vmcnt(32)
    s_waitcnt lgkmcnt(0)
    s_barrier
    s_add_u32 s56, s58, 3145728
    s_add_u32 m0, s65, 98304
    s_nop 0
    buffer_load_dwordx4 v111, s[20:23], s56 offen lds
    s_add_u32 m0, m0, 1024
    s_add_u32 s56, s56, 32768
    buffer_load_dwordx4 v111, s[20:23], s56 offen lds
    s_add_u32 m0, m0, 1024
    s_add_u32 s56, s56, 32768
    buffer_load_dwordx4 v111, s[20:23], s56 offen lds
    s_add_u32 m0, m0, 1024
    s_add_u32 s56, s56, 32768
    buffer_load_dwordx4 v111, s[20:23], s56 offen lds
    ds_read_b64_tr_b16 a[216:217], v110 offset:16384
    ds_read_b64_tr_b16 a[218:219], v110 offset:17408
    ds_read_b64_tr_b16 a[220:221], v110 offset:24576
    ds_read_b64_tr_b16 a[222:223], v110 offset:25600
    ds_read_b64_tr_b16 v[74:75], v110 offset:16416
    ds_read_b64_tr_b16 v[76:77], v110 offset:17440
    ds_read_b64_tr_b16 v[78:79], v110 offset:24608
    ds_read_b64_tr_b16 v[80:81], v110 offset:25632
    s_waitcnt vmcnt(32)
    s_waitcnt lgkmcnt(0)
    s_barrier
    s_add_u32 s56, s58, 3670016
    s_add_u32 m0, s65, 114688
    s_nop 0
    buffer_load_dwordx4 v111, s[20:23], s56 offen lds
    s_add_u32 m0, m0, 1024
    s_add_u32 s56, s56, 32768
    buffer_load_dwordx4 v111, s[20:23], s56 offen lds
    s_add_u32 m0, m0, 1024
    s_add_u32 s56, s56, 32768
    buffer_load_dwordx4 v111, s[20:23], s56 offen lds
    s_add_u32 m0, m0, 1024
    s_add_u32 s56, s56, 32768
    buffer_load_dwordx4 v111, s[20:23], s56 offen lds
    ds_read_b64_tr_b16 a[224:225], v110 offset:32768
    ds_read_b64_tr_b16 a[226:227], v110 offset:33792
    ds_read_b64_tr_b16 a[228:229], v110 offset:40960
    ds_read_b64_tr_b16 a[230:231], v110 offset:41984
    ds_read_b64_tr_b16 v[82:83], v110 offset:32800
    ds_read_b64_tr_b16 v[84:85], v110 offset:33824
    ds_read_b64_tr_b16 v[86:87], v110 offset:40992
    ds_read_b64_tr_b16 v[88:89], v110 offset:42016
    s_waitcnt vmcnt(32)
    s_waitcnt lgkmcnt(0)
    s_barrier
    s_add_u32 s56, s58, 4194304
    s_add_u32 m0, s65, 131072
    s_nop 0
    buffer_load_dwordx4 v111, s[20:23], s56 offen lds
    s_add_u32 m0, m0, 1024
    s_add_u32 s56, s56, 32768
    buffer_load_dwordx4 v111, s[20:23], s56 offen lds
    s_add_u32 m0, m0, 1024
    s_add_u32 s56, s56, 32768
    buffer_load_dwordx4 v111, s[20:23], s56 offen lds
    s_add_u32 m0, m0, 1024
    s_add_u32 s56, s56, 32768
    buffer_load_dwordx4 v111, s[20:23], s56 offen lds
    v_add_u32 v110, 49152, v110
    ds_read_b64_tr_b16 a[232:233], v110 offset:0
    ds_read_b64_tr_b16 a[234:235], v110 offset:1024
    ds_read_b64_tr_b16 a[236:237], v110 offset:8192
    ds_read_b64_tr_b16 a[238:239], v110 offset:9216
    ds_read_b64_tr_b16 v[90:91], v110 offset:32
    ds_read_b64_tr_b16 v[92:93], v110 offset:1056
    ds_read_b64_tr_b16 v[94:95], v110 offset:8224
    ds_read_b64_tr_b16 v[96:97], v110 offset:9248
    s_waitcnt vmcnt(32)
    s_waitcnt lgkmcnt(0)
    s_barrier
    s_add_u32 s56, s58, 4718592
    s_add_u32 m0, s65, 147456
    s_nop 0
    buffer_load_dwordx4 v111, s[20:23], s56 offen lds
    s_add_u32 m0, m0, 1024
    s_add_u32 s56, s56, 32768
    buffer_load_dwordx4 v111, s[20:23], s56 offen lds
    s_add_u32 m0, m0, 1024
    s_add_u32 s56, s56, 32768
    buffer_load_dwordx4 v111, s[20:23], s56 offen lds
    s_add_u32 m0, m0, 1024
    s_add_u32 s56, s56, 32768
    buffer_load_dwordx4 v111, s[20:23], s56 offen lds
    v_add_u32 v110, -147456, v110
    ds_read_b64_tr_b16 a[240:241], v110 offset:0
    ds_read_b64_tr_b16 a[242:243], v110 offset:1024
    ds_read_b64_tr_b16 a[244:245], v110 offset:8192
    ds_read_b64_tr_b16 a[246:247], v110 offset:9216
    ds_read_b64_tr_b16 v[176:177], v110 offset:32
    ds_read_b64_tr_b16 v[178:179], v110 offset:1056
    ds_read_b64_tr_b16 v[180:181], v110 offset:8224
    ds_read_b64_tr_b16 v[182:183], v110 offset:9248
    s_waitcnt vmcnt(32)
    s_waitcnt lgkmcnt(0)
    s_barrier
    s_add_u32 s56, s58, 0
    s_add_u32 m0, s65, 0
    s_nop 0
    buffer_load_dwordx4 v111, s[12:15], s56 offen lds
    s_add_u32 m0, m0, 1024
    s_add_u32 s56, s56, 32768
    buffer_load_dwordx4 v111, s[12:15], s56 offen lds
    s_add_u32 m0, m0, 1024
    s_add_u32 s56, s56, 32768
    buffer_load_dwordx4 v111, s[12:15], s56 offen lds
    s_add_u32 m0, m0, 1024
    s_add_u32 s56, s56, 32768
    buffer_load_dwordx4 v111, s[12:15], s56 offen lds
    ds_read_b64_tr_b16 a[248:249], v110 offset:16384
    ds_read_b64_tr_b16 a[250:251], v110 offset:17408
    ds_read_b64_tr_b16 a[252:253], v110 offset:24576
    ds_read_b64_tr_b16 a[254:255], v110 offset:25600
    ds_read_b64_tr_b16 v[184:185], v110 offset:16416
    ds_read_b64_tr_b16 v[186:187], v110 offset:17440
    ds_read_b64_tr_b16 v[188:189], v110 offset:24608
    ds_read_b64_tr_b16 v[190:191], v110 offset:25632
    s_waitcnt vmcnt(32)
    s_waitcnt lgkmcnt(0)
    s_barrier
    s_add_u32 s56, s58, 524288
    s_add_u32 m0, s65, 16384
    s_nop 0
    buffer_load_dwordx4 v111, s[12:15], s56 offen lds
    s_add_u32 m0, m0, 1024
    s_add_u32 s56, s56, 32768
    buffer_load_dwordx4 v111, s[12:15], s56 offen lds
    s_add_u32 m0, m0, 1024
    s_add_u32 s56, s56, 32768
    buffer_load_dwordx4 v111, s[12:15], s56 offen lds
    s_add_u32 m0, m0, 1024
    s_add_u32 s56, s56, 32768
    buffer_load_dwordx4 v111, s[12:15], s56 offen lds
    ds_read_b64_tr_b16 v[112:113], v110 offset:32768
    ds_read_b64_tr_b16 v[114:115], v110 offset:33792
    ds_read_b64_tr_b16 v[116:117], v110 offset:40960
    ds_read_b64_tr_b16 v[118:119], v110 offset:41984
    ds_read_b64_tr_b16 v[192:193], v110 offset:32800
    ds_read_b64_tr_b16 v[194:195], v110 offset:33824
    ds_read_b64_tr_b16 v[196:197], v110 offset:40992
    ds_read_b64_tr_b16 v[198:199], v110 offset:42016
    s_waitcnt vmcnt(32)
    s_waitcnt lgkmcnt(0)
    s_barrier
    s_add_u32 s56, s58, 1048576
    s_add_u32 m0, s65, 32768
    s_nop 0
    buffer_load_dwordx4 v111, s[12:15], s56 offen lds
    s_add_u32 m0, m0, 1024
    s_add_u32 s56, s56, 32768
    buffer_load_dwordx4 v111, s[12:15], s56 offen lds
    s_add_u32 m0, m0, 1024
    s_add_u32 s56, s56, 32768
    buffer_load_dwordx4 v111, s[12:15], s56 offen lds
    s_add_u32 m0, m0, 1024
    s_add_u32 s56, s56, 32768
    buffer_load_dwordx4 v111, s[12:15], s56 offen lds
    v_add_u32 v110, 49152, v110
    ds_read_b64_tr_b16 v[120:121], v110 offset:0
    ds_read_b64_tr_b16 v[122:123], v110 offset:1024
    ds_read_b64_tr_b16 v[124:125], v110 offset:8192
    ds_read_b64_tr_b16 v[126:127], v110 offset:9216
    ds_read_b64_tr_b16 v[200:201], v110 offset:32
    ds_read_b64_tr_b16 v[202:203], v110 offset:1056
    ds_read_b64_tr_b16 v[204:205], v110 offset:8224
    ds_read_b64_tr_b16 v[206:207], v110 offset:9248
    s_waitcnt vmcnt(32)
    s_waitcnt lgkmcnt(0)
    s_barrier
    s_add_u32 s56, s58, 1572864
    s_add_u32 m0, s65, 49152
    s_nop 0
    buffer_load_dwordx4 v111, s[12:15], s56 offen lds
    s_add_u32 m0, m0, 1024
    s_add_u32 s56, s56, 32768
    buffer_load_dwordx4 v111, s[12:15], s56 offen lds
    s_add_u32 m0, m0, 1024
    s_add_u32 s56, s56, 32768
    buffer_load_dwordx4 v111, s[12:15], s56 offen lds
    s_add_u32 m0, m0, 1024
    s_add_u32 s56, s56, 32768
    buffer_load_dwordx4 v111, s[12:15], s56 offen lds
    ds_read_b64_tr_b16 v[128:129], v110 offset:16384
    ds_read_b64_tr_b16 v[130:131], v110 offset:17408
    ds_read_b64_tr_b16 v[132:133], v110 offset:24576
    ds_read_b64_tr_b16 v[134:135], v110 offset:25600
    ds_read_b64_tr_b16 v[208:209], v110 offset:16416
    ds_read_b64_tr_b16 v[210:211], v110 offset:17440
    ds_read_b64_tr_b16 v[212:213], v110 offset:24608
    ds_read_b64_tr_b16 v[214:215], v110 offset:25632
    s_waitcnt vmcnt(32)
    s_waitcnt lgkmcnt(0)
    s_barrier
    s_add_u32 s56, s58, 2097152
    s_add_u32 m0, s65, 65536
    s_nop 0
    buffer_load_dwordx4 v111, s[12:15], s56 offen lds
    s_add_u32 m0, m0, 1024
    s_add_u32 s56, s56, 32768
    buffer_load_dwordx4 v111, s[12:15], s56 offen lds
    s_add_u32 m0, m0, 1024
    s_add_u32 s56, s56, 32768
    buffer_load_dwordx4 v111, s[12:15], s56 offen lds
    s_add_u32 m0, m0, 1024
    s_add_u32 s56, s56, 32768
    buffer_load_dwordx4 v111, s[12:15], s56 offen lds
    ds_read_b64_tr_b16 v[136:137], v110 offset:32768
    ds_read_b64_tr_b16 v[138:139], v110 offset:33792
    ds_read_b64_tr_b16 v[140:141], v110 offset:40960
    ds_read_b64_tr_b16 v[142:143], v110 offset:41984
    ds_read_b64_tr_b16 v[216:217], v110 offset:32800
    ds_read_b64_tr_b16 v[218:219], v110 offset:33824
    ds_read_b64_tr_b16 v[220:221], v110 offset:40992
    ds_read_b64_tr_b16 v[222:223], v110 offset:42016
    s_waitcnt vmcnt(32)
    s_waitcnt lgkmcnt(0)
    s_barrier
    s_add_u32 s56, s58, 2621440
    s_add_u32 m0, s65, 81920
    s_nop 0
    buffer_load_dwordx4 v111, s[12:15], s56 offen lds
    s_add_u32 m0, m0, 1024
    s_add_u32 s56, s56, 32768
    buffer_load_dwordx4 v111, s[12:15], s56 offen lds
    s_add_u32 m0, m0, 1024
    s_add_u32 s56, s56, 32768
    buffer_load_dwordx4 v111, s[12:15], s56 offen lds
    s_add_u32 m0, m0, 1024
    s_add_u32 s56, s56, 32768
    buffer_load_dwordx4 v111, s[12:15], s56 offen lds
    v_add_u32 v110, 49152, v110
    ds_read_b64_tr_b16 v[144:145], v110 offset:0
    ds_read_b64_tr_b16 v[146:147], v110 offset:1024
    ds_read_b64_tr_b16 v[148:149], v110 offset:8192
    ds_read_b64_tr_b16 v[150:151], v110 offset:9216
    ds_read_b64_tr_b16 v[224:225], v110 offset:32
    ds_read_b64_tr_b16 v[226:227], v110 offset:1056
    ds_read_b64_tr_b16 v[228:229], v110 offset:8224
    ds_read_b64_tr_b16 v[230:231], v110 offset:9248
    s_waitcnt vmcnt(32)
    s_waitcnt lgkmcnt(0)
    s_barrier
    s_add_u32 s56, s58, 3145728
    s_add_u32 m0, s65, 98304
    s_nop 0
    buffer_load_dwordx4 v111, s[12:15], s56 offen lds
    s_add_u32 m0, m0, 1024
    s_add_u32 s56, s56, 32768
    buffer_load_dwordx4 v111, s[12:15], s56 offen lds
    s_add_u32 m0, m0, 1024
    s_add_u32 s56, s56, 32768
    buffer_load_dwordx4 v111, s[12:15], s56 offen lds
    s_add_u32 m0, m0, 1024
    s_add_u32 s56, s56, 32768
    buffer_load_dwordx4 v111, s[12:15], s56 offen lds
    ds_read_b64_tr_b16 v[152:153], v110 offset:16384
    ds_read_b64_tr_b16 v[154:155], v110 offset:17408
    ds_read_b64_tr_b16 v[156:157], v110 offset:24576
    ds_read_b64_tr_b16 v[158:159], v110 offset:25600
    ds_read_b64_tr_b16 v[232:233], v110 offset:16416
    ds_read_b64_tr_b16 v[234:235], v110 offset:17440
    ds_read_b64_tr_b16 v[236:237], v110 offset:24608
    ds_read_b64_tr_b16 v[238:239], v110 offset:25632
    s_waitcnt vmcnt(32)
    s_waitcnt lgkmcnt(0)
    s_barrier
    s_add_u32 s56, s58, 3670016
    s_add_u32 m0, s65, 114688
    s_nop 0
    buffer_load_dwordx4 v111, s[12:15], s56 offen lds
    s_add_u32 m0, m0, 1024
    s_add_u32 s56, s56, 32768
    buffer_load_dwordx4 v111, s[12:15], s56 offen lds
    s_add_u32 m0, m0, 1024
    s_add_u32 s56, s56, 32768
    buffer_load_dwordx4 v111, s[12:15], s56 offen lds
    s_add_u32 m0, m0, 1024
    s_add_u32 s56, s56, 32768
    buffer_load_dwordx4 v111, s[12:15], s56 offen lds
    ds_read_b64_tr_b16 v[160:161], v110 offset:32768
    ds_read_b64_tr_b16 v[162:163], v110 offset:33792
    ds_read_b64_tr_b16 v[164:165], v110 offset:40960
    ds_read_b64_tr_b16 v[166:167], v110 offset:41984
    ds_read_b64_tr_b16 v[240:241], v110 offset:32800
    ds_read_b64_tr_b16 v[242:243], v110 offset:33824
    ds_read_b64_tr_b16 v[244:245], v110 offset:40992
    ds_read_b64_tr_b16 v[246:247], v110 offset:42016
    s_waitcnt vmcnt(32)
    s_waitcnt lgkmcnt(0)
    s_barrier
    s_add_u32 s56, s58, 4194304
    s_add_u32 m0, s65, 131072
    s_nop 0
    buffer_load_dwordx4 v111, s[12:15], s56 offen lds
    s_add_u32 m0, m0, 1024
    s_add_u32 s56, s56, 32768
    buffer_load_dwordx4 v111, s[12:15], s56 offen lds
    s_add_u32 m0, m0, 1024
    s_add_u32 s56, s56, 32768
    buffer_load_dwordx4 v111, s[12:15], s56 offen lds
    s_add_u32 m0, m0, 1024
    s_add_u32 s56, s56, 32768
    buffer_load_dwordx4 v111, s[12:15], s56 offen lds
    v_add_u32 v110, 49152, v110
    ds_read_b64_tr_b16 v[168:169], v110 offset:0
    ds_read_b64_tr_b16 v[170:171], v110 offset:1024
    ds_read_b64_tr_b16 v[172:173], v110 offset:8192
    ds_read_b64_tr_b16 v[174:175], v110 offset:9216
    ds_read_b64_tr_b16 v[248:249], v110 offset:32
    ds_read_b64_tr_b16 v[250:251], v110 offset:1056
    ds_read_b64_tr_b16 v[252:253], v110 offset:8224
    ds_read_b64_tr_b16 v[254:255], v110 offset:9248
    s_waitcnt vmcnt(32)
    s_waitcnt lgkmcnt(0)
    s_barrier
    s_add_u32 s56, s58, 4718592
    s_add_u32 m0, s65, 147456
    s_nop 0
    buffer_load_dwordx4 v111, s[12:15], s56 offen lds
    s_add_u32 m0, m0, 1024
    s_add_u32 s56, s56, 32768
    buffer_load_dwordx4 v111, s[12:15], s56 offen lds
    s_add_u32 m0, m0, 1024
    s_add_u32 s56, s56, 32768
    buffer_load_dwordx4 v111, s[12:15], s56 offen lds
    s_add_u32 m0, m0, 1024
    s_add_u32 s56, s56, 32768
    buffer_load_dwordx4 v111, s[12:15], s56 offen lds
    v_add_u32 v110, -147456, v110
    ds_read_b64_tr_b16 a[0:1], v110 offset:0
    ds_read_b64_tr_b16 a[2:3], v110 offset:1024
    ds_read_b64_tr_b16 a[4:5], v110 offset:8192
    ds_read_b64_tr_b16 a[6:7], v110 offset:9216
    ds_read_b64_tr_b16 a[80:81], v110 offset:32
    ds_read_b64_tr_b16 a[82:83], v110 offset:1056
    ds_read_b64_tr_b16 a[84:85], v110 offset:8224
    ds_read_b64_tr_b16 a[86:87], v110 offset:9248
    s_waitcnt vmcnt(32)
    s_waitcnt lgkmcnt(0)
    s_barrier
    ds_read_b64_tr_b16 a[8:9], v110 offset:16384
    ds_read_b64_tr_b16 a[10:11], v110 offset:17408
    ds_read_b64_tr_b16 a[12:13], v110 offset:24576
    ds_read_b64_tr_b16 a[14:15], v110 offset:25600
    ds_read_b64_tr_b16 a[88:89], v110 offset:16416
    ds_read_b64_tr_b16 a[90:91], v110 offset:17440
    ds_read_b64_tr_b16 a[92:93], v110 offset:24608
    ds_read_b64_tr_b16 a[94:95], v110 offset:25632
    s_waitcnt vmcnt(28)
    s_waitcnt lgkmcnt(0)
    s_barrier
    ds_read_b64_tr_b16 a[16:17], v110 offset:32768
    ds_read_b64_tr_b16 a[18:19], v110 offset:33792
    ds_read_b64_tr_b16 a[20:21], v110 offset:40960
    ds_read_b64_tr_b16 a[22:23], v110 offset:41984
    ds_read_b64_tr_b16 a[96:97], v110 offset:32800
    ds_read_b64_tr_b16 a[98:99], v110 offset:33824
    ds_read_b64_tr_b16 a[100:101], v110 offset:40992
    ds_read_b64_tr_b16 a[102:103], v110 offset:42016
    s_waitcnt vmcnt(24)
    s_waitcnt lgkmcnt(0)
    s_barrier
    v_add_u32 v110, 49152, v110
    ds_read_b64_tr_b16 a[24:25], v110 offset:0
    ds_read_b64_tr_b16 a[26:27], v110 offset:1024
    ds_read_b64_tr_b16 a[28:29], v110 offset:8192
    ds_read_b64_tr_b16 a[30:31], v110 offset:9216
    ds_read_b64_tr_b16 a[104:105], v110 offset:32
    ds_read_b64_tr_b16 a[106:107], v110 offset:1056
    ds_read_b64_tr_b16 a[108:109], v110 offset:8224
    ds_read_b64_tr_b16 a[110:111], v110 offset:9248
    s_waitcnt vmcnt(20)
    s_waitcnt lgkmcnt(0)
    s_barrier
    ds_read_b64_tr_b16 a[32:33], v110 offset:16384
    ds_read_b64_tr_b16 a[34:35], v110 offset:17408
    ds_read_b64_tr_b16 a[36:37], v110 offset:24576
    ds_read_b64_tr_b16 a[38:39], v110 offset:25600
    ds_read_b64_tr_b16 a[112:113], v110 offset:16416
    ds_read_b64_tr_b16 a[114:115], v110 offset:17440
    ds_read_b64_tr_b16 a[116:117], v110 offset:24608
    ds_read_b64_tr_b16 a[118:119], v110 offset:25632
    s_waitcnt vmcnt(16)
    s_waitcnt lgkmcnt(0)
    s_barrier
    ds_read_b64_tr_b16 a[40:41], v110 offset:32768
    ds_read_b64_tr_b16 a[42:43], v110 offset:33792
    ds_read_b64_tr_b16 a[44:45], v110 offset:40960
    ds_read_b64_tr_b16 a[46:47], v110 offset:41984
    ds_read_b64_tr_b16 a[120:121], v110 offset:32800
    ds_read_b64_tr_b16 a[122:123], v110 offset:33824
    ds_read_b64_tr_b16 a[124:125], v110 offset:40992
    ds_read_b64_tr_b16 a[126:127], v110 offset:42016
    s_waitcnt vmcnt(12)
    s_waitcnt lgkmcnt(0)
    s_barrier
    v_add_u32 v110, 49152, v110
    ds_read_b64_tr_b16 a[48:49], v110 offset:0
    ds_read_b64_tr_b16 a[50:51], v110 offset:1024
    ds_read_b64_tr_b16 a[52:53], v110 offset:8192
    ds_read_b64_tr_b16 a[54:55], v110 offset:9216
    ds_read_b64_tr_b16 a[128:129], v110 offset:32
    ds_read_b64_tr_b16 a[130:131], v110 offset:1056
    ds_read_b64_tr_b16 a[132:133], v110 offset:8224
    ds_read_b64_tr_b16 a[134:135], v110 offset:9248
    s_waitcnt vmcnt(8)
    s_waitcnt lgkmcnt(0)
    s_barrier
    ds_read_b64_tr_b16 a[56:57], v110 offset:16384
    ds_read_b64_tr_b16 a[58:59], v110 offset:17408
    ds_read_b64_tr_b16 a[60:61], v110 offset:24576
    ds_read_b64_tr_b16 a[62:63], v110 offset:25600
    ds_read_b64_tr_b16 a[136:137], v110 offset:16416
    ds_read_b64_tr_b16 a[138:139], v110 offset:17440
    ds_read_b64_tr_b16 a[140:141], v110 offset:24608
    ds_read_b64_tr_b16 a[142:143], v110 offset:25632
    s_waitcnt vmcnt(4)
    s_waitcnt lgkmcnt(0)
    s_barrier
    ds_read_b64_tr_b16 a[64:65], v110 offset:32768
    ds_read_b64_tr_b16 a[66:67], v110 offset:33792
    ds_read_b64_tr_b16 a[68:69], v110 offset:40960
    ds_read_b64_tr_b16 a[70:71], v110 offset:41984
    ds_read_b64_tr_b16 a[144:145], v110 offset:32800
    ds_read_b64_tr_b16 a[146:147], v110 offset:33824
    ds_read_b64_tr_b16 a[148:149], v110 offset:40992
    ds_read_b64_tr_b16 a[150:151], v110 offset:42016
    s_waitcnt vmcnt(0)
    s_waitcnt lgkmcnt(0)
    s_barrier
    v_add_u32 v110, 49152, v110
    ds_read_b64_tr_b16 a[72:73], v110 offset:0
    ds_read_b64_tr_b16 a[74:75], v110 offset:1024
    ds_read_b64_tr_b16 a[76:77], v110 offset:8192
    ds_read_b64_tr_b16 a[78:79], v110 offset:9216
    ds_read_b64_tr_b16 a[152:153], v110 offset:32
    ds_read_b64_tr_b16 a[154:155], v110 offset:1056
    ds_read_b64_tr_b16 a[156:157], v110 offset:8224
    ds_read_b64_tr_b16 a[158:159], v110 offset:9248
    s_waitcnt lgkmcnt(0)
    s_branch L_head_ldd
L_head_ld1:
    s_cmp_lg_u32 s3, 1
    s_cbranch_scc1 L_head_ld2
    s_add_u32 s56, s58, 0
    s_add_u32 m0, s65, 0
    s_nop 0
    buffer_load_dwordx4 v111, s[16:19], s56 offen lds
    s_add_u32 m0, m0, 1024
    s_add_u32 s56, s56, 32768
    buffer_load_dwordx4 v111, s[16:19], s56 offen lds
    s_add_u32 m0, m0, 1024
    s_add_u32 s56, s56, 32768
    buffer_load_dwordx4 v111, s[16:19], s56 offen lds
    s_add_u32 m0, m0, 1024
    s_add_u32 s56, s56, 32768
    buffer_load_dwordx4 v111, s[16:19], s56 offen lds
    s_add_u32 s56, s58, 524288
    s_add_u32 m0, s65, 16384
    s_nop 0
    buffer_load_dwordx4 v111, s[16:19], s56 offen lds
    s_add_u32 m0, m0, 1024
    s_add_u32 s56, s56, 32768
    buffer_load_dwordx4 v111, s[16:19], s56 offen lds
    s_add_u32 m0, m0, 1024
    s_add_u32 s56, s56, 32768
    buffer_load_dwordx4 v111, s[16:19], s56 offen lds
    s_add_u32 m0, m0, 1024
    s_add_u32 s56, s56, 32768
    buffer_load_dwordx4 v111, s[16:19], s56 offen lds
    s_add_u32 s56, s58, 1048576
    s_add_u32 m0, s65, 32768
    s_nop 0
    buffer_load_dwordx4 v111, s[16:19], s56 offen lds
    s_add_u32 m0, m0, 1024
    s_add_u32 s56, s56, 32768
    buffer_load_dwordx4 v111, s[16:19], s56 offen lds
    s_add_u32 m0, m0, 1024
    s_add_u32 s56, s56, 32768
    buffer_load_dwordx4 v111, s[16:19], s56 offen lds
    s_add_u32 m0, m0, 1024
    s_add_u32 s56, s56, 32768
    buffer_load_dwordx4 v111, s[16:19], s56 offen lds
    s_add_u32 s56, s58, 1572864
    s_add_u32 m0, s65, 49152
    s_nop 0
    buffer_load_dwordx4 v111, s[16:19], s56 offen lds
    s_add_u32 m0, m0, 1024
    s_add_u32 s56, s56, 32768
    buffer_load_dwordx4 v111, s[16:19], s56 offen lds
    s_add_u32 m0, m0, 1024
    s_add_u32 s56, s56, 32768
    buffer_load_dwordx4 v111, s[16:19], s56 offen lds
    s_add_u32 m0, m0, 1024
    s_add_u32 s56, s56, 32768
    buffer_load_dwordx4 v111, s[16:19], s56 offen lds
    s_add_u32 s56, s58, 2097152
    s_add_u32 m0, s65, 65536
    s_nop 0
    buffer_load_dwordx4 v111, s[16:19], s56 offen lds
    s_add_u32 m0, m0, 1024
    s_add_u32 s56, s56, 32768
    buffer_load_dwordx4 v111, s[16:19], s56 offen lds
    s_add_u32 m0, m0, 1024
    s_add_u32 s56, s56, 32768
    buffer_load_dwordx4 v111, s[16:19], s56 offen lds
    s_add_u32 m0, m0, 1024
    s_add_u32 s56, s56, 32768
    buffer_load_dwordx4 v111, s[16:19], s56 offen lds
    s_add_u32 s56, s58, 2621440
    s_add_u32 m0, s65, 81920
    s_nop 0
    buffer_load_dwordx4 v111, s[16:19], s56 offen lds
    s_add_u32 m0, m0, 1024
    s_add_u32 s56, s56, 32768
    buffer_load_dwordx4 v111, s[16:19], s56 offen lds
    s_add_u32 m0, m0, 1024
    s_add_u32 s56, s56, 32768
    buffer_load_dwordx4 v111, s[16:19], s56 offen lds
    s_add_u32 m0, m0, 1024
    s_add_u32 s56, s56, 32768
    buffer_load_dwordx4 v111, s[16:19], s56 offen lds
    s_add_u32 s56, s58, 3145728
    s_add_u32 m0, s65, 98304
    s_nop 0
    buffer_load_dwordx4 v111, s[16:19], s56 offen lds
    s_add_u32 m0, m0, 1024
    s_add_u32 s56, s56, 32768
    buffer_load_dwordx4 v111, s[16:19], s56 offen lds
    s_add_u32 m0, m0, 1024
    s_add_u32 s56, s56, 32768
    buffer_load_dwordx4 v111, s[16:19], s56 offen lds
    s_add_u32 m0, m0, 1024
    s_add_u32 s56, s56, 32768
    buffer_load_dwordx4 v111, s[16:19], s56 offen lds
    s_add_u32 s56, s58, 3670016
    s_add_u32 m0, s65, 114688
    s_nop 0
    buffer_load_dwordx4 v111, s[16:19], s56 offen lds
    s_add_u32 m0, m0, 1024
    s_add_u32 s56, s56, 32768
    buffer_load_dwordx4 v111, s[16:19], s56 offen lds
    s_add_u32 m0, m0, 1024
    s_add_u32 s56, s56, 32768
    buffer_load_dwordx4 v111, s[16:19], s56 offen lds
    s_add_u32 m0, m0, 1024
    s_add_u32 s56, s56, 32768
    buffer_load_dwordx4 v111, s[16:19], s56 offen lds
    s_add_u32 s56, s58, 4194304
    s_add_u32 m0, s65, 131072
    s_nop 0
    buffer_load_dwordx4 v111, s[16:19], s56 offen lds
    s_add_u32 m0, m0, 1024
    s_add_u32 s56, s56, 32768
    buffer_load_dwordx4 v111, s[16:19], s56 offen lds
    s_add_u32 m0, m0, 1024
    s_add_u32 s56, s56, 32768
    buffer_load_dwordx4 v111, s[16:19], s56 offen lds
    s_add_u32 m0, m0, 1024
    s_add_u32 s56, s56, 32768
    buffer_load_dwordx4 v111, s[16:19], s56 offen lds
    s_waitcnt vmcnt(32)
    s_waitcnt lgkmcnt(0)
    s_barrier
    s_add_u32 s56, s58, 4718592
    s_add_u32 m0, s65, 147456
    s_nop 0
    buffer_load_dwordx4 v111, s[16:19], s56 offen lds
    s_add_u32 m0, m0, 1024
    s_add_u32 s56, s56, 32768
    buffer_load_dwordx4 v111, s[16:19], s56 offen lds
    s_add_u32 m0, m0, 1024
    s_add_u32 s56, s56, 32768
    buffer_load_dwordx4 v111, s[16:19], s56 offen lds
    s_add_u32 m0, m0, 1024
    s_add_u32 s56, s56, 32768
    buffer_load_dwordx4 v111, s[16:19], s56 offen lds
    ds_read_b64_tr_b16 a[208:209], v110 offset:0
    ds_read_b64_tr_b16 a[210:211], v110 offset:1024
    ds_read_b64_tr_b16 a[212:213], v110 offset:8192
    ds_read_b64_tr_b16 a[214:215], v110 offset:9216
    ds_read_b64_tr_b16 v[66:67], v110 offset:32
    ds_read_b64_tr_b16 v[68:69], v110 offset:1056
    ds_read_b64_tr_b16 v[70:71], v110 offset:8224
    ds_read_b64_tr_b16 v[72:73], v110 offset:9248
    s_waitcnt vmcnt(32)
    s_waitcnt lgkmcnt(0)
    s_barrier
    s_add_u32 s56, s58, 0
    s_add_u32 m0, s65, 0
    s_nop 0
    buffer_load_dwordx4 v111, s[20:23], s56 offen lds
    s_add_u32 m0, m0, 1024
    s_add_u32 s56, s56, 32768
    buffer_load_dwordx4 v111, s[20:23], s56 offen lds
    s_add_u32 m0, m0, 1024
    s_add_u32 s56, s56, 32768
    buffer_load_dwordx4 v111, s[20:23], s56 offen lds
    s_add_u32 m0, m0, 1024
    s_add_u32 s56, s56, 32768
    buffer_load_dwordx4 v111, s[20:23], s56 offen lds
    ds_read_b64_tr_b16 a[216:217], v110 offset:16384
    ds_read_b64_tr_b16 a[218:219], v110 offset:17408
    ds_read_b64_tr_b16 a[220:221], v110 offset:24576
    ds_read_b64_tr_b16 a[222:223], v110 offset:25600
    ds_read_b64_tr_b16 v[74:75], v110 offset:16416
    ds_read_b64_tr_b16 v[76:77], v110 offset:17440
    ds_read_b64_tr_b16 v[78:79], v110 offset:24608
    ds_read_b64_tr_b16 v[80:81], v110 offset:25632
    s_waitcnt vmcnt(32)
    s_waitcnt lgkmcnt(0)
    s_barrier
    s_add_u32 s56, s58, 524288
    s_add_u32 m0, s65, 16384
    s_nop 0
    buffer_load_dwordx4 v111, s[20:23], s56 offen lds
    s_add_u32 m0, m0, 1024
    s_add_u32 s56, s56, 32768
    buffer_load_dwordx4 v111, s[20:23], s56 offen lds
    s_add_u32 m0, m0, 1024
    s_add_u32 s56, s56, 32768
    buffer_load_dwordx4 v111, s[20:23], s56 offen lds
    s_add_u32 m0, m0, 1024
    s_add_u32 s56, s56, 32768
    buffer_load_dwordx4 v111, s[20:23], s56 offen lds
    ds_read_b64_tr_b16 a[160:161], v110 offset:32768
    ds_read_b64_tr_b16 a[162:163], v110 offset:33792
    ds_read_b64_tr_b16 a[164:165], v110 offset:40960
    ds_read_b64_tr_b16 a[166:167], v110 offset:41984
    ds_read_b64_tr_b16 v[18:19], v110 offset:32800
    ds_read_b64_tr_b16 v[20:21], v110 offset:33824
    ds_read_b64_tr_b16 v[22:23], v110 offset:40992
    ds_read_b64_tr_b16 v[24:25], v110 offset:42016
    s_waitcnt vmcnt(32)
    s_waitcnt lgkmcnt(0)
    s_barrier
    s_add_u32 s56, s58, 1048576
    s_add_u32 m0, s65, 32768
    s_nop 0
    buffer_load_dwordx4 v111, s[20:23], s56 offen lds
    s_add_u32 m0, m0, 1024
    s_add_u32 s56, s56, 32768
    buffer_load_dwordx4 v111, s[20:23], s56 offen lds
    s_add_u32 m0, m0, 1024
    s_add_u32 s56, s56, 32768
    buffer_load_dwordx4 v111, s[20:23], s56 offen lds
    s_add_u32 m0, m0, 1024
    s_add_u32 s56, s56, 32768
    buffer_load_dwordx4 v111, s[20:23], s56 offen lds
    v_add_u32 v110, 49152, v110
    ds_read_b64_tr_b16 a[168:169], v110 offset:0
    ds_read_b64_tr_b16 a[170:171], v110 offset:1024
    ds_read_b64_tr_b16 a[172:173], v110 offset:8192
    ds_read_b64_tr_b16 a[174:175], v110 offset:9216
    ds_read_b64_tr_b16 v[26:27], v110 offset:32
    ds_read_b64_tr_b16 v[28:29], v110 offset:1056
    ds_read_b64_tr_b16 v[30:31], v110 offset:8224
    ds_read_b64_tr_b16 v[32:33], v110 offset:9248
    s_waitcnt vmcnt(32)
    s_waitcnt lgkmcnt(0)
    s_barrier
    s_add_u32 s56, s58, 1572864
    s_add_u32 m0, s65, 49152
    s_nop 0
    buffer_load_dwordx4 v111, s[20:23], s56 offen lds
    s_add_u32 m0, m0, 1024
    s_add_u32 s56, s56, 32768
    buffer_load_dwordx4 v111, s[20:23], s56 offen lds
    s_add_u32 m0, m0, 1024
    s_add_u32 s56, s56, 32768
    buffer_load_dwordx4 v111, s[20:23], s56 offen lds
    s_add_u32 m0, m0, 1024
    s_add_u32 s56, s56, 32768
    buffer_load_dwordx4 v111, s[20:23], s56 offen lds
    ds_read_b64_tr_b16 a[176:177], v110 offset:16384
    ds_read_b64_tr_b16 a[178:179], v110 offset:17408
    ds_read_b64_tr_b16 a[180:181], v110 offset:24576
    ds_read_b64_tr_b16 a[182:183], v110 offset:25600
    ds_read_b64_tr_b16 v[34:35], v110 offset:16416
    ds_read_b64_tr_b16 v[36:37], v110 offset:17440
    ds_read_b64_tr_b16 v[38:39], v110 offset:24608
    ds_read_b64_tr_b16 v[40:41], v110 offset:25632
    s_waitcnt vmcnt(32)
    s_waitcnt lgkmcnt(0)
    s_barrier
    s_add_u32 s56, s58, 2097152
    s_add_u32 m0, s65, 65536
    s_nop 0
    buffer_load_dwordx4 v111, s[20:23], s56 offen lds
    s_add_u32 m0, m0, 1024
    s_add_u32 s56, s56, 32768
    buffer_load_dwordx4 v111, s[20:23], s56 offen lds
    s_add_u32 m0, m0, 1024
    s_add_u32 s56, s56, 32768
    buffer_load_dwordx4 v111, s[20:23], s56 offen lds
    s_add_u32 m0, m0, 1024
    s_add_u32 s56, s56, 32768
    buffer_load_dwordx4 v111, s[20:23], s56 offen lds
    ds_read_b64_tr_b16 a[184:185], v110 offset:32768
    ds_read_b64_tr_b16 a[186:187], v110 offset:33792
    ds_read_b64_tr_b16 a[188:189], v110 offset:40960
    ds_read_b64_tr_b16 a[190:191], v110 offset:41984
    ds_read_b64_tr_b16 v[42:43], v110 offset:32800
    ds_read_b64_tr_b16 v[44:45], v110 offset:33824
    ds_read_b64_tr_b16 v[46:47], v110 offset:40992
    ds_read_b64_tr_b16 v[48:49], v110 offset:42016
    s_waitcnt vmcnt(32)
    s_waitcnt lgkmcnt(0)
    s_barrier
    s_add_u32 s56, s58, 2621440
    s_add_u32 m0, s65, 81920
    s_nop 0
    buffer_load_dwordx4 v111, s[20:23], s56 offen lds
    s_add_u32 m0, m0, 1024
    s_add_u32 s56, s56, 32768
    buffer_load_dwordx4 v111, s[20:23], s56 offen lds
    s_add_u32 m0, m0, 1024
    s_add_u32 s56, s56, 32768
    buffer_load_dwordx4 v111, s[20:23], s56 offen lds
    s_add_u32 m0, m0, 1024
    s_add_u32 s56, s56, 32768
    buffer_load_dwordx4 v111, s[20:23], s56 offen lds
    v_add_u32 v110, 49152, v110
    ds_read_b64_tr_b16 a[192:193], v110 offset:0
    ds_read_b64_tr_b16 a[194:195], v110 offset:1024
    ds_read_b64_tr_b16 a[196:197], v110 offset:8192
    ds_read_b64_tr_b16 a[198:199], v110 offset:9216
    ds_read_b64_tr_b16 v[50:51], v110 offset:32
    ds_read_b64_tr_b16 v[52:53], v110 offset:1056
    ds_read_b64_tr_b16 v[54:55], v110 offset:8224
    ds_read_b64_tr_b16 v[56:57], v110 offset:9248
    s_waitcnt vmcnt(32)
    s_waitcnt lgkmcnt(0)
    s_barrier
    s_add_u32 s56, s58, 3145728
    s_add_u32 m0, s65, 98304
    s_nop 0
    buffer_load_dwordx4 v111, s[20:23], s56 offen lds
    s_add_u32 m0, m0, 1024
    s_add_u32 s56, s56, 32768
    buffer_load_dwordx4 v111, s[20:23], s56 offen lds
    s_add_u32 m0, m0, 1024
    s_add_u32 s56, s56, 32768
    buffer_load_dwordx4 v111, s[20:23], s56 offen lds
    s_add_u32 m0, m0, 1024
    s_add_u32 s56, s56, 32768
    buffer_load_dwordx4 v111, s[20:23], s56 offen lds
    ds_read_b64_tr_b16 a[200:201], v110 offset:16384
    ds_read_b64_tr_b16 a[202:203], v110 offset:17408
    ds_read_b64_tr_b16 a[204:205], v110 offset:24576
    ds_read_b64_tr_b16 a[206:207], v110 offset:25600
    ds_read_b64_tr_b16 v[58:59], v110 offset:16416
    ds_read_b64_tr_b16 v[60:61], v110 offset:17440
    ds_read_b64_tr_b16 v[62:63], v110 offset:24608
    ds_read_b64_tr_b16 v[64:65], v110 offset:25632
    s_waitcnt vmcnt(32)
    s_waitcnt lgkmcnt(0)
    s_barrier
    s_add_u32 s56, s58, 3670016
    s_add_u32 m0, s65, 114688
    s_nop 0
    buffer_load_dwordx4 v111, s[20:23], s56 offen lds
    s_add_u32 m0, m0, 1024
    s_add_u32 s56, s56, 32768
    buffer_load_dwordx4 v111, s[20:23], s56 offen lds
    s_add_u32 m0, m0, 1024
    s_add_u32 s56, s56, 32768
    buffer_load_dwordx4 v111, s[20:23], s56 offen lds
    s_add_u32 m0, m0, 1024
    s_add_u32 s56, s56, 32768
    buffer_load_dwordx4 v111, s[20:23], s56 offen lds
    ds_read_b64_tr_b16 a[224:225], v110 offset:32768
    ds_read_b64_tr_b16 a[226:227], v110 offset:33792
    ds_read_b64_tr_b16 a[228:229], v110 offset:40960
    ds_read_b64_tr_b16 a[230:231], v110 offset:41984
    ds_read_b64_tr_b16 v[82:83], v110 offset:32800
    ds_read_b64_tr_b16 v[84:85], v110 offset:33824
    ds_read_b64_tr_b16 v[86:87], v110 offset:40992
    ds_read_b64_tr_b16 v[88:89], v110 offset:42016
    s_waitcnt vmcnt(32)
    s_waitcnt lgkmcnt(0)
    s_barrier
    s_add_u32 s56, s58, 4194304
    s_add_u32 m0, s65, 131072
    s_nop 0
    buffer_load_dwordx4 v111, s[20:23], s56 offen lds
    s_add_u32 m0, m0, 1024
    s_add_u32 s56, s56, 32768
    buffer_load_dwordx4 v111, s[20:23], s56 offen lds
    s_add_u32 m0, m0, 1024
    s_add_u32 s56, s56, 32768
    buffer_load_dwordx4 v111, s[20:23], s56 offen lds
    s_add_u32 m0, m0, 1024
    s_add_u32 s56, s56, 32768
    buffer_load_dwordx4 v111, s[20:23], s56 offen lds
    v_add_u32 v110, 49152, v110
    ds_read_b64_tr_b16 a[232:233], v110 offset:0
    ds_read_b64_tr_b16 a[234:235], v110 offset:1024
    ds_read_b64_tr_b16 a[236:237], v110 offset:8192
    ds_read_b64_tr_b16 a[238:239], v110 offset:9216
    ds_read_b64_tr_b16 v[90:91], v110 offset:32
    ds_read_b64_tr_b16 v[92:93], v110 offset:1056
    ds_read_b64_tr_b16 v[94:95], v110 offset:8224
    ds_read_b64_tr_b16 v[96:97], v110 offset:9248
    s_waitcnt vmcnt(32)
    s_waitcnt lgkmcnt(0)
    s_barrier
    s_add_u32 s56, s58, 4718592
    s_add_u32 m0, s65, 147456
    s_nop 0
    buffer_load_dwordx4 v111, s[20:23], s56 offen lds
    s_add_u32 m0, m0, 1024
    s_add_u32 s56, s56, 32768
    buffer_load_dwordx4 v111, s[20:23], s56 offen lds
    s_add_u32 m0, m0, 1024
    s_add_u32 s56, s56, 32768
    buffer_load_dwordx4 v111, s[20:23], s56 offen lds
    s_add_u32 m0, m0, 1024
    s_add_u32 s56, s56, 32768
    buffer_load_dwordx4 v111, s[20:23], s56 offen lds
    v_add_u32 v110, -147456, v110
    ds_read_b64_tr_b16 v[144:145], v110 offset:0
    ds_read_b64_tr_b16 v[146:147], v110 offset:1024
    ds_read_b64_tr_b16 v[148:149], v110 offset:8192
    ds_read_b64_tr_b16 v[150:151], v110 offset:9216
    ds_read_b64_tr_b16 v[224:225], v110 offset:32
    ds_read_b64_tr_b16 v[226:227], v110 offset:1056
    ds_read_b64_tr_b16 v[228:229], v110 offset:8224
    ds_read_b64_tr_b16 v[230:231], v110 offset:9248
    s_waitcnt vmcnt(32)
    s_waitcnt lgkmcnt(0)
    s_barrier
    s_add_u32 s56, s58, 0
    s_add_u32 m0, s65, 0
    s_nop 0
    buffer_load_dwordx4 v111, s[12:15], s56 offen lds
    s_add_u32 m0, m0, 1024
    s_add_u32 s56, s56, 32768
    buffer_load_dwordx4 v111, s[12:15], s56 offen lds
    s_add_u32 m0, m0, 1024
    s_add_u32 s56, s56, 32768
    buffer_load_dwordx4 v111, s[12:15], s56 offen lds
    s_add_u32 m0, m0, 1024
    s_add_u32 s56, s56, 32768
    buffer_load_dwordx4 v111, s[12:15], s56 offen lds
    ds_read_b64_tr_b16 v[152:153], v110 offset:16384
    ds_read_b64_tr_b16 v[154:155], v110 offset:17408
    ds_read_b64_tr_b16 v[156:157], v110 offset:24576
    ds_read_b64_tr_b16 v[158:159], v110 offset:25600
    ds_read_b64_tr_b16 v[232:233], v110 offset:16416
    ds_read_b64_tr_b16 v[234:235], v110 offset:17440
    ds_read_b64_tr_b16 v[236:237], v110 offset:24608
    ds_read_b64_tr_b16 v[238:239], v110 offset:25632
    s_waitcnt vmcnt(32)
    s_waitcnt lgkmcnt(0)
    s_barrier
    s_add_u32 s56, s58, 524288
    s_add_u32 m0, s65, 16384
    s_nop 0
    buffer_load_dwordx4 v111, s[12:15], s56 offen lds
    s_add_u32 m0, m0, 1024
    s_add_u32 s56, s56, 32768
    buffer_load_dwordx4 v111, s[12:15], s56 offen lds
    s_add_u32 m0, m0, 1024
    s_add_u32 s56, s56, 32768
    buffer_load_dwordx4 v111, s[12:15], s56 offen lds
    s_add_u32 m0, m0, 1024
    s_add_u32 s56, s56, 32768
    buffer_load_dwordx4 v111, s[12:15], s56 offen lds
    ds_read_b64_tr_b16 a[240:241], v110 offset:32768
    ds_read_b64_tr_b16 a[242:243], v110 offset:33792
    ds_read_b64_tr_b16 a[244:245], v110 offset:40960
    ds_read_b64_tr_b16 a[246:247], v110 offset:41984
    ds_read_b64_tr_b16 v[176:177], v110 offset:32800
    ds_read_b64_tr_b16 v[178:179], v110 offset:33824
    ds_read_b64_tr_b16 v[180:181], v110 offset:40992
    ds_read_b64_tr_b16 v[182:183], v110 offset:42016
    s_waitcnt vmcnt(32)
    s_waitcnt lgkmcnt(0)
    s_barrier
    s_add_u32 s56, s58, 1048576
    s_add_u32 m0, s65, 32768
    s_nop 0
    buffer_load_dwordx4 v111, s[12:15], s56 offen lds
    s_add_u32 m0, m0, 1024
    s_add_u32 s56, s56, 32768
    buffer_load_dwordx4 v111, s[12:15], s56 offen lds
    s_add_u32 m0, m0, 1024
    s_add_u32 s56, s56, 32768
    buffer_load_dwordx4 v111, s[12:15], s56 offen lds
    s_add_u32 m0, m0, 1024
    s_add_u32 s56, s56, 32768
    buffer_load_dwordx4 v111, s[12:15], s56 offen lds
    v_add_u32 v110, 49152, v110
    ds_read_b64_tr_b16 a[248:249], v110 offset:0
    ds_read_b64_tr_b16 a[250:251], v110 offset:1024
    ds_read_b64_tr_b16 a[252:253], v110 offset:8192
    ds_read_b64_tr_b16 a[254:255], v110 offset:9216
    ds_read_b64_tr_b16 v[184:185], v110 offset:32
    ds_read_b64_tr_b16 v[186:187], v110 offset:1056
    ds_read_b64_tr_b16 v[188:189], v110 offset:8224
    ds_read_b64_tr_b16 v[190:191], v110 offset:9248
    s_waitcnt vmcnt(32)
    s_waitcnt lgkmcnt(0)
    s_barrier
    s_add_u32 s56, s58, 1572864
    s_add_u32 m0, s65, 49152
    s_nop 0
    buffer_load_dwordx4 v111, s[12:15], s56 offen lds
    s_add_u32 m0, m0, 1024
    s_add_u32 s56, s56, 32768
    buffer_load_dwordx4 v111, s[12:15], s56 offen lds
    s_add_u32 m0, m0, 1024
    s_add_u32 s56, s56, 32768
    buffer_load_dwordx4 v111, s[12:15], s56 offen lds
    s_add_u32 m0, m0, 1024
    s_add_u32 s56, s56, 32768
    buffer_load_dwordx4 v111, s[12:15], s56 offen lds
    ds_read_b64_tr_b16 v[112:113], v110 offset:16384
    ds_read_b64_tr_b16 v[114:115], v110 offset:17408
    ds_read_b64_tr_b16 v[116:117], v110 offset:24576
    ds_read_b64_tr_b16 v[118:119], v110 offset:25600
    ds_read_b64_tr_b16 v[192:193], v110 offset:16416
    ds_read_b64_tr_b16 v[194:195], v110 offset:17440
    ds_read_b64_tr_b16 v[196:197], v110 offset:24608
    ds_read_b64_tr_b16 v[198:199], v110 offset:25632
    s_waitcnt vmcnt(32)
    s_waitcnt lgkmcnt(0)
    s_barrier
    s_add_u32 s56, s58, 2097152
    s_add_u32 m0, s65, 65536
    s_nop 0
    buffer_load_dwordx4 v111, s[12:15], s56 offen lds
    s_add_u32 m0, m0, 1024
    s_add_u32 s56, s56, 32768
    buffer_load_dwordx4 v111, s[12:15], s56 offen lds
    s_add_u32 m0, m0, 1024
    s_add_u32 s56, s56, 32768
    buffer_load_dwordx4 v111, s[12:15], s56 offen lds
    s_add_u32 m0, m0, 1024
    s_add_u32 s56, s56, 32768
    buffer_load_dwordx4 v111, s[12:15], s56 offen lds
    ds_read_b64_tr_b16 v[120:121], v110 offset:32768
    ds_read_b64_tr_b16 v[122:123], v110 offset:33792
    ds_read_b64_tr_b16 v[124:125], v110 offset:40960
    ds_read_b64_tr_b16 v[126:127], v110 offset:41984
    ds_read_b64_tr_b16 v[200:201], v110 offset:32800
    ds_read_b64_tr_b16 v[202:203], v110 offset:33824
    ds_read_b64_tr_b16 v[204:205], v110 offset:40992
    ds_read_b64_tr_b16 v[206:207], v110 offset:42016
    s_waitcnt vmcnt(32)
    s_waitcnt lgkmcnt(0)
    s_barrier
    s_add_u32 s56, s58, 2621440
    s_add_u32 m0, s65, 81920
    s_nop 0
    buffer_load_dwordx4 v111, s[12:15], s56 offen lds
    s_add_u32 m0, m0, 1024
    s_add_u32 s56, s56, 32768
    buffer_load_dwordx4 v111, s[12:15], s56 offen lds
    s_add_u32 m0, m0, 1024
    s_add_u32 s56, s56, 32768
    buffer_load_dwordx4 v111, s[12:15], s56 offen lds
    s_add_u32 m0, m0, 1024
    s_add_u32 s56, s56, 32768
    buffer_load_dwordx4 v111, s[12:15], s56 offen lds
    v_add_u32 v110, 49152, v110
    ds_read_b64_tr_b16 v[128:129], v110 offset:0
    ds_read_b64_tr_b16 v[130:131], v110 offset:1024
    ds_read_b64_tr_b16 v[132:133], v110 offset:8192
    ds_read_b64_tr_b16 v[134:135], v110 offset:9216
    ds_read_b64_tr_b16 v[208:209], v110 offset:32
    ds_read_b64_tr_b16 v[210:211], v110 offset:1056
    ds_read_b64_tr_b16 v[212:213], v110 offset:8224
    ds_read_b64_tr_b16 v[214:215], v110 offset:9248
    s_waitcnt vmcnt(32)
    s_waitcnt lgkmcnt(0)
    s_barrier
    s_add_u32 s56, s58, 3145728
    s_add_u32 m0, s65, 98304
    s_nop 0
    buffer_load_dwordx4 v111, s[12:15], s56 offen lds
    s_add_u32 m0, m0, 1024
    s_add_u32 s56, s56, 32768
    buffer_load_dwordx4 v111, s[12:15], s56 offen lds
    s_add_u32 m0, m0, 1024
    s_add_u32 s56, s56, 32768
    buffer_load_dwordx4 v111, s[12:15], s56 offen lds
    s_add_u32 m0, m0, 1024
    s_add_u32 s56, s56, 32768
    buffer_load_dwordx4 v111, s[12:15], s56 offen lds
    ds_read_b64_tr_b16 v[136:137], v110 offset:16384
    ds_read_b64_tr_b16 v[138:139], v110 offset:17408
    ds_read_b64_tr_b16 v[140:141], v110 offset:24576
    ds_read_b64_tr_b16 v[142:143], v110 offset:25600
    ds_read_b64_tr_b16 v[216:217], v110 offset:16416
    ds_read_b64_tr_b16 v[218:219], v110 offset:17440
    ds_read_b64_tr_b16 v[220:221], v110 offset:24608
    ds_read_b64_tr_b16 v[222:223], v110 offset:25632
    s_waitcnt vmcnt(32)
    s_waitcnt lgkmcnt(0)
    s_barrier
    s_add_u32 s56, s58, 3670016
    s_add_u32 m0, s65, 114688
    s_nop 0
    buffer_load_dwordx4 v111, s[12:15], s56 offen lds
    s_add_u32 m0, m0, 1024
    s_add_u32 s56, s56, 32768
    buffer_load_dwordx4 v111, s[12:15], s56 offen lds
    s_add_u32 m0, m0, 1024
    s_add_u32 s56, s56, 32768
    buffer_load_dwordx4 v111, s[12:15], s56 offen lds
    s_add_u32 m0, m0, 1024
    s_add_u32 s56, s56, 32768
    buffer_load_dwordx4 v111, s[12:15], s56 offen lds
    ds_read_b64_tr_b16 v[160:161], v110 offset:32768
    ds_read_b64_tr_b16 v[162:163], v110 offset:33792
    ds_read_b64_tr_b16 v[164:165], v110 offset:40960
    ds_read_b64_tr_b16 v[166:167], v110 offset:41984
    ds_read_b64_tr_b16 v[240:241], v110 offset:32800
    ds_read_b64_tr_b16 v[242:243], v110 offset:33824
    ds_read_b64_tr_b16 v[244:245], v110 offset:40992
    ds_read_b64_tr_b16 v[246:247], v110 offset:42016
    s_waitcnt vmcnt(32)
    s_waitcnt lgkmcnt(0)
    s_barrier
    s_add_u32 s56, s58, 4194304
    s_add_u32 m0, s65, 131072
    s_nop 0
    buffer_load_dwordx4 v111, s[12:15], s56 offen lds
    s_add_u32 m0, m0, 1024
    s_add_u32 s56, s56, 32768
    buffer_load_dwordx4 v111, s[12:15], s56 offen lds
    s_add_u32 m0, m0, 1024
    s_add_u32 s56, s56, 32768
    buffer_load_dwordx4 v111, s[12:15], s56 offen lds
    s_add_u32 m0, m0, 1024
    s_add_u32 s56, s56, 32768
    buffer_load_dwordx4 v111, s[12:15], s56 offen lds
    v_add_u32 v110, 49152, v110
    ds_read_b64_tr_b16 v[168:169], v110 offset:0
    ds_read_b64_tr_b16 v[170:171], v110 offset:1024
    ds_read_b64_tr_b16 v[172:173], v110 offset:8192
    ds_read_b64_tr_b16 v[174:175], v110 offset:9216
    ds_read_b64_tr_b16 v[248:249], v110 offset:32
    ds_read_b64_tr_b16 v[250:251], v110 offset:1056
    ds_read_b64_tr_b16 v[252:253], v110 offset:8224
    ds_read_b64_tr_b16 v[254:255], v110 offset:9248
    s_waitcnt vmcnt(32)
    s_waitcnt lgkmcnt(0)
    s_barrier
    s_add_u32 s56, s58, 4718592
    s_add_u32 m0, s65, 147456
    s_nop 0
    buffer_load_dwordx4 v111, s[12:15], s56 offen lds
    s_add_u32 m0, m0, 1024
    s_add_u32 s56, s56, 32768
    buffer_load_dwordx4 v111, s[12:15], s56 offen lds
    s_add_u32 m0, m0, 1024
    s_add_u32 s56, s56, 32768
    buffer_load_dwordx4 v111, s[12:15], s56 offen lds
    s_add_u32 m0, m0, 1024
    s_add_u32 s56, s56, 32768
    buffer_load_dwordx4 v111, s[12:15], s56 offen lds
    v_add_u32 v110, -147456, v110
    ds_read_b64_tr_b16 a[48:49], v110 offset:0
    ds_read_b64_tr_b16 a[50:51], v110 offset:1024
    ds_read_b64_tr_b16 a[52:53], v110 offset:8192
    ds_read_b64_tr_b16 a[54:55], v110 offset:9216
    ds_read_b64_tr_b16 a[128:129], v110 offset:32
    ds_read_b64_tr_b16 a[130:131], v110 offset:1056
    ds_read_b64_tr_b16 a[132:133], v110 offset:8224
    ds_read_b64_tr_b16 a[134:135], v110 offset:9248
    s_waitcnt vmcnt(32)
    s_waitcnt lgkmcnt(0)
    s_barrier
    ds_read_b64_tr_b16 a[56:57], v110 offset:16384
    ds_read_b64_tr_b16 a[58:59], v110 offset:17408
    ds_read_b64_tr_b16 a[60:61], v110 offset:24576
    ds_read_b64_tr_b16 a[62:63], v110 offset:25600
    ds_read_b64_tr_b16 a[136:137], v110 offset:16416
    ds_read_b64_tr_b16 a[138:139], v110 offset:17440
    ds_read_b64_tr_b16 a[140:141], v110 offset:24608
    ds_read_b64_tr_b16 a[142:143], v110 offset:25632
    s_waitcnt vmcnt(28)
    s_waitcnt lgkmcnt(0)
    s_barrier
    ds_read_b64_tr_b16 a[0:1], v110 offset:32768
    ds_read_b64_tr_b16 a[2:3], v110 offset:33792
    ds_read_b64_tr_b16 a[4:5], v110 offset:40960
    ds_read_b64_tr_b16 a[6:7], v110 offset:41984
    ds_read_b64_tr_b16 a[80:81], v110 offset:32800
    ds_read_b64_tr_b16 a[82:83], v110 offset:33824
    ds_read_b64_tr_b16 a[84:85], v110 offset:40992
    ds_read_b64_tr_b16 a[86:87], v110 offset:42016
    s_waitcnt vmcnt(24)
    s_waitcnt lgkmcnt(0)
    s_barrier
    v_add_u32 v110, 49152, v110
    ds_read_b64_tr_b16 a[8:9], v110 offset:0
    ds_read_b64_tr_b16 a[10:11], v110 offset:1024
    ds_read_b64_tr_b16 a[12:13], v110 offset:8192
    ds_read_b64_tr_b16 a[14:15], v110 offset:9216
    ds_read_b64_tr_b16 a[88:89], v110 offset:32
    ds_read_b64_tr_b16 a[90:91], v110 offset:1056
    ds_read_b64_tr_b16 a[92:93], v110 offset:8224
    ds_read_b64_tr_b16 a[94:95], v110 offset:9248
    s_waitcnt vmcnt(20)
    s_waitcnt lgkmcnt(0)
    s_barrier
    ds_read_b64_tr_b16 a[16:17], v110 offset:16384
    ds_read_b64_tr_b16 a[18:19], v110 offset:17408
    ds_read_b64_tr_b16 a[20:21], v110 offset:24576
    ds_read_b64_tr_b16 a[22:23], v110 offset:25600
    ds_read_b64_tr_b16 a[96:97], v110 offset:16416
    ds_read_b64_tr_b16 a[98:99], v110 offset:17440
    ds_read_b64_tr_b16 a[100:101], v110 offset:24608
    ds_read_b64_tr_b16 a[102:103], v110 offset:25632
    s_waitcnt vmcnt(16)
    s_waitcnt lgkmcnt(0)
    s_barrier
    ds_read_b64_tr_b16 a[24:25], v110 offset:32768
    ds_read_b64_tr_b16 a[26:27], v110 offset:33792
    ds_read_b64_tr_b16 a[28:29], v110 offset:40960
    ds_read_b64_tr_b16 a[30:31], v110 offset:41984
    ds_read_b64_tr_b16 a[104:105], v110 offset:32800
    ds_read_b64_tr_b16 a[106:107], v110 offset:33824
    ds_read_b64_tr_b16 a[108:109], v110 offset:40992
    ds_read_b64_tr_b16 a[110:111], v110 offset:42016
    s_waitcnt vmcnt(12)
    s_waitcnt lgkmcnt(0)
    s_barrier
    v_add_u32 v110, 49152, v110
    ds_read_b64_tr_b16 a[32:33], v110 offset:0
    ds_read_b64_tr_b16 a[34:35], v110 offset:1024
    ds_read_b64_tr_b16 a[36:37], v110 offset:8192
    ds_read_b64_tr_b16 a[38:39], v110 offset:9216
    ds_read_b64_tr_b16 a[112:113], v110 offset:32
    ds_read_b64_tr_b16 a[114:115], v110 offset:1056
    ds_read_b64_tr_b16 a[116:117], v110 offset:8224
    ds_read_b64_tr_b16 a[118:119], v110 offset:9248
    s_waitcnt vmcnt(8)
    s_waitcnt lgkmcnt(0)
    s_barrier
    ds_read_b64_tr_b16 a[40:41], v110 offset:16384
    ds_read_b64_tr_b16 a[42:43], v110 offset:17408
    ds_read_b64_tr_b16 a[44:45], v110 offset:24576
    ds_read_b64_tr_b16 a[46:47], v110 offset:25600
    ds_read_b64_tr_b16 a[120:121], v110 offset:16416
    ds_read_b64_tr_b16 a[122:123], v110 offset:17440
    ds_read_b64_tr_b16 a[124:125], v110 offset:24608
    ds_read_b64_tr_b16 a[126:127], v110 offset:25632
    s_waitcnt vmcnt(4)
    s_waitcnt lgkmcnt(0)
    s_barrier
    ds_read_b64_tr_b16 a[64:65], v110 offset:32768
    ds_read_b64_tr_b16 a[66:67], v110 offset:33792
    ds_read_b64_tr_b16 a[68:69], v110 offset:40960
    ds_read_b64_tr_b16 a[70:71], v110 offset:41984
    ds_read_b64_tr_b16 a[144:145], v110 offset:32800
    ds_read_b64_tr_b16 a[146:147], v110 offset:33824
    ds_read_b64_tr_b16 a[148:149], v110 offset:40992
    ds_read_b64_tr_b16 a[150:151], v110 offset:42016
    s_waitcnt vmcnt(0)
    s_waitcnt lgkmcnt(0)
    s_barrier
    v_add_u32 v110, 49152, v110
    ds_read_b64_tr_b16 a[72:73], v110 offset:0
    ds_read_b64_tr_b16 a[74:75], v110 offset:1024
    ds_read_b64_tr_b16 a[76:77], v110 offset:8192
    ds_read_b64_tr_b16 a[78:79], v110 offset:9216
    ds_read_b64_tr_b16 a[152:153], v110 offset:32
    ds_read_b64_tr_b16 a[154:155], v110 offset:1056
    ds_read_b64_tr_b16 a[156:157], v110 offset:8224
    ds_read_b64_tr_b16 a[158:159], v110 offset:9248
    s_waitcnt lgkmcnt(0)
    s_branch L_head_ldd
L_head_ld2:
    s_cmp_lg_u32 s3, 2
    s_cbranch_scc1 L_head_ld3
    s_add_u32 s56, s58, 0
    s_add_u32 m0, s65, 0
    s_nop 0
    buffer_load_dwordx4 v111, s[16:19], s56 offen lds
    s_add_u32 m0, m0, 1024
    s_add_u32 s56, s56, 32768
    buffer_load_dwordx4 v111, s[16:19], s56 offen lds
    s_add_u32 m0, m0, 1024
    s_add_u32 s56, s56, 32768
    buffer_load_dwordx4 v111, s[16:19], s56 offen lds
    s_add_u32 m0, m0, 1024
    s_add_u32 s56, s56, 32768
    buffer_load_dwordx4 v111, s[16:19], s56 offen lds
    s_add_u32 s56, s58, 524288
    s_add_u32 m0, s65, 16384
    s_nop 0
    buffer_load_dwordx4 v111, s[16:19], s56 offen lds
    s_add_u32 m0, m0, 1024
    s_add_u32 s56, s56, 32768
    buffer_load_dwordx4 v111, s[16:19], s56 offen lds
    s_add_u32 m0, m0, 1024
    s_add_u32 s56, s56, 32768
    buffer_load_dwordx4 v111, s[16:19], s56 offen lds
    s_add_u32 m0, m0, 1024
    s_add_u32 s56, s56, 32768
    buffer_load_dwordx4 v111, s[16:19], s56 offen lds
    s_add_u32 s56, s58, 1048576
    s_add_u32 m0, s65, 32768
    s_nop 0
    buffer_load_dwordx4 v111, s[16:19], s56 offen lds
    s_add_u32 m0, m0, 1024
    s_add_u32 s56, s56, 32768
    buffer_load_dwordx4 v111, s[16:19], s56 offen lds
    s_add_u32 m0, m0, 1024
    s_add_u32 s56, s56, 32768
    buffer_load_dwordx4 v111, s[16:19], s56 offen lds
    s_add_u32 m0, m0, 1024
    s_add_u32 s56, s56, 32768
    buffer_load_dwordx4 v111, s[16:19], s56 offen lds
    s_add_u32 s56, s58, 1572864
    s_add_u32 m0, s65, 49152
    s_nop 0
    buffer_load_dwordx4 v111, s[16:19], s56 offen lds
    s_add_u32 m0, m0, 1024
    s_add_u32 s56, s56, 32768
    buffer_load_dwordx4 v111, s[16:19], s56 offen lds
    s_add_u32 m0, m0, 1024
    s_add_u32 s56, s56, 32768
    buffer_load_dwordx4 v111, s[16:19], s56 offen lds
    s_add_u32 m0, m0, 1024
    s_add_u32 s56, s56, 32768
    buffer_load_dwordx4 v111, s[16:19], s56 offen lds
    s_add_u32 s56, s58, 2097152
    s_add_u32 m0, s65, 65536
    s_nop 0
    buffer_load_dwordx4 v111, s[16:19], s56 offen lds
    s_add_u32 m0, m0, 1024
    s_add_u32 s56, s56, 32768
    buffer_load_dwordx4 v111, s[16:19], s56 offen lds
    s_add_u32 m0, m0, 1024
    s_add_u32 s56, s56, 32768
    buffer_load_dwordx4 v111, s[16:19], s56 offen lds
    s_add_u32 m0, m0, 1024
    s_add_u32 s56, s56, 32768
    buffer_load_dwordx4 v111, s[16:19], s56 offen lds
    s_add_u32 s56, s58, 2621440
    s_add_u32 m0, s65, 81920
    s_nop 0
    buffer_load_dwordx4 v111, s[16:19], s56 offen lds
    s_add_u32 m0, m0, 1024
    s_add_u32 s56, s56, 32768
    buffer_load_dwordx4 v111, s[16:19], s56 offen lds
    s_add_u32 m0, m0, 1024
    s_add_u32 s56, s56, 32768
    buffer_load_dwordx4 v111, s[16:19], s56 offen lds
    s_add_u32 m0, m0, 1024
    s_add_u32 s56, s56, 32768
    buffer_load_dwordx4 v111, s[16:19], s56 offen lds
    s_add_u32 s56, s58, 3145728
    s_add_u32 m0, s65, 98304
    s_nop 0
    buffer_load_dwordx4 v111, s[16:19], s56 offen lds
    s_add_u32 m0, m0, 1024
    s_add_u32 s56, s56, 32768
    buffer_load_dwordx4 v111, s[16:19], s56 offen lds
    s_add_u32 m0, m0, 1024
    s_add_u32 s56, s56, 32768
    buffer_load_dwordx4 v111, s[16:19], s56 offen lds
    s_add_u32 m0, m0, 1024
    s_add_u32 s56, s56, 32768
    buffer_load_dwordx4 v111, s[16:19], s56 offen lds
    s_add_u32 s56, s58, 3670016
    s_add_u32 m0, s65, 114688
    s_nop 0
    buffer_load_dwordx4 v111, s[16:19], s56 offen lds
    s_add_u32 m0, m0, 1024
    s_add_u32 s56, s56, 32768
    buffer_load_dwordx4 v111, s[16:19], s56 offen lds
    s_add_u32 m0, m0, 1024
    s_add_u32 s56, s56, 32768
    buffer_load_dwordx4 v111, s[16:19], s56 offen lds
    s_add_u32 m0, m0, 1024
    s_add_u32 s56, s56, 32768
    buffer_load_dwordx4 v111, s[16:19], s56 offen lds
    s_add_u32 s56, s58, 4194304
    s_add_u32 m0, s65, 131072
    s_nop 0
    buffer_load_dwordx4 v111, s[16:19], s56 offen lds
    s_add_u32 m0, m0, 1024
    s_add_u32 s56, s56, 32768
    buffer_load_dwordx4 v111, s[16:19], s56 offen lds
    s_add_u32 m0, m0, 1024
    s_add_u32 s56, s56, 32768
    buffer_load_dwordx4 v111, s[16:19], s56 offen lds
    s_add_u32 m0, m0, 1024
    s_add_u32 s56, s56, 32768
    buffer_load_dwordx4 v111, s[16:19], s56 offen lds
    s_waitcnt vmcnt(32)
    s_waitcnt lgkmcnt(0)
    s_barrier
    s_add_u32 s56, s58, 4718592
    s_add_u32 m0, s65, 147456
    s_nop 0
    buffer_load_dwordx4 v111, s[16:19], s56 offen lds
    s_add_u32 m0, m0, 1024
    s_add_u32 s56, s56, 32768
    buffer_load_dwordx4 v111, s[16:19], s56 offen lds
    s_add_u32 m0, m0, 1024
    s_add_u32 s56, s56, 32768
    buffer_load_dwordx4 v111, s[16:19], s56 offen lds
    s_add_u32 m0, m0, 1024
    s_add_u32 s56, s56, 32768
    buffer_load_dwordx4 v111, s[16:19], s56 offen lds
    ds_read_b64_tr_b16 a[192:193], v110 offset:0
    ds_read_b64_tr_b16 a[194:195], v110 offset:1024
    ds_read_b64_tr_b16 a[196:197], v110 offset:8192
    ds_read_b64_tr_b16 a[198:199], v110 offset:9216
    ds_read_b64_tr_b16 v[50:51], v110 offset:32
    ds_read_b64_tr_b16 v[52:53], v110 offset:1056
    ds_read_b64_tr_b16 v[54:55], v110 offset:8224
    ds_read_b64_tr_b16 v[56:57], v110 offset:9248
    s_waitcnt vmcnt(32)
    s_waitcnt lgkmcnt(0)
    s_barrier
    s_add_u32 s56, s58, 0
    s_add_u32 m0, s65, 0
    s_nop 0
    buffer_load_dwordx4 v111, s[20:23], s56 offen lds
    s_add_u32 m0, m0, 1024
    s_add_u32 s56, s56, 32768
    buffer_load_dwordx4 v111, s[20:23], s56 offen lds
    s_add_u32 m0, m0, 1024
    s_add_u32 s56, s56, 32768
    buffer_load_dwordx4 v111, s[20:23], s56 offen lds
    s_add_u32 m0, m0, 1024
    s_add_u32 s56, s56, 32768
    buffer_load_dwordx4 v111, s[20:23], s56 offen lds
    ds_read_b64_tr_b16 a[200:201], v110 offset:16384
    ds_read_b64_tr_b16 a[202:203], v110 offset:17408
    ds_read_b64_tr_b16 a[204:205], v110 offset:24576
    ds_read_b64_tr_b16 a[206:207], v110 offset:25600
    ds_read_b64_tr_b16 v[58:59], v110 offset:16416
    ds_read_b64_tr_b16 v[60:61], v110 offset:17440
    ds_read_b64_tr_b16 v[62:63], v110 offset:24608
    ds_read_b64_tr_b16 v[64:65], v110 offset:25632
    s_waitcnt vmcnt(32)
    s_waitcnt lgkmcnt(0)
    s_barrier
    s_add_u32 s56, s58, 524288
    s_add_u32 m0, s65, 16384
    s_nop 0
    buffer_load_dwordx4 v111, s[20:23], s56 offen lds
    s_add_u32 m0, m0, 1024
    s_add_u32 s56, s56, 32768
    buffer_load_dwordx4 v111, s[20:23], s56 offen lds
    s_add_u32 m0, m0, 1024
    s_add_u32 s56, s56, 32768
    buffer_load_dwordx4 v111, s[20:23], s56 offen lds
    s_add_u32 m0, m0, 1024
    s_add_u32 s56, s56, 32768
    buffer_load_dwordx4 v111, s[20:23], s56 offen lds
    ds_read_b64_tr_b16 a[208:209], v110 offset:32768
    ds_read_b64_tr_b16 a[210:211], v110 offset:33792
    ds_read_b64_tr_b16 a[212:213], v110 offset:40960
    ds_read_b64_tr_b16 a[214:215], v110 offset:41984
    ds_read_b64_tr_b16 v[66:67], v110 offset:32800
    ds_read_b64_tr_b16 v[68:69], v110 offset:33824
    ds_read_b64_tr_b16 v[70:71], v110 offset:40992
    ds_read_b64_tr_b16 v[72:73], v110 offset:42016
    s_waitcnt vmcnt(32)
    s_waitcnt lgkmcnt(0)
    s_barrier
    s_add_u32 s56, s58, 1048576
    s_add_u32 m0, s65, 32768
    s_nop 0
    buffer_load_dwordx4 v111, s[20:23], s56 offen lds
    s_add_u32 m0, m0, 1024
    s_add_u32 s56, s56, 32768
    buffer_load_dwordx4 v111, s[20:23], s56 offen lds
    s_add_u32 m0, m0, 1024
    s_add_u32 s56, s56, 32768
    buffer_load_dwordx4 v111, s[20:23], s56 offen lds
    s_add_u32 m0, m0, 1024
    s_add_u32 s56, s56, 32768
    buffer_load_dwordx4 v111, s[20:23], s56 offen lds
    v_add_u32 v110, 49152, v110
    ds_read_b64_tr_b16 a[216:217], v110 offset:0
    ds_read_b64_tr_b16 a[218:219], v110 offset:1024
    ds_read_b64_tr_b16 a[220:221], v110 offset:8192
    ds_read_b64_tr_b16 a[222:223], v110 offset:9216
    ds_read_b64_tr_b16 v[74:75], v110 offset:32
    ds_read_b64_tr_b16 v[76:77], v110 offset:1056
    ds_read_b64_tr_b16 v[78:79], v110 offset:8224
    ds_read_b64_tr_b16 v[80:81], v110 offset:9248
    s_waitcnt vmcnt(32)
    s_waitcnt lgkmcnt(0)
    s_barrier
    s_add_u32 s56, s58, 1572864
    s_add_u32 m0, s65, 49152
    s_nop 0
    buffer_load_dwordx4 v111, s[20:23], s56 offen lds
    s_add_u32 m0, m0, 1024
    s_add_u32 s56, s56, 32768
    buffer_load_dwordx4 v111, s[20:23], s56 offen lds
    s_add_u32 m0, m0, 1024
    s_add_u32 s56, s56, 32768
    buffer_load_dwordx4 v111, s[20:23], s56 offen lds
    s_add_u32 m0, m0, 1024
    s_add_u32 s56, s56, 32768
    buffer_load_dwordx4 v111, s[20:23], s56 offen lds
    ds_read_b64_tr_b16 a[160:161], v110 offset:16384
    ds_read_b64_tr_b16 a[162:163], v110 offset:17408
    ds_read_b64_tr_b16 a[164:165], v110 offset:24576
    ds_read_b64_tr_b16 a[166:167], v110 offset:25600
    ds_read_b64_tr_b16 v[18:19], v110 offset:16416
    ds_read_b64_tr_b16 v[20:21], v110 offset:17440
    ds_read_b64_tr_b16 v[22:23], v110 offset:24608
    ds_read_b64_tr_b16 v[24:25], v110 offset:25632
    s_waitcnt vmcnt(32)
    s_waitcnt lgkmcnt(0)
    s_barrier
    s_add_u32 s56, s58, 2097152
    s_add_u32 m0, s65, 65536
    s_nop 0
    buffer_load_dwordx4 v111, s[20:23], s56 offen lds
    s_add_u32 m0, m0, 1024
    s_add_u32 s56, s56, 32768
    buffer_load_dwordx4 v111, s[20:23], s56 offen lds
    s_add_u32 m0, m0, 1024
    s_add_u32 s56, s56, 32768
    buffer_load_dwordx4 v111, s[20:23], s56 offen lds
    s_add_u32 m0, m0, 1024
    s_add_u32 s56, s56, 32768
    buffer_load_dwordx4 v111, s[20:23], s56 offen lds
    ds_read_b64_tr_b16 a[168:169], v110 offset:32768
    ds_read_b64_tr_b16 a[170:171], v110 offset:33792
    ds_read_b64_tr_b16 a[172:173], v110 offset:40960
    ds_read_b64_tr_b16 a[174:175], v110 offset:41984
    ds_read_b64_tr_b16 v[26:27], v110 offset:32800
    ds_read_b64_tr_b16 v[28:29], v110 offset:33824
    ds_read_b64_tr_b16 v[30:31], v110 offset:40992
    ds_read_b64_tr_b16 v[32:33], v110 offset:42016
    s_waitcnt vmcnt(32)
    s_waitcnt lgkmcnt(0)
    s_barrier
    s_add_u32 s56, s58, 2621440
    s_add_u32 m0, s65, 81920
    s_nop 0
    buffer_load_dwordx4 v111, s[20:23], s56 offen lds
    s_add_u32 m0, m0, 1024
    s_add_u32 s56, s56, 32768
    buffer_load_dwordx4 v111, s[20:23], s56 offen lds
    s_add_u32 m0, m0, 1024
    s_add_u32 s56, s56, 32768
    buffer_load_dwordx4 v111, s[20:23], s56 offen lds
    s_add_u32 m0, m0, 1024
    s_add_u32 s56, s56, 32768
    buffer_load_dwordx4 v111, s[20:23], s56 offen lds
    v_add_u32 v110, 49152, v110
    ds_read_b64_tr_b16 a[176:177], v110 offset:0
    ds_read_b64_tr_b16 a[178:179], v110 offset:1024
    ds_read_b64_tr_b16 a[180:181], v110 offset:8192
    ds_read_b64_tr_b16 a[182:183], v110 offset:9216
    ds_read_b64_tr_b16 v[34:35], v110 offset:32
    ds_read_b64_tr_b16 v[36:37], v110 offset:1056
    ds_read_b64_tr_b16 v[38:39], v110 offset:8224
    ds_read_b64_tr_b16 v[40:41], v110 offset:9248
    s_waitcnt vmcnt(32)
    s_waitcnt lgkmcnt(0)
    s_barrier
    s_add_u32 s56, s58, 3145728
    s_add_u32 m0, s65, 98304
    s_nop 0
    buffer_load_dwordx4 v111, s[20:23], s56 offen lds
    s_add_u32 m0, m0, 1024
    s_add_u32 s56, s56, 32768
    buffer_load_dwordx4 v111, s[20:23], s56 offen lds
    s_add_u32 m0, m0, 1024
    s_add_u32 s56, s56, 32768
    buffer_load_dwordx4 v111, s[20:23], s56 offen lds
    s_add_u32 m0, m0, 1024
    s_add_u32 s56, s56, 32768
    buffer_load_dwordx4 v111, s[20:23], s56 offen lds
    ds_read_b64_tr_b16 a[184:185], v110 offset:16384
    ds_read_b64_tr_b16 a[186:187], v110 offset:17408
    ds_read_b64_tr_b16 a[188:189], v110 offset:24576
    ds_read_b64_tr_b16 a[190:191], v110 offset:25600
    ds_read_b64_tr_b16 v[42:43], v110 offset:16416
    ds_read_b64_tr_b16 v[44:45], v110 offset:17440
    ds_read_b64_tr_b16 v[46:47], v110 offset:24608
    ds_read_b64_tr_b16 v[48:49], v110 offset:25632
    s_waitcnt vmcnt(32)
    s_waitcnt lgkmcnt(0)
    s_barrier
    s_add_u32 s56, s58, 3670016
    s_add_u32 m0, s65, 114688
    s_nop 0
    buffer_load_dwordx4 v111, s[20:23], s56 offen lds
    s_add_u32 m0, m0, 1024
    s_add_u32 s56, s56, 32768
    buffer_load_dwordx4 v111, s[20:23], s56 offen lds
    s_add_u32 m0, m0, 1024
    s_add_u32 s56, s56, 32768
    buffer_load_dwordx4 v111, s[20:23], s56 offen lds
    s_add_u32 m0, m0, 1024
    s_add_u32 s56, s56, 32768
    buffer_load_dwordx4 v111, s[20:23], s56 offen lds
    ds_read_b64_tr_b16 a[224:225], v110 offset:32768
    ds_read_b64_tr_b16 a[226:227], v110 offset:33792
    ds_read_b64_tr_b16 a[228:229], v110 offset:40960
    ds_read_b64_tr_b16 a[230:231], v110 offset:41984
    ds_read_b64_tr_b16 v[82:83], v110 offset:32800
    ds_read_b64_tr_b16 v[84:85], v110 offset:33824
    ds_read_b64_tr_b16 v[86:87], v110 offset:40992
    ds_read_b64_tr_b16 v[88:89], v110 offset:42016
    s_waitcnt vmcnt(32)
    s_waitcnt lgkmcnt(0)
    s_barrier
    s_add_u32 s56, s58, 4194304
    s_add_u32 m0, s65, 131072
    s_nop 0
    buffer_load_dwordx4 v111, s[20:23], s56 offen lds
    s_add_u32 m0, m0, 1024
    s_add_u32 s56, s56, 32768
    buffer_load_dwordx4 v111, s[20:23], s56 offen lds
    s_add_u32 m0, m0, 1024
    s_add_u32 s56, s56, 32768
    buffer_load_dwordx4 v111, s[20:23], s56 offen lds
    s_add_u32 m0, m0, 1024
    s_add_u32 s56, s56, 32768
    buffer_load_dwordx4 v111, s[20:23], s56 offen lds
    v_add_u32 v110, 49152, v110
    ds_read_b64_tr_b16 a[232:233], v110 offset:0
    ds_read_b64_tr_b16 a[234:235], v110 offset:1024
    ds_read_b64_tr_b16 a[236:237], v110 offset:8192
    ds_read_b64_tr_b16 a[238:239], v110 offset:9216
    ds_read_b64_tr_b16 v[90:91], v110 offset:32
    ds_read_b64_tr_b16 v[92:93], v110 offset:1056
    ds_read_b64_tr_b16 v[94:95], v110 offset:8224
    ds_read_b64_tr_b16 v[96:97], v110 offset:9248
    s_waitcnt vmcnt(32)
    s_waitcnt lgkmcnt(0)
    s_barrier
    s_add_u32 s56, s58, 4718592
    s_add_u32 m0, s65, 147456
    s_nop 0
    buffer_load_dwordx4 v111, s[20:23], s56 offen lds
    s_add_u32 m0, m0, 1024
    s_add_u32 s56, s56, 32768
    buffer_load_dwordx4 v111, s[20:23], s56 offen lds
    s_add_u32 m0, m0, 1024
    s_add_u32 s56, s56, 32768
    buffer_load_dwordx4 v111, s[20:23], s56 offen lds
    s_add_u32 m0, m0, 1024
    s_add_u32 s56, s56, 32768
    buffer_load_dwordx4 v111, s[20:23], s56 offen lds
    v_add_u32 v110, -147456, v110
    ds_read_b64_tr_b16 v[128:129], v110 offset:0
    ds_read_b64_tr_b16 v[130:131], v110 offset:1024
    ds_read_b64_tr_b16 v[132:133], v110 offset:8192
    ds_read_b64_tr_b16 v[134:135], v110 offset:9216
    ds_read_b64_tr_b16 v[208:209], v110 offset:32
    ds_read_b64_tr_b16 v[210:211], v110 offset:1056
    ds_read_b64_tr_b16 v[212:213], v110 offset:8224
    ds_read_b64_tr_b16 v[214:215], v110 offset:9248
    s_waitcnt vmcnt(32)
    s_waitcnt lgkmcnt(0)
    s_barrier
    s_add_u32 s56, s58, 0
    s_add_u32 m0, s65, 0
    s_nop 0
    buffer_load_dwordx4 v111, s[12:15], s56 offen lds
    s_add_u32 m0, m0, 1024
    s_add_u32 s56, s56, 32768
    buffer_load_dwordx4 v111, s[12:15], s56 offen lds
    s_add_u32 m0, m0, 1024
    s_add_u32 s56, s56, 32768
    buffer_load_dwordx4 v111, s[12:15], s56 offen lds
    s_add_u32 m0, m0, 1024
    s_add_u32 s56, s56, 32768
    buffer_load_dwordx4 v111, s[12:15], s56 offen lds
    ds_read_b64_tr_b16 v[136:137], v110 offset:16384
    ds_read_b64_tr_b16 v[138:139], v110 offset:17408
    ds_read_b64_tr_b16 v[140:141], v110 offset:24576
    ds_read_b64_tr_b16 v[142:143], v110 offset:25600
    ds_read_b64_tr_b16 v[216:217], v110 offset:16416
    ds_read_b64_tr_b16 v[218:219], v110 offset:17440
    ds_read_b64_tr_b16 v[220:221], v110 offset:24608
    ds_read_b64_tr_b16 v[222:223], v110 offset:25632
    s_waitcnt vmcnt(32)
    s_waitcnt lgkmcnt(0)
    s_barrier
    s_add_u32 s56, s58, 524288
    s_add_u32 m0, s65, 16384
    s_nop 0
    buffer_load_dwordx4 v111, s[12:15], s56 offen lds
    s_add_u32 m0, m0, 1024
    s_add_u32 s56, s56, 32768
    buffer_load_dwordx4 v111, s[12:15], s56 offen lds
    s_add_u32 m0, m0, 1024
    s_add_u32 s56, s56, 32768
    buffer_load_dwordx4 v111, s[12:15], s56 offen lds
    s_add_u32 m0, m0, 1024
    s_add_u32 s56, s56, 32768
    buffer_load_dwordx4 v111, s[12:15], s56 offen lds
    ds_read_b64_tr_b16 v[144:145], v110 offset:32768
    ds_read_b64_tr_b16 v[146:147], v110 offset:33792
    ds_read_b64_tr_b16 v[148:149], v110 offset:40960
    ds_read_b64_tr_b16 v[150:151], v110 offset:41984
    ds_read_b64_tr_b16 v[224:225], v110 offset:32800
    ds_read_b64_tr_b16 v[226:227], v110 offset:33824
    ds_read_b64_tr_b16 v[228:229], v110 offset:40992
    ds_read_b64_tr_b16 v[230:231], v110 offset:42016
    s_waitcnt vmcnt(32)
    s_waitcnt lgkmcnt(0)
    s_barrier
    s_add_u32 s56, s58, 1048576
    s_add_u32 m0, s65, 32768
    s_nop 0
    buffer_load_dwordx4 v111, s[12:15], s56 offen lds
    s_add_u32 m0, m0, 1024
    s_add_u32 s56, s56, 32768
    buffer_load_dwordx4 v111, s[12:15], s56 offen lds
    s_add_u32 m0, m0, 1024
    s_add_u32 s56, s56, 32768
    buffer_load_dwordx4 v111, s[12:15], s56 offen lds
    s_add_u32 m0, m0, 1024
    s_add_u32 s56, s56, 32768
    buffer_load_dwordx4 v111, s[12:15], s56 offen lds
    v_add_u32 v110, 49152, v110
    ds_read_b64_tr_b16 v[152:153], v110 offset:0
    ds_read_b64_tr_b16 v[154:155], v110 offset:1024
    ds_read_b64_tr_b16 v[156:157], v110 offset:8192
    ds_read_b64_tr_b16 v[158:159], v110 offset:9216
    ds_read_b64_tr_b16 v[232:233], v110 offset:32
    ds_read_b64_tr_b16 v[234:235], v110 offset:1056
    ds_read_b64_tr_b16 v[236:237], v110 offset:8224
    ds_read_b64_tr_b16 v[238:239], v110 offset:9248
    s_waitcnt vmcnt(32)
    s_waitcnt lgkmcnt(0)
    s_barrier
    s_add_u32 s56, s58, 1572864
    s_add_u32 m0, s65, 49152
    s_nop 0
    buffer_load_dwordx4 v111, s[12:15], s56 offen lds
    s_add_u32 m0, m0, 1024
    s_add_u32 s56, s56, 32768
    buffer_load_dwordx4 v111, s[12:15], s56 offen lds
    s_add_u32 m0, m0, 1024
    s_add_u32 s56, s56, 32768
    buffer_load_dwordx4 v111, s[12:15], s56 offen lds
    s_add_u32 m0, m0, 1024
    s_add_u32 s56, s56, 32768
    buffer_load_dwordx4 v111, s[12:15], s56 offen lds
    ds_read_b64_tr_b16 a[240:241], v110 offset:16384
    ds_read_b64_tr_b16 a[242:243], v110 offset:17408
    ds_read_b64_tr_b16 a[244:245], v110 offset:24576
    ds_read_b64_tr_b16 a[246:247], v110 offset:25600
    ds_read_b64_tr_b16 v[176:177], v110 offset:16416
    ds_read_b64_tr_b16 v[178:179], v110 offset:17440
    ds_read_b64_tr_b16 v[180:181], v110 offset:24608
    ds_read_b64_tr_b16 v[182:183], v110 offset:25632
    s_waitcnt vmcnt(32)
    s_waitcnt lgkmcnt(0)
    s_barrier
    s_add_u32 s56, s58, 2097152
    s_add_u32 m0, s65, 65536
    s_nop 0
    buffer_load_dwordx4 v111, s[12:15], s56 offen lds
    s_add_u32 m0, m0, 1024
    s_add_u32 s56, s56, 32768
    buffer_load_dwordx4 v111, s[12:15], s56 offen lds
    s_add_u32 m0, m0, 1024
    s_add_u32 s56, s56, 32768
    buffer_load_dwordx4 v111, s[12:15], s56 offen lds
    s_add_u32 m0, m0, 1024
    s_add_u32 s56, s56, 32768
    buffer_load_dwordx4 v111, s[12:15], s56 offen lds
    ds_read_b64_tr_b16 a[248:249], v110 offset:32768
    ds_read_b64_tr_b16 a[250:251], v110 offset:33792
    ds_read_b64_tr_b16 a[252:253], v110 offset:40960
    ds_read_b64_tr_b16 a[254:255], v110 offset:41984
    ds_read_b64_tr_b16 v[184:185], v110 offset:32800
    ds_read_b64_tr_b16 v[186:187], v110 offset:33824
    ds_read_b64_tr_b16 v[188:189], v110 offset:40992
    ds_read_b64_tr_b16 v[190:191], v110 offset:42016
    s_waitcnt vmcnt(32)
    s_waitcnt lgkmcnt(0)
    s_barrier
    s_add_u32 s56, s58, 2621440
    s_add_u32 m0, s65, 81920
    s_nop 0
    buffer_load_dwordx4 v111, s[12:15], s56 offen lds
    s_add_u32 m0, m0, 1024
    s_add_u32 s56, s56, 32768
    buffer_load_dwordx4 v111, s[12:15], s56 offen lds
    s_add_u32 m0, m0, 1024
    s_add_u32 s56, s56, 32768
    buffer_load_dwordx4 v111, s[12:15], s56 offen lds
    s_add_u32 m0, m0, 1024
    s_add_u32 s56, s56, 32768
    buffer_load_dwordx4 v111, s[12:15], s56 offen lds
    v_add_u32 v110, 49152, v110
    ds_read_b64_tr_b16 v[112:113], v110 offset:0
    ds_read_b64_tr_b16 v[114:115], v110 offset:1024
    ds_read_b64_tr_b16 v[116:117], v110 offset:8192
    ds_read_b64_tr_b16 v[118:119], v110 offset:9216
    ds_read_b64_tr_b16 v[192:193], v110 offset:32
    ds_read_b64_tr_b16 v[194:195], v110 offset:1056
    ds_read_b64_tr_b16 v[196:197], v110 offset:8224
    ds_read_b64_tr_b16 v[198:199], v110 offset:9248
    s_waitcnt vmcnt(32)
    s_waitcnt lgkmcnt(0)
    s_barrier
    s_add_u32 s56, s58, 3145728
    s_add_u32 m0, s65, 98304
    s_nop 0
    buffer_load_dwordx4 v111, s[12:15], s56 offen lds
    s_add_u32 m0, m0, 1024
    s_add_u32 s56, s56, 32768
    buffer_load_dwordx4 v111, s[12:15], s56 offen lds
    s_add_u32 m0, m0, 1024
    s_add_u32 s56, s56, 32768
    buffer_load_dwordx4 v111, s[12:15], s56 offen lds
    s_add_u32 m0, m0, 1024
    s_add_u32 s56, s56, 32768
    buffer_load_dwordx4 v111, s[12:15], s56 offen lds
    ds_read_b64_tr_b16 v[120:121], v110 offset:16384
    ds_read_b64_tr_b16 v[122:123], v110 offset:17408
    ds_read_b64_tr_b16 v[124:125], v110 offset:24576
    ds_read_b64_tr_b16 v[126:127], v110 offset:25600
    ds_read_b64_tr_b16 v[200:201], v110 offset:16416
    ds_read_b64_tr_b16 v[202:203], v110 offset:17440
    ds_read_b64_tr_b16 v[204:205], v110 offset:24608
    ds_read_b64_tr_b16 v[206:207], v110 offset:25632
    s_waitcnt vmcnt(32)
    s_waitcnt lgkmcnt(0)
    s_barrier
    s_add_u32 s56, s58, 3670016
    s_add_u32 m0, s65, 114688
    s_nop 0
    buffer_load_dwordx4 v111, s[12:15], s56 offen lds
    s_add_u32 m0, m0, 1024
    s_add_u32 s56, s56, 32768
    buffer_load_dwordx4 v111, s[12:15], s56 offen lds
    s_add_u32 m0, m0, 1024
    s_add_u32 s56, s56, 32768
    buffer_load_dwordx4 v111, s[12:15], s56 offen lds
    s_add_u32 m0, m0, 1024
    s_add_u32 s56, s56, 32768
    buffer_load_dwordx4 v111, s[12:15], s56 offen lds
    ds_read_b64_tr_b16 v[160:161], v110 offset:32768
    ds_read_b64_tr_b16 v[162:163], v110 offset:33792
    ds_read_b64_tr_b16 v[164:165], v110 offset:40960
    ds_read_b64_tr_b16 v[166:167], v110 offset:41984
    ds_read_b64_tr_b16 v[240:241], v110 offset:32800
    ds_read_b64_tr_b16 v[242:243], v110 offset:33824
    ds_read_b64_tr_b16 v[244:245], v110 offset:40992
    ds_read_b64_tr_b16 v[246:247], v110 offset:42016
    s_waitcnt vmcnt(32)
    s_waitcnt lgkmcnt(0)
    s_barrier
    s_add_u32 s56, s58, 4194304
    s_add_u32 m0, s65, 131072
    s_nop 0
    buffer_load_dwordx4 v111, s[12:15], s56 offen lds
    s_add_u32 m0, m0, 1024
    s_add_u32 s56, s56, 32768
    buffer_load_dwordx4 v111, s[12:15], s56 offen lds
    s_add_u32 m0, m0, 1024
    s_add_u32 s56, s56, 32768
    buffer_load_dwordx4 v111, s[12:15], s56 offen lds
    s_add_u32 m0, m0, 1024
    s_add_u32 s56, s56, 32768
    buffer_load_dwordx4 v111, s[12:15], s56 offen lds
    v_add_u32 v110, 49152, v110
    ds_read_b64_tr_b16 v[168:169], v110 offset:0
    ds_read_b64_tr_b16 v[170:171], v110 offset:1024
    ds_read_b64_tr_b16 v[172:173], v110 offset:8192
    ds_read_b64_tr_b16 v[174:175], v110 offset:9216
    ds_read_b64_tr_b16 v[248:249], v110 offset:32
    ds_read_b64_tr_b16 v[250:251], v110 offset:1056
    ds_read_b64_tr_b16 v[252:253], v110 offset:8224
    ds_read_b64_tr_b16 v[254:255], v110 offset:9248
    s_waitcnt vmcnt(32)
    s_waitcnt lgkmcnt(0)
    s_barrier
    s_add_u32 s56, s58, 4718592
    s_add_u32 m0, s65, 147456
    s_nop 0
    buffer_load_dwordx4 v111, s[12:15], s56 offen lds
    s_add_u32 m0, m0, 1024
    s_add_u32 s56, s56, 32768
    buffer_load_dwordx4 v111, s[12:15], s56 offen lds
    s_add_u32 m0, m0, 1024
    s_add_u32 s56, s56, 32768
    buffer_load_dwordx4 v111, s[12:15], s56 offen lds
    s_add_u32 m0, m0, 1024
    s_add_u32 s56, s56, 32768
    buffer_load_dwordx4 v111, s[12:15], s56 offen lds
    v_add_u32 v110, -147456, v110
    ds_read_b64_tr_b16 a[32:33], v110 offset:0
    ds_read_b64_tr_b16 a[34:35], v110 offset:1024
    ds_read_b64_tr_b16 a[36:37], v110 offset:8192
    ds_read_b64_tr_b16 a[38:39], v110 offset:9216
    ds_read_b64_tr_b16 a[112:113], v110 offset:32
    ds_read_b64_tr_b16 a[114:115], v110 offset:1056
    ds_read_b64_tr_b16 a[116:117], v110 offset:8224
    ds_read_b64_tr_b16 a[118:119], v110 offset:9248
    s_waitcnt vmcnt(32)
    s_waitcnt lgkmcnt(0)
    s_barrier
    ds_read_b64_tr_b16 a[40:41], v110 offset:16384
    ds_read_b64_tr_b16 a[42:43], v110 offset:17408
    ds_read_b64_tr_b16 a[44:45], v110 offset:24576
    ds_read_b64_tr_b16 a[46:47], v110 offset:25600
    ds_read_b64_tr_b16 a[120:121], v110 offset:16416
    ds_read_b64_tr_b16 a[122:123], v110 offset:17440
    ds_read_b64_tr_b16 a[124:125], v110 offset:24608
    ds_read_b64_tr_b16 a[126:127], v110 offset:25632
    s_waitcnt vmcnt(28)
    s_waitcnt lgkmcnt(0)
    s_barrier
    ds_read_b64_tr_b16 a[48:49], v110 offset:32768
    ds_read_b64_tr_b16 a[50:51], v110 offset:33792
    ds_read_b64_tr_b16 a[52:53], v110 offset:40960
    ds_read_b64_tr_b16 a[54:55], v110 offset:41984
    ds_read_b64_tr_b16 a[128:129], v110 offset:32800
    ds_read_b64_tr_b16 a[130:131], v110 offset:33824
    ds_read_b64_tr_b16 a[132:133], v110 offset:40992
    ds_read_b64_tr_b16 a[134:135], v110 offset:42016
    s_waitcnt vmcnt(24)
    s_waitcnt lgkmcnt(0)
    s_barrier
    v_add_u32 v110, 49152, v110
    ds_read_b64_tr_b16 a[56:57], v110 offset:0
    ds_read_b64_tr_b16 a[58:59], v110 offset:1024
    ds_read_b64_tr_b16 a[60:61], v110 offset:8192
    ds_read_b64_tr_b16 a[62:63], v110 offset:9216
    ds_read_b64_tr_b16 a[136:137], v110 offset:32
    ds_read_b64_tr_b16 a[138:139], v110 offset:1056
    ds_read_b64_tr_b16 a[140:141], v110 offset:8224
    ds_read_b64_tr_b16 a[142:143], v110 offset:9248
    s_waitcnt vmcnt(20)
    s_waitcnt lgkmcnt(0)
    s_barrier
    ds_read_b64_tr_b16 a[0:1], v110 offset:16384
    ds_read_b64_tr_b16 a[2:3], v110 offset:17408
    ds_read_b64_tr_b16 a[4:5], v110 offset:24576
    ds_read_b64_tr_b16 a[6:7], v110 offset:25600
    ds_read_b64_tr_b16 a[80:81], v110 offset:16416
    ds_read_b64_tr_b16 a[82:83], v110 offset:17440
    ds_read_b64_tr_b16 a[84:85], v110 offset:24608
    ds_read_b64_tr_b16 a[86:87], v110 offset:25632
    s_waitcnt vmcnt(16)
    s_waitcnt lgkmcnt(0)
    s_barrier
    ds_read_b64_tr_b16 a[8:9], v110 offset:32768
    ds_read_b64_tr_b16 a[10:11], v110 offset:33792
    ds_read_b64_tr_b16 a[12:13], v110 offset:40960
    ds_read_b64_tr_b16 a[14:15], v110 offset:41984
    ds_read_b64_tr_b16 a[88:89], v110 offset:32800
    ds_read_b64_tr_b16 a[90:91], v110 offset:33824
    ds_read_b64_tr_b16 a[92:93], v110 offset:40992
    ds_read_b64_tr_b16 a[94:95], v110 offset:42016
    s_waitcnt vmcnt(12)
    s_waitcnt lgkmcnt(0)
    s_barrier
    v_add_u32 v110, 49152, v110
    ds_read_b64_tr_b16 a[16:17], v110 offset:0
    ds_read_b64_tr_b16 a[18:19], v110 offset:1024
    ds_read_b64_tr_b16 a[20:21], v110 offset:8192
    ds_read_b64_tr_b16 a[22:23], v110 offset:9216
    ds_read_b64_tr_b16 a[96:97], v110 offset:32
    ds_read_b64_tr_b16 a[98:99], v110 offset:1056
    ds_read_b64_tr_b16 a[100:101], v110 offset:8224
    ds_read_b64_tr_b16 a[102:103], v110 offset:9248
    s_waitcnt vmcnt(8)
    s_waitcnt lgkmcnt(0)
    s_barrier
    ds_read_b64_tr_b16 a[24:25], v110 offset:16384
    ds_read_b64_tr_b16 a[26:27], v110 offset:17408
    ds_read_b64_tr_b16 a[28:29], v110 offset:24576
    ds_read_b64_tr_b16 a[30:31], v110 offset:25600
    ds_read_b64_tr_b16 a[104:105], v110 offset:16416
    ds_read_b64_tr_b16 a[106:107], v110 offset:17440
    ds_read_b64_tr_b16 a[108:109], v110 offset:24608
    ds_read_b64_tr_b16 a[110:111], v110 offset:25632
    s_waitcnt vmcnt(4)
    s_waitcnt lgkmcnt(0)
    s_barrier
    ds_read_b64_tr_b16 a[64:65], v110 offset:32768
    ds_read_b64_tr_b16 a[66:67], v110 offset:33792
    ds_read_b64_tr_b16 a[68:69], v110 offset:40960
    ds_read_b64_tr_b16 a[70:71], v110 offset:41984
    ds_read_b64_tr_b16 a[144:145], v110 offset:32800
    ds_read_b64_tr_b16 a[146:147], v110 offset:33824
    ds_read_b64_tr_b16 a[148:149], v110 offset:40992
    ds_read_b64_tr_b16 a[150:151], v110 offset:42016
    s_waitcnt vmcnt(0)
    s_waitcnt lgkmcnt(0)
    s_barrier
    v_add_u32 v110, 49152, v110
    ds_read_b64_tr_b16 a[72:73], v110 offset:0
    ds_read_b64_tr_b16 a[74:75], v110 offset:1024
    ds_read_b64_tr_b16 a[76:77], v110 offset:8192
    ds_read_b64_tr_b16 a[78:79], v110 offset:9216
    ds_read_b64_tr_b16 a[152:153], v110 offset:32
    ds_read_b64_tr_b16 a[154:155], v110 offset:1056
    ds_read_b64_tr_b16 a[156:157], v110 offset:8224
    ds_read_b64_tr_b16 a[158:159], v110 offset:9248
    s_waitcnt lgkmcnt(0)
    s_branch L_head_ldd
L_head_ld3:
    s_add_u32 s56, s58, 0
    s_add_u32 m0, s65, 0
    s_nop 0
    buffer_load_dwordx4 v111, s[16:19], s56 offen lds
    s_add_u32 m0, m0, 1024
    s_add_u32 s56, s56, 32768
    buffer_load_dwordx4 v111, s[16:19], s56 offen lds
    s_add_u32 m0, m0, 1024
    s_add_u32 s56, s56, 32768
    buffer_load_dwordx4 v111, s[16:19], s56 offen lds
    s_add_u32 m0, m0, 1024
    s_add_u32 s56, s56, 32768
    buffer_load_dwordx4 v111, s[16:19], s56 offen lds
    s_add_u32 s56, s58, 524288
    s_add_u32 m0, s65, 16384
    s_nop 0
    buffer_load_dwordx4 v111, s[16:19], s56 offen lds
    s_add_u32 m0, m0, 1024
    s_add_u32 s56, s56, 32768
    buffer_load_dwordx4 v111, s[16:19], s56 offen lds
    s_add_u32 m0, m0, 1024
    s_add_u32 s56, s56, 32768
    buffer_load_dwordx4 v111, s[16:19], s56 offen lds
    s_add_u32 m0, m0, 1024
    s_add_u32 s56, s56, 32768
    buffer_load_dwordx4 v111, s[16:19], s56 offen lds
    s_add_u32 s56, s58, 1048576
    s_add_u32 m0, s65, 32768
    s_nop 0
    buffer_load_dwordx4 v111, s[16:19], s56 offen lds
    s_add_u32 m0, m0, 1024
    s_add_u32 s56, s56, 32768
    buffer_load_dwordx4 v111, s[16:19], s56 offen lds
    s_add_u32 m0, m0, 1024
    s_add_u32 s56, s56, 32768
    buffer_load_dwordx4 v111, s[16:19], s56 offen lds
    s_add_u32 m0, m0, 1024
    s_add_u32 s56, s56, 32768
    buffer_load_dwordx4 v111, s[16:19], s56 offen lds
    s_add_u32 s56, s58, 1572864
    s_add_u32 m0, s65, 49152
    s_nop 0
    buffer_load_dwordx4 v111, s[16:19], s56 offen lds
    s_add_u32 m0, m0, 1024
    s_add_u32 s56, s56, 32768
    buffer_load_dwordx4 v111, s[16:19], s56 offen lds
    s_add_u32 m0, m0, 1024
    s_add_u32 s56, s56, 32768
    buffer_load_dwordx4 v111, s[16:19], s56 offen lds
    s_add_u32 m0, m0, 1024
    s_add_u32 s56, s56, 32768
    buffer_load_dwordx4 v111, s[16:19], s56 offen lds
    s_add_u32 s56, s58, 2097152
    s_add_u32 m0, s65, 65536
    s_nop 0
    buffer_load_dwordx4 v111, s[16:19], s56 offen lds
    s_add_u32 m0, m0, 1024
    s_add_u32 s56, s56, 32768
    buffer_load_dwordx4 v111, s[16:19], s56 offen lds
    s_add_u32 m0, m0, 1024
    s_add_u32 s56, s56, 32768
    buffer_load_dwordx4 v111, s[16:19], s56 offen lds
    s_add_u32 m0, m0, 1024
    s_add_u32 s56, s56, 32768
    buffer_load_dwordx4 v111, s[16:19], s56 offen lds
    s_add_u32 s56, s58, 2621440
    s_add_u32 m0, s65, 81920
    s_nop 0
    buffer_load_dwordx4 v111, s[16:19], s56 offen lds
    s_add_u32 m0, m0, 1024
    s_add_u32 s56, s56, 32768
    buffer_load_dwordx4 v111, s[16:19], s56 offen lds
    s_add_u32 m0, m0, 1024
    s_add_u32 s56, s56, 32768
    buffer_load_dwordx4 v111, s[16:19], s56 offen lds
    s_add_u32 m0, m0, 1024
    s_add_u32 s56, s56, 32768
    buffer_load_dwordx4 v111, s[16:19], s56 offen lds
    s_add_u32 s56, s58, 3145728
    s_add_u32 m0, s65, 98304
    s_nop 0
    buffer_load_dwordx4 v111, s[16:19], s56 offen lds
    s_add_u32 m0, m0, 1024
    s_add_u32 s56, s56, 32768
    buffer_load_dwordx4 v111, s[16:19], s56 offen lds
    s_add_u32 m0, m0, 1024
    s_add_u32 s56, s56, 32768
    buffer_load_dwordx4 v111, s[16:19], s56 offen lds
    s_add_u32 m0, m0, 1024
    s_add_u32 s56, s56, 32768
    buffer_load_dwordx4 v111, s[16:19], s56 offen lds
    s_add_u32 s56, s58, 3670016
    s_add_u32 m0, s65, 114688
    s_nop 0
    buffer_load_dwordx4 v111, s[16:19], s56 offen lds
    s_add_u32 m0, m0, 1024
    s_add_u32 s56, s56, 32768
    buffer_load_dwordx4 v111, s[16:19], s56 offen lds
    s_add_u32 m0, m0, 1024
    s_add_u32 s56, s56, 32768
    buffer_load_dwordx4 v111, s[16:19], s56 offen lds
    s_add_u32 m0, m0, 1024
    s_add_u32 s56, s56, 32768
    buffer_load_dwordx4 v111, s[16:19], s56 offen lds
    s_add_u32 s56, s58, 4194304
    s_add_u32 m0, s65, 131072
    s_nop 0
    buffer_load_dwordx4 v111, s[16:19], s56 offen lds
    s_add_u32 m0, m0, 1024
    s_add_u32 s56, s56, 32768
    buffer_load_dwordx4 v111, s[16:19], s56 offen lds
    s_add_u32 m0, m0, 1024
    s_add_u32 s56, s56, 32768
    buffer_load_dwordx4 v111, s[16:19], s56 offen lds
    s_add_u32 m0, m0, 1024
    s_add_u32 s56, s56, 32768
    buffer_load_dwordx4 v111, s[16:19], s56 offen lds
    s_waitcnt vmcnt(32)
    s_waitcnt lgkmcnt(0)
    s_barrier
    s_add_u32 s56, s58, 4718592
    s_add_u32 m0, s65, 147456
    s_nop 0
    buffer_load_dwordx4 v111, s[16:19], s56 offen lds
    s_add_u32 m0, m0, 1024
    s_add_u32 s56, s56, 32768
    buffer_load_dwordx4 v111, s[16:19], s56 offen lds
    s_add_u32 m0, m0, 1024
    s_add_u32 s56, s56, 32768
    buffer_load_dwordx4 v111, s[16:19], s56 offen lds
    s_add_u32 m0, m0, 1024
    s_add_u32 s56, s56, 32768
    buffer_load_dwordx4 v111, s[16:19], s56 offen lds
    ds_read_b64_tr_b16 a[176:177], v110 offset:0
    ds_read_b64_tr_b16 a[178:179], v110 offset:1024
    ds_read_b64_tr_b16 a[180:181], v110 offset:8192
    ds_read_b64_tr_b16 a[182:183], v110 offset:9216
    ds_read_b64_tr_b16 v[34:35], v110 offset:32
    ds_read_b64_tr_b16 v[36:37], v110 offset:1056
    ds_read_b64_tr_b16 v[38:39], v110 offset:8224
    ds_read_b64_tr_b16 v[40:41], v110 offset:9248
    s_waitcnt vmcnt(32)
    s_waitcnt lgkmcnt(0)
    s_barrier
    s_add_u32 s56, s58, 0
    s_add_u32 m0, s65, 0
    s_nop 0
    buffer_load_dwordx4 v111, s[20:23], s56 offen lds
    s_add_u32 m0, m0, 1024
    s_add_u32 s56, s56, 32768
    buffer_load_dwordx4 v111, s[20:23], s56 offen lds
    s_add_u32 m0, m0, 1024
    s_add_u32 s56, s56, 32768
    buffer_load_dwordx4 v111, s[20:23], s56 offen lds
    s_add_u32 m0, m0, 1024
    s_add_u32 s56, s56, 32768
    buffer_load_dwordx4 v111, s[20:23], s56 offen lds
    ds_read_b64_tr_b16 a[184:185], v110 offset:16384
    ds_read_b64_tr_b16 a[186:187], v110 offset:17408
    ds_read_b64_tr_b16 a[188:189], v110 offset:24576
    ds_read_b64_tr_b16 a[190:191], v110 offset:25600
    ds_read_b64_tr_b16 v[42:43], v110 offset:16416
    ds_read_b64_tr_b16 v[44:45], v110 offset:17440
    ds_read_b64_tr_b16 v[46:47], v110 offset:24608
    ds_read_b64_tr_b16 v[48:49], v110 offset:25632
    s_waitcnt vmcnt(32)
    s_waitcnt lgkmcnt(0)
    s_barrier
    s_add_u32 s56, s58, 524288
    s_add_u32 m0, s65, 16384
    s_nop 0
    buffer_load_dwordx4 v111, s[20:23], s56 offen lds
    s_add_u32 m0, m0, 1024
    s_add_u32 s56, s56, 32768
    buffer_load_dwordx4 v111, s[20:23], s56 offen lds
    s_add_u32 m0, m0, 1024
    s_add_u32 s56, s56, 32768
    buffer_load_dwordx4 v111, s[20:23], s56 offen lds
    s_add_u32 m0, m0, 1024
    s_add_u32 s56, s56, 32768
    buffer_load_dwordx4 v111, s[20:23], s56 offen lds
    ds_read_b64_tr_b16 a[192:193], v110 offset:32768
    ds_read_b64_tr_b16 a[194:195], v110 offset:33792
    ds_read_b64_tr_b16 a[196:197], v110 offset:40960
    ds_read_b64_tr_b16 a[198:199], v110 offset:41984
    ds_read_b64_tr_b16 v[50:51], v110 offset:32800
    ds_read_b64_tr_b16 v[52:53], v110 offset:33824
    ds_read_b64_tr_b16 v[54:55], v110 offset:40992
    ds_read_b64_tr_b16 v[56:57], v110 offset:42016
    s_waitcnt vmcnt(32)
    s_waitcnt lgkmcnt(0)
    s_barrier
    s_add_u32 s56, s58, 1048576
    s_add_u32 m0, s65, 32768
    s_nop 0
    buffer_load_dwordx4 v111, s[20:23], s56 offen lds
    s_add_u32 m0, m0, 1024
    s_add_u32 s56, s56, 32768
    buffer_load_dwordx4 v111, s[20:23], s56 offen lds
    s_add_u32 m0, m0, 1024
    s_add_u32 s56, s56, 32768
    buffer_load_dwordx4 v111, s[20:23], s56 offen lds
    s_add_u32 m0, m0, 1024
    s_add_u32 s56, s56, 32768
    buffer_load_dwordx4 v111, s[20:23], s56 offen lds
    v_add_u32 v110, 49152, v110
    ds_read_b64_tr_b16 a[200:201], v110 offset:0
    ds_read_b64_tr_b16 a[202:203], v110 offset:1024
    ds_read_b64_tr_b16 a[204:205], v110 offset:8192
    ds_read_b64_tr_b16 a[206:207], v110 offset:9216
    ds_read_b64_tr_b16 v[58:59], v110 offset:32
    ds_read_b64_tr_b16 v[60:61], v110 offset:1056
    ds_read_b64_tr_b16 v[62:63], v110 offset:8224
    ds_read_b64_tr_b16 v[64:65], v110 offset:9248
    s_waitcnt vmcnt(32)
    s_waitcnt lgkmcnt(0)
    s_barrier
    s_add_u32 s56, s58, 1572864
    s_add_u32 m0, s65, 49152
    s_nop 0
    buffer_load_dwordx4 v111, s[20:23], s56 offen lds
    s_add_u32 m0, m0, 1024
    s_add_u32 s56, s56, 32768
    buffer_load_dwordx4 v111, s[20:23], s56 offen lds
    s_add_u32 m0, m0, 1024
    s_add_u32 s56, s56, 32768
    buffer_load_dwordx4 v111, s[20:23], s56 offen lds
    s_add_u32 m0, m0, 1024
    s_add_u32 s56, s56, 32768
    buffer_load_dwordx4 v111, s[20:23], s56 offen lds
    ds_read_b64_tr_b16 a[208:209], v110 offset:16384
    ds_read_b64_tr_b16 a[210:211], v110 offset:17408
    ds_read_b64_tr_b16 a[212:213], v110 offset:24576
    ds_read_b64_tr_b16 a[214:215], v110 offset:25600
    ds_read_b64_tr_b16 v[66:67], v110 offset:16416
    ds_read_b64_tr_b16 v[68:69], v110 offset:17440
    ds_read_b64_tr_b16 v[70:71], v110 offset:24608
    ds_read_b64_tr_b16 v[72:73], v110 offset:25632
    s_waitcnt vmcnt(32)
    s_waitcnt lgkmcnt(0)
    s_barrier
    s_add_u32 s56, s58, 2097152
    s_add_u32 m0, s65, 65536
    s_nop 0
    buffer_load_dwordx4 v111, s[20:23], s56 offen lds
    s_add_u32 m0, m0, 1024
    s_add_u32 s56, s56, 32768
    buffer_load_dwordx4 v111, s[20:23], s56 offen lds
    s_add_u32 m0, m0, 1024
    s_add_u32 s56, s56, 32768
    buffer_load_dwordx4 v111, s[20:23], s56 offen lds
    s_add_u32 m0, m0, 1024
    s_add_u32 s56, s56, 32768
    buffer_load_dwordx4 v111, s[20:23], s56 offen lds
    ds_read_b64_tr_b16 a[216:217], v110 offset:32768
    ds_read_b64_tr_b16 a[218:219], v110 offset:33792
    ds_read_b64_tr_b16 a[220:221], v110 offset:40960
    ds_read_b64_tr_b16 a[222:223], v110 offset:41984
    ds_read_b64_tr_b16 v[74:75], v110 offset:32800
    ds_read_b64_tr_b16 v[76:77], v110 offset:33824
    ds_read_b64_tr_b16 v[78:79], v110 offset:40992
    ds_read_b64_tr_b16 v[80:81], v110 offset:42016
    s_waitcnt vmcnt(32)
    s_waitcnt lgkmcnt(0)
    s_barrier
    s_add_u32 s56, s58, 2621440
    s_add_u32 m0, s65, 81920
    s_nop 0
    buffer_load_dwordx4 v111, s[20:23], s56 offen lds
    s_add_u32 m0, m0, 1024
    s_add_u32 s56, s56, 32768
    buffer_load_dwordx4 v111, s[20:23], s56 offen lds
    s_add_u32 m0, m0, 1024
    s_add_u32 s56, s56, 32768
    buffer_load_dwordx4 v111, s[20:23], s56 offen lds
    s_add_u32 m0, m0, 1024
    s_add_u32 s56, s56, 32768
    buffer_load_dwordx4 v111, s[20:23], s56 offen lds
    v_add_u32 v110, 49152, v110
    ds_read_b64_tr_b16 a[160:161], v110 offset:0
    ds_read_b64_tr_b16 a[162:163], v110 offset:1024
    ds_read_b64_tr_b16 a[164:165], v110 offset:8192
    ds_read_b64_tr_b16 a[166:167], v110 offset:9216
    ds_read_b64_tr_b16 v[18:19], v110 offset:32
    ds_read_b64_tr_b16 v[20:21], v110 offset:1056
    ds_read_b64_tr_b16 v[22:23], v110 offset:8224
    ds_read_b64_tr_b16 v[24:25], v110 offset:9248
    s_waitcnt vmcnt(32)
    s_waitcnt lgkmcnt(0)
    s_barrier
    s_add_u32 s56, s58, 3145728
    s_add_u32 m0, s65, 98304
    s_nop 0
    buffer_load_dwordx4 v111, s[20:23], s56 offen lds
    s_add_u32 m0, m0, 1024
    s_add_u32 s56, s56, 32768
    buffer_load_dwordx4 v111, s[20:23], s56 offen lds
    s_add_u32 m0, m0, 1024
    s_add_u32 s56, s56, 32768
    buffer_load_dwordx4 v111, s[20:23], s56 offen lds
    s_add_u32 m0, m0, 1024
    s_add_u32 s56, s56, 32768
    buffer_load_dwordx4 v111, s[20:23], s56 offen lds
    ds_read_b64_tr_b16 a[168:169], v110 offset:16384
    ds_read_b64_tr_b16 a[170:171], v110 offset:17408
    ds_read_b64_tr_b16 a[172:173], v110 offset:24576
    ds_read_b64_tr_b16 a[174:175], v110 offset:25600
    ds_read_b64_tr_b16 v[26:27], v110 offset:16416
    ds_read_b64_tr_b16 v[28:29], v110 offset:17440
    ds_read_b64_tr_b16 v[30:31], v110 offset:24608
    ds_read_b64_tr_b16 v[32:33], v110 offset:25632
    s_waitcnt vmcnt(32)
    s_waitcnt lgkmcnt(0)
    s_barrier
    s_add_u32 s56, s58, 3670016
    s_add_u32 m0, s65, 114688
    s_nop 0
    buffer_load_dwordx4 v111, s[20:23], s56 offen lds
    s_add_u32 m0, m0, 1024
    s_add_u32 s56, s56, 32768
    buffer_load_dwordx4 v111, s[20:23], s56 offen lds
    s_add_u32 m0, m0, 1024
    s_add_u32 s56, s56, 32768
    buffer_load_dwordx4 v111, s[20:23], s56 offen lds
    s_add_u32 m0, m0, 1024
    s_add_u32 s56, s56, 32768
    buffer_load_dwordx4 v111, s[20:23], s56 offen lds
    ds_read_b64_tr_b16 a[224:225], v110 offset:32768
    ds_read_b64_tr_b16 a[226:227], v110 offset:33792
    ds_read_b64_tr_b16 a[228:229], v110 offset:40960
    ds_read_b64_tr_b16 a[230:231], v110 offset:41984
    ds_read_b64_tr_b16 v[82:83], v110 offset:32800
    ds_read_b64_tr_b16 v[84:85], v110 offset:33824
    ds_read_b64_tr_b16 v[86:87], v110 offset:40992
    ds_read_b64_tr_b16 v[88:89], v110 offset:42016
    s_waitcnt vmcnt(32)
    s_waitcnt lgkmcnt(0)
    s_barrier
    s_add_u32 s56, s58, 4194304
    s_add_u32 m0, s65, 131072
    s_nop 0
    buffer_load_dwordx4 v111, s[20:23], s56 offen lds
    s_add_u32 m0, m0, 1024
    s_add_u32 s56, s56, 32768
    buffer_load_dwordx4 v111, s[20:23], s56 offen lds
    s_add_u32 m0, m0, 1024
    s_add_u32 s56, s56, 32768
    buffer_load_dwordx4 v111, s[20:23], s56 offen lds
    s_add_u32 m0, m0, 1024
    s_add_u32 s56, s56, 32768
    buffer_load_dwordx4 v111, s[20:23], s56 offen lds
    v_add_u32 v110, 49152, v110
    ds_read_b64_tr_b16 a[232:233], v110 offset:0
    ds_read_b64_tr_b16 a[234:235], v110 offset:1024
    ds_read_b64_tr_b16 a[236:237], v110 offset:8192
    ds_read_b64_tr_b16 a[238:239], v110 offset:9216
    ds_read_b64_tr_b16 v[90:91], v110 offset:32
    ds_read_b64_tr_b16 v[92:93], v110 offset:1056
    ds_read_b64_tr_b16 v[94:95], v110 offset:8224
    ds_read_b64_tr_b16 v[96:97], v110 offset:9248
    s_waitcnt vmcnt(32)
    s_waitcnt lgkmcnt(0)
    s_barrier
    s_add_u32 s56, s58, 4718592
    s_add_u32 m0, s65, 147456
    s_nop 0
    buffer_load_dwordx4 v111, s[20:23], s56 offen lds
    s_add_u32 m0, m0, 1024
    s_add_u32 s56, s56, 32768
    buffer_load_dwordx4 v111, s[20:23], s56 offen lds
    s_add_u32 m0, m0, 1024
    s_add_u32 s56, s56, 32768
    buffer_load_dwordx4 v111, s[20:23], s56 offen lds
    s_add_u32 m0, m0, 1024
    s_add_u32 s56, s56, 32768
    buffer_load_dwordx4 v111, s[20:23], s56 offen lds
    v_add_u32 v110, -147456, v110
    ds_read_b64_tr_b16 v[112:113], v110 offset:0
    ds_read_b64_tr_b16 v[114:115], v110 offset:1024
    ds_read_b64_tr_b16 v[116:117], v110 offset:8192
    ds_read_b64_tr_b16 v[118:119], v110 offset:9216
    ds_read_b64_tr_b16 v[192:193], v110 offset:32
    ds_read_b64_tr_b16 v[194:195], v110 offset:1056
    ds_read_b64_tr_b16 v[196:197], v110 offset:8224
    ds_read_b64_tr_b16 v[198:199], v110 offset:9248
    s_waitcnt vmcnt(32)
    s_waitcnt lgkmcnt(0)
    s_barrier
    s_add_u32 s56, s58, 0
    s_add_u32 m0, s65, 0
    s_nop 0
    buffer_load_dwordx4 v111, s[12:15], s56 offen lds
    s_add_u32 m0, m0, 1024
    s_add_u32 s56, s56, 32768
    buffer_load_dwordx4 v111, s[12:15], s56 offen lds
    s_add_u32 m0, m0, 1024
    s_add_u32 s56, s56, 32768
    buffer_load_dwordx4 v111, s[12:15], s56 offen lds
    s_add_u32 m0, m0, 1024
    s_add_u32 s56, s56, 32768
    buffer_load_dwordx4 v111, s[12:15], s56 offen lds
    ds_read_b64_tr_b16 v[120:121], v110 offset:16384
    ds_read_b64_tr_b16 v[122:123], v110 offset:17408
    ds_read_b64_tr_b16 v[124:125], v110 offset:24576
    ds_read_b64_tr_b16 v[126:127], v110 offset:25600
    ds_read_b64_tr_b16 v[200:201], v110 offset:16416
    ds_read_b64_tr_b16 v[202:203], v110 offset:17440
    ds_read_b64_tr_b16 v[204:205], v110 offset:24608
    ds_read_b64_tr_b16 v[206:207], v110 offset:25632
    s_waitcnt vmcnt(32)
    s_waitcnt lgkmcnt(0)
    s_barrier
    s_add_u32 s56, s58, 524288
    s_add_u32 m0, s65, 16384
    s_nop 0
    buffer_load_dwordx4 v111, s[12:15], s56 offen lds
    s_add_u32 m0, m0, 1024
    s_add_u32 s56, s56, 32768
    buffer_load_dwordx4 v111, s[12:15], s56 offen lds
    s_add_u32 m0, m0, 1024
    s_add_u32 s56, s56, 32768
    buffer_load_dwordx4 v111, s[12:15], s56 offen lds
    s_add_u32 m0, m0, 1024
    s_add_u32 s56, s56, 32768
    buffer_load_dwordx4 v111, s[12:15], s56 offen lds
    ds_read_b64_tr_b16 v[128:129], v110 offset:32768
    ds_read_b64_tr_b16 v[130:131], v110 offset:33792
    ds_read_b64_tr_b16 v[132:133], v110 offset:40960
    ds_read_b64_tr_b16 v[134:135], v110 offset:41984
    ds_read_b64_tr_b16 v[208:209], v110 offset:32800
    ds_read_b64_tr_b16 v[210:211], v110 offset:33824
    ds_read_b64_tr_b16 v[212:213], v110 offset:40992
    ds_read_b64_tr_b16 v[214:215], v110 offset:42016
    s_waitcnt vmcnt(32)
    s_waitcnt lgkmcnt(0)
    s_barrier
    s_add_u32 s56, s58, 1048576
    s_add_u32 m0, s65, 32768
    s_nop 0
    buffer_load_dwordx4 v111, s[12:15], s56 offen lds
    s_add_u32 m0, m0, 1024
    s_add_u32 s56, s56, 32768
    buffer_load_dwordx4 v111, s[12:15], s56 offen lds
    s_add_u32 m0, m0, 1024
    s_add_u32 s56, s56, 32768
    buffer_load_dwordx4 v111, s[12:15], s56 offen lds
    s_add_u32 m0, m0, 1024
    s_add_u32 s56, s56, 32768
    buffer_load_dwordx4 v111, s[12:15], s56 offen lds
    v_add_u32 v110, 49152, v110
    ds_read_b64_tr_b16 v[136:137], v110 offset:0
    ds_read_b64_tr_b16 v[138:139], v110 offset:1024
    ds_read_b64_tr_b16 v[140:141], v110 offset:8192
    ds_read_b64_tr_b16 v[142:143], v110 offset:9216
    ds_read_b64_tr_b16 v[216:217], v110 offset:32
    ds_read_b64_tr_b16 v[218:219], v110 offset:1056
    ds_read_b64_tr_b16 v[220:221], v110 offset:8224
    ds_read_b64_tr_b16 v[222:223], v110 offset:9248
    s_waitcnt vmcnt(32)
    s_waitcnt lgkmcnt(0)
    s_barrier
    s_add_u32 s56, s58, 1572864
    s_add_u32 m0, s65, 49152
    s_nop 0
    buffer_load_dwordx4 v111, s[12:15], s56 offen lds
    s_add_u32 m0, m0, 1024
    s_add_u32 s56, s56, 32768
    buffer_load_dwordx4 v111, s[12:15], s56 offen lds
    s_add_u32 m0, m0, 1024
    s_add_u32 s56, s56, 32768
    buffer_load_dwordx4 v111, s[12:15], s56 offen lds
    s_add_u32 m0, m0, 1024
    s_add_u32 s56, s56, 32768
    buffer_load_dwordx4 v111, s[12:15], s56 offen lds
    ds_read_b64_tr_b16 v[144:145], v110 offset:16384
    ds_read_b64_tr_b16 v[146:147], v110 offset:17408
    ds_read_b64_tr_b16 v[148:149], v110 offset:24576
    ds_read_b64_tr_b16 v[150:151], v110 offset:25600
    ds_read_b64_tr_b16 v[224:225], v110 offset:16416
    ds_read_b64_tr_b16 v[226:227], v110 offset:17440
    ds_read_b64_tr_b16 v[228:229], v110 offset:24608
    ds_read_b64_tr_b16 v[230:231], v110 offset:25632
    s_waitcnt vmcnt(32)
    s_waitcnt lgkmcnt(0)
    s_barrier
    s_add_u32 s56, s58, 2097152
    s_add_u32 m0, s65, 65536
    s_nop 0
    buffer_load_dwordx4 v111, s[12:15], s56 offen lds
    s_add_u32 m0, m0, 1024
    s_add_u32 s56, s56, 32768
    buffer_load_dwordx4 v111, s[12:15], s56 offen lds
    s_add_u32 m0, m0, 1024
    s_add_u32 s56, s56, 32768
    buffer_load_dwordx4 v111, s[12:15], s56 offen lds
    s_add_u32 m0, m0, 1024
    s_add_u32 s56, s56, 32768
    buffer_load_dwordx4 v111, s[12:15], s56 offen lds
    ds_read_b64_tr_b16 v[152:153], v110 offset:32768
    ds_read_b64_tr_b16 v[154:155], v110 offset:33792
    ds_read_b64_tr_b16 v[156:157], v110 offset:40960
    ds_read_b64_tr_b16 v[158:159], v110 offset:41984
    ds_read_b64_tr_b16 v[232:233], v110 offset:32800
    ds_read_b64_tr_b16 v[234:235], v110 offset:33824
    ds_read_b64_tr_b16 v[236:237], v110 offset:40992
    ds_read_b64_tr_b16 v[238:239], v110 offset:42016
    s_waitcnt vmcnt(32)
    s_waitcnt lgkmcnt(0)
    s_barrier
    s_add_u32 s56, s58, 2621440
    s_add_u32 m0, s65, 81920
    s_nop 0
    buffer_load_dwordx4 v111, s[12:15], s56 offen lds
    s_add_u32 m0, m0, 1024
    s_add_u32 s56, s56, 32768
    buffer_load_dwordx4 v111, s[12:15], s56 offen lds
    s_add_u32 m0, m0, 1024
    s_add_u32 s56, s56, 32768
    buffer_load_dwordx4 v111, s[12:15], s56 offen lds
    s_add_u32 m0, m0, 1024
    s_add_u32 s56, s56, 32768
    buffer_load_dwordx4 v111, s[12:15], s56 offen lds
    v_add_u32 v110, 49152, v110
    ds_read_b64_tr_b16 a[240:241], v110 offset:0
    ds_read_b64_tr_b16 a[242:243], v110 offset:1024
    ds_read_b64_tr_b16 a[244:245], v110 offset:8192
    ds_read_b64_tr_b16 a[246:247], v110 offset:9216
    ds_read_b64_tr_b16 v[176:177], v110 offset:32
    ds_read_b64_tr_b16 v[178:179], v110 offset:1056
    ds_read_b64_tr_b16 v[180:181], v110 offset:8224
    ds_read_b64_tr_b16 v[182:183], v110 offset:9248
    s_waitcnt vmcnt(32)
    s_waitcnt lgkmcnt(0)
    s_barrier
    s_add_u32 s56, s58, 3145728
    s_add_u32 m0, s65, 98304
    s_nop 0
    buffer_load_dwordx4 v111, s[12:15], s56 offen lds
    s_add_u32 m0, m0, 1024
    s_add_u32 s56, s56, 32768
    buffer_load_dwordx4 v111, s[12:15], s56 offen lds
    s_add_u32 m0, m0, 1024
    s_add_u32 s56, s56, 32768
    buffer_load_dwordx4 v111, s[12:15], s56 offen lds
    s_add_u32 m0, m0, 1024
    s_add_u32 s56, s56, 32768
    buffer_load_dwordx4 v111, s[12:15], s56 offen lds
    ds_read_b64_tr_b16 a[248:249], v110 offset:16384
    ds_read_b64_tr_b16 a[250:251], v110 offset:17408
    ds_read_b64_tr_b16 a[252:253], v110 offset:24576
    ds_read_b64_tr_b16 a[254:255], v110 offset:25600
    ds_read_b64_tr_b16 v[184:185], v110 offset:16416
    ds_read_b64_tr_b16 v[186:187], v110 offset:17440
    ds_read_b64_tr_b16 v[188:189], v110 offset:24608
    ds_read_b64_tr_b16 v[190:191], v110 offset:25632
    s_waitcnt vmcnt(32)
    s_waitcnt lgkmcnt(0)
    s_barrier
    s_add_u32 s56, s58, 3670016
    s_add_u32 m0, s65, 114688
    s_nop 0
    buffer_load_dwordx4 v111, s[12:15], s56 offen lds
    s_add_u32 m0, m0, 1024
    s_add_u32 s56, s56, 32768
    buffer_load_dwordx4 v111, s[12:15], s56 offen lds
    s_add_u32 m0, m0, 1024
    s_add_u32 s56, s56, 32768
    buffer_load_dwordx4 v111, s[12:15], s56 offen lds
    s_add_u32 m0, m0, 1024
    s_add_u32 s56, s56, 32768
    buffer_load_dwordx4 v111, s[12:15], s56 offen lds
    ds_read_b64_tr_b16 v[160:161], v110 offset:32768
    ds_read_b64_tr_b16 v[162:163], v110 offset:33792
    ds_read_b64_tr_b16 v[164:165], v110 offset:40960
    ds_read_b64_tr_b16 v[166:167], v110 offset:41984
    ds_read_b64_tr_b16 v[240:241], v110 offset:32800
    ds_read_b64_tr_b16 v[242:243], v110 offset:33824
    ds_read_b64_tr_b16 v[244:245], v110 offset:40992
    ds_read_b64_tr_b16 v[246:247], v110 offset:42016
    s_waitcnt vmcnt(32)
    s_waitcnt lgkmcnt(0)
    s_barrier
    s_add_u32 s56, s58, 4194304
    s_add_u32 m0, s65, 131072
    s_nop 0
    buffer_load_dwordx4 v111, s[12:15], s56 offen lds
    s_add_u32 m0, m0, 1024
    s_add_u32 s56, s56, 32768
    buffer_load_dwordx4 v111, s[12:15], s56 offen lds
    s_add_u32 m0, m0, 1024
    s_add_u32 s56, s56, 32768
    buffer_load_dwordx4 v111, s[12:15], s56 offen lds
    s_add_u32 m0, m0, 1024
    s_add_u32 s56, s56, 32768
    buffer_load_dwordx4 v111, s[12:15], s56 offen lds
    v_add_u32 v110, 49152, v110
    ds_read_b64_tr_b16 v[168:169], v110 offset:0
    ds_read_b64_tr_b16 v[170:171], v110 offset:1024
    ds_read_b64_tr_b16 v[172:173], v110 offset:8192
    ds_read_b64_tr_b16 v[174:175], v110 offset:9216
    ds_read_b64_tr_b16 v[248:249], v110 offset:32
    ds_read_b64_tr_b16 v[250:251], v110 offset:1056
    ds_read_b64_tr_b16 v[252:253], v110 offset:8224
    ds_read_b64_tr_b16 v[254:255], v110 offset:9248
    s_waitcnt vmcnt(32)
    s_waitcnt lgkmcnt(0)
    s_barrier
    s_add_u32 s56, s58, 4718592
    s_add_u32 m0, s65, 147456
    s_nop 0
    buffer_load_dwordx4 v111, s[12:15], s56 offen lds
    s_add_u32 m0, m0, 1024
    s_add_u32 s56, s56, 32768
    buffer_load_dwordx4 v111, s[12:15], s56 offen lds
    s_add_u32 m0, m0, 1024
    s_add_u32 s56, s56, 32768
    buffer_load_dwordx4 v111, s[12:15], s56 offen lds
    s_add_u32 m0, m0, 1024
    s_add_u32 s56, s56, 32768
    buffer_load_dwordx4 v111, s[12:15], s56 offen lds
    v_add_u32 v110, -147456, v110
    ds_read_b64_tr_b16 a[16:17], v110 offset:0
    ds_read_b64_tr_b16 a[18:19], v110 offset:1024
    ds_read_b64_tr_b16 a[20:21], v110 offset:8192
    ds_read_b64_tr_b16 a[22:23], v110 offset:9216
    ds_read_b64_tr_b16 a[96:97], v110 offset:32
    ds_read_b64_tr_b16 a[98:99], v110 offset:1056
    ds_read_b64_tr_b16 a[100:101], v110 offset:8224
    ds_read_b64_tr_b16 a[102:103], v110 offset:9248
    s_waitcnt vmcnt(32)
    s_waitcnt lgkmcnt(0)
    s_barrier
    ds_read_b64_tr_b16 a[24:25], v110 offset:16384
    ds_read_b64_tr_b16 a[26:27], v110 offset:17408
    ds_read_b64_tr_b16 a[28:29], v110 offset:24576
    ds_read_b64_tr_b16 a[30:31], v110 offset:25600
    ds_read_b64_tr_b16 a[104:105], v110 offset:16416
    ds_read_b64_tr_b16 a[106:107], v110 offset:17440
    ds_read_b64_tr_b16 a[108:109], v110 offset:24608
    ds_read_b64_tr_b16 a[110:111], v110 offset:25632
    s_waitcnt vmcnt(28)
    s_waitcnt lgkmcnt(0)
    s_barrier
    ds_read_b64_tr_b16 a[32:33], v110 offset:32768
    ds_read_b64_tr_b16 a[34:35], v110 offset:33792
    ds_read_b64_tr_b16 a[36:37], v110 offset:40960
    ds_read_b64_tr_b16 a[38:39], v110 offset:41984
    ds_read_b64_tr_b16 a[112:113], v110 offset:32800
    ds_read_b64_tr_b16 a[114:115], v110 offset:33824
    ds_read_b64_tr_b16 a[116:117], v110 offset:40992
    ds_read_b64_tr_b16 a[118:119], v110 offset:42016
    s_waitcnt vmcnt(24)
    s_waitcnt lgkmcnt(0)
    s_barrier
    v_add_u32 v110, 49152, v110
    ds_read_b64_tr_b16 a[40:41], v110 offset:0
    ds_read_b64_tr_b16 a[42:43], v110 offset:1024
    ds_read_b64_tr_b16 a[44:45], v110 offset:8192
    ds_read_b64_tr_b16 a[46:47], v110 offset:9216
    ds_read_b64_tr_b16 a[120:121], v110 offset:32
    ds_read_b64_tr_b16 a[122:123], v110 offset:1056
    ds_read_b64_tr_b16 a[124:125], v110 offset:8224
    ds_read_b64_tr_b16 a[126:127], v110 offset:9248
    s_waitcnt vmcnt(20)
    s_waitcnt lgkmcnt(0)
    s_barrier
    ds_read_b64_tr_b16 a[48:49], v110 offset:16384
    ds_read_b64_tr_b16 a[50:51], v110 offset:17408
    ds_read_b64_tr_b16 a[52:53], v110 offset:24576
    ds_read_b64_tr_b16 a[54:55], v110 offset:25600
    ds_read_b64_tr_b16 a[128:129], v110 offset:16416
    ds_read_b64_tr_b16 a[130:131], v110 offset:17440
    ds_read_b64_tr_b16 a[132:133], v110 offset:24608
    ds_read_b64_tr_b16 a[134:135], v110 offset:25632
    s_waitcnt vmcnt(16)
    s_waitcnt lgkmcnt(0)
    s_barrier
    ds_read_b64_tr_b16 a[56:57], v110 offset:32768
    ds_read_b64_tr_b16 a[58:59], v110 offset:33792
    ds_read_b64_tr_b16 a[60:61], v110 offset:40960
    ds_read_b64_tr_b16 a[62:63], v110 offset:41984
    ds_read_b64_tr_b16 a[136:137], v110 offset:32800
    ds_read_b64_tr_b16 a[138:139], v110 offset:33824
    ds_read_b64_tr_b16 a[140:141], v110 offset:40992
    ds_read_b64_tr_b16 a[142:143], v110 offset:42016
    s_waitcnt vmcnt(12)
    s_waitcnt lgkmcnt(0)
    s_barrier
    v_add_u32 v110, 49152, v110
    ds_read_b64_tr_b16 a[0:1], v110 offset:0
    ds_read_b64_tr_b16 a[2:3], v110 offset:1024
    ds_read_b64_tr_b16 a[4:5], v110 offset:8192
    ds_read_b64_tr_b16 a[6:7], v110 offset:9216
    ds_read_b64_tr_b16 a[80:81], v110 offset:32
    ds_read_b64_tr_b16 a[82:83], v110 offset:1056
    ds_read_b64_tr_b16 a[84:85], v110 offset:8224
    ds_read_b64_tr_b16 a[86:87], v110 offset:9248
    s_waitcnt vmcnt(8)
    s_waitcnt lgkmcnt(0)
    s_barrier
    ds_read_b64_tr_b16 a[8:9], v110 offset:16384
    ds_read_b64_tr_b16 a[10:11], v110 offset:17408
    ds_read_b64_tr_b16 a[12:13], v110 offset:24576
    ds_read_b64_tr_b16 a[14:15], v110 offset:25600
    ds_read_b64_tr_b16 a[88:89], v110 offset:16416
    ds_read_b64_tr_b16 a[90:91], v110 offset:17440
    ds_read_b64_tr_b16 a[92:93], v110 offset:24608
    ds_read_b64_tr_b16 a[94:95], v110 offset:25632
    s_waitcnt vmcnt(4)
    s_waitcnt lgkmcnt(0)
    s_barrier
    ds_read_b64_tr_b16 a[64:65], v110 offset:32768
    ds_read_b64_tr_b16 a[66:67], v110 offset:33792
    ds_read_b64_tr_b16 a[68:69], v110 offset:40960
    ds_read_b64_tr_b16 a[70:71], v110 offset:41984
    ds_read_b64_tr_b16 a[144:145], v110 offset:32800
    ds_read_b64_tr_b16 a[146:147], v110 offset:33824
    ds_read_b64_tr_b16 a[148:149], v110 offset:40992
    ds_read_b64_tr_b16 a[150:151], v110 offset:42016
    s_waitcnt vmcnt(0)
    s_waitcnt lgkmcnt(0)
    s_barrier
    v_add_u32 v110, 49152, v110
    ds_read_b64_tr_b16 a[72:73], v110 offset:0
    ds_read_b64_tr_b16 a[74:75], v110 offset:1024
    ds_read_b64_tr_b16 a[76:77], v110 offset:8192
    ds_read_b64_tr_b16 a[78:79], v110 offset:9216
    ds_read_b64_tr_b16 a[152:153], v110 offset:32
    ds_read_b64_tr_b16 a[154:155], v110 offset:1056
    ds_read_b64_tr_b16 a[156:157], v110 offset:8224
    ds_read_b64_tr_b16 a[158:159], v110 offset:9248
    s_waitcnt lgkmcnt(0)
L_head_ldd:
    s_barrier
    ds_write_b128 v4, v[18:21] offset:0
    ds_write_b128 v4, v[22:25] offset:1024
    ds_write_b128 v4, v[26:29] offset:2048
    ds_write_b128 v4, v[30:33] offset:3072
    ds_write_b128 v4, v[34:37] offset:4096
    ds_write_b128 v4, v[38:41] offset:5120
    ds_write_b128 v4, v[42:45] offset:6144
    ds_write_b128 v4, v[46:49] offset:7168
    ds_write_b128 v4, v[50:53] offset:8192
    ds_write_b128 v4, v[54:57] offset:9216
    ds_write_b128 v4, v[58:61] offset:10240
    ds_write_b128 v4, v[62:65] offset:11264
    ds_write_b128 v4, v[66:69] offset:12288
    ds_write_b128 v4, v[70:73] offset:13312
    ds_write_b128 v4, v[74:77] offset:14336
    ds_write_b128 v4, v[78:81] offset:15360
    ds_write_b128 v4, v[82:85] offset:16384
    ds_write_b128 v4, v[86:89] offset:17408
    ds_write_b128 v4, v[90:93] offset:18432
    ds_write_b128 v4, v[94:97] offset:19456
    s_waitcnt lgkmcnt(0)
    v_mov_b32 v18, 128
Lp_137:
    buffer_load_dword v14, v18, s[8:11], 0 offen sc1
    s_waitcnt vmcnt(0)
    v_cmp_gt_i32 vcc, 1, v14
    s_cbranch_vccz Lpd_138
    s_sleep 8
    s_mov_b32 s54, 80
    s_sub_u32 s52, s52, 1
    s_cbranch_scc1 L_abort
    s_branch Lp_137
Lpd_138:
    v_mbcnt_lo_u32_b32 v14, -1, 0
    v_and_b32 v14, 1, v14
    v_lshlrev_b32 v14, 2, v14
    s_lshl_b32 s55, s50, 3
    buffer_load_dword v14, v14, s[8:11], s55 offen sc1
    s_getreg_b32 s55, hwreg(HW_REG_XCC_ID)
    s_and_b32 s55, s55, 7
    s_lshl_b32 s55, s55, 3
    s_lshl_b64 s[56:57], 0xff, s55
    s_waitcnt vmcnt(0)
    v_readlane_b32 s96, v14, 0
    v_readlane_b32 s97, v14, 1
    s_andn2_b64 s[56:57], s[96:97], s[56:57]
    s_cselect_b32 s64, 1, 0
    v_mov_b32 v18, 132
Lp_139:
    buffer_load_dword v14, v18, s[8:11], 0 offen sc1
    s_waitcnt vmcnt(0)
    v_cmp_gt_i32 vcc, 1, v14
    s_cbranch_vccz Lpd_140
    s_sleep 8
    s_mov_b32 s54, 112
    s_sub_u32 s52, s52, 1
    s_cbranch_scc1 L_abort
    s_branch Lp_139
Lpd_140:
    v_readfirstlane_b32 s25, v14
    s_and_b32 s25, s25, 2
    s_lshl_b32 s25, s25, 12
    s_lshr_b32 s28, s60, 1
    s_lshl_b32 s28, s28, 14
    s_and_b32 s55, s60, 1
    s_lshl_b32 s55, s55, 12
    s_add_u32 s28, s28, s55
    s_add_u32 s28, s28, s38
    s_add_u32 s28, s28, 142606336
    s_lshl_b32 s56, s3, 9
    s_add_u32 s28, s28, s56
    s_lshl_b32 s26, s60, 11
    s_add_u32 s26, s26, s56
    s_add_u32 s26, s26, s38
    s_add_u32 s26, s26, 2097152
    s_lshl_b32 s55, s50, 14
    s_add_u32 s55, s55, s38
    s_add_u32 s36, s55, 2621440
    s_add_u32 s37, s38, 2883584
    s_add_u32 s35, s55, 2634240
    s_lshl_b32 s56, s51, 2
    s_add_u32 s56, s56, s3
    s_lshl_b32 s56, s56, 2
    s_add_u32 s34, s55, s56
    s_add_u32 s34, s34, 2633728
    v_min_u32 v1, 9, v1
    s_lshl_b32 s55, s3, 3
    s_lshl_b32 s56, s3, 1
    s_add_u32 s56, s56, 24
    v_mov_b32 v14, s55
    v_mov_b32 v15, s56
    v_cmp_gt_u32 vcc, 8, v1
    s_nop 1
    v_cndmask_b32 v14, v15, v14, vcc
    v_add_lshl_u32 v1, v1, v14, 2
    s_lshl_b32 s55, s60, 2
    s_add_u32 s55, s55, s3
    s_lshl_b32 s67, s55, 12
    s_add_u32 s67, s67, 8388608
    s_add_u32 s69, s55, 672
    s_lshl_b32 s69, s69, 7
    s_mov_b32 s62, 0
    s_mov_b32 s63, 1
    s_lshl_b32 s66, s3, 12
    s_add_u32 s66, s66, 16384
    s_mov_b32 s58, 0
    s_mov_b32 s59, 262144000
    s_mov_b32 s29, 262144000
    s_mov_b32 s24, -1
    s_barrier
    s_and_b32 s72, s51, 7
    s_lshl_b32 s72, s72, 15
    s_add_u32 s72, s72, s36
    s_add_u32 s68, s72, 4096
    s_add_u32 s74, s72, 8192
    buffer_load_dwordx4 v[18:21], v3, s[4:7], s72 offen offset:0 sc1
    buffer_load_dwordx4 v[22:25], v3, s[4:7], s72 offen offset:1024 sc1
    buffer_load_dwordx4 v[26:29], v3, s[4:7], s72 offen offset:2048 sc1
    buffer_load_dwordx4 v[30:33], v3, s[4:7], s72 offen offset:3072 sc1
    buffer_load_dwordx4 v[34:37], v3, s[4:7], s68 offen offset:0 sc1
    buffer_load_dwordx4 v[38:41], v3, s[4:7], s68 offen offset:1024 sc1
    buffer_load_dwordx4 v[42:45], v3, s[4:7], s68 offen offset:2048 sc1
    buffer_load_dwordx4 v[46:49], v3, s[4:7], s68 offen offset:3072 sc1
    buffer_load_dwordx4 v[50:53], v3, s[4:7], s74 offen offset:0 sc1
    buffer_load_dwordx4 v[54:57], v3, s[4:7], s74 offen offset:1024 sc1
    s_lshl_b32 s39, s3, 11
    s_lshl_b32 s41, s3, 9
    s_add_u32 s41, s41, 8192
    s_mov_b32 s72, s37
    s_add_u32 s68, s72, s39
    s_add_u32 s74, s72, s41
    s_mov_b32 s75, -1
    s_add_u32 s55, s3, 1
    s_and_b32 s55, s55, 3
    s_lshl_b32 s55, s55, 11
    v_add_u32 v0, s55, v3
    s_add_u32 s55, s3, 2
    s_and_b32 s55, s55, 3
    s_lshl_b32 s55, s55, 11
    v_add_u32 v9, s55, v3
    s_add_u32 s55, s3, 3
    s_and_b32 s55, s55, 3
    s_lshl_b32 s55, s55, 11
    v_add_u32 v15, s55, v3
    s_and_b32 s76, s62, 63
    s_add_u32 s76, s76, 1
    s_and_b32 s77, s62, 0xc0
    s_lshl_b32 s77, s77, 8
    s_lshl_b32 s78, s62, 19
    s_add_u32 s78, s78, s67
    s_mov_b32 s31, s76
    s_mov_b32 s32, s77
    s_mov_b32 s33, s78
    v_mov_b32 v14, -1
    s_and_b32 s76, s63, 63
    s_add_u32 s76, s76, 1
    s_and_b32 s77, s63, 0xc0
    s_lshl_b32 s77, s77, 8
    s_lshl_b32 s78, s63, 19
    s_add_u32 s78, s78, s67
    ds_read_b128 v[82:85], v4 offset:0
    ds_read_b128 v[86:89], v4 offset:1024
    ds_read_b128 v[90:93], v4 offset:2048
    ds_read_b128 v[94:97], v4 offset:3072
    ds_read_b128 v[98:101], v4 offset:4096
    ds_read_b128 v[102:105], v4 offset:5120
    v_mov_b64 v[58:59], 0
    v_mov_b64 v[60:61], 0
    v_mov_b64 v[62:63], 0
    v_mov_b64 v[64:65], 0
    v_mov_b64 v[66:67], 0
    v_mov_b64 v[68:69], 0
    v_mov_b64 v[70:71], 0
    v_mov_b64 v[72:73], 0
    v_mov_b64 v[74:75], 0
    v_mov_b64 v[76:77], 0
    v_mov_b64 v[78:79], 0
    v_mov_b64 v[80:81], 0
    s_branch L_head_kvlate
.p2align 6
    s_nop 0
    s_nop 0
L_head_same:
    s_waitcnt vmcnt(0)
    v_mov_b32 v17, s58
    buffer_store_dword v17, off, s[4:7], s59 sc1
    s_mov_b32 s59, 262144000
    s_cmp_eq_u32 s30, 262144000
    s_cbranch_scc1 L_head_kvlate
L_head_wait:
    buffer_load_dword v16, v1, s[4:7], s35 offen sc1
    s_sleep 2
L_head_probe:
    buffer_load_dword v17, v1, s[4:7], s35 offen sc1
    s_waitcnt vmcnt(1)
    v_cmp_gt_i32 vcc, s75, v16
    s_cbranch_vccnz L_head_p0
    buffer_load_dwordx4 v[18:21], v3, s[4:7], s68 offen offset:0 sc1
    buffer_load_dwordx4 v[22:25], v3, s[4:7], s68 offen offset:1024 sc1
    s_mov_b32 exec_hi, 0
    buffer_load_dwordx4 v3, s[4:7], s74 offen sc1 lds
    s_mov_b32 exec_hi, -1
    s_branch L_head_gone
L_head_p0:
    buffer_load_dword v16, v1, s[4:7], s35 offen sc1
    s_mov_b32 s54, 86
    s_sub_u32 s52, s52, 1
    s_cbranch_scc1 L_abort
    s_waitcnt vmcnt(1)
    v_cmp_gt_i32 vcc, s75, v17
    s_cbranch_vccnz L_head_probe
L_head_go:
    buffer_load_dwordx4 v[18:21], v3, s[4:7], s68 offen offset:0 sc1
    buffer_load_dwordx4 v[22:25], v3, s[4:7], s68 offen offset:1024 sc1
    s_mov_b32 exec_hi, 0
    buffer_load_dwordx4 v3, s[4:7], s74 offen sc1 lds
    s_mov_b32 exec_hi, -1
L_head_gone:
    s_add_u32 s24, s24, 1
    s_xor_b32 s66, s66, 0xc000
    s_mov_b32 m0, s66
    s_mov_b32 s31, s76
    s_mov_b32 s32, s77
    s_mov_b32 s33, s78
    s_waitcnt lgkmcnt(0)
    s_waitcnt vmcnt(2)
    v_add_u32 v16, s39, v3
    ds_write_b128 v16, v[18:21]
    v_smfmac_f32_16x16x64_bf16 v[70:73], v[18:21], v[82:89], v2
    v_cmp_gt_i32 vcc, s31, v14
    s_waitcnt vmcnt(1)
    ds_write_b128 v16, v[22:25] offset:1024
    s_mov_b32 s42, s72
    s_mov_b32 s61, s62
    v_smfmac_f32_16x16x64_bf16 v[58:61], v[18:21], a[0:7], v2
    s_cmp_eq_u64 vcc, 0
    s_cselect_b32 s30, s33, 262144000
    v_smfmac_f32_16x16x64_bf16 v[66:69], v[18:21], a[160:167], v2
    ds_read_b128 v[82:85], v4 offset:6144
    ds_read_b128 v[86:89], v4 offset:7168
    v_smfmac_f32_16x16x64_bf16 v[62:65], v[18:21], a[80:87], v2
    s_mov_b32 s62, s63
    s_add_u32 s55, s24, -7
    s_lshr_b32 s56, s55, 1
    v_smfmac_f32_16x16x64_bf16 v[70:73], v[22:25], v[90:97], v2
    s_waitcnt vmcnt(0)
    s_waitcnt lgkmcnt(2)
    s_barrier
    ds_read_b128 v[26:29], v0 offset:0
    ds_read_b128 v[30:33], v0 offset:1024
    v_smfmac_f32_16x16x64_bf16 v[58:61], v[22:25], a[8:15], v2
    buffer_store_dwordx2 v[106:107], v11, s[4:7], s29 offen offset:2048 sc1
    s_bitcmp1_b32 s55, 0
    s_cselect_b32 s57, 64, 9
    v_smfmac_f32_16x16x64_bf16 v[66:69], v[22:25], a[168:175], v2
    ds_read_b128 v[90:93], v4 offset:8192
    ds_read_b128 v[94:97], v4 offset:9216
    v_smfmac_f32_16x16x64_bf16 v[62:65], v[22:25], a[88:95], v2
    buffer_store_dwordx2 v[110:111], v11, s[4:7], s29 offen sc1
    s_add_u32 s56, s56, s57
    s_add_u32 s57, s24, 2
    s_waitcnt lgkmcnt(3)
    v_smfmac_f32_16x16x64_bf16 v[70:73], v[26:29], v[98:105], v2
    ds_read_b128 v[34:37], v9 offset:0
    s_cmp_lt_u32 s55, 110
    s_cselect_b32 s63, s56, s57
    v_smfmac_f32_16x16x64_bf16 v[58:61], v[26:29], a[16:23], v2
    buffer_load_dwordx4 v3, s[4:7], s30 offen offset:0 sc1 lds
    s_and_b32 s76, s63, 63
    s_add_u32 s76, s76, 1
    v_smfmac_f32_16x16x64_bf16 v[66:69], v[26:29], a[176:183], v2
    ds_read_b128 v[98:101], v4 offset:10240
    ds_read_b128 v[102:105], v4 offset:11264
    v_smfmac_f32_16x16x64_bf16 v[62:65], v[26:29], a[96:103], v2
    s_and_b32 s77, s63, 0xc0
    s_lshl_b32 s77, s77, 8
    s_lshl_b32 s78, s63, 19
    s_waitcnt lgkmcnt(5)
    v_smfmac_f32_16x16x64_bf16 v[70:73], v[30:33], v[82:89], v2
    ds_read_b128 v[38:41], v9 offset:1024
    s_add_u32 s78, s78, s67
    s_and_b32 s55, s24, 7
    v_smfmac_f32_16x16x64_bf16 v[58:61], v[30:33], a[24:31], v2
    buffer_load_dwordx4 v3, s[4:7], s30 offen offset:1024 sc1 lds
    s_lshl_b32 s55, s55, 16
    s_add_u32 s73, s26, s55
    v_smfmac_f32_16x16x64_bf16 v[66:69], v[30:33], a[184:191], v2
    ds_read_b128 v[82:85], v4 offset:12288
    ds_read_b128 v[86:89], v4 offset:13312
    v_smfmac_f32_16x16x64_bf16 v[62:65], v[30:33], a[104:111], v2
    s_xor_b32 s55, s55, 0x40000
    s_add_u32 s40, s26, s55
    v_xor_b32 v5, 0xc000, v5
    s_waitcnt lgkmcnt(5)
    v_smfmac_f32_16x16x64_bf16 v[70:73], v[34:37], v[90:97], v2
    ds_read_b128 v[42:45], v15 offset:0
    v_xor_b32 v6, 0xc000, v6
    v_mov_b64 v[108:109], -1
    v_smfmac_f32_16x16x64_bf16 v[58:61], v[34:37], a[32:39], v2
    buffer_load_dwordx4 v3, s[4:7], s30 offen offset:2048 sc1 lds
    s_add_u32 s55, s24, 1
    s_and_b32 s55, s55, 7
    v_smfmac_f32_16x16x64_bf16 v[66:69], v[34:37], a[192:199], v2
    ds_read_b128 v[90:93], v4 offset:14336
    ds_read_b128 v[94:97], v4 offset:15360
    v_smfmac_f32_16x16x64_bf16 v[62:65], v[34:37], a[112:119], v2
    s_lshl_b32 s55, s55, 15
    s_add_u32 s72, s36, s55
    s_add_u32 s75, s24, 1
    s_waitcnt lgkmcnt(5)
    v_smfmac_f32_16x16x64_bf16 v[70:73], v[38:41], v[98:105], v2
    ds_read_b128 v[46:49], v15 offset:1024
    v_smfmac_f32_16x16x64_bf16 v[58:61], v[38:41], a[40:47], v2
    buffer_load_dwordx4 v3, s[4:7], s30 offen offset:3072 sc1 lds
    s_mov_b32 m0, s41
    v_smfmac_f32_16x16x64_bf16 v[66:69], v[38:41], a[200:207], v2
    ds_read_b128 v[98:101], v4 offset:16384
    ds_read_b128 v[102:105], v4 offset:17408
    v_smfmac_f32_16x16x64_bf16 v[62:65], v[38:41], a[120:127], v2
    s_cmp_eq_u32 s62, 64
    s_cselect_b32 s72, s37, s72
    s_cselect_b32 s75, -1, s75
    s_waitcnt lgkmcnt(5)
    v_smfmac_f32_16x16x64_bf16 v[70:73], v[42:45], v[82:89], v2
    ds_read_b128 v[50:53], v3 offset:8192
    s_add_u32 s68, s72, s39
    s_add_u32 s74, s72, s41
    v_smfmac_f32_16x16x64_bf16 v[58:61], v[42:45], a[48:55], v2
    s_xor_b32 s79, s61, s62
    v_smfmac_f32_16x16x64_bf16 v[66:69], v[42:45], a[208:215], v2
    ds_read_b128 v[82:85], v4 offset:18432
    ds_read_b128 v[86:89], v4 offset:19456
    v_smfmac_f32_16x16x64_bf16 v[62:65], v[42:45], a[128:135], v2
    s_cmp_eq_u32 s30, 262144000
    s_cselect_b32 s79, 0, s79
    s_lshl_b32 s55, s61, 10
    s_waitcnt lgkmcnt(5)
    v_smfmac_f32_16x16x64_bf16 v[70:73], v[46:49], v[90:97], v2
    ds_read_b128 v[54:57], v3 offset:9216
    s_and_b32 s55, s55, 0x2000
    s_xor_b32 s55, s55, s25
    s_lshl_b32 s29, s61, 18
    v_smfmac_f32_16x16x64_bf16 v[58:61], v[46:49], a[56:63], v2
    s_add_u32 s29, s29, s55
    s_add_u32 s29, s29, s28
    v_smfmac_f32_16x16x64_bf16 v[66:69], v[46:49], a[216:223], v2
    v_smfmac_f32_16x16x64_bf16 v[62:65], v[46:49], a[136:143], v2
    s_waitcnt lgkmcnt(3)
    v_smfmac_f32_16x16x64_bf16 v[70:73], v[50:53], v[98:105], v2
    v_smfmac_f32_16x16x64_bf16 v[58:61], v[50:53], a[64:71], v2
    s_cmp_lg_u32 s64, 0
    s_cbranch_scc1 Lls_141
    buffer_store_dwordx2 v[108:109], v11, s[4:7], s40 offen
Lld_142:
    v_smfmac_f32_16x16x64_bf16 v[66:69], v[50:53], a[224:231], v2
    v_smfmac_f32_16x16x64_bf16 v[62:65], v[50:53], a[144:151], v2
    s_waitcnt lgkmcnt(0)
    v_smfmac_f32_16x16x64_bf16 v[70:73], v[54:57], v[82:89], v2
    v_smfmac_f32_16x16x64_bf16 v[58:61], v[54:57], a[72:79], v2
    v_smfmac_f32_16x16x64_bf16 v[66:69], v[54:57], a[232:239], v2
    v_smfmac_f32_16x16x64_bf16 v[62:65], v[54:57], a[152:159], v2
L_head_p2:
    v_smfmac_f32_16x16x64_bf16 v[74:77], v[18:21], a[240:247], v2
    s_nop 2
    v_smfmac_f32_16x16x64_bf16 v[78:81], v[18:21], v[176:183], v2
    v_add_f32 v70, v70, v72
    v_add_f32 v71, v71, v73
    v_add_f32 v58, v58, v60
    v_add_f32 v59, v59, v61
    v_add_f32 v66, v66, v68
    v_add_f32 v67, v67, v69
    v_cmp_u_f32 vcc, v70, v71
    v_add_f32 v62, v62, v64
    v_add_f32 v63, v63, v65
    v_cvt_pk_bf16_f32 v100, v66, v70
    v_cvt_pk_bf16_f32 v101, v67, v71
    ds_write2_b32 v7, v100, v101 offset0:64 offset1:200
    v_cvt_pk_bf16_f32 v98, v58, v62
    v_cvt_pk_bf16_f32 v99, v59, v63
    ds_write2_b32 v7, v98, v99 offset0:0 offset1:136
    s_cbranch_vccnz L_head_nan
L_head_p2b:
    v_mov_b32 v17, s58
    v_smfmac_f32_16x16x64_bf16 v[74:77], v[22:25], a[248:255], v2
    ds_read_b128 v[82:85], v5 offset:0
    s_waitcnt vmcnt(5)
    buffer_store_dword v17, off, s[4:7], s59 sc1
    v_smfmac_f32_16x16x64_bf16 v[78:81], v[22:25], v[184:191], v2
    ds_read_b128 v[86:89], v5 offset:2048
    buffer_load_dword v14, v13, s[4:7], s77 offen sc1
    v_smfmac_f32_16x16x64_bf16 v[74:77], v[26:29], v[112:119], v2
    ds_read_b128 v[90:93], v5 offset:4096
    v_smfmac_f32_16x16x64_bf16 v[78:81], v[26:29], v[192:199], v2
    ds_read_b128 v[94:97], v5 offset:6144
    s_waitcnt lgkmcnt(4)
    s_barrier
    s_cmp_eq_u32 s61, 127
    s_cbranch_scc1 L_head_last
    ds_read_b128 v[58:61], v8 offset:0
    ds_read_b128 v[62:65], v8 offset:64
    v_smfmac_f32_16x16x64_bf16 v[74:77], v[30:33], v[120:127], v2
    ds_read_b128 v[66:69], v8 offset:128
    v_smfmac_f32_16x16x64_bf16 v[78:81], v[30:33], v[200:207], v2
    ds_read_b128 v[70:73], v8 offset:192
    ds_read_b128 v[18:21], v8 offset:256
    v_smfmac_f32_16x16x64_bf16 v[74:77], v[34:37], v[128:135], v2
    ds_read_b128 v[22:25], v8 offset:320
    v_smfmac_f32_16x16x64_bf16 v[78:81], v[34:37], v[208:215], v2
    ds_read_b128 v[26:29], v8 offset:384
    v_smfmac_f32_16x16x64_bf16 v[74:77], v[38:41], v[136:143], v2
    ds_read_b128 v[30:33], v8 offset:448
    v_smfmac_f32_16x16x64_bf16 v[78:81], v[38:41], v[216:223], v2
    s_waitcnt lgkmcnt(7)
    v_mfma_f32_16x16x32_bf16 v[98:101], v[82:85], v[58:61], 0
    ds_read_b128 v[34:37], v5 offset:256
    s_waitcnt lgkmcnt(7)
    v_mfma_f32_16x16x32_bf16 v[98:101], v[86:89], v[62:65], v[98:101]
    ds_read_b128 v[38:41], v5 offset:2304
    s_waitcnt lgkmcnt(7)
    v_mfma_f32_16x16x32_bf16 v[98:101], v[90:93], v[66:69], v[98:101]
    ds_read_b128 v[82:85], v5 offset:4352
    s_waitcnt lgkmcnt(7)
    v_mfma_f32_16x16x32_bf16 v[98:101], v[94:97], v[70:73], v[98:101]
    ds_read_b128 v[86:89], v5 offset:6400
    s_waitcnt lgkmcnt(7)
    v_mfma_f32_16x16x32_bf16 v[102:105], v[18:21], v[58:61], 0
    ds_read_b64 v[110:111], v12
    s_waitcnt lgkmcnt(7)
    v_mfma_f32_16x16x32_bf16 v[102:105], v[22:25], v[62:65], v[102:105]
    ds_read_b128 v[18:21], v6 offset:8192
    s_waitcnt lgkmcnt(7)
    v_mfma_f32_16x16x32_bf16 v[102:105], v[26:29], v[66:69], v[102:105]
    ds_read_b128 v[22:25], v6 offset:8448
    s_waitcnt lgkmcnt(7)
    v_mfma_f32_16x16x32_bf16 v[102:105], v[30:33], v[70:73], v[102:105]
    v_mov_b32 v26, 0x3f803f80
    v_mov_b32 v27, 0x3f803f80
    s_waitcnt lgkmcnt(6)
    v_mfma_f32_16x16x32_bf16 v[106:109], v[34:37], v[58:61], 0
    v_mov_b64 v[28:29], v[26:27]
    v_mov_b32 v31, 0
    s_waitcnt lgkmcnt(5)
    v_mfma_f32_16x16x32_bf16 v[106:109], v[38:41], v[62:65], v[106:109]
    v_mov_b32 v32, 0
    v_max3_f32 v94, v98, v99, v100
    s_waitcnt lgkmcnt(4)
    v_mfma_f32_16x16x32_bf16 v[106:109], v[82:85], v[66:69], v[106:109]
    v_mov_b64 v[58:59], 0
    v_mov_b64 v[60:61], 0
    s_waitcnt lgkmcnt(3)
    v_mfma_f32_16x16x32_bf16 v[106:109], v[86:89], v[70:73], v[106:109]
    v_max3_f32 v95, v101, v102, v103
    v_mov_b64 v[62:63], 0
    v_smfmac_f32_16x16x64_bf16 v[74:77], v[42:45], v[144:151], v2
    s_and_b32 s59, s61, 64
    s_lshl_b32 s59, s59, 8
    s_add_u32 s59, s59, s69
    v_smfmac_f32_16x16x64_bf16 v[78:81], v[42:45], v[224:231], v2
    s_and_b32 s58, s61, 63
    s_add_u32 s58, s58, 1
    v_smfmac_f32_16x16x64_bf16 v[74:77], v[46:49], v[152:159], v2
    v_smfmac_f32_16x16x64_bf16 v[78:81], v[46:49], v[232:239], v2
    v_smfmac_f32_16x16x64_bf16 v[74:77], v[50:53], v[160:167], v2
    v_smfmac_f32_16x16x64_bf16 v[78:81], v[50:53], v[240:247], v2
    v_max3_f32 v94, v94, v106, v107
    v_max3_f32 v95, v95, v108, v109
    v_max_f32 v94, v94, v95
    v_mov_b32 v95, v94
    v_smfmac_f32_16x16x64_bf16 v[74:77], v[54:57], v[168:175], v2
    s_nop 0
    v_permlane32_swap_b32 v94, v95
    v_max_f32 v94, v94, v95
    v_mov_b32 v95, v94
    v_smfmac_f32_16x16x64_bf16 v[78:81], v[54:57], v[248:255], v2
    s_nop 0
    v_permlane16_swap_b32 v94, v95
    v_max_f32 v94, v94, v95
    v_mul_f32 v94, s70, v94
    v_pk_fma_f32 v[102:103], v[102:103], s[70:71], v[94:95] op_sel_hi:[1,1,0] neg_lo:[0,0,1] neg_hi:[0,0,1]
    v_pk_fma_f32 v[98:99], v[98:99], s[70:71], v[94:95] op_sel_hi:[1,1,0] neg_lo:[0,0,1] neg_hi:[0,0,1]
    v_pk_fma_f32 v[100:101], v[100:101], s[70:71], v[94:95] op_sel_hi:[1,1,0] neg_lo:[0,0,1] neg_hi:[0,0,1]
    v_pk_fma_f32 v[106:107], v[106:107], s[70:71], v[94:95] op_sel_hi:[1,1,0] neg_lo:[0,0,1] neg_hi:[0,0,1]
    v_pk_fma_f32 v[108:109], v[108:109], s[70:71], v[94:95] op_sel_hi:[1,1,0] neg_lo:[0,0,1] neg_hi:[0,0,1]
    v_exp_f32 v102, v102
    v_exp_f32 v103, v103
    v_add_f32 v74, v74, v76
    v_add_f32 v75, v75, v77
    v_cvt_pk_bf16_f32 v30, v102, v103
    v_add_f32 v78, v78, v80
    v_add_f32 v79, v79, v81
    v_mfma_f32_16x16x16_bf16 v[50:53], v[26:27], v[30:31], 0
    v_cvt_pk_bf16_f32 v96, v74, v75
    v_cvt_pk_bf16_f32 v97, v78, v79
    v_exp_f32 v98, v98
    v_mov_b32 v33, v30
    v_mfma_f32_16x16x16_bf16 v[42:45], v[96:97], v[30:31], 0
    v_exp_f32 v99, v99
    v_mfma_f32_16x16x16_bf16 v[46:49], v[96:97], v[32:33], 0
    v_exp_f32 v100, v100
    v_exp_f32 v101, v101
    v_cvt_pk_bf16_f32 v90, v98, v99
    v_exp_f32 v106, v106
    v_exp_f32 v107, v107
    v_cvt_pk_bf16_f32 v91, v100, v101
    v_exp_f32 v108, v108
    v_exp_f32 v109, v109
    v_cvt_pk_bf16_f32 v92, v106, v107
    s_waitcnt lgkmcnt(0)
    v_cvt_pk_bf16_f32 v93, v108, v109
    v_mov_b64 v[106:107], v[96:97]
    v_mov_b64 v[64:65], 0
    v_mfma_f32_16x16x32_bf16 v[50:53], v[26:29], v[90:93], v[50:53]
    v_mov_b64 v[66:67], 0
    buffer_load_dword v17, v1, s[4:7], s35 offen sc1
    v_mfma_f32_16x16x32_bf16 v[42:45], v[18:21], v[90:93], v[42:45]
    v_mov_b64 v[68:69], 0
    v_mov_b32 v94, s24
    v_mfma_f32_16x16x32_bf16 v[46:49], v[22:25], v[90:93], v[46:49]
    s_cmp_lg_u32 s64, 0
    s_cbranch_scc1 Lls_143
    buffer_store_dword v94, off, s[4:7], s34
Lld_144:
    v_mov_b64 v[70:71], 0
    v_rcp_f32 v50, v50
    v_mov_b64 v[72:73], 0
    v_mov_b64 v[74:75], 0
    v_mov_b64 v[76:77], 0
    v_cndmask_b32 v42, v42, v46, s[46:47]
    v_cndmask_b32 v43, v43, v47, s[46:47]
    v_cndmask_b32 v44, v44, v48, s[46:47]
    v_cndmask_b32 v45, v45, v49, s[46:47]
    v_pk_mul_f32 v[42:43], v[42:43], v[50:51] op_sel_hi:[1,0]
    v_pk_mul_f32 v[44:45], v[44:45], v[50:51] op_sel_hi:[1,0]
    v_cvt_pk_bf16_f32 v54, v42, v43
    v_cvt_pk_bf16_f32 v55, v44, v45
    v_min_u32 v54, -2, v54
    v_min_u32 v55, -2, v55
    s_cmp_lg_u32 s64, 0
    s_cbranch_scc1 Lls_145
    buffer_store_dwordx2 v[54:55], v10, s[4:7], s73 offen
Lld_146:
    s_bitcmp0_b32 s79, 6
    s_cbranch_scc1 L_head_end2
    buffer_load_dword v16, v1, s[4:7], s35 offen sc1
    v_mov_b64 v[78:79], 0
    v_mov_b64 v[80:81], 0
    ds_read_b128 v[82:85], v4 offset:0
    ds_read_b128 v[86:89], v4 offset:1024
    ds_read_b128 v[98:101], v4 offset:4096
    ds_read_b128 v[102:105], v4 offset:5120
    ds_read_b128 v[90:93], v4 offset:2048
    ds_read_b128 v[94:97], v4 offset:3072
    s_waitcnt vmcnt(3)
    v_cmp_gt_i32 vcc, s75, v17
    s_cbranch_vccnz L_head_probe
    buffer_load_dwordx4 v[18:21], v3, s[4:7], s68 offen offset:0 sc1
    buffer_load_dwordx4 v[22:25], v3, s[4:7], s68 offen offset:1024 sc1
    s_mov_b32 exec_hi, 0
    buffer_load_dwordx4 v3, s[4:7], s74 offen sc1 lds
    s_mov_b32 exec_hi, -1
    s_branch L_head_gone
L_head_end2:
    buffer_store_dwordx2 v[106:107], v11, s[4:7], s29 offen offset:2048 sc1
    buffer_store_dwordx2 v[110:111], v11, s[4:7], s29 offen sc1
    s_mov_b32 s29, 262144000
    v_mov_b64 v[78:79], 0
    v_mov_b64 v[80:81], 0
    ds_read_b128 v[82:85], v4 offset:0
    ds_read_b128 v[86:89], v4 offset:1024
    ds_read_b128 v[98:101], v4 offset:4096
    ds_read_b128 v[102:105], v4 offset:5120
    ds_read_b128 v[90:93], v4 offset:2048
    ds_read_b128 v[94:97], v4 offset:3072
    s_branch L_head_same
L_head_nan:
    s_cmp_eq_u32 s42, -1
    s_cbranch_scc1 L_head_p2b
    s_add_u32 s44, s42, 4096
    s_add_u32 s45, s42, 8192
    s_waitcnt lgkmcnt(0)
L_head_nanp:
    v_add_u32 v16, s39, v3
    buffer_load_dwordx4 v[18:21], v16, s[4:7], s42 offen offset:0 sc1
    buffer_load_dwordx4 v[22:25], v16, s[4:7], s42 offen offset:1024 sc1
    buffer_load_dwordx4 v[26:29], v0, s[4:7], s42 offen offset:0 sc1
    buffer_load_dwordx4 v[30:33], v0, s[4:7], s42 offen offset:1024 sc1
    buffer_load_dwordx4 v[34:37], v9, s[4:7], s42 offen offset:0 sc1
    buffer_load_dwordx4 v[38:41], v9, s[4:7], s42 offen offset:1024 sc1
    buffer_load_dwordx4 v[42:45], v15, s[4:7], s42 offen offset:0 sc1
    buffer_load_dwordx4 v[46:49], v15, s[4:7], s42 offen offset:1024 sc1
    buffer_load_dwordx4 v[50:53], v3, s[4:7], s45 offen offset:0 sc1
    buffer_load_dwordx4 v[54:57], v3, s[4:7], s45 offen offset:1024 sc1
    s_mov_b32 s54, 85
    s_sub_u32 s52, s52, 1
    s_cbranch_scc1 L_abort
    s_waitcnt vmcnt(0)
    v_max_u32 v17, v18, v19
    v_max3_u32 v17, v17, v20, v21
    v_max3_u32 v17, v17, v22, v23
    v_max3_u32 v17, v17, v24, v25
    v_max3_u32 v17, v17, v26, v27
    v_max3_u32 v17, v17, v28, v29
    v_max3_u32 v17, v17, v30, v31
    v_max3_u32 v17, v17, v32, v33
    v_max3_u32 v17, v17, v34, v35
    v_max3_u32 v17, v17, v36, v37
    v_max3_u32 v17, v17, v38, v39
    v_max3_u32 v17, v17, v40, v41
    v_max3_u32 v17, v17, v42, v43
    v_max3_u32 v17, v17, v44, v45
    v_max3_u32 v17, v17, v46, v47
    v_max3_u32 v17, v17, v48, v49
    v_max3_u32 v17, v17, v50, v51
    v_max3_u32 v17, v17, v52, v53
    v_max3_u32 v17, v17, v54, v55
    v_max3_u32 v17, v17, v56, v57
    v_cmp_eq_u32 vcc, -1, v17
    s_cbranch_vccnz L_head_nanp
    ds_read_b128 v[82:85], v4 offset:0
    ds_read_b128 v[86:89], v4 offset:1024
    ds_read_b128 v[90:93], v4 offset:2048
    ds_read_b128 v[94:97], v4 offset:3072
    ds_read_b128 v[98:101], v4 offset:4096
    ds_read_b128 v[102:105], v4 offset:5120
    v_mov_b64 v[58:59], 0
    v_mov_b64 v[60:61], 0
    v_mov_b64 v[62:63], 0
    v_mov_b64 v[64:65], 0
    v_mov_b64 v[66:67], 0
    v_mov_b64 v[68:69], 0
    v_mov_b64 v[70:71], 0
    v_mov_b64 v[72:73], 0
    v_mov_b64 v[74:75], 0
    v_mov_b64 v[76:77], 0
    v_mov_b64 v[78:79], 0
    v_mov_b64 v[80:81], 0
    s_mov_b32 s42, -1
    s_waitcnt lgkmcnt(0)
    v_smfmac_f32_16x16x64_bf16 v[70:73], v[18:21], v[82:89], v2
    v_smfmac_f32_16x16x64_bf16 v[58:61], v[18:21], a[0:7], v2
    v_smfmac_f32_16x16x64_bf16 v[66:69], v[18:21], a[160:167], v2
    ds_read_b128 v[82:85], v4 offset:6144
    ds_read_b128 v[86:89], v4 offset:7168
    v_smfmac_f32_16x16x64_bf16 v[62:65], v[18:21], a[80:87], v2
    v_smfmac_f32_16x16x64_bf16 v[70:73], v[22:25], v[90:97], v2
    v_smfmac_f32_16x16x64_bf16 v[58:61], v[22:25], a[8:15], v2
    v_smfmac_f32_16x16x64_bf16 v[66:69], v[22:25], a[168:175], v2
    ds_read_b128 v[90:93], v4 offset:8192
    ds_read_b128 v[94:97], v4 offset:9216
    v_smfmac_f32_16x16x64_bf16 v[62:65], v[22:25], a[88:95], v2
    v_smfmac_f32_16x16x64_bf16 v[70:73], v[26:29], v[98:105], v2
    v_smfmac_f32_16x16x64_bf16 v[58:61], v[26:29], a[16:23], v2
    v_smfmac_f32_16x16x64_bf16 v[66:69], v[26:29], a[176:183], v2
    ds_read_b128 v[98:101], v4 offset:10240
    ds_read_b128 v[102:105], v4 offset:11264
    v_smfmac_f32_16x16x64_bf16 v[62:65], v[26:29], a[96:103], v2
    s_waitcnt lgkmcnt(4)
    v_smfmac_f32_16x16x64_bf16 v[70:73], v[30:33], v[82:89], v2
    v_smfmac_f32_16x16x64_bf16 v[58:61], v[30:33], a[24:31], v2
    v_smfmac_f32_16x16x64_bf16 v[66:69], v[30:33], a[184:191], v2
    ds_read_b128 v[82:85], v4 offset:12288
    ds_read_b128 v[86:89], v4 offset:13312
    v_smfmac_f32_16x16x64_bf16 v[62:65], v[30:33], a[104:111], v2
    s_waitcnt lgkmcnt(4)
    v_smfmac_f32_16x16x64_bf16 v[70:73], v[34:37], v[90:97], v2
    v_smfmac_f32_16x16x64_bf16 v[58:61], v[34:37], a[32:39], v2
    v_smfmac_f32_16x16x64_bf16 v[66:69], v[34:37], a[192:199], v2
    ds_read_b128 v[90:93], v4 offset:14336
    ds_read_b128 v[94:97], v4 offset:15360
    v_smfmac_f32_16x16x64_bf16 v[62:65], v[34:37], a[112:119], v2
    s_waitcnt lgkmcnt(4)
    v_smfmac_f32_16x16x64_bf16 v[70:73], v[38:41], v[98:105], v2
    v_smfmac_f32_16x16x64_bf16 v[58:61], v[38:41], a[40:47], v2
    v_smfmac_f32_16x16x64_bf16 v[66:69], v[38:41], a[200:207], v2
    ds_read_b128 v[98:101], v4 offset:16384
    ds_read_b128 v[102:105], v4 offset:17408
    v_smfmac_f32_16x16x64_bf16 v[62:65], v[38:41], a[120:127], v2
    s_waitcnt lgkmcnt(4)
    v_smfmac_f32_16x16x64_bf16 v[70:73], v[42:45], v[82:89], v2
    v_smfmac_f32_16x16x64_bf16 v[58:61], v[42:45], a[48:55], v2
    v_smfmac_f32_16x16x64_bf16 v[66:69], v[42:45], a[208:215], v2
    ds_read_b128 v[82:85], v4 offset:18432
    ds_read_b128 v[86:89], v4 offset:19456
    v_smfmac_f32_16x16x64_bf16 v[62:65], v[42:45], a[128:135], v2
    s_waitcnt lgkmcnt(4)
    v_smfmac_f32_16x16x64_bf16 v[70:73], v[46:49], v[90:97], v2
    v_smfmac_f32_16x16x64_bf16 v[58:61], v[46:49], a[56:63], v2
    v_smfmac_f32_16x16x64_bf16 v[66:69], v[46:49], a[216:223], v2
    v_smfmac_f32_16x16x64_bf16 v[62:65], v[46:49], a[136:143], v2
    s_waitcnt lgkmcnt(2)
    v_smfmac_f32_16x16x64_bf16 v[70:73], v[50:53], v[98:105], v2
    v_smfmac_f32_16x16x64_bf16 v[58:61], v[50:53], a[64:71], v2
    v_smfmac_f32_16x16x64_bf16 v[66:69], v[50:53], a[224:231], v2
    v_smfmac_f32_16x16x64_bf16 v[62:65], v[50:53], a[144:151], v2
    s_waitcnt lgkmcnt(0)
    v_smfmac_f32_16x16x64_bf16 v[70:73], v[54:57], v[82:89], v2
    v_smfmac_f32_16x16x64_bf16 v[58:61], v[54:57], a[72:79], v2
    v_smfmac_f32_16x16x64_bf16 v[66:69], v[54:57], a[232:239], v2
    v_smfmac_f32_16x16x64_bf16 v[62:65], v[54:57], a[152:159], v2
    s_branch L_head_p2
L_head_kvlate:
    s_mov_b32 s54, 83
    s_sub_u32 s52, s52, 1
    s_cbranch_scc1 L_abort
    buffer_load_dword v17, v13, s[4:7], s32 offen sc1
    s_waitcnt vmcnt(0)
    v_cmp_gt_i32 vcc, s31, v17
    s_cbranch_vccnz L_head_kvlate
    s_mov_b32 m0, s66
    s_nop 0
    buffer_load_dwordx4 v3, s[4:7], s33 offen offset:0 sc1 lds
    buffer_load_dwordx4 v3, s[4:7], s33 offen offset:1024 sc1 lds
    buffer_load_dwordx4 v3, s[4:7], s33 offen offset:2048 sc1 lds
    buffer_load_dwordx4 v3, s[4:7], s33 offen offset:3072 sc1 lds
    s_mov_b32 m0, s41
    s_branch L_head_wait
Lls_141:
    buffer_store_dwordx2 v[108:109], v11, s[4:7], s40 offen sc1
    s_branch Lld_142
L_head_last:
    ds_read_b64 v[110:111], v12
    v_smfmac_f32_16x16x64_bf16 v[74:77], v[30:33], v[120:127], v2
    v_smfmac_f32_16x16x64_bf16 v[78:81], v[30:33], v[200:207], v2
    v_smfmac_f32_16x16x64_bf16 v[74:77], v[34:37], v[128:135], v2
    v_smfmac_f32_16x16x64_bf16 v[78:81], v[34:37], v[208:215], v2
    v_smfmac_f32_16x16x64_bf16 v[74:77], v[38:41], v[136:143], v2
    v_smfmac_f32_16x16x64_bf16 v[78:81], v[38:41], v[216:223], v2
    v_smfmac_f32_16x16x64_bf16 v[74:77], v[42:45], v[144:151], v2
    v_smfmac_f32_16x16x64_bf16 v[78:81], v[42:45], v[224:231], v2
    v_smfmac_f32_16x16x64_bf16 v[74:77], v[46:49], v[152:159], v2
    v_smfmac_f32_16x16x64_bf16 v[78:81], v[46:49], v[232:239], v2
    v_smfmac_f32_16x16x64_bf16 v[74:77], v[50:53], v[160:167], v2
    v_smfmac_f32_16x16x64_bf16 v[78:81], v[50:53], v[240:247], v2
    v_smfmac_f32_16x16x64_bf16 v[74:77], v[54:57], v[168:175], v2
    v_smfmac_f32_16x16x64_bf16 v[78:81], v[54:57], v[248:255], v2
    s_waitcnt lgkmcnt(0)
    buffer_store_dwordx2 v[110:111], v11, s[4:7], s29 offen sc1
    s_and_b32 s58, s61, 63
    s_add_u32 s58, s58, 1
    s_and_b32 s59, s61, 64
    s_lshl_b32 s59, s59, 8
    s_add_u32 s59, s59, s69
    v_add_f32 v74, v74, v76
    v_add_f32 v75, v75, v77
    v_add_f32 v78, v78, v80
    v_add_f32 v79, v79, v81
    v_cvt_pk_bf16_f32 v106, v74, v75
    v_cvt_pk_bf16_f32 v107, v78, v79
    buffer_store_dwordx2 v[106:107], v11, s[4:7], s29 offen offset:2048 sc1
    s_waitcnt vmcnt(0)
    v_mov_b32 v17, s58
    buffer_store_dword v17, off, s[4:7], s59 sc1
    s_endpgm
Lls_143:
    buffer_store_dword v94, off, s[4:7], s34 sc1
    s_branch Lld_144
Lls_145:
    buffer_store_dwordx2 v[54:55], v10, s[4:7], s73 offen sc1
    s_branch Lld_146
.section .rodata,"a"
.p2align 6
.amdhsa_kernel interleave_layers__memory_aug_recurrent_mem_tr__dense_activation_silu__prompt_kernel
  .amdhsa_next_free_vgpr 512
  .amdhsa_next_free_sgpr 102
  .amdhsa_accum_offset 256
  .amdhsa_group_segment_fixed_size 0
  .amdhsa_kernarg_size 104
  .amdhsa_user_sgpr_count 2
  .amdhsa_user_sgpr_kernarg_segment_ptr 1
  .amdhsa_system_sgpr_workgroup_id_x 1
.end_amdhsa_kernel
```
